```python
import torch

def _softmax(x, axis=-1):
    return torch.softmax(x, dim=axis)

def _gelu(x):
    return torch.nn.functional.gelu(x, approximate='tanh')

def _silu(x):
    return torch.nn.functional.silu(x)

def _sigmoid(x):
    return torch.sigmoid(x)

def _layernorm(x, axis=-1, eps=1e-05):
    m = x.mean(dim=axis, keepdim=True)
    v = x.var(dim=axis, keepdim=True, unbiased=False)
    return (x - m) / torch.sqrt(v + eps)

def _scatter_add(tgt, idx, src, axis=0):
    return tgt.clone().index_add_(axis, idx, src)

def _segment_sum(src, seg, n):
    out = torch.zeros((n,) + src.shape[1:], dtype=src.dtype)
    return out.index_add_(0, seg, src)

def _pad(x, pw):
    flat = tuple((v for pair in reversed(pw) for v in pair))
    return torch.nn.functional.pad(x, flat)
kernel_name = 'adaLN_cond__grouped_kv_mqa__glu_gated_swiglu__prompt'

def setup_inputs():

    _w = lambda a: (lambda t: t.to(torch.bfloat16) if t.is_floating_point() else t)(torch.as_tensor(a))

    def _A_setup():
        B, S, D, H = (1, 2048, 640, 32)
        Dh = D // H
        return {'x': _w((lambda *s: torch.randn(*s, dtype=torch.bfloat16) * 0.05)(B, S, D)), 'wq': _w((lambda *s: torch.randn(*s, dtype=torch.bfloat16) * 0.05)(D, H * Dh)), 'wk': _w((lambda *s: torch.randn(*s, dtype=torch.bfloat16) * 0.05)(D, Dh)), 'wv': _w((lambda *s: torch.randn(*s, dtype=torch.bfloat16) * 0.05)(D, Dh)), 'wo': _w((lambda *s: torch.randn(*s, dtype=torch.bfloat16) * 0.05)(H * Dh, D))}
    _A_in = _A_setup()

    def _B_setup():
        B, S, D, F = (1, 2048, 640, 1728)
        return {'x': _w((lambda *s: torch.randn(*s, dtype=torch.bfloat16) * 0.05)(B, S, D)), 'w1': _w((lambda *s: torch.randn(*s, dtype=torch.bfloat16) * 0.8)(D, F) * (2.0 / D) ** 0.5), 'w3': _w((lambda *s: torch.randn(*s, dtype=torch.bfloat16) * 0.8)(D, F) * (2.0 / D) ** 0.5), 'w2': _w((lambda *s: torch.randn(*s, dtype=torch.bfloat16) * 0.8)(F, D) * (2.0 / F) ** 0.5)}
    _B_in = _B_setup()
    return {'A_x': _A_in['x'], 'A_wq': _A_in['wq'], 'A_wk': _A_in['wk'], 'A_wv': _A_in['wv'], 'A_wo': _A_in['wo'], 'B_x': _B_in['x'], 'B_w1': _B_in['w1'], 'B_w3': _B_in['w3'], 'B_w2': _B_in['w2'], 'c': _w((lambda *s: torch.randn(*s, dtype=torch.bfloat16) * 0.2)(1, 640) * 8.0), 'w_mod': _w((lambda *s: torch.randn(*s, dtype=torch.bfloat16) * 0.2)(640, 6 * 640) * 640 ** (-0.5) * 8.0)}

def reference(A_x, A_wq, A_wk, A_wv, A_wo, B_x, B_w1, B_w3, B_w2, c, w_mod):

    def _A_ref(x, wq, wk, wv, wo):
        B, S, D = x.shape
        H = 32
        Dh = D // H
        q = (lambda x, *d: x.permute(*d))((x @ wq).reshape(B, S, H, Dh), 0, 2, 1, 3)
        k = x @ wk
        v = x @ wv
        scores = torch.einsum('bhqd,bkd->bhqk', q, k) * Dh ** (-0.5)
        p = _softmax(scores, axis=-1)
        o = torch.einsum('bhqk,bkd->bhqd', p, v)
        return (lambda x, *d: x.permute(*d))(o, 0, 2, 1, 3).reshape(B, S, H * Dh) @ wo

    def _B_ref(x, w1, w3, w2):
        gate = torch.einsum('bsd,df->bsf', x, w1)
        up = torch.einsum('bsd,df->bsf', x, w3)
        h = _silu(gate) * up
        out = torch.einsum('bsf,fd->bsd', h, w2)
        return out
    x = A_x
    mod = (_silu(c) @ w_mod).reshape(c.shape[0], 6, 1, -1)
    sa, ca, ga, sb, cb, gb = (mod[:, 0].clone(), mod[:, 1].clone(), mod[:, 2].clone(), mod[:, 3].clone(), mod[:, 4].clone(), mod[:, 5].clone())
    h = _layernorm(x, axis=-1) * (1 + ca) + sa
    x = x + ga * _A_ref(h, A_wq, A_wk, A_wv, A_wo)
    h = _layernorm(x, axis=-1) * (1 + cb) + sb
    x = x + gb * _B_ref(h, B_w1, B_w3, B_w2)
    return x
```

```asm
; @launch grid=(256,1,1) block=(512,1,1) lds=163840
.amdgcn_target "amdgcn-amd-amdhsa--gfx950"
.text
.globl adaLN_cond__grouped_kv_mqa__glu_gated_swiglu__prompt_kernel
.p2align 8
.type adaLN_cond__grouped_kv_mqa__glu_gated_swiglu__prompt_kernel,@function
adaLN_cond__grouped_kv_mqa__glu_gated_swiglu__prompt_kernel:
    s_cmp_ge_u32 s2, 256
    s_cbranch_scc1 mega_end
    v_lshrrev_b32 v1, 6, v0
    s_nop 0
    v_readfirstlane_b32 s3, v1
    v_and_b32 v1, 63, v0
    s_load_dwordx2 s[4:5], s[0:1], 0
    s_load_dwordx2 s[6:7], s[0:1], 104
    s_load_dwordx2 s[8:9], s[0:1], 88
    s_load_dwordx2 s[10:11], s[0:1], 48
    s_load_dwordx2 s[12:13], s[0:1], 56
    s_waitcnt lgkmcnt(0)
    s_add_u32 s60, s6, 24117248
    s_addc_u32 s61, s7, 0
    s_mov_b32 s62, 65536
    s_mov_b32 s63, 0x00020000
    s_and_b32 s36, s2, 7
    s_lshl_b32 s36, s36, 8
    s_lshr_b32 s37, s2, 6
    s_lshl_b32 s37, s37, 6
    s_add_u32 s36, s36, s37
    s_bfe_u32 s37, s2, 0x30003
    s_load_dwordx2 s[38:39], s[0:1], 80
    s_load_dwordx2 s[40:41], s[0:1], 72
    s_load_dwordx2 s[42:43], s[0:1], 8
    s_load_dwordx2 s[44:45], s[0:1], 16
    s_load_dwordx2 s[46:47], s[0:1], 24
    s_load_dwordx2 s[48:49], s[0:1], 96
    s_waitcnt lgkmcnt(0)
    s_mov_b32 s16, s4
    s_mov_b32 s17, s5
    s_mov_b32 s18, 2621440
    s_mov_b32 s19, 0x00020000
    s_mov_b32 s20, s38
    s_mov_b32 s21, s39
    s_mov_b32 s22, 4915200
    s_mov_b32 s23, 0x00020000
    s_mov_b32 s28, s40
    s_mov_b32 s29, s41
    s_mov_b32 s30, 1280
    s_mov_b32 s31, 0x00020000
    s_mov_b32 s32, s6
    s_mov_b32 s33, s7
    s_mov_b32 s34, 61440
    s_mov_b32 s35, 0x00020000
    s_add_u32 s24, s6, 196608
    s_addc_u32 s25, s7, 0
    s_mov_b32 s26, 163840
    s_mov_b32 s27, 0x00020000
    s_mov_b32 s52, s42
    s_mov_b32 s53, s43
    s_mov_b32 s54, 819200
    s_mov_b32 s55, 0x00020000
    s_and_b32 s50, s37, 1
    s_cmp_eq_u32 s50, 1
    s_cselect_b32 s56, s46, s44
    s_cselect_b32 s57, s47, s45
    s_mov_b32 s58, 25600
    s_mov_b32 s59, 0x00020000
    s_mov_b32 s64, s48
    s_mov_b32 s65, s49
    s_mov_b32 s66, 256
    s_mov_b32 s67, 0x00020000
    s_lshr_b32 s51, s37, 1
    s_lshr_b32 s49, s37, 2
    s_mov_b32 s15, 15360
    s_mov_b32 s69, 30720
    s_mov_b32 s70, 46080
    s_cmp_lg_u32 s3, 7
    s_cbranch_scc1 adaLN_cond__grouped_kv_mqa__glu_gated_swiglu__prompt_kernel_cpf_1
    s_getpc_b64 s[38:39]
adaLN_cond__grouped_kv_mqa__glu_gated_swiglu__prompt_kernel_pc_2:
    s_sub_u32 s38, s38, (adaLN_cond__grouped_kv_mqa__glu_gated_swiglu__prompt_kernel_pc_2 - adaLN_cond__grouped_kv_mqa__glu_gated_swiglu__prompt_kernel)
    s_subb_u32 s39, s39, 0
    s_mov_b32 s40, ((adaLN_cond__grouped_kv_mqa__glu_gated_swiglu__prompt_kernel_code_end - adaLN_cond__grouped_kv_mqa__glu_gated_swiglu__prompt_kernel + 4095) >> 12)
    s_lshr_b32 s41, s2, 3
    s_mul_i32 s41, s41, s40
    v_add_u32 v2, s41, v1
    v_lshlrev_b32 v2, 7, v2
    s_mov_b32 s41, (adaLN_cond__grouped_kv_mqa__glu_gated_swiglu__prompt_kernel_code_end - adaLN_cond__grouped_kv_mqa__glu_gated_swiglu__prompt_kernel - 4)
    v_min_u32 v2, s41, v2
    v_cmp_gt_u32 vcc, s40, v1
    s_nop 0
    s_and_saveexec_b64 s[42:43], vcc
    global_load_dword v98, v2, s[38:39]
    s_mov_b64 exec, -1
adaLN_cond__grouped_kv_mqa__glu_gated_swiglu__prompt_kernel_cpf_1:
    s_cmp_lg_u32 s2, 0
    s_cbranch_scc1 adaLN_cond__grouped_kv_mqa__glu_gated_swiglu__prompt_kernel_nonce_3
    s_cmp_lg_u32 s3, 0
    s_cbranch_scc1 adaLN_cond__grouped_kv_mqa__glu_gated_swiglu__prompt_kernel_nonce_3
    s_memrealtime s[38:39]
    s_waitcnt lgkmcnt(0)
    s_or_b32 s38, s38, 1
    v_mov_b32 v2, s38
    v_mov_b32 v3, 0
    s_mov_b64 exec, 1
    buffer_store_dword v2, v3, s[64:67], 0 offen sc1
    s_mov_b64 exec, -1
adaLN_cond__grouped_kv_mqa__glu_gated_swiglu__prompt_kernel_nonce_3:
    s_mov_b32 s46, 0x3f803f80
    s_cmp_ge_u32 s2, 80
    s_cbranch_scc1 adaLN_cond__grouped_kv_mqa__glu_gated_swiglu__prompt_kernel_late_4
    s_mul_i32 s39, s2, 3277
    s_lshr_b32 s39, s39, 16
    s_mul_i32 s40, s39, 20
    s_sub_u32 s40, s2, s40
    s_mul_i32 s41, s39, 160
    s_lshl_b32 s47, s40, 7
    v_lshrrev_b32 v76, 4, v1
    s_mul_i32 s42, s3, 20
    v_add_u32 v76, s42, v76
    s_mov_b32 s43, 7680
    v_mul_lo_u32 v70, v76, s43
    v_and_b32 v77, 15, v1
    v_lshl_add_u32 v70, v77, 3, v70
    s_mul_i32 s42, s41, 7680
    s_add_u32 s42, s42, s47
    buffer_load_dwordx2 v[60:61], v70, s[20:23], s42 offen
    s_add_u32 s42, s42, 30720
    buffer_load_dwordx2 v[62:63], v70, s[20:23], s42 offen
    s_add_u32 s42, s42, 30720
    buffer_load_dwordx2 v[64:65], v70, s[20:23], s42 offen
    s_add_u32 s42, s42, 30720
    buffer_load_dwordx2 v[66:67], v70, s[20:23], s42 offen
    s_add_u32 s42, s42, 30720
    buffer_load_dwordx2 v[68:69], v70, s[20:23], s42 offen
    v_lshrrev_b32 v3, 4, v1
    s_mul_i32 s42, s3, 20
    s_add_u32 s42, s42, s41
    v_add_u32 v3, s42, v3
    v_lshlrev_b32 v3, 1, v3
    buffer_load_ushort v80, v3, s[28:31], 0 offen offset:0
    buffer_load_ushort v81, v3, s[28:31], 0 offen offset:8
    buffer_load_ushort v82, v3, s[28:31], 0 offen offset:16
    buffer_load_ushort v83, v3, s[28:31], 0 offen offset:24
    buffer_load_ushort v84, v3, s[28:31], 0 offen offset:32
    s_mul_i32 s48, s39, 15360
    s_lshl_b32 s42, s40, 8
    s_add_u32 s48, s48, s42
    s_cmp_eq_u32 s3, 0
    s_cbranch_scc1 adaLN_cond__grouped_kv_mqa__glu_gated_swiglu__prompt_kernel_pf2_7
    s_cmp_eq_u32 s3, 7
    s_cbranch_scc1 adaLN_cond__grouped_kv_mqa__glu_gated_swiglu__prompt_kernel_pf2_7
    s_sub_u32 s42, s3, 4
    s_cmp_lt_u32 s42, 2
    s_cbranch_scc0 adaLN_cond__grouped_kv_mqa__glu_gated_swiglu__prompt_kernel_pf1_6
    s_lshl_b32 s42, s42, 6
    v_add_u32 v100, s42, v1
    v_min_u32 v100, 79, v100
    s_mul_i32 s42, s37, 80
    v_add_u32 v100, s42, v100
    v_lshlrev_b32 v100, 7, v100
    s_mul_i32 s42, s36, 1280
    buffer_load_dword v101, v100, s[16:19], s42 offen
    s_branch adaLN_cond__grouped_kv_mqa__glu_gated_swiglu__prompt_kernel_pf2_7
adaLN_cond__grouped_kv_mqa__glu_gated_swiglu__prompt_kernel_pf1_6:
    s_cmp_eq_u32 s3, 6
    s_cselect_b32 s42, 4, s3
    s_sub_u32 s42, s42, 1
    s_lshl_b32 s42, s42, 6
    v_add_u32 v100, s42, v1
    v_min_u32 v100, 199, v100
    s_lshr_b32 s42, s2, 3
    s_mul_i32 s42, s42, 200
    v_add_u32 v100, s42, v100
    v_lshlrev_b32 v100, 7, v100
    buffer_load_dword v101, v100, s[52:55], 0 offen
adaLN_cond__grouped_kv_mqa__glu_gated_swiglu__prompt_kernel_pf2_7:
    s_cmp_eq_u32 s3, 0
    s_cbranch_scc1 adaLN_cond__grouped_kv_mqa__glu_gated_swiglu__prompt_kernel_nx_8
    v_lshrrev_b32 v2, 4, v1
    s_lshl_b32 s42, s3, 2
    v_add_u32 v2, s42, v2
    v_mul_u32_u24 v2, 1280, v2
    v_and_b32 v3, 15, v1
    v_lshl_add_u32 v2, v3, 4, v2
    s_mul_i32 s42, s36, 1280
    s_mul_i32 s43, s49, 40960
    s_add_u32 s44, s42, s43
    s_xor_b32 s43, s49, 1
    s_mul_i32 s43, s43, 40960
    s_add_u32 s45, s42, s43
    buffer_load_dwordx4 v[16:19], v2, s[16:19], s44 offen offset:0
    buffer_load_dwordx4 v[20:23], v2, s[16:19], s44 offen offset:256
    buffer_load_dwordx4 v[24:27], v2, s[16:19], s44 offen offset:512
    buffer_load_dwordx4 v[28:31], v2, s[16:19], s44 offen offset:768
    buffer_load_dwordx4 v[32:35], v2, s[16:19], s44 offen offset:1024
    buffer_load_dwordx4 v[36:39], v2, s[16:19], s45 offen offset:0
    buffer_load_dwordx4 v[40:43], v2, s[16:19], s45 offen offset:256
    buffer_load_dwordx4 v[44:47], v2, s[16:19], s45 offen offset:512
    buffer_load_dwordx4 v[48:51], v2, s[16:19], s45 offen offset:768
    buffer_load_dwordx4 v[52:55], v2, s[16:19], s45 offen offset:1024
adaLN_cond__grouped_kv_mqa__glu_gated_swiglu__prompt_kernel_nx_8:
    s_cmp_lg_u32 s3, 0
    s_cbranch_scc1 adaLN_cond__grouped_kv_mqa__glu_gated_swiglu__prompt_kernel_w0_9
    v_mov_b32 v3, 0
    s_mov_b32 s44, 65536
adaLN_cond__grouped_kv_mqa__glu_gated_swiglu__prompt_kernel_nl_10:
    buffer_load_dword v2, v3, s[64:67], 0 offen sc1
    s_waitcnt vmcnt(0)
    v_readfirstlane_b32 s71, v2
    s_sub_u32 s44, s44, 1
    s_cmp_eq_u32 s44, 0
    s_cbranch_scc1 adaLN_cond__grouped_kv_mqa__glu_gated_swiglu__prompt_kernel_nd_11
    s_cmp_eq_u32 s71, 0
    s_cbranch_scc1 adaLN_cond__grouped_kv_mqa__glu_gated_swiglu__prompt_kernel_nl_10
adaLN_cond__grouped_kv_mqa__glu_gated_swiglu__prompt_kernel_nd_11:
adaLN_cond__grouped_kv_mqa__glu_gated_swiglu__prompt_kernel_w0_9:
    s_waitcnt vmcnt(4)
    v_lshlrev_b32 v80, 16, v80
    v_mul_f32 v85, 0xbfb8aa3b, v80
    v_exp_f32 v85, v85
    s_nop 0
    v_add_f32 v85, 1.0, v85
    v_rcp_f32 v85, v85
    s_nop 0
    v_mul_f32 v80, v80, v85
    v_cvt_pk_bf16_f32 v80, v80, v80
    v_lshlrev_b32 v80, 16, v80
    s_waitcnt vmcnt(3)
    v_lshlrev_b32 v81, 16, v81
    v_mul_f32 v85, 0xbfb8aa3b, v81
    v_exp_f32 v85, v85
    s_nop 0
    v_add_f32 v85, 1.0, v85
    v_rcp_f32 v85, v85
    s_nop 0
    v_mul_f32 v81, v81, v85
    v_cvt_pk_bf16_f32 v81, v81, v81
    v_lshlrev_b32 v81, 16, v81
    s_waitcnt vmcnt(2)
    v_lshlrev_b32 v82, 16, v82
    v_mul_f32 v85, 0xbfb8aa3b, v82
    v_exp_f32 v85, v85
    s_nop 0
    v_add_f32 v85, 1.0, v85
    v_rcp_f32 v85, v85
    s_nop 0
    v_mul_f32 v82, v82, v85
    v_cvt_pk_bf16_f32 v82, v82, v82
    v_lshlrev_b32 v82, 16, v82
    s_waitcnt vmcnt(1)
    v_lshlrev_b32 v83, 16, v83
    v_mul_f32 v85, 0xbfb8aa3b, v83
    v_exp_f32 v85, v85
    s_nop 0
    v_add_f32 v85, 1.0, v85
    v_rcp_f32 v85, v85
    s_nop 0
    v_mul_f32 v83, v83, v85
    v_cvt_pk_bf16_f32 v83, v83, v83
    v_lshlrev_b32 v83, 16, v83
    s_waitcnt vmcnt(0)
    v_lshlrev_b32 v84, 16, v84
    v_mul_f32 v85, 0xbfb8aa3b, v84
    v_exp_f32 v85, v85
    s_nop 0
    v_add_f32 v85, 1.0, v85
    v_rcp_f32 v85, v85
    s_nop 0
    v_mul_f32 v84, v84, v85
    v_cvt_pk_bf16_f32 v84, v84, v84
    v_lshlrev_b32 v84, 16, v84
    s_add_u32 s20, s6, 655360
    s_addc_u32 s21, s7, 0
    s_mov_b32 s22, 40960
    s_mov_b32 s23, 0x00020000
    s_mul_i32 s48, s39, 10240
    s_lshl_b32 s42, s40, 9
    s_add_u32 s48, s48, s42
    v_mov_b32 v72, 0
    v_mov_b32 v73, 0
    v_mov_b32 v74, 0
    v_mov_b32 v75, 0
    v_lshlrev_b32 v76, 16, v60
    v_and_b32 v77, 0xffff0000, v60
    v_lshlrev_b32 v78, 16, v61
    v_and_b32 v79, 0xffff0000, v61
    v_fmac_f32 v72, v80, v76
    v_fmac_f32 v73, v80, v77
    v_fmac_f32 v74, v80, v78
    v_fmac_f32 v75, v80, v79
    v_lshlrev_b32 v76, 16, v62
    v_and_b32 v77, 0xffff0000, v62
    v_lshlrev_b32 v78, 16, v63
    v_and_b32 v79, 0xffff0000, v63
    v_fmac_f32 v72, v81, v76
    v_fmac_f32 v73, v81, v77
    v_fmac_f32 v74, v81, v78
    v_fmac_f32 v75, v81, v79
    v_lshlrev_b32 v76, 16, v64
    v_and_b32 v77, 0xffff0000, v64
    v_lshlrev_b32 v78, 16, v65
    v_and_b32 v79, 0xffff0000, v65
    v_fmac_f32 v72, v82, v76
    v_fmac_f32 v73, v82, v77
    v_fmac_f32 v74, v82, v78
    v_fmac_f32 v75, v82, v79
    v_lshlrev_b32 v76, 16, v66
    v_and_b32 v77, 0xffff0000, v66
    v_lshlrev_b32 v78, 16, v67
    v_and_b32 v79, 0xffff0000, v67
    v_fmac_f32 v72, v83, v76
    v_fmac_f32 v73, v83, v77
    v_fmac_f32 v74, v83, v78
    v_fmac_f32 v75, v83, v79
    v_lshlrev_b32 v76, 16, v68
    v_and_b32 v77, 0xffff0000, v68
    v_lshlrev_b32 v78, 16, v69
    v_and_b32 v79, 0xffff0000, v69
    v_fmac_f32 v72, v84, v76
    v_fmac_f32 v73, v84, v77
    v_fmac_f32 v74, v84, v78
    v_fmac_f32 v75, v84, v79
    v_mov_b32 v76, v72
    s_nop 1
    v_permlane32_swap_b32 v72, v76
    v_add_f32 v72, v72, v76
    v_mov_b32 v76, v72
    s_nop 1
    v_permlane16_swap_b32 v72, v76
    v_add_f32 v72, v72, v76
    v_mov_b32 v76, v73
    s_nop 1
    v_permlane32_swap_b32 v73, v76
    v_add_f32 v73, v73, v76
    v_mov_b32 v76, v73
    s_nop 1
    v_permlane16_swap_b32 v73, v76
    v_add_f32 v73, v73, v76
    v_mov_b32 v76, v74
    s_nop 1
    v_permlane32_swap_b32 v74, v76
    v_add_f32 v74, v74, v76
    v_mov_b32 v76, v74
    s_nop 1
    v_permlane16_swap_b32 v74, v76
    v_add_f32 v74, v74, v76
    v_mov_b32 v76, v75
    s_nop 1
    v_permlane32_swap_b32 v75, v76
    v_add_f32 v75, v75, v76
    v_mov_b32 v76, v75
    s_nop 1
    v_permlane16_swap_b32 v75, v76
    v_add_f32 v75, v75, v76
    v_and_b32 v76, 15, v1
    v_lshlrev_b32 v76, 4, v76
    s_lshl_b32 s42, s3, 8
    v_add_u32 v76, s42, v76
    v_add_u32 v76, 151552, v76
    s_mov_b64 exec, 0xffff
    ds_write_b128 v76, v[72:75] offset:0
    s_mov_b64 exec, -1
    s_waitcnt lgkmcnt(0)
    s_barrier
    s_cmp_ge_u32 s3, 1
    s_cbranch_scc1 adaLN_cond__grouped_kv_mqa__glu_gated_swiglu__prompt_kernel_gemv_done_12
    s_lshl_b32 s42, s3, 11
    v_lshlrev_b32 v76, 2, v1
    v_add_u32 v77, s42, v76
    v_add_u32 v77, 151552, v77
    ds_read_b32 v60, v77 offset:0
    ds_read_b32 v61, v77 offset:256
    ds_read_b32 v62, v77 offset:512
    ds_read_b32 v63, v77 offset:768
    ds_read_b32 v64, v77 offset:1024
    ds_read_b32 v65, v77 offset:1280
    ds_read_b32 v66, v77 offset:1536
    ds_read_b32 v67, v77 offset:1792
    s_waitcnt lgkmcnt(6)
    v_add_f32 v60, v60, v61
    s_waitcnt lgkmcnt(5)
    v_add_f32 v60, v60, v62
    s_waitcnt lgkmcnt(4)
    v_add_f32 v60, v60, v63
    s_waitcnt lgkmcnt(3)
    v_add_f32 v60, v60, v64
    s_waitcnt lgkmcnt(2)
    v_add_f32 v60, v60, v65
    s_waitcnt lgkmcnt(1)
    v_add_f32 v60, v60, v66
    s_waitcnt lgkmcnt(0)
    v_add_f32 v60, v60, v67
    s_mul_i32 s42, s3, 0
    s_add_u32 s42, s42, s48
    v_mov_b32 v61, s71
    v_lshlrev_b32 v76, 1, v76
    buffer_store_dwordx2 v[60:61], v76, s[20:23], s42 offen sc1
adaLN_cond__grouped_kv_mqa__glu_gated_swiglu__prompt_kernel_gemv_done_12:
    s_cmp_lg_u32 s3, 0
    s_cbranch_scc1 adaLN_cond__grouped_kv_mqa__glu_gated_swiglu__prompt_kernel_w0_13
    s_getreg_b32 s42, hwreg(HW_REG_XCC_ID, 0, 4)
    s_add_u32 s42, s42, 1
    s_add_u32 s42, s42, s71
    s_and_b32 s43, s2, 7
    s_lshl_b32 s43, s43, 7
    s_lshr_b32 s44, s2, 3
    s_lshl_b32 s44, s44, 2
    s_add_u32 s43, s43, s44
    s_add_u32 s43, s43, 40960
    v_mov_b32 v2, s42
    v_mov_b32 v3, 0
    s_mov_b64 exec, 1
    buffer_store_dword v2, v3, s[60:63], s43 offen sc1
    s_mov_b64 exec, -1
    v_mov_b32 v4, s71
    v_mov_b32 v5, 0
    v_mov_b32 v3, 153600
    ds_write_b64 v3, v[4:5]
adaLN_cond__grouped_kv_mqa__glu_gated_swiglu__prompt_kernel_w0_13:
    s_cmp_lg_u32 s3, 0
    s_cbranch_scc1 adaLN_cond__grouped_kv_mqa__glu_gated_swiglu__prompt_kernel_nx_14
    v_lshrrev_b32 v2, 4, v1
    s_lshl_b32 s42, s3, 2
    v_add_u32 v2, s42, v2
    v_mul_u32_u24 v2, 1280, v2
    v_and_b32 v3, 15, v1
    v_lshl_add_u32 v2, v3, 4, v2
    s_mul_i32 s42, s36, 1280
    s_mul_i32 s43, s49, 40960
    s_add_u32 s44, s42, s43
    s_xor_b32 s43, s49, 1
    s_mul_i32 s43, s43, 40960
    s_add_u32 s45, s42, s43
    buffer_load_dwordx4 v[16:19], v2, s[16:19], s44 offen offset:0
    buffer_load_dwordx4 v[20:23], v2, s[16:19], s44 offen offset:256
    buffer_load_dwordx4 v[24:27], v2, s[16:19], s44 offen offset:512
    buffer_load_dwordx4 v[28:31], v2, s[16:19], s44 offen offset:768
    buffer_load_dwordx4 v[32:35], v2, s[16:19], s44 offen offset:1024
    buffer_load_dwordx4 v[36:39], v2, s[16:19], s45 offen offset:0
    buffer_load_dwordx4 v[40:43], v2, s[16:19], s45 offen offset:256
    buffer_load_dwordx4 v[44:47], v2, s[16:19], s45 offen offset:512
    buffer_load_dwordx4 v[48:51], v2, s[16:19], s45 offen offset:768
    buffer_load_dwordx4 v[52:55], v2, s[16:19], s45 offen offset:1024
adaLN_cond__grouped_kv_mqa__glu_gated_swiglu__prompt_kernel_nx_14:
    v_mov_b32 v6, 0
    v_mov_b32 v7, 0
    v_mov_b32 v8, 0
    v_mov_b32 v9, 0
    s_waitcnt vmcnt(9)
    v_dot2c_f32_bf16 v6, s46, v16
    v_dot2c_f32_bf16 v8, v16, v16
    v_dot2c_f32_bf16 v7, s46, v17
    v_dot2c_f32_bf16 v9, v17, v17
    v_dot2c_f32_bf16 v6, s46, v18
    v_dot2c_f32_bf16 v8, v18, v18
    v_dot2c_f32_bf16 v7, s46, v19
    v_dot2c_f32_bf16 v9, v19, v19
    s_waitcnt vmcnt(8)
    v_dot2c_f32_bf16 v6, s46, v20
    v_dot2c_f32_bf16 v8, v20, v20
    v_lshlrev_b32 v90, 4, v1
    s_lshl_b32 s40, s3, 10
    s_add_u32 s39, s40, 122880
    s_mov_b32 m0, s39
    s_nop 0
    buffer_load_dwordx4 v90, s[56:59], s40 offen lds
    s_add_u32 s40, s40, 8192
    v_dot2c_f32_bf16 v7, s46, v21
    v_dot2c_f32_bf16 v9, v21, v21
    v_dot2c_f32_bf16 v6, s46, v22
    v_dot2c_f32_bf16 v8, v22, v22
    v_dot2c_f32_bf16 v7, s46, v23
    v_dot2c_f32_bf16 v9, v23, v23
    s_waitcnt vmcnt(8)
    v_dot2c_f32_bf16 v6, s46, v24
    v_dot2c_f32_bf16 v8, v24, v24
    v_dot2c_f32_bf16 v7, s46, v25
    v_dot2c_f32_bf16 v9, v25, v25
    s_add_u32 s39, s40, 122880
    s_mov_b32 m0, s39
    s_nop 0
    buffer_load_dwordx4 v90, s[56:59], s40 offen lds
    s_add_u32 s40, s40, 8192
    s_add_u32 s39, s40, 122880
    s_mov_b32 m0, s39
    s_nop 0
    buffer_load_dwordx4 v90, s[56:59], s40 offen lds
    s_add_u32 s40, s40, 8192
    v_dot2c_f32_bf16 v6, s46, v26
    v_dot2c_f32_bf16 v8, v26, v26
    v_dot2c_f32_bf16 v7, s46, v27
    v_dot2c_f32_bf16 v9, v27, v27
    s_waitcnt vmcnt(9)
    v_dot2c_f32_bf16 v6, s46, v28
    v_dot2c_f32_bf16 v8, v28, v28
    v_dot2c_f32_bf16 v7, s46, v29
    v_dot2c_f32_bf16 v9, v29, v29
    v_dot2c_f32_bf16 v6, s46, v30
    v_dot2c_f32_bf16 v8, v30, v30
    s_cmp_ge_u32 s3, 1
    s_cbranch_scc1 adaLN_cond__grouped_kv_mqa__glu_gated_swiglu__prompt_kernel_wkd_15
    s_add_u32 s39, s40, 122880
    s_mov_b32 m0, s39
    s_nop 0
    buffer_load_dwordx4 v90, s[56:59], s40 offen lds
adaLN_cond__grouped_kv_mqa__glu_gated_swiglu__prompt_kernel_wkd_15:
    s_mov_b32 s38, 43691
    v_mov_b32 v95, 0x7ff00000
    s_lshl_b32 s42, s3, 6
    s_add_u32 s42, s42, 0
    v_add_u32 v93, s42, v1
    v_mul_u32_u24 v90, s38, v93
    v_lshrrev_b32 v90, 19, v90
    v_mul_u32_u24 v94, 12, v90
    v_sub_u32 v94, v93, v94
    v_mul_u32_u24 v90, 1280, v90
    v_lshl_add_u32 v90, v94, 4, v90
    v_cmp_lt_u32 vcc, 9, v94
    s_nop 1
    v_cndmask_b32 v90, v90, v95, vcc
    s_lshl_b32 s42, s3, 6
    s_add_u32 s42, s42, 512
    v_add_u32 v93, s42, v1
    v_mul_u32_u24 v91, s38, v93
    v_lshrrev_b32 v91, 19, v91
    v_mul_u32_u24 v94, 12, v91
    v_sub_u32 v94, v93, v94
    v_mul_u32_u24 v91, 1280, v91
    v_lshl_add_u32 v91, v94, 4, v91
    v_cmp_lt_u32 vcc, 9, v94
    s_nop 1
    v_cndmask_b32 v91, v91, v95, vcc
    s_lshl_b32 s42, s3, 6
    s_add_u32 s42, s42, 1024
    v_add_u32 v93, s42, v1
    v_mul_u32_u24 v92, s38, v93
    v_lshrrev_b32 v92, 19, v92
    v_mul_u32_u24 v94, 12, v92
    v_sub_u32 v94, v93, v94
    v_mul_u32_u24 v92, 1280, v92
    v_lshl_add_u32 v92, v94, 4, v92
    v_cmp_lt_u32 vcc, 9, v94
    s_nop 1
    v_cndmask_b32 v92, v92, v95, vcc
    s_mul_i32 s39, s37, 160
    s_lshl_b32 s40, s3, 10
    v_dot2c_f32_bf16 v7, s46, v31
    v_dot2c_f32_bf16 v9, v31, v31
    s_waitcnt vmcnt(8)
    v_dot2c_f32_bf16 v6, s46, v32
    v_dot2c_f32_bf16 v8, v32, v32
    v_dot2c_f32_bf16 v7, s46, v33
    v_dot2c_f32_bf16 v9, v33, v33
    v_dot2c_f32_bf16 v6, s46, v34
    v_dot2c_f32_bf16 v8, v34, v34
    v_dot2c_f32_bf16 v7, s46, v35
    v_dot2c_f32_bf16 v9, v35, v35
    s_mov_b32 m0, s40
    s_nop 0
    buffer_load_dwordx4 v90, s[52:55], s39 offen lds
    s_add_u32 s40, s40, 8192
    s_mov_b32 m0, s40
    s_nop 0
    buffer_load_dwordx4 v91, s[52:55], s39 offen lds
    s_add_u32 s40, s40, 8192
    v_add_f32 v6, v6, v7
    v_add_f32 v8, v8, v9
    s_nop 0
    v_add_f32_dpp v6, v6, v6 row_ror:8 row_mask:0xf bank_mask:0xf
    v_add_f32_dpp v8, v8, v8 row_ror:8 row_mask:0xf bank_mask:0xf
    s_nop 0
    v_add_f32_dpp v6, v6, v6 row_ror:4 row_mask:0xf bank_mask:0xf
    v_add_f32_dpp v8, v8, v8 row_ror:4 row_mask:0xf bank_mask:0xf
    s_nop 0
    v_add_f32_dpp v6, v6, v6 row_ror:2 row_mask:0xf bank_mask:0xf
    v_add_f32_dpp v8, v8, v8 row_ror:2 row_mask:0xf bank_mask:0xf
    s_nop 0
    v_add_f32_dpp v6, v6, v6 row_ror:1 row_mask:0xf bank_mask:0xf
    v_add_f32_dpp v8, v8, v8 row_ror:1 row_mask:0xf bank_mask:0xf
    v_mul_f32 v6, 0x3acccccd, v6
    v_mov_b32 v10, 0x3727c5ac
    v_fmac_f32 v10, 0x3acccccd, v8
    v_fma_f32 v10, -v6, v6, v10
    v_max_f32 v10, 0x3727c5ac, v10
    v_rsq_f32 v10, v10
    s_nop 0
    v_mul_f32 v12, v6, v10
    v_sub_f32 v12, 0, v12
    v_lshlrev_b32 v14, 16, v16
    v_and_b32 v15, 0xffff0000, v16
    v_pk_fma_f32 v[14:15], v[14:15], v[10:11], v[12:13] op_sel_hi:[1,0,0]
    v_cvt_pk_f16_f32 v16, v14, v15
    v_lshlrev_b32 v6, 16, v17
    v_and_b32 v7, 0xffff0000, v17
    v_pk_fma_f32 v[6:7], v[6:7], v[10:11], v[12:13] op_sel_hi:[1,0,0]
    v_cvt_pk_f16_f32 v17, v6, v7
    v_lshlrev_b32 v14, 16, v18
    v_and_b32 v15, 0xffff0000, v18
    v_pk_fma_f32 v[14:15], v[14:15], v[10:11], v[12:13] op_sel_hi:[1,0,0]
    v_cvt_pk_f16_f32 v18, v14, v15
    v_lshlrev_b32 v6, 16, v19
    v_and_b32 v7, 0xffff0000, v19
    v_pk_fma_f32 v[6:7], v[6:7], v[10:11], v[12:13] op_sel_hi:[1,0,0]
    v_cvt_pk_f16_f32 v19, v6, v7
    v_lshlrev_b32 v14, 16, v20
    v_and_b32 v15, 0xffff0000, v20
    v_pk_fma_f32 v[14:15], v[14:15], v[10:11], v[12:13] op_sel_hi:[1,0,0]
    v_cvt_pk_f16_f32 v20, v14, v15
    s_mov_b32 m0, s40
    s_nop 0
    buffer_load_dwordx4 v92, s[52:55], s39 offen lds
    s_add_u32 s40, s40, 8192
    s_add_u32 s39, s39, 163840
    s_mov_b32 m0, s40
    s_nop 0
    buffer_load_dwordx4 v90, s[52:55], s39 offen lds
    s_add_u32 s40, s40, 8192
    v_lshlrev_b32 v6, 16, v21
    v_and_b32 v7, 0xffff0000, v21
    v_pk_fma_f32 v[6:7], v[6:7], v[10:11], v[12:13] op_sel_hi:[1,0,0]
    v_cvt_pk_f16_f32 v21, v6, v7
    v_lshlrev_b32 v14, 16, v22
    v_and_b32 v15, 0xffff0000, v22
    v_pk_fma_f32 v[14:15], v[14:15], v[10:11], v[12:13] op_sel_hi:[1,0,0]
    v_cvt_pk_f16_f32 v22, v14, v15
    v_lshlrev_b32 v6, 16, v23
    v_and_b32 v7, 0xffff0000, v23
    v_pk_fma_f32 v[6:7], v[6:7], v[10:11], v[12:13] op_sel_hi:[1,0,0]
    v_cvt_pk_f16_f32 v23, v6, v7
    v_lshlrev_b32 v14, 16, v24
    v_and_b32 v15, 0xffff0000, v24
    v_pk_fma_f32 v[14:15], v[14:15], v[10:11], v[12:13] op_sel_hi:[1,0,0]
    v_cvt_pk_f16_f32 v24, v14, v15
    v_lshlrev_b32 v6, 16, v25
    v_and_b32 v7, 0xffff0000, v25
    v_pk_fma_f32 v[6:7], v[6:7], v[10:11], v[12:13] op_sel_hi:[1,0,0]
    v_cvt_pk_f16_f32 v25, v6, v7
    s_mov_b32 m0, s40
    s_nop 0
    buffer_load_dwordx4 v91, s[52:55], s39 offen lds
    s_add_u32 s40, s40, 8192
    s_mov_b32 m0, s40
    s_nop 0
    buffer_load_dwordx4 v92, s[52:55], s39 offen lds
    s_add_u32 s40, s40, 8192
    s_add_u32 s39, s39, 163840
    v_lshlrev_b32 v14, 16, v26
    v_and_b32 v15, 0xffff0000, v26
    v_pk_fma_f32 v[14:15], v[14:15], v[10:11], v[12:13] op_sel_hi:[1,0,0]
    v_cvt_pk_f16_f32 v26, v14, v15
    v_lshlrev_b32 v6, 16, v27
    v_and_b32 v7, 0xffff0000, v27
    v_pk_fma_f32 v[6:7], v[6:7], v[10:11], v[12:13] op_sel_hi:[1,0,0]
    v_cvt_pk_f16_f32 v27, v6, v7
    v_lshlrev_b32 v14, 16, v28
    v_and_b32 v15, 0xffff0000, v28
    v_pk_fma_f32 v[14:15], v[14:15], v[10:11], v[12:13] op_sel_hi:[1,0,0]
    v_cvt_pk_f16_f32 v28, v14, v15
    v_lshlrev_b32 v6, 16, v29
    v_and_b32 v7, 0xffff0000, v29
    v_pk_fma_f32 v[6:7], v[6:7], v[10:11], v[12:13] op_sel_hi:[1,0,0]
    v_cvt_pk_f16_f32 v29, v6, v7
    v_lshlrev_b32 v14, 16, v30
    v_and_b32 v15, 0xffff0000, v30
    v_pk_fma_f32 v[14:15], v[14:15], v[10:11], v[12:13] op_sel_hi:[1,0,0]
    v_cvt_pk_f16_f32 v30, v14, v15
    s_mov_b32 m0, s40
    s_nop 0
    buffer_load_dwordx4 v90, s[52:55], s39 offen lds
    s_add_u32 s40, s40, 8192
    s_mov_b32 m0, s40
    s_nop 0
    buffer_load_dwordx4 v91, s[52:55], s39 offen lds
    s_add_u32 s40, s40, 8192
    v_lshlrev_b32 v6, 16, v31
    v_and_b32 v7, 0xffff0000, v31
    v_pk_fma_f32 v[6:7], v[6:7], v[10:11], v[12:13] op_sel_hi:[1,0,0]
    v_cvt_pk_f16_f32 v31, v6, v7
    v_lshlrev_b32 v14, 16, v32
    v_and_b32 v15, 0xffff0000, v32
    v_pk_fma_f32 v[14:15], v[14:15], v[10:11], v[12:13] op_sel_hi:[1,0,0]
    v_cvt_pk_f16_f32 v32, v14, v15
    v_lshlrev_b32 v6, 16, v33
    v_and_b32 v7, 0xffff0000, v33
    v_pk_fma_f32 v[6:7], v[6:7], v[10:11], v[12:13] op_sel_hi:[1,0,0]
    v_cvt_pk_f16_f32 v33, v6, v7
    v_lshlrev_b32 v14, 16, v34
    v_and_b32 v15, 0xffff0000, v34
    v_pk_fma_f32 v[14:15], v[14:15], v[10:11], v[12:13] op_sel_hi:[1,0,0]
    v_cvt_pk_f16_f32 v34, v14, v15
    v_lshlrev_b32 v6, 16, v35
    v_and_b32 v7, 0xffff0000, v35
    v_pk_fma_f32 v[6:7], v[6:7], v[10:11], v[12:13] op_sel_hi:[1,0,0]
    v_cvt_pk_f16_f32 v35, v6, v7
    s_mov_b32 m0, s40
    s_nop 0
    buffer_load_dwordx4 v92, s[52:55], s39 offen lds
    s_add_u32 s40, s40, 8192
    s_add_u32 s39, s39, 163840
    s_mov_b32 m0, s40
    s_nop 0
    buffer_load_dwordx4 v90, s[52:55], s39 offen lds
    s_add_u32 s40, s40, 8192
    v_mov_b32 v6, 0
    v_mov_b32 v7, 0
    v_mov_b32 v8, 0
    v_mov_b32 v9, 0
    s_waitcnt vmcnt(17)
    v_dot2c_f32_bf16 v6, s46, v36
    v_dot2c_f32_bf16 v8, v36, v36
    v_dot2c_f32_bf16 v7, s46, v37
    v_dot2c_f32_bf16 v9, v37, v37
    v_dot2c_f32_bf16 v6, s46, v38
    v_dot2c_f32_bf16 v8, v38, v38
    v_dot2c_f32_bf16 v7, s46, v39
    v_dot2c_f32_bf16 v9, v39, v39
    s_waitcnt vmcnt(16)
    v_dot2c_f32_bf16 v6, s46, v40
    v_dot2c_f32_bf16 v8, v40, v40
    s_mov_b32 m0, s40
    s_nop 0
    buffer_load_dwordx4 v91, s[52:55], s39 offen lds
    s_add_u32 s40, s40, 8192
    s_mov_b32 m0, s40
    s_nop 0
    buffer_load_dwordx4 v92, s[52:55], s39 offen lds
    s_add_u32 s40, s40, 8192
    s_add_u32 s39, s39, 163840
    v_dot2c_f32_bf16 v7, s46, v41
    v_dot2c_f32_bf16 v9, v41, v41
    v_dot2c_f32_bf16 v6, s46, v42
    v_dot2c_f32_bf16 v8, v42, v42
    v_dot2c_f32_bf16 v7, s46, v43
    v_dot2c_f32_bf16 v9, v43, v43
    s_waitcnt vmcnt(17)
    v_dot2c_f32_bf16 v6, s46, v44
    v_dot2c_f32_bf16 v8, v44, v44
    v_dot2c_f32_bf16 v7, s46, v45
    v_dot2c_f32_bf16 v9, v45, v45
    s_mov_b32 m0, s40
    s_nop 0
    buffer_load_dwordx4 v90, s[52:55], s39 offen lds
    s_add_u32 s40, s40, 8192
    s_mov_b32 m0, s40
    s_nop 0
    buffer_load_dwordx4 v91, s[52:55], s39 offen lds
    s_add_u32 s40, s40, 8192
    v_dot2c_f32_bf16 v6, s46, v46
    v_dot2c_f32_bf16 v8, v46, v46
    v_dot2c_f32_bf16 v7, s46, v47
    v_dot2c_f32_bf16 v9, v47, v47
    s_waitcnt vmcnt(18)
    v_dot2c_f32_bf16 v6, s46, v48
    v_dot2c_f32_bf16 v8, v48, v48
    v_dot2c_f32_bf16 v7, s46, v49
    v_dot2c_f32_bf16 v9, v49, v49
    v_dot2c_f32_bf16 v6, s46, v50
    v_dot2c_f32_bf16 v8, v50, v50
    s_mov_b32 m0, s40
    s_nop 0
    buffer_load_dwordx4 v92, s[52:55], s39 offen lds
    v_dot2c_f32_bf16 v7, s46, v51
    v_dot2c_f32_bf16 v9, v51, v51
    s_waitcnt vmcnt(18)
    v_dot2c_f32_bf16 v6, s46, v52
    v_dot2c_f32_bf16 v8, v52, v52
    v_dot2c_f32_bf16 v7, s46, v53
    v_dot2c_f32_bf16 v9, v53, v53
    v_dot2c_f32_bf16 v6, s46, v54
    v_dot2c_f32_bf16 v8, v54, v54
    v_dot2c_f32_bf16 v7, s46, v55
    v_dot2c_f32_bf16 v9, v55, v55
    s_nop 1
    v_add_f32 v6, v6, v7
    v_add_f32 v8, v8, v9
    s_nop 0
    v_add_f32_dpp v6, v6, v6 row_ror:8 row_mask:0xf bank_mask:0xf
    v_add_f32_dpp v8, v8, v8 row_ror:8 row_mask:0xf bank_mask:0xf
    s_nop 0
    v_add_f32_dpp v6, v6, v6 row_ror:4 row_mask:0xf bank_mask:0xf
    v_add_f32_dpp v8, v8, v8 row_ror:4 row_mask:0xf bank_mask:0xf
    s_nop 0
    v_add_f32_dpp v6, v6, v6 row_ror:2 row_mask:0xf bank_mask:0xf
    v_add_f32_dpp v8, v8, v8 row_ror:2 row_mask:0xf bank_mask:0xf
    s_nop 0
    v_add_f32_dpp v6, v6, v6 row_ror:1 row_mask:0xf bank_mask:0xf
    v_add_f32_dpp v8, v8, v8 row_ror:1 row_mask:0xf bank_mask:0xf
    v_mul_f32 v6, 0x3acccccd, v6
    v_mov_b32 v10, 0x3727c5ac
    v_fmac_f32 v10, 0x3acccccd, v8
    v_fma_f32 v10, -v6, v6, v10
    v_max_f32 v10, 0x3727c5ac, v10
    v_rsq_f32 v10, v10
    s_nop 0
    v_mul_f32 v12, v6, v10
    v_sub_f32 v12, 0, v12
    v_lshlrev_b32 v14, 16, v36
    v_and_b32 v15, 0xffff0000, v36
    v_pk_fma_f32 v[14:15], v[14:15], v[10:11], v[12:13] op_sel_hi:[1,0,0]
    v_cvt_pk_f16_f32 v36, v14, v15
    v_lshlrev_b32 v6, 16, v37
    v_and_b32 v7, 0xffff0000, v37
    v_pk_fma_f32 v[6:7], v[6:7], v[10:11], v[12:13] op_sel_hi:[1,0,0]
    v_cvt_pk_f16_f32 v37, v6, v7
    v_lshlrev_b32 v14, 16, v38
    v_and_b32 v15, 0xffff0000, v38
    v_pk_fma_f32 v[14:15], v[14:15], v[10:11], v[12:13] op_sel_hi:[1,0,0]
    v_cvt_pk_f16_f32 v38, v14, v15
    v_lshlrev_b32 v6, 16, v39
    v_and_b32 v7, 0xffff0000, v39
    v_pk_fma_f32 v[6:7], v[6:7], v[10:11], v[12:13] op_sel_hi:[1,0,0]
    v_cvt_pk_f16_f32 v39, v6, v7
    v_lshlrev_b32 v14, 16, v40
    v_and_b32 v15, 0xffff0000, v40
    v_pk_fma_f32 v[14:15], v[14:15], v[10:11], v[12:13] op_sel_hi:[1,0,0]
    v_cvt_pk_f16_f32 v40, v14, v15
    v_lshlrev_b32 v6, 16, v41
    v_and_b32 v7, 0xffff0000, v41
    v_pk_fma_f32 v[6:7], v[6:7], v[10:11], v[12:13] op_sel_hi:[1,0,0]
    v_cvt_pk_f16_f32 v41, v6, v7
    v_lshlrev_b32 v14, 16, v42
    v_and_b32 v15, 0xffff0000, v42
    v_pk_fma_f32 v[14:15], v[14:15], v[10:11], v[12:13] op_sel_hi:[1,0,0]
    v_cvt_pk_f16_f32 v42, v14, v15
    v_lshlrev_b32 v6, 16, v43
    v_and_b32 v7, 0xffff0000, v43
    v_pk_fma_f32 v[6:7], v[6:7], v[10:11], v[12:13] op_sel_hi:[1,0,0]
    v_cvt_pk_f16_f32 v43, v6, v7
    v_lshlrev_b32 v14, 16, v44
    v_and_b32 v15, 0xffff0000, v44
    v_pk_fma_f32 v[14:15], v[14:15], v[10:11], v[12:13] op_sel_hi:[1,0,0]
    v_cvt_pk_f16_f32 v44, v14, v15
    v_lshlrev_b32 v6, 16, v45
    v_and_b32 v7, 0xffff0000, v45
    v_pk_fma_f32 v[6:7], v[6:7], v[10:11], v[12:13] op_sel_hi:[1,0,0]
    v_cvt_pk_f16_f32 v45, v6, v7
    v_lshlrev_b32 v14, 16, v46
    v_and_b32 v15, 0xffff0000, v46
    v_pk_fma_f32 v[14:15], v[14:15], v[10:11], v[12:13] op_sel_hi:[1,0,0]
    v_cvt_pk_f16_f32 v46, v14, v15
    v_lshlrev_b32 v6, 16, v47
    v_and_b32 v7, 0xffff0000, v47
    v_pk_fma_f32 v[6:7], v[6:7], v[10:11], v[12:13] op_sel_hi:[1,0,0]
    v_cvt_pk_f16_f32 v47, v6, v7
    v_lshlrev_b32 v14, 16, v48
    v_and_b32 v15, 0xffff0000, v48
    v_pk_fma_f32 v[14:15], v[14:15], v[10:11], v[12:13] op_sel_hi:[1,0,0]
    v_cvt_pk_f16_f32 v48, v14, v15
    v_lshlrev_b32 v6, 16, v49
    v_and_b32 v7, 0xffff0000, v49
    v_pk_fma_f32 v[6:7], v[6:7], v[10:11], v[12:13] op_sel_hi:[1,0,0]
    v_cvt_pk_f16_f32 v49, v6, v7
    v_lshlrev_b32 v14, 16, v50
    v_and_b32 v15, 0xffff0000, v50
    v_pk_fma_f32 v[14:15], v[14:15], v[10:11], v[12:13] op_sel_hi:[1,0,0]
    v_cvt_pk_f16_f32 v50, v14, v15
    v_lshlrev_b32 v6, 16, v51
    v_and_b32 v7, 0xffff0000, v51
    v_pk_fma_f32 v[6:7], v[6:7], v[10:11], v[12:13] op_sel_hi:[1,0,0]
    v_cvt_pk_f16_f32 v51, v6, v7
    v_lshlrev_b32 v14, 16, v52
    v_and_b32 v15, 0xffff0000, v52
    v_pk_fma_f32 v[14:15], v[14:15], v[10:11], v[12:13] op_sel_hi:[1,0,0]
    v_cvt_pk_f16_f32 v52, v14, v15
    v_lshlrev_b32 v6, 16, v53
    v_and_b32 v7, 0xffff0000, v53
    v_pk_fma_f32 v[6:7], v[6:7], v[10:11], v[12:13] op_sel_hi:[1,0,0]
    v_cvt_pk_f16_f32 v53, v6, v7
    v_lshlrev_b32 v14, 16, v54
    v_and_b32 v15, 0xffff0000, v54
    v_pk_fma_f32 v[14:15], v[14:15], v[10:11], v[12:13] op_sel_hi:[1,0,0]
    v_cvt_pk_f16_f32 v54, v14, v15
    v_lshlrev_b32 v6, 16, v55
    v_and_b32 v7, 0xffff0000, v55
    v_pk_fma_f32 v[6:7], v[6:7], v[10:11], v[12:13] op_sel_hi:[1,0,0]
    v_cvt_pk_f16_f32 v55, v6, v7
    s_branch adaLN_cond__grouped_kv_mqa__glu_gated_swiglu__prompt_kernel_both_5
adaLN_cond__grouped_kv_mqa__glu_gated_swiglu__prompt_kernel_late_4:
    s_cmp_eq_u32 s3, 0
    s_cbranch_scc1 adaLN_cond__grouped_kv_mqa__glu_gated_swiglu__prompt_kernel_pf2_17
    s_cmp_eq_u32 s3, 7
    s_cbranch_scc1 adaLN_cond__grouped_kv_mqa__glu_gated_swiglu__prompt_kernel_pf2_17
    s_sub_u32 s42, s3, 4
    s_cmp_lt_u32 s42, 2
    s_cbranch_scc0 adaLN_cond__grouped_kv_mqa__glu_gated_swiglu__prompt_kernel_pf1_16
    s_lshl_b32 s42, s42, 6
    v_add_u32 v100, s42, v1
    v_min_u32 v100, 79, v100
    s_mul_i32 s42, s37, 80
    v_add_u32 v100, s42, v100
    v_lshlrev_b32 v100, 7, v100
    s_mul_i32 s42, s36, 1280
    buffer_load_dword v101, v100, s[16:19], s42 offen
    s_waitcnt vmcnt(0)
    s_branch adaLN_cond__grouped_kv_mqa__glu_gated_swiglu__prompt_kernel_pf2_17
adaLN_cond__grouped_kv_mqa__glu_gated_swiglu__prompt_kernel_pf1_16:
    s_cmp_eq_u32 s3, 6
    s_cselect_b32 s42, 4, s3
    s_sub_u32 s42, s42, 1
    s_lshl_b32 s42, s42, 6
    v_add_u32 v100, s42, v1
    v_min_u32 v100, 199, v100
    s_lshr_b32 s42, s2, 3
    s_mul_i32 s42, s42, 200
    v_add_u32 v100, s42, v100
    v_lshlrev_b32 v100, 7, v100
    buffer_load_dword v101, v100, s[52:55], 0 offen
adaLN_cond__grouped_kv_mqa__glu_gated_swiglu__prompt_kernel_pf2_17:
    s_barrier
    v_lshrrev_b32 v2, 4, v1
    s_lshl_b32 s42, s3, 2
    v_add_u32 v2, s42, v2
    v_mul_u32_u24 v2, 1280, v2
    v_and_b32 v3, 15, v1
    v_lshl_add_u32 v2, v3, 4, v2
    s_mul_i32 s42, s36, 1280
    s_mul_i32 s43, s49, 40960
    s_add_u32 s44, s42, s43
    s_xor_b32 s43, s49, 1
    s_mul_i32 s43, s43, 40960
    s_add_u32 s45, s42, s43
    buffer_load_dwordx4 v[16:19], v2, s[16:19], s44 offen offset:0
    buffer_load_dwordx4 v[20:23], v2, s[16:19], s44 offen offset:256
    buffer_load_dwordx4 v[24:27], v2, s[16:19], s44 offen offset:512
    buffer_load_dwordx4 v[28:31], v2, s[16:19], s44 offen offset:768
    buffer_load_dwordx4 v[32:35], v2, s[16:19], s44 offen offset:1024
    buffer_load_dwordx4 v[36:39], v2, s[16:19], s45 offen offset:0
    buffer_load_dwordx4 v[40:43], v2, s[16:19], s45 offen offset:256
    buffer_load_dwordx4 v[44:47], v2, s[16:19], s45 offen offset:512
    buffer_load_dwordx4 v[48:51], v2, s[16:19], s45 offen offset:768
    buffer_load_dwordx4 v[52:55], v2, s[16:19], s45 offen offset:1024
    v_mov_b32 v6, 0
    v_mov_b32 v7, 0
    v_mov_b32 v8, 0
    v_mov_b32 v9, 0
    s_waitcnt vmcnt(9)
    v_dot2c_f32_bf16 v6, s46, v16
    v_dot2c_f32_bf16 v8, v16, v16
    v_dot2c_f32_bf16 v7, s46, v17
    v_dot2c_f32_bf16 v9, v17, v17
    v_dot2c_f32_bf16 v6, s46, v18
    v_dot2c_f32_bf16 v8, v18, v18
    v_dot2c_f32_bf16 v7, s46, v19
    v_dot2c_f32_bf16 v9, v19, v19
    s_waitcnt vmcnt(8)
    v_dot2c_f32_bf16 v6, s46, v20
    v_dot2c_f32_bf16 v8, v20, v20
    v_lshlrev_b32 v90, 4, v1
    s_lshl_b32 s40, s3, 10
    s_add_u32 s39, s40, 122880
    s_mov_b32 m0, s39
    s_nop 0
    buffer_load_dwordx4 v90, s[56:59], s40 offen lds
    s_add_u32 s40, s40, 8192
    v_dot2c_f32_bf16 v7, s46, v21
    v_dot2c_f32_bf16 v9, v21, v21
    v_dot2c_f32_bf16 v6, s46, v22
    v_dot2c_f32_bf16 v8, v22, v22
    v_dot2c_f32_bf16 v7, s46, v23
    v_dot2c_f32_bf16 v9, v23, v23
    s_waitcnt vmcnt(8)
    v_dot2c_f32_bf16 v6, s46, v24
    v_dot2c_f32_bf16 v8, v24, v24
    v_dot2c_f32_bf16 v7, s46, v25
    v_dot2c_f32_bf16 v9, v25, v25
    s_add_u32 s39, s40, 122880
    s_mov_b32 m0, s39
    s_nop 0
    buffer_load_dwordx4 v90, s[56:59], s40 offen lds
    s_add_u32 s40, s40, 8192
    s_add_u32 s39, s40, 122880
    s_mov_b32 m0, s39
    s_nop 0
    buffer_load_dwordx4 v90, s[56:59], s40 offen lds
    s_add_u32 s40, s40, 8192
    v_dot2c_f32_bf16 v6, s46, v26
    v_dot2c_f32_bf16 v8, v26, v26
    v_dot2c_f32_bf16 v7, s46, v27
    v_dot2c_f32_bf16 v9, v27, v27
    s_waitcnt vmcnt(9)
    v_dot2c_f32_bf16 v6, s46, v28
    v_dot2c_f32_bf16 v8, v28, v28
    v_dot2c_f32_bf16 v7, s46, v29
    v_dot2c_f32_bf16 v9, v29, v29
    v_dot2c_f32_bf16 v6, s46, v30
    v_dot2c_f32_bf16 v8, v30, v30
    s_cmp_ge_u32 s3, 1
    s_cbranch_scc1 adaLN_cond__grouped_kv_mqa__glu_gated_swiglu__prompt_kernel_wkd_18
    s_add_u32 s39, s40, 122880
    s_mov_b32 m0, s39
    s_nop 0
    buffer_load_dwordx4 v90, s[56:59], s40 offen lds
adaLN_cond__grouped_kv_mqa__glu_gated_swiglu__prompt_kernel_wkd_18:
    s_mov_b32 s38, 43691
    v_mov_b32 v95, 0x7ff00000
    s_lshl_b32 s42, s3, 6
    s_add_u32 s42, s42, 0
    v_add_u32 v93, s42, v1
    v_mul_u32_u24 v90, s38, v93
    v_lshrrev_b32 v90, 19, v90
    v_mul_u32_u24 v94, 12, v90
    v_sub_u32 v94, v93, v94
    v_mul_u32_u24 v90, 1280, v90
    v_lshl_add_u32 v90, v94, 4, v90
    v_cmp_lt_u32 vcc, 9, v94
    s_nop 1
    v_cndmask_b32 v90, v90, v95, vcc
    s_lshl_b32 s42, s3, 6
    s_add_u32 s42, s42, 512
    v_add_u32 v93, s42, v1
    v_mul_u32_u24 v91, s38, v93
    v_lshrrev_b32 v91, 19, v91
    v_mul_u32_u24 v94, 12, v91
    v_sub_u32 v94, v93, v94
    v_mul_u32_u24 v91, 1280, v91
    v_lshl_add_u32 v91, v94, 4, v91
    v_cmp_lt_u32 vcc, 9, v94
    s_nop 1
    v_cndmask_b32 v91, v91, v95, vcc
    s_lshl_b32 s42, s3, 6
    s_add_u32 s42, s42, 1024
    v_add_u32 v93, s42, v1
    v_mul_u32_u24 v92, s38, v93
    v_lshrrev_b32 v92, 19, v92
    v_mul_u32_u24 v94, 12, v92
    v_sub_u32 v94, v93, v94
    v_mul_u32_u24 v92, 1280, v92
    v_lshl_add_u32 v92, v94, 4, v92
    v_cmp_lt_u32 vcc, 9, v94
    s_nop 1
    v_cndmask_b32 v92, v92, v95, vcc
    s_mul_i32 s39, s37, 160
    s_lshl_b32 s40, s3, 10
    v_dot2c_f32_bf16 v7, s46, v31
    v_dot2c_f32_bf16 v9, v31, v31
    s_waitcnt vmcnt(8)
    v_dot2c_f32_bf16 v6, s46, v32
    v_dot2c_f32_bf16 v8, v32, v32
    v_dot2c_f32_bf16 v7, s46, v33
    v_dot2c_f32_bf16 v9, v33, v33
    v_dot2c_f32_bf16 v6, s46, v34
    v_dot2c_f32_bf16 v8, v34, v34
    v_dot2c_f32_bf16 v7, s46, v35
    v_dot2c_f32_bf16 v9, v35, v35
    s_mov_b32 m0, s40
    s_nop 0
    buffer_load_dwordx4 v90, s[52:55], s39 offen lds
    s_add_u32 s40, s40, 8192
    s_mov_b32 m0, s40
    s_nop 0
    buffer_load_dwordx4 v91, s[52:55], s39 offen lds
    s_add_u32 s40, s40, 8192
    v_add_f32 v6, v6, v7
    v_add_f32 v8, v8, v9
    s_nop 0
    v_add_f32_dpp v6, v6, v6 row_ror:8 row_mask:0xf bank_mask:0xf
    v_add_f32_dpp v8, v8, v8 row_ror:8 row_mask:0xf bank_mask:0xf
    s_nop 0
    v_add_f32_dpp v6, v6, v6 row_ror:4 row_mask:0xf bank_mask:0xf
    v_add_f32_dpp v8, v8, v8 row_ror:4 row_mask:0xf bank_mask:0xf
    s_nop 0
    v_add_f32_dpp v6, v6, v6 row_ror:2 row_mask:0xf bank_mask:0xf
    v_add_f32_dpp v8, v8, v8 row_ror:2 row_mask:0xf bank_mask:0xf
    s_nop 0
    v_add_f32_dpp v6, v6, v6 row_ror:1 row_mask:0xf bank_mask:0xf
    v_add_f32_dpp v8, v8, v8 row_ror:1 row_mask:0xf bank_mask:0xf
    v_mul_f32 v6, 0x3acccccd, v6
    v_mov_b32 v10, 0x3727c5ac
    v_fmac_f32 v10, 0x3acccccd, v8
    v_fma_f32 v10, -v6, v6, v10
    v_max_f32 v10, 0x3727c5ac, v10
    v_rsq_f32 v10, v10
    s_nop 0
    v_mul_f32 v12, v6, v10
    v_sub_f32 v12, 0, v12
    v_lshlrev_b32 v14, 16, v16
    v_and_b32 v15, 0xffff0000, v16
    v_pk_fma_f32 v[14:15], v[14:15], v[10:11], v[12:13] op_sel_hi:[1,0,0]
    v_cvt_pk_f16_f32 v16, v14, v15
    v_lshlrev_b32 v6, 16, v17
    v_and_b32 v7, 0xffff0000, v17
    v_pk_fma_f32 v[6:7], v[6:7], v[10:11], v[12:13] op_sel_hi:[1,0,0]
    v_cvt_pk_f16_f32 v17, v6, v7
    v_lshlrev_b32 v14, 16, v18
    v_and_b32 v15, 0xffff0000, v18
    v_pk_fma_f32 v[14:15], v[14:15], v[10:11], v[12:13] op_sel_hi:[1,0,0]
    v_cvt_pk_f16_f32 v18, v14, v15
    v_lshlrev_b32 v6, 16, v19
    v_and_b32 v7, 0xffff0000, v19
    v_pk_fma_f32 v[6:7], v[6:7], v[10:11], v[12:13] op_sel_hi:[1,0,0]
    v_cvt_pk_f16_f32 v19, v6, v7
    v_lshlrev_b32 v14, 16, v20
    v_and_b32 v15, 0xffff0000, v20
    v_pk_fma_f32 v[14:15], v[14:15], v[10:11], v[12:13] op_sel_hi:[1,0,0]
    v_cvt_pk_f16_f32 v20, v14, v15
    s_mov_b32 m0, s40
    s_nop 0
    buffer_load_dwordx4 v92, s[52:55], s39 offen lds
    s_add_u32 s40, s40, 8192
    s_add_u32 s39, s39, 163840
    s_mov_b32 m0, s40
    s_nop 0
    buffer_load_dwordx4 v90, s[52:55], s39 offen lds
    s_add_u32 s40, s40, 8192
    v_lshlrev_b32 v6, 16, v21
    v_and_b32 v7, 0xffff0000, v21
    v_pk_fma_f32 v[6:7], v[6:7], v[10:11], v[12:13] op_sel_hi:[1,0,0]
    v_cvt_pk_f16_f32 v21, v6, v7
    v_lshlrev_b32 v14, 16, v22
    v_and_b32 v15, 0xffff0000, v22
    v_pk_fma_f32 v[14:15], v[14:15], v[10:11], v[12:13] op_sel_hi:[1,0,0]
    v_cvt_pk_f16_f32 v22, v14, v15
    v_lshlrev_b32 v6, 16, v23
    v_and_b32 v7, 0xffff0000, v23
    v_pk_fma_f32 v[6:7], v[6:7], v[10:11], v[12:13] op_sel_hi:[1,0,0]
    v_cvt_pk_f16_f32 v23, v6, v7
    v_lshlrev_b32 v14, 16, v24
    v_and_b32 v15, 0xffff0000, v24
    v_pk_fma_f32 v[14:15], v[14:15], v[10:11], v[12:13] op_sel_hi:[1,0,0]
    v_cvt_pk_f16_f32 v24, v14, v15
    v_lshlrev_b32 v6, 16, v25
    v_and_b32 v7, 0xffff0000, v25
    v_pk_fma_f32 v[6:7], v[6:7], v[10:11], v[12:13] op_sel_hi:[1,0,0]
    v_cvt_pk_f16_f32 v25, v6, v7
    s_mov_b32 m0, s40
    s_nop 0
    buffer_load_dwordx4 v91, s[52:55], s39 offen lds
    s_add_u32 s40, s40, 8192
    s_mov_b32 m0, s40
    s_nop 0
    buffer_load_dwordx4 v92, s[52:55], s39 offen lds
    s_add_u32 s40, s40, 8192
    s_add_u32 s39, s39, 163840
    v_lshlrev_b32 v14, 16, v26
    v_and_b32 v15, 0xffff0000, v26
    v_pk_fma_f32 v[14:15], v[14:15], v[10:11], v[12:13] op_sel_hi:[1,0,0]
    v_cvt_pk_f16_f32 v26, v14, v15
    v_lshlrev_b32 v6, 16, v27
    v_and_b32 v7, 0xffff0000, v27
    v_pk_fma_f32 v[6:7], v[6:7], v[10:11], v[12:13] op_sel_hi:[1,0,0]
    v_cvt_pk_f16_f32 v27, v6, v7
    v_lshlrev_b32 v14, 16, v28
    v_and_b32 v15, 0xffff0000, v28
    v_pk_fma_f32 v[14:15], v[14:15], v[10:11], v[12:13] op_sel_hi:[1,0,0]
    v_cvt_pk_f16_f32 v28, v14, v15
    v_lshlrev_b32 v6, 16, v29
    v_and_b32 v7, 0xffff0000, v29
    v_pk_fma_f32 v[6:7], v[6:7], v[10:11], v[12:13] op_sel_hi:[1,0,0]
    v_cvt_pk_f16_f32 v29, v6, v7
    v_lshlrev_b32 v14, 16, v30
    v_and_b32 v15, 0xffff0000, v30
    v_pk_fma_f32 v[14:15], v[14:15], v[10:11], v[12:13] op_sel_hi:[1,0,0]
    v_cvt_pk_f16_f32 v30, v14, v15
    s_mov_b32 m0, s40
    s_nop 0
    buffer_load_dwordx4 v90, s[52:55], s39 offen lds
    s_add_u32 s40, s40, 8192
    s_mov_b32 m0, s40
    s_nop 0
    buffer_load_dwordx4 v91, s[52:55], s39 offen lds
    s_add_u32 s40, s40, 8192
    v_lshlrev_b32 v6, 16, v31
    v_and_b32 v7, 0xffff0000, v31
    v_pk_fma_f32 v[6:7], v[6:7], v[10:11], v[12:13] op_sel_hi:[1,0,0]
    v_cvt_pk_f16_f32 v31, v6, v7
    v_lshlrev_b32 v14, 16, v32
    v_and_b32 v15, 0xffff0000, v32
    v_pk_fma_f32 v[14:15], v[14:15], v[10:11], v[12:13] op_sel_hi:[1,0,0]
    v_cvt_pk_f16_f32 v32, v14, v15
    v_lshlrev_b32 v6, 16, v33
    v_and_b32 v7, 0xffff0000, v33
    v_pk_fma_f32 v[6:7], v[6:7], v[10:11], v[12:13] op_sel_hi:[1,0,0]
    v_cvt_pk_f16_f32 v33, v6, v7
    v_lshlrev_b32 v14, 16, v34
    v_and_b32 v15, 0xffff0000, v34
    v_pk_fma_f32 v[14:15], v[14:15], v[10:11], v[12:13] op_sel_hi:[1,0,0]
    v_cvt_pk_f16_f32 v34, v14, v15
    v_lshlrev_b32 v6, 16, v35
    v_and_b32 v7, 0xffff0000, v35
    v_pk_fma_f32 v[6:7], v[6:7], v[10:11], v[12:13] op_sel_hi:[1,0,0]
    v_cvt_pk_f16_f32 v35, v6, v7
    s_mov_b32 m0, s40
    s_nop 0
    buffer_load_dwordx4 v92, s[52:55], s39 offen lds
    s_add_u32 s40, s40, 8192
    s_add_u32 s39, s39, 163840
    s_mov_b32 m0, s40
    s_nop 0
    buffer_load_dwordx4 v90, s[52:55], s39 offen lds
    s_add_u32 s40, s40, 8192
    v_mov_b32 v6, 0
    v_mov_b32 v7, 0
    v_mov_b32 v8, 0
    v_mov_b32 v9, 0
    s_waitcnt vmcnt(17)
    v_dot2c_f32_bf16 v6, s46, v36
    v_dot2c_f32_bf16 v8, v36, v36
    v_dot2c_f32_bf16 v7, s46, v37
    v_dot2c_f32_bf16 v9, v37, v37
    v_dot2c_f32_bf16 v6, s46, v38
    v_dot2c_f32_bf16 v8, v38, v38
    v_dot2c_f32_bf16 v7, s46, v39
    v_dot2c_f32_bf16 v9, v39, v39
    s_waitcnt vmcnt(16)
    v_dot2c_f32_bf16 v6, s46, v40
    v_dot2c_f32_bf16 v8, v40, v40
    s_mov_b32 m0, s40
    s_nop 0
    buffer_load_dwordx4 v91, s[52:55], s39 offen lds
    s_add_u32 s40, s40, 8192
    s_mov_b32 m0, s40
    s_nop 0
    buffer_load_dwordx4 v92, s[52:55], s39 offen lds
    s_add_u32 s40, s40, 8192
    s_add_u32 s39, s39, 163840
    v_dot2c_f32_bf16 v7, s46, v41
    v_dot2c_f32_bf16 v9, v41, v41
    v_dot2c_f32_bf16 v6, s46, v42
    v_dot2c_f32_bf16 v8, v42, v42
    v_dot2c_f32_bf16 v7, s46, v43
    v_dot2c_f32_bf16 v9, v43, v43
    s_waitcnt vmcnt(17)
    v_dot2c_f32_bf16 v6, s46, v44
    v_dot2c_f32_bf16 v8, v44, v44
    v_dot2c_f32_bf16 v7, s46, v45
    v_dot2c_f32_bf16 v9, v45, v45
    s_mov_b32 m0, s40
    s_nop 0
    buffer_load_dwordx4 v90, s[52:55], s39 offen lds
    s_add_u32 s40, s40, 8192
    s_mov_b32 m0, s40
    s_nop 0
    buffer_load_dwordx4 v91, s[52:55], s39 offen lds
    s_add_u32 s40, s40, 8192
    v_dot2c_f32_bf16 v6, s46, v46
    v_dot2c_f32_bf16 v8, v46, v46
    v_dot2c_f32_bf16 v7, s46, v47
    v_dot2c_f32_bf16 v9, v47, v47
    s_waitcnt vmcnt(18)
    v_dot2c_f32_bf16 v6, s46, v48
    v_dot2c_f32_bf16 v8, v48, v48
    v_dot2c_f32_bf16 v7, s46, v49
    v_dot2c_f32_bf16 v9, v49, v49
    v_dot2c_f32_bf16 v6, s46, v50
    v_dot2c_f32_bf16 v8, v50, v50
    s_mov_b32 m0, s40
    s_nop 0
    buffer_load_dwordx4 v92, s[52:55], s39 offen lds
    v_dot2c_f32_bf16 v7, s46, v51
    v_dot2c_f32_bf16 v9, v51, v51
    s_waitcnt vmcnt(18)
    v_dot2c_f32_bf16 v6, s46, v52
    v_dot2c_f32_bf16 v8, v52, v52
    v_dot2c_f32_bf16 v7, s46, v53
    v_dot2c_f32_bf16 v9, v53, v53
    v_dot2c_f32_bf16 v6, s46, v54
    v_dot2c_f32_bf16 v8, v54, v54
    v_dot2c_f32_bf16 v7, s46, v55
    v_dot2c_f32_bf16 v9, v55, v55
    s_nop 1
    v_add_f32 v6, v6, v7
    v_add_f32 v8, v8, v9
    s_nop 0
    v_add_f32_dpp v6, v6, v6 row_ror:8 row_mask:0xf bank_mask:0xf
    v_add_f32_dpp v8, v8, v8 row_ror:8 row_mask:0xf bank_mask:0xf
    s_nop 0
    v_add_f32_dpp v6, v6, v6 row_ror:4 row_mask:0xf bank_mask:0xf
    v_add_f32_dpp v8, v8, v8 row_ror:4 row_mask:0xf bank_mask:0xf
    s_nop 0
    v_add_f32_dpp v6, v6, v6 row_ror:2 row_mask:0xf bank_mask:0xf
    v_add_f32_dpp v8, v8, v8 row_ror:2 row_mask:0xf bank_mask:0xf
    s_nop 0
    v_add_f32_dpp v6, v6, v6 row_ror:1 row_mask:0xf bank_mask:0xf
    v_add_f32_dpp v8, v8, v8 row_ror:1 row_mask:0xf bank_mask:0xf
    v_mul_f32 v6, 0x3acccccd, v6
    v_mov_b32 v10, 0x3727c5ac
    v_fmac_f32 v10, 0x3acccccd, v8
    v_fma_f32 v10, -v6, v6, v10
    v_max_f32 v10, 0x3727c5ac, v10
    v_rsq_f32 v10, v10
    s_nop 0
    v_mul_f32 v12, v6, v10
    v_sub_f32 v12, 0, v12
    v_lshlrev_b32 v14, 16, v36
    v_and_b32 v15, 0xffff0000, v36
    v_pk_fma_f32 v[14:15], v[14:15], v[10:11], v[12:13] op_sel_hi:[1,0,0]
    v_cvt_pk_f16_f32 v36, v14, v15
    v_lshlrev_b32 v6, 16, v37
    v_and_b32 v7, 0xffff0000, v37
    v_pk_fma_f32 v[6:7], v[6:7], v[10:11], v[12:13] op_sel_hi:[1,0,0]
    v_cvt_pk_f16_f32 v37, v6, v7
    v_lshlrev_b32 v14, 16, v38
    v_and_b32 v15, 0xffff0000, v38
    v_pk_fma_f32 v[14:15], v[14:15], v[10:11], v[12:13] op_sel_hi:[1,0,0]
    v_cvt_pk_f16_f32 v38, v14, v15
    v_lshlrev_b32 v6, 16, v39
    v_and_b32 v7, 0xffff0000, v39
    v_pk_fma_f32 v[6:7], v[6:7], v[10:11], v[12:13] op_sel_hi:[1,0,0]
    v_cvt_pk_f16_f32 v39, v6, v7
    v_lshlrev_b32 v14, 16, v40
    v_and_b32 v15, 0xffff0000, v40
    v_pk_fma_f32 v[14:15], v[14:15], v[10:11], v[12:13] op_sel_hi:[1,0,0]
    v_cvt_pk_f16_f32 v40, v14, v15
    v_lshlrev_b32 v6, 16, v41
    v_and_b32 v7, 0xffff0000, v41
    v_pk_fma_f32 v[6:7], v[6:7], v[10:11], v[12:13] op_sel_hi:[1,0,0]
    v_cvt_pk_f16_f32 v41, v6, v7
    v_lshlrev_b32 v14, 16, v42
    v_and_b32 v15, 0xffff0000, v42
    v_pk_fma_f32 v[14:15], v[14:15], v[10:11], v[12:13] op_sel_hi:[1,0,0]
    v_cvt_pk_f16_f32 v42, v14, v15
    v_lshlrev_b32 v6, 16, v43
    v_and_b32 v7, 0xffff0000, v43
    v_pk_fma_f32 v[6:7], v[6:7], v[10:11], v[12:13] op_sel_hi:[1,0,0]
    v_cvt_pk_f16_f32 v43, v6, v7
    v_lshlrev_b32 v14, 16, v44
    v_and_b32 v15, 0xffff0000, v44
    v_pk_fma_f32 v[14:15], v[14:15], v[10:11], v[12:13] op_sel_hi:[1,0,0]
    v_cvt_pk_f16_f32 v44, v14, v15
    v_lshlrev_b32 v6, 16, v45
    v_and_b32 v7, 0xffff0000, v45
    v_pk_fma_f32 v[6:7], v[6:7], v[10:11], v[12:13] op_sel_hi:[1,0,0]
    v_cvt_pk_f16_f32 v45, v6, v7
    v_lshlrev_b32 v14, 16, v46
    v_and_b32 v15, 0xffff0000, v46
    v_pk_fma_f32 v[14:15], v[14:15], v[10:11], v[12:13] op_sel_hi:[1,0,0]
    v_cvt_pk_f16_f32 v46, v14, v15
    v_lshlrev_b32 v6, 16, v47
    v_and_b32 v7, 0xffff0000, v47
    v_pk_fma_f32 v[6:7], v[6:7], v[10:11], v[12:13] op_sel_hi:[1,0,0]
    v_cvt_pk_f16_f32 v47, v6, v7
    v_lshlrev_b32 v14, 16, v48
    v_and_b32 v15, 0xffff0000, v48
    v_pk_fma_f32 v[14:15], v[14:15], v[10:11], v[12:13] op_sel_hi:[1,0,0]
    v_cvt_pk_f16_f32 v48, v14, v15
    v_lshlrev_b32 v6, 16, v49
    v_and_b32 v7, 0xffff0000, v49
    v_pk_fma_f32 v[6:7], v[6:7], v[10:11], v[12:13] op_sel_hi:[1,0,0]
    v_cvt_pk_f16_f32 v49, v6, v7
    v_lshlrev_b32 v14, 16, v50
    v_and_b32 v15, 0xffff0000, v50
    v_pk_fma_f32 v[14:15], v[14:15], v[10:11], v[12:13] op_sel_hi:[1,0,0]
    v_cvt_pk_f16_f32 v50, v14, v15
    v_lshlrev_b32 v6, 16, v51
    v_and_b32 v7, 0xffff0000, v51
    v_pk_fma_f32 v[6:7], v[6:7], v[10:11], v[12:13] op_sel_hi:[1,0,0]
    v_cvt_pk_f16_f32 v51, v6, v7
    v_lshlrev_b32 v14, 16, v52
    v_and_b32 v15, 0xffff0000, v52
    v_pk_fma_f32 v[14:15], v[14:15], v[10:11], v[12:13] op_sel_hi:[1,0,0]
    v_cvt_pk_f16_f32 v52, v14, v15
    v_lshlrev_b32 v6, 16, v53
    v_and_b32 v7, 0xffff0000, v53
    v_pk_fma_f32 v[6:7], v[6:7], v[10:11], v[12:13] op_sel_hi:[1,0,0]
    v_cvt_pk_f16_f32 v53, v6, v7
    v_lshlrev_b32 v14, 16, v54
    v_and_b32 v15, 0xffff0000, v54
    v_pk_fma_f32 v[14:15], v[14:15], v[10:11], v[12:13] op_sel_hi:[1,0,0]
    v_cvt_pk_f16_f32 v54, v14, v15
    v_lshlrev_b32 v6, 16, v55
    v_and_b32 v7, 0xffff0000, v55
    v_pk_fma_f32 v[6:7], v[6:7], v[10:11], v[12:13] op_sel_hi:[1,0,0]
    v_cvt_pk_f16_f32 v55, v6, v7
    s_cmp_lg_u32 s3, 0
    s_cbranch_scc1 adaLN_cond__grouped_kv_mqa__glu_gated_swiglu__prompt_kernel_w0_19
    v_mov_b32 v3, 0
    s_mov_b32 s44, 65536
adaLN_cond__grouped_kv_mqa__glu_gated_swiglu__prompt_kernel_nl_20:
    buffer_load_dword v2, v3, s[64:67], 0 offen sc1
    s_waitcnt vmcnt(0)
    v_readfirstlane_b32 s71, v2
    s_sub_u32 s44, s44, 1
    s_cmp_eq_u32 s44, 0
    s_cbranch_scc1 adaLN_cond__grouped_kv_mqa__glu_gated_swiglu__prompt_kernel_nd_21
    s_cmp_eq_u32 s71, 0
    s_cbranch_scc1 adaLN_cond__grouped_kv_mqa__glu_gated_swiglu__prompt_kernel_nl_20
adaLN_cond__grouped_kv_mqa__glu_gated_swiglu__prompt_kernel_nd_21:
adaLN_cond__grouped_kv_mqa__glu_gated_swiglu__prompt_kernel_w0_19:
    s_cmp_lg_u32 s3, 0
    s_cbranch_scc1 adaLN_cond__grouped_kv_mqa__glu_gated_swiglu__prompt_kernel_w0_22
    s_getreg_b32 s42, hwreg(HW_REG_XCC_ID, 0, 4)
    s_add_u32 s42, s42, 1
    s_add_u32 s42, s42, s71
    s_and_b32 s43, s2, 7
    s_lshl_b32 s43, s43, 7
    s_lshr_b32 s44, s2, 3
    s_lshl_b32 s44, s44, 2
    s_add_u32 s43, s43, s44
    s_add_u32 s43, s43, 40960
    v_mov_b32 v2, s42
    v_mov_b32 v3, 0
    s_mov_b64 exec, 1
    buffer_store_dword v2, v3, s[60:63], s43 offen sc1
    s_mov_b64 exec, -1
    v_mov_b32 v4, s71
    v_mov_b32 v5, 0
    v_mov_b32 v3, 153600
    ds_write_b64 v3, v[4:5]
adaLN_cond__grouped_kv_mqa__glu_gated_swiglu__prompt_kernel_w0_22:
adaLN_cond__grouped_kv_mqa__glu_gated_swiglu__prompt_kernel_both_5:
    s_waitcnt vmcnt(0)
    s_waitcnt lgkmcnt(0)
    s_barrier
    v_mov_b32 v2, 153600
    ds_read_b32 v2, v2
    s_waitcnt lgkmcnt(0)
    v_readfirstlane_b32 s71, v2
    s_add_u32 s56, s6, 655360
    s_addc_u32 s57, s7, 0
    s_mov_b32 s58, 40960
    s_mov_b32 s59, 0x00020000
    v_and_b32 v216, 255, v0
    v_lshrrev_b32 v219, 8, v0
    v_cmp_eq_u32 vcc, 0, v219
    v_mov_b32 v217, 156224
    v_mov_b32 v218, 153664
    v_cndmask_b32 v217, v217, v218, vcc
    v_lshl_add_u32 v217, v216, 4, v217
    v_mov_b32 v218, 5120
    v_cndmask_b32 v218, 0, v218, vcc
    v_lshl_add_u32 v218, v216, 5, v218
    v_cndmask_b32 v219, 0, 1.0, vcc
    v_cmp_gt_u32 vcc, 160, v216
    s_nop 0
    s_mov_b64 s[44:45], vcc
    s_mov_b64 exec, s[44:45]
    s_cbranch_execz adaLN_cond__grouped_kv_mqa__glu_gated_swiglu__prompt_kernel_ml1_23
    s_mov_b32 s42, 0
    buffer_load_dwordx4 v[224:227], v218, s[56:59], s42 offen sc1
    buffer_load_dwordx4 v[228:231], v218, s[56:59], s42 offen offset:16 sc1
    s_mov_b32 s42, 10240
    buffer_load_dwordx4 v[232:235], v218, s[56:59], s42 offen sc1
    buffer_load_dwordx4 v[236:239], v218, s[56:59], s42 offen offset:16 sc1
    s_mov_b32 s42, 20480
    buffer_load_dwordx4 v[240:243], v218, s[56:59], s42 offen sc1
    buffer_load_dwordx4 v[244:247], v218, s[56:59], s42 offen offset:16 sc1
    s_mov_b32 s42, 30720
    buffer_load_dwordx4 v[248:251], v218, s[56:59], s42 offen sc1
    buffer_load_dwordx4 v[252:255], v218, s[56:59], s42 offen offset:16 sc1
adaLN_cond__grouped_kv_mqa__glu_gated_swiglu__prompt_kernel_ml1_23:
    s_mov_b64 exec, -1
    v_lshrrev_b32 v2, 5, v1
    v_lshlrev_b32 v2, 3, v2
    v_bfe_u32 v3, v1, 2, 2
    v_add_u32 v2, v2, v3
    v_mul_u32_u24 v2, 192, v2
    v_bfe_u32 v3, v1, 4, 1
    v_lshl_add_u32 v2, v3, 5, v2
    v_and_b32 v3, 3, v1
    v_lshl_add_u32 v2, v3, 3, v2
    s_lshr_b32 s42, s3, 1
    s_mul_i32 s42, s42, 40
    v_add_u32 v2, s42, v2
    v_add_u32 v3, 61440, v2
    ds_read_b64_tr_b16 v[56:57], v2 offset:0
    ds_read_b64_tr_b16 v[58:59], v2 offset:768
    ds_read_b64_tr_b16 v[60:61], v2 offset:3072
    ds_read_b64_tr_b16 v[62:63], v2 offset:3840
    ds_read_b64_tr_b16 v[64:65], v2 offset:6144
    ds_read_b64_tr_b16 v[66:67], v2 offset:6912
    ds_read_b64_tr_b16 v[68:69], v2 offset:9216
    ds_read_b64_tr_b16 v[70:71], v2 offset:9984
    ds_read_b64_tr_b16 v[72:73], v2 offset:12288
    ds_read_b64_tr_b16 v[74:75], v2 offset:13056
    ds_read_b64_tr_b16 v[76:77], v2 offset:15360
    ds_read_b64_tr_b16 v[78:79], v2 offset:16128
    ds_read_b64_tr_b16 v[80:81], v2 offset:18432
    ds_read_b64_tr_b16 v[82:83], v2 offset:19200
    ds_read_b64_tr_b16 v[84:85], v2 offset:21504
    ds_read_b64_tr_b16 v[86:87], v2 offset:22272
    ds_read_b64_tr_b16 v[88:89], v2 offset:24576
    ds_read_b64_tr_b16 v[90:91], v2 offset:25344
    ds_read_b64_tr_b16 v[92:93], v2 offset:27648
    ds_read_b64_tr_b16 v[94:95], v2 offset:28416
    ds_read_b64_tr_b16 v[96:97], v2 offset:30720
    ds_read_b64_tr_b16 v[98:99], v2 offset:31488
    ds_read_b64_tr_b16 v[100:101], v2 offset:33792
    ds_read_b64_tr_b16 v[102:103], v2 offset:34560
    ds_read_b64_tr_b16 v[104:105], v2 offset:36864
    ds_read_b64_tr_b16 v[106:107], v2 offset:37632
    ds_read_b64_tr_b16 v[108:109], v2 offset:39936
    ds_read_b64_tr_b16 v[110:111], v2 offset:40704
    ds_read_b64_tr_b16 v[112:113], v2 offset:43008
    ds_read_b64_tr_b16 v[114:115], v2 offset:43776
    ds_read_b64_tr_b16 v[116:117], v2 offset:46080
    ds_read_b64_tr_b16 v[118:119], v2 offset:46848
    ds_read_b64_tr_b16 v[120:121], v2 offset:49152
    ds_read_b64_tr_b16 v[122:123], v2 offset:49920
    ds_read_b64_tr_b16 v[124:125], v2 offset:52224
    ds_read_b64_tr_b16 v[126:127], v2 offset:52992
    ds_read_b64_tr_b16 v[128:129], v2 offset:55296
    ds_read_b64_tr_b16 v[130:131], v2 offset:56064
    ds_read_b64_tr_b16 v[132:133], v2 offset:58368
    ds_read_b64_tr_b16 v[134:135], v2 offset:59136
    ds_read_b64_tr_b16 v[136:137], v3 offset:0
    ds_read_b64_tr_b16 v[138:139], v3 offset:768
    ds_read_b64_tr_b16 v[140:141], v3 offset:3072
    ds_read_b64_tr_b16 v[142:143], v3 offset:3840
    ds_read_b64_tr_b16 v[144:145], v3 offset:6144
    ds_read_b64_tr_b16 v[146:147], v3 offset:6912
    ds_read_b64_tr_b16 v[148:149], v3 offset:9216
    ds_read_b64_tr_b16 v[150:151], v3 offset:9984
    ds_read_b64_tr_b16 v[152:153], v3 offset:12288
    ds_read_b64_tr_b16 v[154:155], v3 offset:13056
    ds_read_b64_tr_b16 v[156:157], v3 offset:15360
    ds_read_b64_tr_b16 v[158:159], v3 offset:16128
    ds_read_b64_tr_b16 v[160:161], v3 offset:18432
    ds_read_b64_tr_b16 v[162:163], v3 offset:19200
    ds_read_b64_tr_b16 v[164:165], v3 offset:21504
    ds_read_b64_tr_b16 v[166:167], v3 offset:22272
    ds_read_b64_tr_b16 v[168:169], v3 offset:24576
    ds_read_b64_tr_b16 v[170:171], v3 offset:25344
    ds_read_b64_tr_b16 v[172:173], v3 offset:27648
    ds_read_b64_tr_b16 v[174:175], v3 offset:28416
    ds_read_b64_tr_b16 v[176:177], v3 offset:30720
    ds_read_b64_tr_b16 v[178:179], v3 offset:31488
    ds_read_b64_tr_b16 v[180:181], v3 offset:33792
    ds_read_b64_tr_b16 v[182:183], v3 offset:34560
    ds_read_b64_tr_b16 v[184:185], v3 offset:36864
    ds_read_b64_tr_b16 v[186:187], v3 offset:37632
    ds_read_b64_tr_b16 v[188:189], v3 offset:39936
    ds_read_b64_tr_b16 v[190:191], v3 offset:40704
    ds_read_b64_tr_b16 v[192:193], v3 offset:43008
    ds_read_b64_tr_b16 v[194:195], v3 offset:43776
    ds_read_b64_tr_b16 v[196:197], v3 offset:46080
    ds_read_b64_tr_b16 v[198:199], v3 offset:46848
    ds_read_b64_tr_b16 v[200:201], v3 offset:49152
    ds_read_b64_tr_b16 v[202:203], v3 offset:49920
    ds_read_b64_tr_b16 v[204:205], v3 offset:52224
    ds_read_b64_tr_b16 v[206:207], v3 offset:52992
    ds_read_b64_tr_b16 v[208:209], v3 offset:55296
    ds_read_b64_tr_b16 v[210:211], v3 offset:56064
    ds_read_b64_tr_b16 v[212:213], v3 offset:58368
    ds_read_b64_tr_b16 v[214:215], v3 offset:59136
    s_mov_b64 exec, s[44:45]
    s_cbranch_execz adaLN_cond__grouped_kv_mqa__glu_gated_swiglu__prompt_kernel_mp_skip_24
    s_mov_b32 s43, 65536
adaLN_cond__grouped_kv_mqa__glu_gated_swiglu__prompt_kernel_mp_poll_25:
    s_waitcnt vmcnt(7)
    v_xor_b32 v220, s71, v225
    v_xor_b32 v221, s71, v227
    v_or_b32 v220, v220, v221
    s_waitcnt vmcnt(6)
    v_xor_b32 v221, s71, v229
    v_or_b32 v220, v220, v221
    v_xor_b32 v221, s71, v231
    v_or_b32 v220, v220, v221
    s_waitcnt vmcnt(5)
    v_xor_b32 v221, s71, v233
    v_or_b32 v220, v220, v221
    v_xor_b32 v221, s71, v235
    v_or_b32 v220, v220, v221
    s_waitcnt vmcnt(4)
    v_xor_b32 v221, s71, v237
    v_or_b32 v220, v220, v221
    v_xor_b32 v221, s71, v239
    v_or_b32 v220, v220, v221
    s_waitcnt vmcnt(3)
    v_xor_b32 v221, s71, v241
    v_or_b32 v220, v220, v221
    v_xor_b32 v221, s71, v243
    v_or_b32 v220, v220, v221
    s_waitcnt vmcnt(2)
    v_xor_b32 v221, s71, v245
    v_or_b32 v220, v220, v221
    v_xor_b32 v221, s71, v247
    v_or_b32 v220, v220, v221
    s_waitcnt vmcnt(1)
    v_xor_b32 v221, s71, v249
    v_or_b32 v220, v220, v221
    v_xor_b32 v221, s71, v251
    v_or_b32 v220, v220, v221
    s_waitcnt vmcnt(0)
    v_xor_b32 v221, s71, v253
    v_or_b32 v220, v220, v221
    v_xor_b32 v221, s71, v255
    v_or_b32 v220, v220, v221
    v_cmp_ne_u32 vcc, 0, v220
    s_nop 0
    s_cbranch_vccz adaLN_cond__grouped_kv_mqa__glu_gated_swiglu__prompt_kernel_mp_done_26
    s_sub_u32 s43, s43, 1
    s_cmp_eq_u32 s43, 0
    s_cbranch_scc1 adaLN_cond__grouped_kv_mqa__glu_gated_swiglu__prompt_kernel_mp_done_26
    s_mov_b32 s42, 0
    buffer_load_dwordx4 v[224:227], v218, s[56:59], s42 offen sc1
    buffer_load_dwordx4 v[228:231], v218, s[56:59], s42 offen offset:16 sc1
    s_mov_b32 s42, 10240
    buffer_load_dwordx4 v[232:235], v218, s[56:59], s42 offen sc1
    buffer_load_dwordx4 v[236:239], v218, s[56:59], s42 offen offset:16 sc1
    s_mov_b32 s42, 20480
    buffer_load_dwordx4 v[240:243], v218, s[56:59], s42 offen sc1
    buffer_load_dwordx4 v[244:247], v218, s[56:59], s42 offen offset:16 sc1
    s_mov_b32 s42, 30720
    buffer_load_dwordx4 v[248:251], v218, s[56:59], s42 offen sc1
    buffer_load_dwordx4 v[252:255], v218, s[56:59], s42 offen offset:16 sc1
    s_branch adaLN_cond__grouped_kv_mqa__glu_gated_swiglu__prompt_kernel_mp_poll_25
adaLN_cond__grouped_kv_mqa__glu_gated_swiglu__prompt_kernel_mp_done_26:
    v_add_f32 v224, v224, v232
    v_add_f32 v240, v240, v248
    v_add_f32 v224, v224, v240
    v_cvt_pk_bf16_f32 v224, v224, v224
    v_lshlrev_b32 v224, 16, v224
    v_add_f32 v224, v224, v219
    v_cvt_pk_bf16_f32 v232, v224, v224
    v_lshlrev_b32 v232, 16, v232
    v_add_f32 v226, v226, v234
    v_add_f32 v242, v242, v250
    v_add_f32 v226, v226, v242
    v_cvt_pk_bf16_f32 v226, v226, v226
    v_lshlrev_b32 v226, 16, v226
    v_add_f32 v226, v226, v219
    v_cvt_pk_bf16_f32 v233, v226, v226
    v_lshlrev_b32 v233, 16, v233
    v_add_f32 v228, v228, v236
    v_add_f32 v244, v244, v252
    v_add_f32 v228, v228, v244
    v_cvt_pk_bf16_f32 v228, v228, v228
    v_lshlrev_b32 v228, 16, v228
    v_add_f32 v228, v228, v219
    v_cvt_pk_bf16_f32 v234, v228, v228
    v_lshlrev_b32 v234, 16, v234
    v_add_f32 v230, v230, v238
    v_add_f32 v246, v246, v254
    v_add_f32 v230, v230, v246
    v_cvt_pk_bf16_f32 v230, v230, v230
    v_lshlrev_b32 v230, 16, v230
    v_add_f32 v230, v230, v219
    v_cvt_pk_bf16_f32 v235, v230, v230
    v_lshlrev_b32 v235, 16, v235
    ds_write_b128 v217, v[232:235]
adaLN_cond__grouped_kv_mqa__glu_gated_swiglu__prompt_kernel_mp_skip_24:
    s_mov_b64 exec, -1
    v_lshrrev_b32 v4, 4, v1
    v_lshlrev_b32 v4, 3, v4
    v_bfe_u32 v5, v1, 2, 2
    v_add_u32 v4, v4, v5
    s_lshr_b32 s42, s3, 1
    s_lshl_b32 s42, s42, 5
    v_add_u32 v4, s42, v4
    v_mul_u32_u24 v4, 40, v4
    v_and_b32 v5, 3, v1
    v_lshl_add_u32 v4, v5, 3, v4
    s_and_b32 s42, s3, 1
    s_lshl_b32 s42, s42, 5
    s_add_u32 s42, s42, 122880
    v_add_u32 v4, s42, v4
    ds_read_b64_tr_b16 v[216:217], v4 offset:0
    ds_read_b64_tr_b16 v[218:219], v4 offset:160
    ds_read_b64_tr_b16 v[220:221], v4 offset:5120
    ds_read_b64_tr_b16 v[222:223], v4 offset:5280
    s_waitcnt vmcnt(7)
    ds_read_b64_tr_b16 v[224:225], v4 offset:10240
    ds_read_b64_tr_b16 v[226:227], v4 offset:10400
    s_waitcnt vmcnt(6)
    ds_read_b64_tr_b16 v[228:229], v4 offset:15360
    ds_read_b64_tr_b16 v[230:231], v4 offset:15520
    s_waitcnt vmcnt(5)
    ds_read_b64_tr_b16 v[232:233], v4 offset:20480
    ds_read_b64_tr_b16 v[234:235], v4 offset:20640
    v_and_b32 v2, 15, v1
    v_lshlrev_b32 v2, 5, v2
    v_add_u32 v2, 153664, v2
    v_lshrrev_b32 v6, 4, v1
    s_lshl_b32 s42, s3, 2
    v_add_u32 v6, s42, v6
    s_lshl_b32 s42, s49, 5
    v_add_u32 v3, s42, v6
    s_xor_b32 s42, s42, 32
    v_add_u32 v4, s42, v6
    v_and_b32 v7, 7, v1
    v_xor_b32 v3, v3, v7
    v_xor_b32 v4, v4, v7
    v_and_b32 v7, 15, v1
    v_lshlrev_b32 v7, 10, v7
    v_add_u32 v7, 0, v7
    v_lshl_add_u32 v3, v3, 4, v7
    v_lshl_add_u32 v4, v4, 4, v7
    s_waitcnt lgkmcnt(0)
    s_barrier
    s_waitcnt vmcnt(4)
    ds_read_b128 v[236:239], v2 offset:0
    s_waitcnt vmcnt(3)
    ds_read_b128 v[240:243], v2 offset:2560
    s_waitcnt vmcnt(2)
    ds_read_b128 v[244:247], v2 offset:16
    s_waitcnt vmcnt(1)
    ds_read_b128 v[248:251], v2 offset:2576
    ds_read_b128 v[6:9], v2 offset:512
    ds_read_b128 v[10:13], v2 offset:3072
    s_waitcnt lgkmcnt(4)
    v_fma_mix_f32 v236, v16, v236, v240 op_sel_hi:[1,0,0]
    v_fma_mix_f32 v237, v16, v237, v241 op_sel:[1,0,0] op_sel_hi:[1,0,0]
    v_fma_mix_f32 v238, v17, v238, v242 op_sel_hi:[1,0,0]
    v_fma_mix_f32 v239, v17, v239, v243 op_sel:[1,0,0] op_sel_hi:[1,0,0]
    v_cvt_pk_bf16_f32 v16, v236, v237
    v_cvt_pk_bf16_f32 v17, v238, v239
    ds_read_b128 v[236:239], v2 offset:528
    ds_read_b128 v[240:243], v2 offset:3088
    s_waitcnt lgkmcnt(4)
    v_fma_mix_f32 v244, v18, v244, v248 op_sel_hi:[1,0,0]
    v_fma_mix_f32 v245, v18, v245, v249 op_sel:[1,0,0] op_sel_hi:[1,0,0]
    v_fma_mix_f32 v246, v19, v246, v250 op_sel_hi:[1,0,0]
    v_fma_mix_f32 v247, v19, v247, v251 op_sel:[1,0,0] op_sel_hi:[1,0,0]
    v_cvt_pk_bf16_f32 v18, v244, v245
    v_cvt_pk_bf16_f32 v19, v246, v247
    ds_read_b128 v[244:247], v2 offset:1024
    ds_read_b128 v[248:251], v2 offset:3584
    s_waitcnt lgkmcnt(4)
    v_fma_mix_f32 v6, v20, v6, v10 op_sel_hi:[1,0,0]
    v_fma_mix_f32 v7, v20, v7, v11 op_sel:[1,0,0] op_sel_hi:[1,0,0]
    v_fma_mix_f32 v8, v21, v8, v12 op_sel_hi:[1,0,0]
    v_fma_mix_f32 v9, v21, v9, v13 op_sel:[1,0,0] op_sel_hi:[1,0,0]
    v_cvt_pk_bf16_f32 v20, v6, v7
    v_cvt_pk_bf16_f32 v21, v8, v9
    ds_read_b128 v[6:9], v2 offset:1040
    ds_read_b128 v[10:13], v2 offset:3600
    s_waitcnt lgkmcnt(4)
    v_fma_mix_f32 v236, v22, v236, v240 op_sel_hi:[1,0,0]
    v_fma_mix_f32 v237, v22, v237, v241 op_sel:[1,0,0] op_sel_hi:[1,0,0]
    v_fma_mix_f32 v238, v23, v238, v242 op_sel_hi:[1,0,0]
    v_fma_mix_f32 v239, v23, v239, v243 op_sel:[1,0,0] op_sel_hi:[1,0,0]
    v_cvt_pk_bf16_f32 v22, v236, v237
    v_cvt_pk_bf16_f32 v23, v238, v239
    ds_read_b128 v[236:239], v2 offset:1536
    ds_read_b128 v[240:243], v2 offset:4096
    s_waitcnt lgkmcnt(4)
    v_fma_mix_f32 v244, v24, v244, v248 op_sel_hi:[1,0,0]
    v_fma_mix_f32 v245, v24, v245, v249 op_sel:[1,0,0] op_sel_hi:[1,0,0]
    v_fma_mix_f32 v246, v25, v246, v250 op_sel_hi:[1,0,0]
    v_fma_mix_f32 v247, v25, v247, v251 op_sel:[1,0,0] op_sel_hi:[1,0,0]
    v_cvt_pk_bf16_f32 v24, v244, v245
    v_cvt_pk_bf16_f32 v25, v246, v247
    ds_read_b128 v[244:247], v2 offset:1552
    ds_read_b128 v[248:251], v2 offset:4112
    s_waitcnt lgkmcnt(4)
    v_fma_mix_f32 v6, v26, v6, v10 op_sel_hi:[1,0,0]
    v_fma_mix_f32 v7, v26, v7, v11 op_sel:[1,0,0] op_sel_hi:[1,0,0]
    v_fma_mix_f32 v8, v27, v8, v12 op_sel_hi:[1,0,0]
    v_fma_mix_f32 v9, v27, v9, v13 op_sel:[1,0,0] op_sel_hi:[1,0,0]
    v_cvt_pk_bf16_f32 v26, v6, v7
    v_cvt_pk_bf16_f32 v27, v8, v9
    ds_read_b128 v[6:9], v2 offset:2048
    ds_read_b128 v[10:13], v2 offset:4608
    s_waitcnt lgkmcnt(4)
    v_fma_mix_f32 v236, v28, v236, v240 op_sel_hi:[1,0,0]
    v_fma_mix_f32 v237, v28, v237, v241 op_sel:[1,0,0] op_sel_hi:[1,0,0]
    v_fma_mix_f32 v238, v29, v238, v242 op_sel_hi:[1,0,0]
    v_fma_mix_f32 v239, v29, v239, v243 op_sel:[1,0,0] op_sel_hi:[1,0,0]
    v_cvt_pk_bf16_f32 v28, v236, v237
    v_cvt_pk_bf16_f32 v29, v238, v239
    ds_read_b128 v[236:239], v2 offset:2064
    ds_read_b128 v[240:243], v2 offset:4624
    s_waitcnt lgkmcnt(4)
    v_fma_mix_f32 v244, v30, v244, v248 op_sel_hi:[1,0,0]
    v_fma_mix_f32 v245, v30, v245, v249 op_sel:[1,0,0] op_sel_hi:[1,0,0]
    v_fma_mix_f32 v246, v31, v246, v250 op_sel_hi:[1,0,0]
    v_fma_mix_f32 v247, v31, v247, v251 op_sel:[1,0,0] op_sel_hi:[1,0,0]
    v_cvt_pk_bf16_f32 v30, v244, v245
    v_cvt_pk_bf16_f32 v31, v246, v247
    s_waitcnt lgkmcnt(2)
    v_fma_mix_f32 v6, v32, v6, v10 op_sel_hi:[1,0,0]
    v_fma_mix_f32 v7, v32, v7, v11 op_sel:[1,0,0] op_sel_hi:[1,0,0]
    v_fma_mix_f32 v8, v33, v8, v12 op_sel_hi:[1,0,0]
    v_fma_mix_f32 v9, v33, v9, v13 op_sel:[1,0,0] op_sel_hi:[1,0,0]
    v_cvt_pk_bf16_f32 v32, v6, v7
    v_cvt_pk_bf16_f32 v33, v8, v9
    s_waitcnt lgkmcnt(0)
    v_fma_mix_f32 v236, v34, v236, v240 op_sel_hi:[1,0,0]
    v_fma_mix_f32 v237, v34, v237, v241 op_sel:[1,0,0] op_sel_hi:[1,0,0]
    v_fma_mix_f32 v238, v35, v238, v242 op_sel_hi:[1,0,0]
    v_fma_mix_f32 v239, v35, v239, v243 op_sel:[1,0,0] op_sel_hi:[1,0,0]
    v_cvt_pk_bf16_f32 v34, v236, v237
    v_cvt_pk_bf16_f32 v35, v238, v239
    ds_write_b128 v3, v[16:19] offset:0
    ds_write_b128 v3, v[20:23] offset:16384
    ds_write_b128 v3, v[24:27] offset:32768
    ds_write_b128 v3, v[28:31] offset:49152
    v_add_u32 v15, 65536, v3
    ds_write_b128 v15, v[32:35] offset:0
    s_waitcnt lgkmcnt(0)
    s_barrier
    v_lshrrev_b32 v5, 4, v1
    s_lshr_b32 s42, s3, 1
    s_and_b32 s43, s42, 1
    s_lshl_b32 s43, s43, 2
    v_add_u32 v6, s43, v5
    v_and_b32 v7, 15, v1
    s_lshl_b32 s43, s51, 4
    v_add_u32 v7, s43, v7
    v_xor_b32 v6, v6, v7
    s_lshl_b32 s42, s42, 2
    v_add_u32 v5, s42, v5
    v_lshlrev_b32 v5, 10, v5
    v_lshl_add_u32 v5, v6, 4, v5
    v_add_u32 v5, 0, v5
    v_add_u32 v6, 49152, v5
    ds_read_b128 v[236:239], v5 offset:0
    ds_read_b128 v[240:243], v5 offset:16384
    ds_read_b128 v[244:247], v5 offset:32768
    ds_read_b128 v[248:251], v6 offset:0
    s_waitcnt vmcnt(0)
    ds_read_b128 v[252:255], v6 offset:16384
    s_cmp_eq_u32 s50, 1
    s_cbranch_scc1 adaLN_cond__grouped_kv_mqa__glu_gated_swiglu__prompt_kernel_kv_v_28
    s_waitcnt lgkmcnt(4)
    v_mfma_f32_16x16x32_bf16 v[12:15], v[216:219], v[236:239], 0
    s_waitcnt lgkmcnt(3)
    v_mfma_f32_16x16x32_bf16 v[12:15], v[220:223], v[240:243], v[12:15]
    s_waitcnt lgkmcnt(2)
    v_mfma_f32_16x16x32_bf16 v[12:15], v[224:227], v[244:247], v[12:15]
    s_waitcnt lgkmcnt(1)
    v_mfma_f32_16x16x32_bf16 v[12:15], v[228:231], v[248:251], v[12:15]
    s_waitcnt lgkmcnt(0)
    v_mfma_f32_16x16x32_bf16 v[12:15], v[232:235], v[252:255], v[12:15]
    s_branch adaLN_cond__grouped_kv_mqa__glu_gated_swiglu__prompt_kernel_kv_j_29
adaLN_cond__grouped_kv_mqa__glu_gated_swiglu__prompt_kernel_kv_v_28:
    s_waitcnt lgkmcnt(4)
    v_mfma_f32_16x16x32_bf16 v[12:15], v[236:239], v[216:219], 0
    s_waitcnt lgkmcnt(3)
    v_mfma_f32_16x16x32_bf16 v[12:15], v[240:243], v[220:223], v[12:15]
    s_waitcnt lgkmcnt(2)
    v_mfma_f32_16x16x32_bf16 v[12:15], v[244:247], v[224:227], v[12:15]
    s_waitcnt lgkmcnt(1)
    v_mfma_f32_16x16x32_bf16 v[12:15], v[248:251], v[228:231], v[12:15]
    s_waitcnt lgkmcnt(0)
    v_mfma_f32_16x16x32_bf16 v[12:15], v[252:255], v[232:235], v[12:15]
adaLN_cond__grouped_kv_mqa__glu_gated_swiglu__prompt_kernel_kv_j_29:
    v_lshlrev_b32 v5, 4, v1
    s_lshl_b32 s42, s3, 10
    v_add_u32 v5, s42, v5
    v_add_u32 v5, 81920, v5
    s_nop 3
    ds_write_b128 v5, v[12:15]
    s_waitcnt lgkmcnt(0)
    s_barrier
    s_cmp_ge_u32 s3, 2
    s_cbranch_scc1 adaLN_cond__grouped_kv_mqa__glu_gated_swiglu__prompt_kernel_kv_fin_30
    v_lshlrev_b32 v5, 4, v1
    s_lshl_b32 s42, s3, 10
    v_add_u32 v5, s42, v5
    v_add_u32 v5, 81920, v5
    ds_read_b128 v[236:239], v5 offset:0
    ds_read_b128 v[240:243], v5 offset:2048
    ds_read_b128 v[244:247], v5 offset:4096
    ds_read_b128 v[248:251], v5 offset:6144
    s_lshl_b32 s42, s51, 4
    s_add_u32 s42, s42, s36
    s_lshr_b32 s42, s42, 5
    s_mul_i32 s42, s42, 2560
    s_and_b32 s43, s51, 1
    v_and_b32 v6, 15, v1
    v_lshrrev_b32 v7, 4, v1
    v_and_b32 v8, 1, v7
    v_lshrrev_b32 v9, 1, v7
    s_waitcnt lgkmcnt(2)
    v_add_f32 v236, v236, v240
    s_waitcnt lgkmcnt(0)
    v_add_f32 v244, v244, v248
    v_add_f32 v236, v236, v244
    v_add_f32 v237, v237, v241
    v_add_f32 v245, v245, v249
    v_add_f32 v237, v237, v245
    v_add_f32 v238, v238, v242
    v_add_f32 v246, v246, v250
    v_add_f32 v238, v238, v246
    v_add_f32 v239, v239, v243
    v_add_f32 v247, v247, v251
    v_add_f32 v239, v239, v247
    v_cvt_pk_bf16_f32 v10, v236, v237
    v_cvt_pk_bf16_f32 v11, v238, v239
    s_cmp_eq_u32 s50, 1
    s_cbranch_scc1 adaLN_cond__grouped_kv_mqa__glu_gated_swiglu__prompt_kernel_kv_sv_31
    s_lshl_b32 s44, s43, 4
    v_add_u32 v6, s44, v6
    s_cmp_eq_u32 s3, 1
    s_cbranch_scc1 adaLN_cond__grouped_kv_mqa__glu_gated_swiglu__prompt_kernel_kv_k1_32
    v_lshl_add_u32 v8, v8, 5, v6
    v_lshlrev_b32 v8, 4, v8
    v_lshl_add_u32 v8, v9, 3, v8
    buffer_store_dwordx2 v[10:11], v8, s[24:27], s42 offen sc1
    s_branch adaLN_cond__grouped_kv_mqa__glu_gated_swiglu__prompt_kernel_kv_sd_33
adaLN_cond__grouped_kv_mqa__glu_gated_swiglu__prompt_kernel_kv_k1_32:
    v_lshlrev_b32 v6, 3, v6
    s_mov_b64 exec, 0xffff
    buffer_store_dwordx2 v[10:11], v6, s[24:27], s42 offen offset:1024 sc1
    s_mov_b64 exec, -1
    s_branch adaLN_cond__grouped_kv_mqa__glu_gated_swiglu__prompt_kernel_kv_sd_33
adaLN_cond__grouped_kv_mqa__glu_gated_swiglu__prompt_kernel_kv_sv_31:
    s_lshl_b32 s44, s3, 4
    v_add_u32 v6, s44, v6
    s_lshl_b32 s43, s43, 1
    v_add_u32 v8, s43, v8
    v_mul_u32_u24 v8, 20, v8
    v_add_u32 v8, v8, v6
    v_lshlrev_b32 v8, 4, v8
    v_lshl_add_u32 v8, v9, 3, v8
    v_cmp_gt_u32 vcc, 20, v6
    s_nop 0
    s_and_saveexec_b64 s[44:45], vcc
    buffer_store_dwordx2 v[10:11], v8, s[24:27], s42 offen offset:1280 sc1
    s_mov_b64 exec, -1
adaLN_cond__grouped_kv_mqa__glu_gated_swiglu__prompt_kernel_kv_sd_33:
adaLN_cond__grouped_kv_mqa__glu_gated_swiglu__prompt_kernel_kv_fin_30:
    ds_read_b128 v[236:239], v2 offset:0
    ds_read_b128 v[240:243], v2 offset:2560
    ds_read_b128 v[244:247], v2 offset:16
    ds_read_b128 v[248:251], v2 offset:2576
    ds_read_b128 v[6:9], v2 offset:512
    ds_read_b128 v[10:13], v2 offset:3072
    s_waitcnt lgkmcnt(4)
    v_fma_mix_f32 v236, v36, v236, v240 op_sel_hi:[1,0,0]
    v_fma_mix_f32 v237, v36, v237, v241 op_sel:[1,0,0] op_sel_hi:[1,0,0]
    v_fma_mix_f32 v238, v37, v238, v242 op_sel_hi:[1,0,0]
    v_fma_mix_f32 v239, v37, v239, v243 op_sel:[1,0,0] op_sel_hi:[1,0,0]
    v_cvt_pk_bf16_f32 v36, v236, v237
    v_cvt_pk_bf16_f32 v37, v238, v239
    ds_read_b128 v[236:239], v2 offset:528
    ds_read_b128 v[240:243], v2 offset:3088
    s_waitcnt lgkmcnt(4)
    v_fma_mix_f32 v244, v38, v244, v248 op_sel_hi:[1,0,0]
    v_fma_mix_f32 v245, v38, v245, v249 op_sel:[1,0,0] op_sel_hi:[1,0,0]
    v_fma_mix_f32 v246, v39, v246, v250 op_sel_hi:[1,0,0]
    v_fma_mix_f32 v247, v39, v247, v251 op_sel:[1,0,0] op_sel_hi:[1,0,0]
    v_cvt_pk_bf16_f32 v38, v244, v245
    v_cvt_pk_bf16_f32 v39, v246, v247
    ds_read_b128 v[244:247], v2 offset:1024
    ds_read_b128 v[248:251], v2 offset:3584
    s_waitcnt lgkmcnt(4)
    v_fma_mix_f32 v6, v40, v6, v10 op_sel_hi:[1,0,0]
    v_fma_mix_f32 v7, v40, v7, v11 op_sel:[1,0,0] op_sel_hi:[1,0,0]
    v_fma_mix_f32 v8, v41, v8, v12 op_sel_hi:[1,0,0]
    v_fma_mix_f32 v9, v41, v9, v13 op_sel:[1,0,0] op_sel_hi:[1,0,0]
    v_cvt_pk_bf16_f32 v40, v6, v7
    v_cvt_pk_bf16_f32 v41, v8, v9
    ds_read_b128 v[6:9], v2 offset:1040
    ds_read_b128 v[10:13], v2 offset:3600
    s_waitcnt lgkmcnt(4)
    v_fma_mix_f32 v236, v42, v236, v240 op_sel_hi:[1,0,0]
    v_fma_mix_f32 v237, v42, v237, v241 op_sel:[1,0,0] op_sel_hi:[1,0,0]
    v_fma_mix_f32 v238, v43, v238, v242 op_sel_hi:[1,0,0]
    v_fma_mix_f32 v239, v43, v239, v243 op_sel:[1,0,0] op_sel_hi:[1,0,0]
    v_cvt_pk_bf16_f32 v42, v236, v237
    v_cvt_pk_bf16_f32 v43, v238, v239
    ds_read_b128 v[236:239], v2 offset:1536
    ds_read_b128 v[240:243], v2 offset:4096
    s_waitcnt lgkmcnt(4)
    v_fma_mix_f32 v244, v44, v244, v248 op_sel_hi:[1,0,0]
    v_fma_mix_f32 v245, v44, v245, v249 op_sel:[1,0,0] op_sel_hi:[1,0,0]
    v_fma_mix_f32 v246, v45, v246, v250 op_sel_hi:[1,0,0]
    v_fma_mix_f32 v247, v45, v247, v251 op_sel:[1,0,0] op_sel_hi:[1,0,0]
    v_cvt_pk_bf16_f32 v44, v244, v245
    v_cvt_pk_bf16_f32 v45, v246, v247
    ds_read_b128 v[244:247], v2 offset:1552
    ds_read_b128 v[248:251], v2 offset:4112
    s_waitcnt lgkmcnt(4)
    v_fma_mix_f32 v6, v46, v6, v10 op_sel_hi:[1,0,0]
    v_fma_mix_f32 v7, v46, v7, v11 op_sel:[1,0,0] op_sel_hi:[1,0,0]
    v_fma_mix_f32 v8, v47, v8, v12 op_sel_hi:[1,0,0]
    v_fma_mix_f32 v9, v47, v9, v13 op_sel:[1,0,0] op_sel_hi:[1,0,0]
    v_cvt_pk_bf16_f32 v46, v6, v7
    v_cvt_pk_bf16_f32 v47, v8, v9
    ds_read_b128 v[6:9], v2 offset:2048
    ds_read_b128 v[10:13], v2 offset:4608
    s_waitcnt lgkmcnt(4)
    v_fma_mix_f32 v236, v48, v236, v240 op_sel_hi:[1,0,0]
    v_fma_mix_f32 v237, v48, v237, v241 op_sel:[1,0,0] op_sel_hi:[1,0,0]
    v_fma_mix_f32 v238, v49, v238, v242 op_sel_hi:[1,0,0]
    v_fma_mix_f32 v239, v49, v239, v243 op_sel:[1,0,0] op_sel_hi:[1,0,0]
    v_cvt_pk_bf16_f32 v48, v236, v237
    v_cvt_pk_bf16_f32 v49, v238, v239
    ds_read_b128 v[236:239], v2 offset:2064
    ds_read_b128 v[240:243], v2 offset:4624
    s_waitcnt lgkmcnt(4)
    v_fma_mix_f32 v244, v50, v244, v248 op_sel_hi:[1,0,0]
    v_fma_mix_f32 v245, v50, v245, v249 op_sel:[1,0,0] op_sel_hi:[1,0,0]
    v_fma_mix_f32 v246, v51, v246, v250 op_sel_hi:[1,0,0]
    v_fma_mix_f32 v247, v51, v247, v251 op_sel:[1,0,0] op_sel_hi:[1,0,0]
    v_cvt_pk_bf16_f32 v50, v244, v245
    v_cvt_pk_bf16_f32 v51, v246, v247
    s_waitcnt lgkmcnt(2)
    v_fma_mix_f32 v6, v52, v6, v10 op_sel_hi:[1,0,0]
    v_fma_mix_f32 v7, v52, v7, v11 op_sel:[1,0,0] op_sel_hi:[1,0,0]
    v_fma_mix_f32 v8, v53, v8, v12 op_sel_hi:[1,0,0]
    v_fma_mix_f32 v9, v53, v9, v13 op_sel:[1,0,0] op_sel_hi:[1,0,0]
    v_cvt_pk_bf16_f32 v52, v6, v7
    v_cvt_pk_bf16_f32 v53, v8, v9
    s_waitcnt lgkmcnt(0)
    v_fma_mix_f32 v236, v54, v236, v240 op_sel_hi:[1,0,0]
    v_fma_mix_f32 v237, v54, v237, v241 op_sel:[1,0,0] op_sel_hi:[1,0,0]
    v_fma_mix_f32 v238, v55, v238, v242 op_sel_hi:[1,0,0]
    v_fma_mix_f32 v239, v55, v239, v243 op_sel:[1,0,0] op_sel_hi:[1,0,0]
    v_cvt_pk_bf16_f32 v54, v236, v237
    v_cvt_pk_bf16_f32 v55, v238, v239
    ds_write_b128 v4, v[36:39] offset:0
    ds_write_b128 v4, v[40:43] offset:16384
    ds_write_b128 v4, v[44:47] offset:32768
    ds_write_b128 v4, v[48:51] offset:49152
    v_add_u32 v15, 65536, v4
    ds_write_b128 v15, v[52:55] offset:0
    s_cmp_lt_u32 s2, 80
    s_cbranch_scc1 adaLN_cond__grouped_kv_mqa__glu_gated_swiglu__prompt_kernel_isl_34
    s_sub_u32 s38, s2, 80
    s_min_u32 s38, s38, 159
    s_mul_i32 s39, s38, 1639
    s_lshr_b32 s39, s39, 16
    s_mul_i32 s40, s39, 40
    s_sub_u32 s40, s38, s40
    s_add_u32 s40, s40, 20
    s_mul_i32 s41, s39, 160
    s_lshl_b32 s47, s40, 7
    v_lshrrev_b32 v232, 4, v1
    s_mul_i32 s42, s3, 20
    v_add_u32 v232, s42, v232
    s_mov_b32 s43, 7680
    v_mul_lo_u32 v226, v232, s43
    v_and_b32 v233, 15, v1
    v_lshl_add_u32 v226, v233, 3, v226
    s_mul_i32 s42, s41, 7680
    s_add_u32 s42, s42, s47
    buffer_load_dwordx2 v[216:217], v226, s[20:23], s42 offen
    s_add_u32 s42, s42, 30720
    buffer_load_dwordx2 v[218:219], v226, s[20:23], s42 offen
    s_add_u32 s42, s42, 30720
    buffer_load_dwordx2 v[220:221], v226, s[20:23], s42 offen
    s_add_u32 s42, s42, 30720
    buffer_load_dwordx2 v[222:223], v226, s[20:23], s42 offen
    s_add_u32 s42, s42, 30720
    buffer_load_dwordx2 v[224:225], v226, s[20:23], s42 offen
    v_lshrrev_b32 v3, 4, v1
    s_mul_i32 s42, s3, 20
    s_add_u32 s42, s42, s41
    v_add_u32 v3, s42, v3
    v_lshlrev_b32 v3, 1, v3
    buffer_load_ushort v227, v3, s[28:31], 0 offen offset:0
    buffer_load_ushort v228, v3, s[28:31], 0 offen offset:8
    buffer_load_ushort v229, v3, s[28:31], 0 offen offset:16
    buffer_load_ushort v230, v3, s[28:31], 0 offen offset:24
    buffer_load_ushort v231, v3, s[28:31], 0 offen offset:32
    s_mul_i32 s48, s39, 15360
    s_lshl_b32 s42, s40, 8
    s_add_u32 s48, s48, s42
adaLN_cond__grouped_kv_mqa__glu_gated_swiglu__prompt_kernel_isl_34:
    s_waitcnt lgkmcnt(0)
    s_barrier
    s_cmp_ge_u32 s3, 2
    s_cbranch_scc1 adaLN_cond__grouped_kv_mqa__glu_gated_swiglu__prompt_kernel_kv_nf_35
    s_waitcnt vmcnt(0)
    v_mov_b32 v8, 153604
    v_mov_b32 v9, 1
    s_mov_b64 exec, 1
    ds_add_rtn_u32 v10, v8, v9
    s_waitcnt lgkmcnt(0)
    v_readfirstlane_b32 s43, v10
    s_mov_b64 exec, -1
    s_cmp_lg_u32 s43, 1
    s_cbranch_scc1 adaLN_cond__grouped_kv_mqa__glu_gated_swiglu__prompt_kernel_kv_nf_35
    s_and_b32 s42, s2, 7
    s_lshl_b32 s42, s42, 7
    s_lshr_b32 s43, s2, 3
    s_lshl_b32 s43, s43, 2
    s_add_u32 s42, s42, s43
    s_add_u32 s42, s42, 4096
    v_mov_b32 v8, s71
    v_mov_b32 v9, 0
    s_mov_b64 exec, 1
    buffer_store_dword v8, v9, s[60:63], s42 offen sc1
    s_mov_b64 exec, -1
adaLN_cond__grouped_kv_mqa__glu_gated_swiglu__prompt_kernel_kv_nf_35:
    s_cmp_lt_u32 s2, 248
    s_cbranch_scc1 adaLN_cond__grouped_kv_mqa__glu_gated_swiglu__prompt_kernel_ldr_36
    s_cmp_lg_u32 s3, 7
    s_cbranch_scc1 adaLN_cond__grouped_kv_mqa__glu_gated_swiglu__prompt_kernel_ldr_36
    s_and_b32 s45, s2, 7
    s_lshl_b32 s45, s45, 7
    s_add_u32 s45, s45, 4096
    v_mul_u32_u24 v2, 4, v1
    s_mov_b32 s42, 4294967295
    s_mov_b32 s43, 0
    s_mov_b64 exec, s[42:43]
    s_mov_b32 s44, 65536
adaLN_cond__grouped_kv_mqa__glu_gated_swiglu__prompt_kernel_poll_37:
    buffer_load_dword v3, v2, s[60:63], s45 offen sc1
    s_sub_u32 s44, s44, 1
    s_cmp_eq_u32 s44, 0
    s_cbranch_scc1 adaLN_cond__grouped_kv_mqa__glu_gated_swiglu__prompt_kernel_polldone_38
    s_waitcnt vmcnt(0)
    v_cmp_ne_u32 vcc, s71, v3
    s_nop 0
    s_cbranch_vccnz adaLN_cond__grouped_kv_mqa__glu_gated_swiglu__prompt_kernel_poll_37
adaLN_cond__grouped_kv_mqa__glu_gated_swiglu__prompt_kernel_polldone_38:
    s_mov_b64 exec, -1
    s_waitcnt vmcnt(0)
    v_lshlrev_b32 v3, 7, v1
    s_and_b32 s45, s2, 7
    s_lshl_b32 s45, s45, 2
    s_add_u32 s45, s45, 6144
    v_mov_b32 v2, s71
    s_mov_b64 exec, 0xff
    buffer_store_dword v2, v3, s[60:63], s45 offen sc1
    s_mov_b64 exec, -1
adaLN_cond__grouped_kv_mqa__glu_gated_swiglu__prompt_kernel_ldr_36:
    v_lshrrev_b32 v6, 5, v1
    v_and_b32 v7, 31, v1
    s_and_b32 s42, s3, 1
    s_lshl_b32 s42, s42, 5
    v_add_u32 v7, s42, v7
    v_add_u32 v8, 0, v6
    v_xor_b32 v9, v7, v8
    v_lshlrev_b32 v8, 10, v8
    v_lshl_add_u32 v2, v9, 4, v8
    v_add_u32 v2, 0, v2
    v_add_u32 v8, 2, v6
    v_xor_b32 v9, v7, v8
    v_lshlrev_b32 v8, 10, v8
    v_lshl_add_u32 v3, v9, 4, v8
    v_add_u32 v3, 0, v3
    v_add_u32 v8, 4, v6
    v_xor_b32 v9, v7, v8
    v_lshlrev_b32 v8, 10, v8
    v_lshl_add_u32 v4, v9, 4, v8
    v_add_u32 v4, 0, v4
    v_add_u32 v8, 6, v6
    v_xor_b32 v9, v7, v8
    v_lshlrev_b32 v8, 10, v8
    v_lshl_add_u32 v5, v9, 4, v8
    v_add_u32 v5, 0, v5
    v_add_u32 v10, 40960, v2
    v_add_u32 v11, 40960, v3
    v_add_u32 v12, 40960, v4
    v_add_u32 v13, 40960, v5
    ds_read_b128 v[16:19], v2 offset:0
    ds_read_b128 v[20:23], v3 offset:0
    ds_read_b128 v[24:27], v4 offset:0
    ds_read_b128 v[28:31], v5 offset:0
    ds_read_b128 v[32:35], v2 offset:8192
    ds_read_b128 v[36:39], v3 offset:8192
    ds_read_b128 v[40:43], v4 offset:8192
    ds_read_b128 v[44:47], v5 offset:8192
    ds_read_b128 v[48:51], v2 offset:16384
    ds_read_b128 v[52:55], v3 offset:16384
    s_waitcnt lgkmcnt(8)
    v_mfma_f32_32x32x16_bf16 v[240:255], v[56:59], v[16:19], 0
    ds_read_b128 v[16:19], v4 offset:16384
    v_mfma_f32_32x32x16_bf16 v[240:255], v[60:63], v[20:23], v[240:255]
    ds_read_b128 v[20:23], v5 offset:16384
    s_waitcnt lgkmcnt(8)
    v_mfma_f32_32x32x16_bf16 v[240:255], v[64:67], v[24:27], v[240:255]
    ds_read_b128 v[24:27], v2 offset:24576
    v_mfma_f32_32x32x16_bf16 v[240:255], v[68:71], v[28:31], v[240:255]
    ds_read_b128 v[28:31], v3 offset:24576
    s_waitcnt lgkmcnt(8)
    v_mfma_f32_32x32x16_bf16 v[240:255], v[72:75], v[32:35], v[240:255]
    ds_read_b128 v[32:35], v4 offset:24576
    v_mfma_f32_32x32x16_bf16 v[240:255], v[76:79], v[36:39], v[240:255]
    ds_read_b128 v[36:39], v5 offset:24576
    s_waitcnt lgkmcnt(8)
    v_mfma_f32_32x32x16_bf16 v[240:255], v[80:83], v[40:43], v[240:255]
    ds_read_b128 v[40:43], v2 offset:32768
    v_mfma_f32_32x32x16_bf16 v[240:255], v[84:87], v[44:47], v[240:255]
    ds_read_b128 v[44:47], v3 offset:32768
    s_waitcnt lgkmcnt(8)
    v_mfma_f32_32x32x16_bf16 v[240:255], v[88:91], v[48:51], v[240:255]
    ds_read_b128 v[48:51], v4 offset:32768
    v_mfma_f32_32x32x16_bf16 v[240:255], v[92:95], v[52:55], v[240:255]
    ds_read_b128 v[52:55], v5 offset:32768
    s_waitcnt lgkmcnt(8)
    v_mfma_f32_32x32x16_bf16 v[240:255], v[96:99], v[16:19], v[240:255]
    ds_read_b128 v[16:19], v10 offset:0
    v_mfma_f32_32x32x16_bf16 v[240:255], v[100:103], v[20:23], v[240:255]
    ds_read_b128 v[20:23], v11 offset:0
    s_waitcnt lgkmcnt(8)
    v_mfma_f32_32x32x16_bf16 v[240:255], v[104:107], v[24:27], v[240:255]
    ds_read_b128 v[24:27], v12 offset:0
    v_mfma_f32_32x32x16_bf16 v[240:255], v[108:111], v[28:31], v[240:255]
    ds_read_b128 v[28:31], v13 offset:0
    s_waitcnt lgkmcnt(8)
    v_mfma_f32_32x32x16_bf16 v[240:255], v[112:115], v[32:35], v[240:255]
    ds_read_b128 v[32:35], v10 offset:8192
    v_mfma_f32_32x32x16_bf16 v[240:255], v[116:119], v[36:39], v[240:255]
    ds_read_b128 v[36:39], v11 offset:8192
    s_waitcnt lgkmcnt(8)
    v_mfma_f32_32x32x16_bf16 v[240:255], v[120:123], v[40:43], v[240:255]
    ds_read_b128 v[40:43], v12 offset:8192
    v_mfma_f32_32x32x16_bf16 v[240:255], v[124:127], v[44:47], v[240:255]
    ds_read_b128 v[44:47], v13 offset:8192
    s_waitcnt lgkmcnt(8)
    v_mfma_f32_32x32x16_bf16 v[240:255], v[128:131], v[48:51], v[240:255]
    ds_read_b128 v[48:51], v10 offset:16384
    v_mfma_f32_32x32x16_bf16 v[240:255], v[132:135], v[52:55], v[240:255]
    ds_read_b128 v[52:55], v11 offset:16384
    s_waitcnt lgkmcnt(8)
    v_mfma_f32_32x32x16_bf16 v[240:255], v[136:139], v[16:19], v[240:255]
    ds_read_b128 v[16:19], v12 offset:16384
    v_mfma_f32_32x32x16_bf16 v[240:255], v[140:143], v[20:23], v[240:255]
    ds_read_b128 v[20:23], v13 offset:16384
    s_waitcnt lgkmcnt(8)
    v_mfma_f32_32x32x16_bf16 v[240:255], v[144:147], v[24:27], v[240:255]
    ds_read_b128 v[24:27], v10 offset:24576
    v_mfma_f32_32x32x16_bf16 v[240:255], v[148:151], v[28:31], v[240:255]
    ds_read_b128 v[28:31], v11 offset:24576
    s_waitcnt lgkmcnt(8)
    v_mfma_f32_32x32x16_bf16 v[240:255], v[152:155], v[32:35], v[240:255]
    ds_read_b128 v[32:35], v12 offset:24576
    v_mfma_f32_32x32x16_bf16 v[240:255], v[156:159], v[36:39], v[240:255]
    ds_read_b128 v[36:39], v13 offset:24576
    s_waitcnt lgkmcnt(8)
    v_mfma_f32_32x32x16_bf16 v[240:255], v[160:163], v[40:43], v[240:255]
    ds_read_b128 v[40:43], v10 offset:32768
    v_mfma_f32_32x32x16_bf16 v[240:255], v[164:167], v[44:47], v[240:255]
    ds_read_b128 v[44:47], v11 offset:32768
    s_waitcnt lgkmcnt(8)
    v_mfma_f32_32x32x16_bf16 v[240:255], v[168:171], v[48:51], v[240:255]
    ds_read_b128 v[48:51], v12 offset:32768
    v_mfma_f32_32x32x16_bf16 v[240:255], v[172:175], v[52:55], v[240:255]
    ds_read_b128 v[52:55], v13 offset:32768
    s_waitcnt lgkmcnt(8)
    v_mfma_f32_32x32x16_bf16 v[240:255], v[176:179], v[16:19], v[240:255]
    v_mfma_f32_32x32x16_bf16 v[240:255], v[180:183], v[20:23], v[240:255]
    s_waitcnt lgkmcnt(6)
    v_mfma_f32_32x32x16_bf16 v[240:255], v[184:187], v[24:27], v[240:255]
    v_mfma_f32_32x32x16_bf16 v[240:255], v[188:191], v[28:31], v[240:255]
    s_waitcnt lgkmcnt(4)
    v_mfma_f32_32x32x16_bf16 v[240:255], v[192:195], v[32:35], v[240:255]
    v_mfma_f32_32x32x16_bf16 v[240:255], v[196:199], v[36:39], v[240:255]
    s_waitcnt lgkmcnt(2)
    v_mfma_f32_32x32x16_bf16 v[240:255], v[200:203], v[40:43], v[240:255]
    v_mfma_f32_32x32x16_bf16 v[240:255], v[204:207], v[44:47], v[240:255]
    s_waitcnt lgkmcnt(0)
    v_mfma_f32_32x32x16_bf16 v[240:255], v[208:211], v[48:51], v[240:255]
    v_mfma_f32_32x32x16_bf16 v[240:255], v[212:215], v[52:55], v[240:255]
    s_cmp_lt_u32 s2, 80
    s_cbranch_scc1 adaLN_cond__grouped_kv_mqa__glu_gated_swiglu__prompt_kernel_isl2_39
    s_cmp_lt_u32 s2, 240
    s_cselect_b32 s42, -1, 0
    s_and_b32 s34, s34, s42
    s_waitcnt vmcnt(4)
    v_lshlrev_b32 v227, 16, v227
    v_mul_f32 v70, 0xbfb8aa3b, v227
    v_exp_f32 v70, v70
    s_nop 0
    v_add_f32 v70, 1.0, v70
    v_rcp_f32 v70, v70
    s_nop 0
    v_mul_f32 v227, v227, v70
    v_cvt_pk_bf16_f32 v227, v227, v227
    v_lshlrev_b32 v227, 16, v227
    s_waitcnt vmcnt(3)
    v_lshlrev_b32 v228, 16, v228
    v_mul_f32 v70, 0xbfb8aa3b, v228
    v_exp_f32 v70, v70
    s_nop 0
    v_add_f32 v70, 1.0, v70
    v_rcp_f32 v70, v70
    s_nop 0
    v_mul_f32 v228, v228, v70
    v_cvt_pk_bf16_f32 v228, v228, v228
    v_lshlrev_b32 v228, 16, v228
    s_waitcnt vmcnt(2)
    v_lshlrev_b32 v229, 16, v229
    v_mul_f32 v70, 0xbfb8aa3b, v229
    v_exp_f32 v70, v70
    s_nop 0
    v_add_f32 v70, 1.0, v70
    v_rcp_f32 v70, v70
    s_nop 0
    v_mul_f32 v229, v229, v70
    v_cvt_pk_bf16_f32 v229, v229, v229
    v_lshlrev_b32 v229, 16, v229
    s_waitcnt vmcnt(1)
    v_lshlrev_b32 v230, 16, v230
    v_mul_f32 v70, 0xbfb8aa3b, v230
    v_exp_f32 v70, v70
    s_nop 0
    v_add_f32 v70, 1.0, v70
    v_rcp_f32 v70, v70
    s_nop 0
    v_mul_f32 v230, v230, v70
    v_cvt_pk_bf16_f32 v230, v230, v230
    v_lshlrev_b32 v230, 16, v230
    s_waitcnt vmcnt(0)
    v_lshlrev_b32 v231, 16, v231
    v_mul_f32 v70, 0xbfb8aa3b, v231
    v_exp_f32 v70, v70
    s_nop 0
    v_add_f32 v70, 1.0, v70
    v_rcp_f32 v70, v70
    s_nop 0
    v_mul_f32 v231, v231, v70
    v_cvt_pk_bf16_f32 v231, v231, v231
    v_lshlrev_b32 v231, 16, v231
    v_mov_b32 v60, 0
    v_mov_b32 v61, 0
    v_mov_b32 v62, 0
    v_mov_b32 v63, 0
    v_lshlrev_b32 v64, 16, v216
    v_and_b32 v65, 0xffff0000, v216
    v_lshlrev_b32 v66, 16, v217
    v_and_b32 v67, 0xffff0000, v217
    v_fmac_f32 v60, v227, v64
    v_fmac_f32 v61, v227, v65
    v_fmac_f32 v62, v227, v66
    v_fmac_f32 v63, v227, v67
    v_lshlrev_b32 v64, 16, v218
    v_and_b32 v65, 0xffff0000, v218
    v_lshlrev_b32 v66, 16, v219
    v_and_b32 v67, 0xffff0000, v219
    v_fmac_f32 v60, v228, v64
    v_fmac_f32 v61, v228, v65
    v_fmac_f32 v62, v228, v66
    v_fmac_f32 v63, v228, v67
    v_lshlrev_b32 v64, 16, v220
    v_and_b32 v65, 0xffff0000, v220
    v_lshlrev_b32 v66, 16, v221
    v_and_b32 v67, 0xffff0000, v221
    v_fmac_f32 v60, v229, v64
    v_fmac_f32 v61, v229, v65
    v_fmac_f32 v62, v229, v66
    v_fmac_f32 v63, v229, v67
    v_lshlrev_b32 v64, 16, v222
    v_and_b32 v65, 0xffff0000, v222
    v_lshlrev_b32 v66, 16, v223
    v_and_b32 v67, 0xffff0000, v223
    v_fmac_f32 v60, v230, v64
    v_fmac_f32 v61, v230, v65
    v_fmac_f32 v62, v230, v66
    v_fmac_f32 v63, v230, v67
    v_lshlrev_b32 v64, 16, v224
    v_and_b32 v65, 0xffff0000, v224
    v_lshlrev_b32 v66, 16, v225
    v_and_b32 v67, 0xffff0000, v225
    v_fmac_f32 v60, v231, v64
    v_fmac_f32 v61, v231, v65
    v_fmac_f32 v62, v231, v66
    v_fmac_f32 v63, v231, v67
    v_mov_b32 v64, v60
    s_nop 1
    v_permlane32_swap_b32 v60, v64
    v_add_f32 v60, v60, v64
    v_mov_b32 v64, v60
    s_nop 1
    v_permlane16_swap_b32 v60, v64
    v_add_f32 v60, v60, v64
    v_mov_b32 v64, v61
    s_nop 1
    v_permlane32_swap_b32 v61, v64
    v_add_f32 v61, v61, v64
    v_mov_b32 v64, v61
    s_nop 1
    v_permlane16_swap_b32 v61, v64
    v_add_f32 v61, v61, v64
    v_mov_b32 v64, v62
    s_nop 1
    v_permlane32_swap_b32 v62, v64
    v_add_f32 v62, v62, v64
    v_mov_b32 v64, v62
    s_nop 1
    v_permlane16_swap_b32 v62, v64
    v_add_f32 v62, v62, v64
    v_mov_b32 v64, v63
    s_nop 1
    v_permlane32_swap_b32 v63, v64
    v_add_f32 v63, v63, v64
    v_mov_b32 v64, v63
    s_nop 1
    v_permlane16_swap_b32 v63, v64
    v_add_f32 v63, v63, v64
    v_and_b32 v64, 15, v1
    v_lshlrev_b32 v64, 4, v64
    s_lshl_b32 s42, s3, 8
    v_add_u32 v64, s42, v64
    v_add_u32 v64, 151552, v64
    s_mov_b64 exec, 0xffff
    ds_write_b128 v64, v[60:63] offset:0
    s_mov_b64 exec, -1
    s_waitcnt lgkmcnt(0)
    s_barrier
    s_cmp_ge_u32 s3, 1
    s_cbranch_scc1 adaLN_cond__grouped_kv_mqa__glu_gated_swiglu__prompt_kernel_gemv_done_40
    s_lshl_b32 s42, s3, 11
    v_lshlrev_b32 v64, 2, v1
    v_add_u32 v65, s42, v64
    v_add_u32 v65, 151552, v65
    ds_read_b32 v216, v65 offset:0
    ds_read_b32 v217, v65 offset:256
    ds_read_b32 v218, v65 offset:512
    ds_read_b32 v219, v65 offset:768
    ds_read_b32 v220, v65 offset:1024
    ds_read_b32 v221, v65 offset:1280
    ds_read_b32 v222, v65 offset:1536
    ds_read_b32 v223, v65 offset:1792
    s_waitcnt lgkmcnt(6)
    v_add_f32 v216, v216, v217
    s_waitcnt lgkmcnt(5)
    v_add_f32 v216, v216, v218
    s_waitcnt lgkmcnt(4)
    v_add_f32 v216, v216, v219
    s_waitcnt lgkmcnt(3)
    v_add_f32 v216, v216, v220
    s_waitcnt lgkmcnt(2)
    v_add_f32 v216, v216, v221
    s_waitcnt lgkmcnt(1)
    v_add_f32 v216, v216, v222
    s_waitcnt lgkmcnt(0)
    v_add_f32 v216, v216, v223
    s_mul_i32 s42, s3, 0
    s_add_u32 s42, s42, s48
    buffer_store_dword v216, v64, s[32:35], s42 offen sc1
adaLN_cond__grouped_kv_mqa__glu_gated_swiglu__prompt_kernel_gemv_done_40:
    s_mov_b32 s34, 61440
adaLN_cond__grouped_kv_mqa__glu_gated_swiglu__prompt_kernel_isl2_39:
    s_cmp_lg_u32 s3, 0
    s_cbranch_scc1 adaLN_cond__grouped_kv_mqa__glu_gated_swiglu__prompt_kernel_mfl_41
    s_waitcnt vmcnt(0)
    s_and_b32 s42, s2, 7
    s_lshl_b32 s42, s42, 7
    s_lshr_b32 s43, s2, 3
    s_lshl_b32 s43, s43, 2
    s_add_u32 s42, s42, s43
    s_add_u32 s42, s42, 12288
    v_mov_b32 v2, s71
    v_mov_b32 v3, 0
    s_mov_b64 exec, 1
    buffer_store_dword v2, v3, s[60:63], s42 offen sc1
    s_mov_b64 exec, -1
adaLN_cond__grouped_kv_mqa__glu_gated_swiglu__prompt_kernel_mfl_41:
    s_and_b32 s45, s2, 7
    s_lshl_b32 s45, s45, 7
    s_add_u32 s45, s45, 6144
    s_cmp_lg_u32 s3, 7
    s_cbranch_scc1 adaLN_cond__grouped_kv_mqa__glu_gated_swiglu__prompt_kernel_wf_42
    v_mul_u32_u24 v2, 4, v1
    s_mov_b32 s42, 255
    s_mov_b32 s43, 0
    s_mov_b64 exec, s[42:43]
    s_mov_b32 s44, 65536
adaLN_cond__grouped_kv_mqa__glu_gated_swiglu__prompt_kernel_poll_43:
    buffer_load_dword v3, v2, s[60:63], s45 offen sc1
    s_sub_u32 s44, s44, 1
    s_cmp_eq_u32 s44, 0
    s_cbranch_scc1 adaLN_cond__grouped_kv_mqa__glu_gated_swiglu__prompt_kernel_polldone_44
    s_waitcnt vmcnt(0)
    v_cmp_ne_u32 vcc, s71, v3
    s_nop 0
    s_cbranch_vccnz adaLN_cond__grouped_kv_mqa__glu_gated_swiglu__prompt_kernel_poll_43
adaLN_cond__grouped_kv_mqa__glu_gated_swiglu__prompt_kernel_polldone_44:
    s_mov_b64 exec, -1
adaLN_cond__grouped_kv_mqa__glu_gated_swiglu__prompt_kernel_wf_42:
    s_barrier
    s_mov_b32 s42, 52429
    s_mov_b32 s43, 8960
    v_add_u32 v2, 0, v1
    s_waitcnt vmcnt(0)
    v_mul_u32_u24 v3, s42, v2
    v_lshrrev_b32 v3, 22, v3
    v_mul_u32_u24 v3, s43, v3
    v_lshl_add_u32 v210, v2, 4, v3
    v_add_u32 v2, 64, v1
    v_mul_u32_u24 v3, s42, v2
    v_lshrrev_b32 v3, 22, v3
    v_mul_u32_u24 v3, s43, v3
    v_lshl_add_u32 v211, v2, 4, v3
    v_add_u32 v2, 128, v1
    v_mul_u32_u24 v3, s42, v2
    v_lshrrev_b32 v3, 22, v3
    v_mul_u32_u24 v3, s43, v3
    v_lshl_add_u32 v212, v2, 4, v3
    v_add_u32 v2, 192, v1
    v_mul_u32_u24 v3, s42, v2
    v_lshrrev_b32 v3, 22, v3
    v_mul_u32_u24 v3, s43, v3
    v_lshl_add_u32 v213, v2, 4, v3
    v_add_u32 v2, 256, v1
    v_mul_u32_u24 v3, s42, v2
    v_lshrrev_b32 v3, 22, v3
    v_mul_u32_u24 v3, s43, v3
    v_lshl_add_u32 v214, v2, 4, v3
    s_add_u32 s28, s6, 8847360
    s_addc_u32 s29, s7, 0
    s_mov_b32 s30, 2621440
    s_mov_b32 s31, 0x00020000
    s_add_u32 s32, s6, 1310720
    s_addc_u32 s33, s7, 0
    s_mov_b32 s34, 819200
    s_mov_b32 s35, 0x00020000
    s_add_u32 s16, s6, 2162688
    s_addc_u32 s17, s7, 0
    s_mov_b32 s18, 4440064
    s_mov_b32 s19, 0x00020000
    s_getreg_b32 s40, hwreg(HW_REG_XCC_ID, 0, 4)
    s_add_u32 s40, s40, 1
    s_add_u32 s40, s40, s71
    s_and_b32 s41, s2, 7
    s_lshl_b32 s41, s41, 7
    s_add_u32 s41, s41, 40960
    v_and_b32 v4, 31, v1
    v_lshlrev_b32 v4, 2, v4
    buffer_load_dword v5, v4, s[60:63], s41 offen sc1
    v_lshlrev_b32 v2, 4, v1
    s_lshl_b32 s96, s3, 10
    s_cmp_ge_u32 s3, 4
    s_cbranch_scc1 adaLN_cond__grouped_kv_mqa__glu_gated_swiglu__prompt_kernel_kvd_45
    s_add_u32 s97, s96, 0
    s_mov_b32 m0, s97
    s_nop 0
    buffer_load_dwordx4 v2, s[24:27], s97 offen sc1 lds
    s_add_u32 s97, s96, 4096
    s_mov_b32 m0, s97
    s_nop 0
    buffer_load_dwordx4 v2, s[24:27], s97 offen sc1 lds
    s_add_u32 s97, s96, 8192
    s_mov_b32 m0, s97
    s_nop 0
    buffer_load_dwordx4 v2, s[24:27], s97 offen sc1 lds
    s_add_u32 s97, s96, 12288
    s_mov_b32 m0, s97
    s_nop 0
    buffer_load_dwordx4 v2, s[24:27], s97 offen sc1 lds
adaLN_cond__grouped_kv_mqa__glu_gated_swiglu__prompt_kernel_kvd_45:
    s_waitcnt vmcnt(0)
    v_cmp_ne_u32 vcc, s40, v5
    s_nop 0
    s_cmp_eq_u64 vcc, 0
    s_cselect_b32 s14, 1, 0
    v_mul_f32 v240, 0x3ea52b5c, v240
    v_mul_f32 v241, 0x3ea52b5c, v241
    v_mul_f32 v242, 0x3ea52b5c, v242
    v_mul_f32 v243, 0x3ea52b5c, v243
    v_mul_f32 v244, 0x3ea52b5c, v244
    v_mul_f32 v245, 0x3ea52b5c, v245
    v_mul_f32 v246, 0x3ea52b5c, v246
    v_mul_f32 v247, 0x3ea52b5c, v247
    v_mul_f32 v248, 0x3ea52b5c, v248
    v_mul_f32 v249, 0x3ea52b5c, v249
    v_mul_f32 v250, 0x3ea52b5c, v250
    v_mul_f32 v251, 0x3ea52b5c, v251
    v_cvt_pk_bf16_f32 v16, v240, v241
    v_cvt_pk_bf16_f32 v17, v242, v243
    v_cvt_pk_bf16_f32 v18, v244, v245
    v_cvt_pk_bf16_f32 v19, v246, v247
    v_mov_b32 v20, 0
    v_mov_b32 v21, 0
    v_mov_b32 v22, 0
    v_mov_b32 v23, 0
    s_mov_b64 exec, 0xffffffff
    v_cvt_pk_bf16_f32 v20, v248, v249
    v_cvt_pk_bf16_f32 v21, v250, v251
    s_mov_b64 exec, -1
    v_lshlrev_b32 v112, 4, v1
    v_and_b32 v115, 31, v1
    v_lshlrev_b32 v113, 3, v115
    v_add_u32 v113, 1024, v113
    v_lshrrev_b32 v116, 5, v1
    v_mul_u32_u24 v116, 20, v116
    v_add_u32 v116, v116, v115
    v_lshlrev_b32 v114, 4, v116
    v_add_u32 v114, 1280, v114
    s_mov_b32 s98, 0x000fffff
    s_mov_b32 s99, 0x000fffff
    v_mov_b32 v116, 0x3f803f80
    v_cmp_eq_u32 vcc, 20, v115
    s_nop 1
    v_cndmask_b32 v32, 0, v116, vcc
    v_cndmask_b32 v36, 0, v116, vcc
    v_cndmask_b32 v33, 0, v116, vcc
    v_cndmask_b32 v37, 0, v116, vcc
    v_cndmask_b32 v34, 0, v116, vcc
    v_cndmask_b32 v38, 0, v116, vcc
    v_cndmask_b32 v35, 0, v116, vcc
    v_cndmask_b32 v39, 0, v116, vcc
    v_mov_b32 v30, 0
    v_mov_b32 v31, 0
    s_lshr_b32 s48, s2, 3
    s_lshl_b32 s49, s3, 6
    v_add_u32 v224, s49, v1
    v_mov_b32 v225, v224
    v_lshlrev_b32 v224, 7, v224
    s_mul_i32 s49, s48, 25600
    v_add_u32 v224, s49, v224
    v_lshrrev_b32 v226, 3, v225
    v_and_b32 v225, 7, v225
    v_lshlrev_b32 v225, 7, v225
    v_min_u32 v226, 79, v226
    v_mul_u32_u24 v226, 27648, v226
    v_add_u32 v225, v225, v226
    s_lshr_b32 s49, s48, 1
    s_mul_i32 s50, s49, 7
    s_mul_i32 s51, s49, 6
    s_add_u32 s51, s51, 12
    s_cmp_lt_u32 s49, 12
    s_cselect_b32 s50, s50, s51
    s_lshl_b32 s50, s50, 8
    s_and_b32 s49, s48, 1
    s_mul_i32 s49, s49, 2228224
    s_add_u32 s50, s50, s49
    s_mul_i32 s64, s37, 1280
    v_mov_b32 v208, v112
    v_mov_b32 v209, v113
    v_mov_b32 v215, v114
    s_cmp_ge_u32 s3, 4
    s_cbranch_scc1 adaLN_cond__grouped_kv_mqa__glu_gated_swiglu__prompt_kernel_kvw_46
    s_waitcnt vmcnt(0)
adaLN_cond__grouped_kv_mqa__glu_gated_swiglu__prompt_kernel_kvw_46:
    s_barrier
    ds_read_b128 v[24:27], v112
    ds_read_b64 v[28:29], v113
    s_waitcnt lgkmcnt(1)
    v_mfma_f32_32x32x16_bf16 v[48:63], v[24:27], v[16:19], 0
    s_waitcnt lgkmcnt(0)
    v_mfma_f32_32x32x16_bf16 v[48:63], v[28:31], v[20:23], v[48:63]
    s_nop 11
    v_max3_f32 v115, v48, v49, v50
    v_max3_f32 v115, v115, v51, v52
    v_max3_f32 v115, v115, v53, v54
    v_max3_f32 v115, v115, v55, v56
    v_max3_f32 v115, v115, v57, v58
    v_max3_f32 v115, v115, v59, v60
    v_max3_f32 v115, v115, v61, v62
    v_max_f32 v115, v115, v63
    v_mov_b32 v116, v115
    s_nop 1
    v_permlane32_swap_b32 v115, v116
    v_max_f32 v115, v115, v116
    v_sub_f32 v96, 0, v115
    v_sub_f32 v97, 0, v115
    v_sub_f32 v98, 0, v115
    v_sub_f32 v99, 0, v115
    v_sub_f32 v100, 0, v115
    v_sub_f32 v101, 0, v115
    v_sub_f32 v102, 0, v115
    v_sub_f32 v103, 0, v115
    v_sub_f32 v104, 0, v115
    v_sub_f32 v105, 0, v115
    v_sub_f32 v106, 0, v115
    v_sub_f32 v107, 0, v115
    v_sub_f32 v108, 0, v115
    v_sub_f32 v109, 0, v115
    v_sub_f32 v110, 0, v115
    v_sub_f32 v111, 0, v115
    v_mov_b32 v80, 0
    v_mov_b32 v81, 0
    v_mov_b32 v82, 0
    v_mov_b32 v83, 0
    v_mov_b32 v84, 0
    v_mov_b32 v85, 0
    v_mov_b32 v86, 0
    v_mov_b32 v87, 0
    v_mov_b32 v88, 0
    v_mov_b32 v89, 0
    v_mov_b32 v90, 0
    v_mov_b32 v91, 0
    v_mov_b32 v92, 0
    v_mov_b32 v93, 0
    v_mov_b32 v94, 0
    v_mov_b32 v95, 0
    v_mov_b32 v44, 0
    v_mov_b32 v45, 0
    v_mov_b32 v46, 0
    v_mov_b32 v47, 0
    v_mov_b32 v76, 0
    v_mov_b32 v77, 0
    v_mov_b32 v78, 0
    v_mov_b32 v79, 0
    v_mfma_f32_32x32x16_bf16 v[48:63], v[24:27], v[16:19], v[96:111]
    v_mfma_f32_32x32x16_bf16 v[48:63], v[28:31], v[20:23], v[48:63]
    ds_read_b128 v[24:27], v112 offset:2560
    ds_read_b64 v[28:29], v113 offset:2560
    s_cmp_ge_u32 s3, 4
    s_cbranch_scc1 adaLN_cond__grouped_kv_mqa__glu_gated_swiglu__prompt_kernel_kvd_47
    s_add_u32 s97, s96, 16384
    s_mov_b32 m0, s97
    s_nop 0
    buffer_load_dwordx4 v2, s[24:27], s97 offen sc1 lds
    s_add_u32 s97, s96, 20480
    s_mov_b32 m0, s97
    s_nop 0
    buffer_load_dwordx4 v2, s[24:27], s97 offen sc1 lds
    s_add_u32 s97, s96, 24576
    s_mov_b32 m0, s97
    s_nop 0
    buffer_load_dwordx4 v2, s[24:27], s97 offen sc1 lds
    s_add_u32 s97, s96, 28672
    s_mov_b32 m0, s97
    s_nop 0
    buffer_load_dwordx4 v2, s[24:27], s97 offen sc1 lds
    s_add_u32 s97, s96, 32768
    s_mov_b32 m0, s97
    s_nop 0
    buffer_load_dwordx4 v2, s[24:27], s97 offen sc1 lds
    s_add_u32 s97, s96, 36864
    s_mov_b32 m0, s97
    s_nop 0
    buffer_load_dwordx4 v2, s[24:27], s97 offen sc1 lds
adaLN_cond__grouped_kv_mqa__glu_gated_swiglu__prompt_kernel_kvd_47:
    s_nop 7
    v_exp_f32 v48, v48
    v_exp_f32 v49, v49
    v_cvt_pk_bf16_f32 v46, v76, v77
    v_cvt_pk_bf16_f32 v47, v78, v79
    v_exp_f32 v50, v50
    v_exp_f32 v51, v51
    v_mfma_f32_32x32x16_bf16 v[80:95], v[36:39], v[44:47], v[80:95]
    s_mov_b64 exec, s[98:99]
    ds_read_b128 v[32:35], v114 offset:0
    ds_read_b128 v[36:39], v114 offset:640
    s_mov_b64 exec, -1
    v_exp_f32 v52, v52
    v_exp_f32 v53, v53
    v_cvt_pk_bf16_f32 v40, v48, v49
    v_cvt_pk_bf16_f32 v41, v50, v51
    s_waitcnt lgkmcnt(2)
    v_mfma_f32_32x32x16_bf16 v[64:79], v[24:27], v[16:19], v[96:111]
    ds_read_b128 v[24:27], v112 offset:5120
    v_exp_f32 v54, v54
    v_exp_f32 v55, v55
    v_exp_f32 v56, v56
    v_exp_f32 v57, v57
    v_cvt_pk_bf16_f32 v42, v52, v53
    v_cvt_pk_bf16_f32 v43, v54, v55
    v_mfma_f32_32x32x16_bf16 v[64:79], v[28:31], v[20:23], v[64:79]
    ds_read_b64 v[28:29], v113 offset:5120
    v_exp_f32 v58, v58
    v_exp_f32 v59, v59
    v_exp_f32 v60, v60
    v_exp_f32 v61, v61
    v_cvt_pk_bf16_f32 v44, v56, v57
    v_cvt_pk_bf16_f32 v45, v58, v59
    s_waitcnt lgkmcnt(2)
    v_mfma_f32_32x32x16_bf16 v[80:95], v[32:35], v[40:43], v[80:95]
    v_exp_f32 v62, v62
    v_exp_f32 v63, v63
    s_cmp_ge_u32 s3, 4
    s_cbranch_scc1 adaLN_cond__grouped_kv_mqa__glu_gated_swiglu__prompt_kernel_kvd_48
    s_add_u32 s97, s96, 40960
    s_mov_b32 m0, s97
    s_nop 0
    buffer_load_dwordx4 v2, s[24:27], s97 offen sc1 lds
    s_add_u32 s97, s96, 45056
    s_mov_b32 m0, s97
    s_nop 0
    buffer_load_dwordx4 v2, s[24:27], s97 offen sc1 lds
    s_add_u32 s97, s96, 49152
    s_mov_b32 m0, s97
    s_nop 0
    buffer_load_dwordx4 v2, s[24:27], s97 offen sc1 lds
    s_add_u32 s97, s96, 53248
    s_mov_b32 m0, s97
    s_nop 0
    buffer_load_dwordx4 v2, s[24:27], s97 offen sc1 lds
    s_add_u32 s97, s96, 57344
    s_mov_b32 m0, s97
    s_nop 0
    buffer_load_dwordx4 v2, s[24:27], s97 offen sc1 lds
    s_add_u32 s97, s96, 61440
    s_mov_b32 m0, s97
    s_nop 0
    buffer_load_dwordx4 v2, s[24:27], s97 offen sc1 lds
adaLN_cond__grouped_kv_mqa__glu_gated_swiglu__prompt_kernel_kvd_48:
    v_exp_f32 v64, v64
    v_exp_f32 v65, v65
    v_cvt_pk_bf16_f32 v46, v60, v61
    v_cvt_pk_bf16_f32 v47, v62, v63
    v_exp_f32 v66, v66
    v_exp_f32 v67, v67
    v_mfma_f32_32x32x16_bf16 v[80:95], v[36:39], v[44:47], v[80:95]
    s_mov_b64 exec, s[98:99]
    ds_read_b128 v[32:35], v114 offset:2560
    ds_read_b128 v[36:39], v114 offset:3200
    s_mov_b64 exec, -1
    v_exp_f32 v68, v68
    v_exp_f32 v69, v69
    v_cvt_pk_bf16_f32 v40, v64, v65
    v_cvt_pk_bf16_f32 v41, v66, v67
    s_waitcnt lgkmcnt(2)
    v_mfma_f32_32x32x16_bf16 v[48:63], v[24:27], v[16:19], v[96:111]
    ds_read_b128 v[24:27], v112 offset:7680
    v_exp_f32 v70, v70
    v_exp_f32 v71, v71
    v_exp_f32 v72, v72
    v_exp_f32 v73, v73
    v_cvt_pk_bf16_f32 v42, v68, v69
    v_cvt_pk_bf16_f32 v43, v70, v71
    v_mfma_f32_32x32x16_bf16 v[48:63], v[28:31], v[20:23], v[48:63]
    ds_read_b64 v[28:29], v113 offset:7680
    v_exp_f32 v74, v74
    v_exp_f32 v75, v75
    v_exp_f32 v76, v76
    v_exp_f32 v77, v77
    v_cvt_pk_bf16_f32 v44, v72, v73
    v_cvt_pk_bf16_f32 v45, v74, v75
    s_waitcnt lgkmcnt(2)
    v_mfma_f32_32x32x16_bf16 v[80:95], v[32:35], v[40:43], v[80:95]
    v_exp_f32 v78, v78
    v_exp_f32 v79, v79
    s_cmp_ge_u32 s3, 4
    s_cbranch_scc1 adaLN_cond__grouped_kv_mqa__glu_gated_swiglu__prompt_kernel_kvd_49
    s_add_u32 s97, s96, 65536
    s_mov_b32 m0, s97
    s_nop 0
    buffer_load_dwordx4 v2, s[24:27], s97 offen sc1 lds
    s_add_u32 s97, s96, 69632
    s_mov_b32 m0, s97
    s_nop 0
    buffer_load_dwordx4 v2, s[24:27], s97 offen sc1 lds
    s_add_u32 s97, s96, 73728
    s_mov_b32 m0, s97
    s_nop 0
    buffer_load_dwordx4 v2, s[24:27], s97 offen sc1 lds
    s_add_u32 s97, s96, 77824
    s_mov_b32 m0, s97
    s_nop 0
    buffer_load_dwordx4 v2, s[24:27], s97 offen sc1 lds
    s_add_u32 s97, s96, 81920
    s_mov_b32 m0, s97
    s_nop 0
    buffer_load_dwordx4 v2, s[24:27], s97 offen sc1 lds
    s_add_u32 s97, s96, 86016
    s_mov_b32 m0, s97
    s_nop 0
    buffer_load_dwordx4 v2, s[24:27], s97 offen sc1 lds
    s_add_u32 s97, s96, 90112
    s_mov_b32 m0, s97
    s_nop 0
    buffer_load_dwordx4 v2, s[24:27], s97 offen sc1 lds
adaLN_cond__grouped_kv_mqa__glu_gated_swiglu__prompt_kernel_kvd_49:
    v_exp_f32 v48, v48
    v_exp_f32 v49, v49
    v_cvt_pk_bf16_f32 v46, v76, v77
    v_cvt_pk_bf16_f32 v47, v78, v79
    v_exp_f32 v50, v50
    v_exp_f32 v51, v51
    v_mfma_f32_32x32x16_bf16 v[80:95], v[36:39], v[44:47], v[80:95]
    s_mov_b64 exec, s[98:99]
    ds_read_b128 v[32:35], v114 offset:5120
    ds_read_b128 v[36:39], v114 offset:5760
    s_mov_b64 exec, -1
    v_exp_f32 v52, v52
    v_exp_f32 v53, v53
    v_cvt_pk_bf16_f32 v40, v48, v49
    v_cvt_pk_bf16_f32 v41, v50, v51
    s_waitcnt lgkmcnt(2)
    v_mfma_f32_32x32x16_bf16 v[64:79], v[24:27], v[16:19], v[96:111]
    ds_read_b128 v[24:27], v112 offset:10240
    v_exp_f32 v54, v54
    v_exp_f32 v55, v55
    v_exp_f32 v56, v56
    v_exp_f32 v57, v57
    v_cvt_pk_bf16_f32 v42, v52, v53
    v_cvt_pk_bf16_f32 v43, v54, v55
    v_mfma_f32_32x32x16_bf16 v[64:79], v[28:31], v[20:23], v[64:79]
    ds_read_b64 v[28:29], v113 offset:10240
    v_exp_f32 v58, v58
    v_exp_f32 v59, v59
    v_exp_f32 v60, v60
    v_exp_f32 v61, v61
    v_cvt_pk_bf16_f32 v44, v56, v57
    v_cvt_pk_bf16_f32 v45, v58, v59
    s_waitcnt lgkmcnt(2)
    v_mfma_f32_32x32x16_bf16 v[80:95], v[32:35], v[40:43], v[80:95]
    v_exp_f32 v62, v62
    v_exp_f32 v63, v63
    s_cmp_ge_u32 s3, 4
    s_cbranch_scc1 adaLN_cond__grouped_kv_mqa__glu_gated_swiglu__prompt_kernel_kvd_50
    s_add_u32 s97, s96, 94208
    s_mov_b32 m0, s97
    s_nop 0
    buffer_load_dwordx4 v2, s[24:27], s97 offen sc1 lds
    s_add_u32 s97, s96, 98304
    s_mov_b32 m0, s97
    s_nop 0
    buffer_load_dwordx4 v2, s[24:27], s97 offen sc1 lds
    s_add_u32 s97, s96, 102400
    s_mov_b32 m0, s97
    s_nop 0
    buffer_load_dwordx4 v2, s[24:27], s97 offen sc1 lds
    s_add_u32 s97, s96, 106496
    s_mov_b32 m0, s97
    s_nop 0
    buffer_load_dwordx4 v2, s[24:27], s97 offen sc1 lds
    s_add_u32 s97, s96, 110592
    s_mov_b32 m0, s97
    s_nop 0
    buffer_load_dwordx4 v2, s[24:27], s97 offen sc1 lds
    s_add_u32 s97, s96, 114688
    s_mov_b32 m0, s97
    s_nop 0
    buffer_load_dwordx4 v2, s[24:27], s97 offen sc1 lds
    s_add_u32 s97, s96, 118784
    s_mov_b32 m0, s97
    s_nop 0
    buffer_load_dwordx4 v2, s[24:27], s97 offen sc1 lds
adaLN_cond__grouped_kv_mqa__glu_gated_swiglu__prompt_kernel_kvd_50:
    v_exp_f32 v64, v64
    v_exp_f32 v65, v65
    v_cvt_pk_bf16_f32 v46, v60, v61
    v_cvt_pk_bf16_f32 v47, v62, v63
    v_exp_f32 v66, v66
    v_exp_f32 v67, v67
    v_mfma_f32_32x32x16_bf16 v[80:95], v[36:39], v[44:47], v[80:95]
    s_mov_b64 exec, s[98:99]
    ds_read_b128 v[32:35], v114 offset:7680
    ds_read_b128 v[36:39], v114 offset:8320
    s_mov_b64 exec, -1
    v_exp_f32 v68, v68
    v_exp_f32 v69, v69
    v_cvt_pk_bf16_f32 v40, v64, v65
    v_cvt_pk_bf16_f32 v41, v66, v67
    s_waitcnt lgkmcnt(2)
    v_mfma_f32_32x32x16_bf16 v[48:63], v[24:27], v[16:19], v[96:111]
    ds_read_b128 v[24:27], v112 offset:12800
    v_exp_f32 v70, v70
    v_exp_f32 v71, v71
    v_exp_f32 v72, v72
    v_exp_f32 v73, v73
    v_cvt_pk_bf16_f32 v42, v68, v69
    v_cvt_pk_bf16_f32 v43, v70, v71
    v_mfma_f32_32x32x16_bf16 v[48:63], v[28:31], v[20:23], v[48:63]
    ds_read_b64 v[28:29], v113 offset:12800
    v_exp_f32 v74, v74
    v_exp_f32 v75, v75
    v_exp_f32 v76, v76
    v_exp_f32 v77, v77
    v_cvt_pk_bf16_f32 v44, v72, v73
    v_cvt_pk_bf16_f32 v45, v74, v75
    s_waitcnt lgkmcnt(2)
    v_mfma_f32_32x32x16_bf16 v[80:95], v[32:35], v[40:43], v[80:95]
    v_exp_f32 v78, v78
    v_exp_f32 v79, v79
    s_cmp_ge_u32 s3, 4
    s_cbranch_scc1 adaLN_cond__grouped_kv_mqa__glu_gated_swiglu__prompt_kernel_kvw_51
    s_waitcnt vmcnt(20)
adaLN_cond__grouped_kv_mqa__glu_gated_swiglu__prompt_kernel_kvw_51:
    s_barrier
    v_exp_f32 v48, v48
    v_exp_f32 v49, v49
    v_cvt_pk_bf16_f32 v46, v76, v77
    v_cvt_pk_bf16_f32 v47, v78, v79
    v_exp_f32 v50, v50
    v_exp_f32 v51, v51
    v_mfma_f32_32x32x16_bf16 v[80:95], v[36:39], v[44:47], v[80:95]
    s_mov_b64 exec, s[98:99]
    ds_read_b128 v[32:35], v114 offset:10240
    ds_read_b128 v[36:39], v114 offset:10880
    s_mov_b64 exec, -1
    v_exp_f32 v52, v52
    v_exp_f32 v53, v53
    v_cvt_pk_bf16_f32 v40, v48, v49
    v_cvt_pk_bf16_f32 v41, v50, v51
    s_waitcnt lgkmcnt(2)
    v_mfma_f32_32x32x16_bf16 v[64:79], v[24:27], v[16:19], v[96:111]
    ds_read_b128 v[24:27], v112 offset:15360
    v_exp_f32 v54, v54
    v_exp_f32 v55, v55
    v_exp_f32 v56, v56
    v_exp_f32 v57, v57
    v_cvt_pk_bf16_f32 v42, v52, v53
    v_cvt_pk_bf16_f32 v43, v54, v55
    v_mfma_f32_32x32x16_bf16 v[64:79], v[28:31], v[20:23], v[64:79]
    ds_read_b64 v[28:29], v113 offset:15360
    v_exp_f32 v58, v58
    v_exp_f32 v59, v59
    v_exp_f32 v60, v60
    v_exp_f32 v61, v61
    v_cvt_pk_bf16_f32 v44, v56, v57
    v_cvt_pk_bf16_f32 v45, v58, v59
    s_waitcnt lgkmcnt(2)
    v_mfma_f32_32x32x16_bf16 v[80:95], v[32:35], v[40:43], v[80:95]
    v_exp_f32 v62, v62
    v_exp_f32 v63, v63
    s_cmp_eq_u32 s3, 0
    s_cbranch_scc1 adaLN_cond__grouped_kv_mqa__glu_gated_swiglu__prompt_kernel_ool_52
adaLN_cond__grouped_kv_mqa__glu_gated_swiglu__prompt_kernel_ret_53:
    v_exp_f32 v64, v64
    v_exp_f32 v65, v65
    v_cvt_pk_bf16_f32 v46, v60, v61
    v_cvt_pk_bf16_f32 v47, v62, v63
    v_exp_f32 v66, v66
    v_exp_f32 v67, v67
    v_mfma_f32_32x32x16_bf16 v[80:95], v[36:39], v[44:47], v[80:95]
    s_mov_b64 exec, s[98:99]
    ds_read_b128 v[32:35], v114 offset:12800
    ds_read_b128 v[36:39], v114 offset:13440
    s_mov_b64 exec, -1
    v_exp_f32 v68, v68
    v_exp_f32 v69, v69
    v_cvt_pk_bf16_f32 v40, v64, v65
    v_cvt_pk_bf16_f32 v41, v66, v67
    s_waitcnt lgkmcnt(2)
    v_mfma_f32_32x32x16_bf16 v[48:63], v[24:27], v[16:19], v[96:111]
    ds_read_b128 v[24:27], v112 offset:17920
    v_exp_f32 v70, v70
    v_exp_f32 v71, v71
    v_exp_f32 v72, v72
    v_exp_f32 v73, v73
    v_cvt_pk_bf16_f32 v42, v68, v69
    v_cvt_pk_bf16_f32 v43, v70, v71
    v_mfma_f32_32x32x16_bf16 v[48:63], v[28:31], v[20:23], v[48:63]
    ds_read_b64 v[28:29], v113 offset:17920
    v_exp_f32 v74, v74
    v_exp_f32 v75, v75
    v_exp_f32 v76, v76
    v_exp_f32 v77, v77
    v_cvt_pk_bf16_f32 v44, v72, v73
    v_cvt_pk_bf16_f32 v45, v74, v75
    s_waitcnt lgkmcnt(2)
    v_mfma_f32_32x32x16_bf16 v[80:95], v[32:35], v[40:43], v[80:95]
    v_exp_f32 v78, v78
    v_exp_f32 v79, v79
    s_cmp_ge_u32 s3, 4
    s_cbranch_scc1 adaLN_cond__grouped_kv_mqa__glu_gated_swiglu__prompt_kernel_ool_54
adaLN_cond__grouped_kv_mqa__glu_gated_swiglu__prompt_kernel_ret_55:
    v_exp_f32 v48, v48
    v_exp_f32 v49, v49
    v_cvt_pk_bf16_f32 v46, v76, v77
    v_cvt_pk_bf16_f32 v47, v78, v79
    v_exp_f32 v50, v50
    v_exp_f32 v51, v51
    v_mfma_f32_32x32x16_bf16 v[80:95], v[36:39], v[44:47], v[80:95]
    s_mov_b64 exec, s[98:99]
    ds_read_b128 v[32:35], v114 offset:15360
    ds_read_b128 v[36:39], v114 offset:16000
    s_mov_b64 exec, -1
    v_exp_f32 v52, v52
    v_exp_f32 v53, v53
    v_cvt_pk_bf16_f32 v40, v48, v49
    v_cvt_pk_bf16_f32 v41, v50, v51
    s_waitcnt lgkmcnt(2)
    v_mfma_f32_32x32x16_bf16 v[64:79], v[24:27], v[16:19], v[96:111]
    ds_read_b128 v[24:27], v112 offset:20480
    v_exp_f32 v54, v54
    v_exp_f32 v55, v55
    v_exp_f32 v56, v56
    v_exp_f32 v57, v57
    v_cvt_pk_bf16_f32 v42, v52, v53
    v_cvt_pk_bf16_f32 v43, v54, v55
    v_mfma_f32_32x32x16_bf16 v[64:79], v[28:31], v[20:23], v[64:79]
    ds_read_b64 v[28:29], v113 offset:20480
    v_exp_f32 v58, v58
    v_exp_f32 v59, v59
    v_exp_f32 v60, v60
    v_exp_f32 v61, v61
    v_cvt_pk_bf16_f32 v44, v56, v57
    v_cvt_pk_bf16_f32 v45, v58, v59
    s_waitcnt lgkmcnt(2)
    v_mfma_f32_32x32x16_bf16 v[80:95], v[32:35], v[40:43], v[80:95]
    v_exp_f32 v62, v62
    v_exp_f32 v63, v63
    s_nop 0
    v_exp_f32 v64, v64
    v_exp_f32 v65, v65
    v_cvt_pk_bf16_f32 v46, v60, v61
    v_cvt_pk_bf16_f32 v47, v62, v63
    v_exp_f32 v66, v66
    v_exp_f32 v67, v67
    v_mfma_f32_32x32x16_bf16 v[80:95], v[36:39], v[44:47], v[80:95]
    s_mov_b64 exec, s[98:99]
    ds_read_b128 v[32:35], v114 offset:17920
    ds_read_b128 v[36:39], v114 offset:18560
    s_mov_b64 exec, -1
    v_exp_f32 v68, v68
    v_exp_f32 v69, v69
    v_cvt_pk_bf16_f32 v40, v64, v65
    v_cvt_pk_bf16_f32 v41, v66, v67
    s_waitcnt lgkmcnt(2)
    v_mfma_f32_32x32x16_bf16 v[48:63], v[24:27], v[16:19], v[96:111]
    ds_read_b128 v[24:27], v112 offset:23040
    v_exp_f32 v70, v70
    v_exp_f32 v71, v71
    v_exp_f32 v72, v72
    v_exp_f32 v73, v73
    v_cvt_pk_bf16_f32 v42, v68, v69
    v_cvt_pk_bf16_f32 v43, v70, v71
    v_mfma_f32_32x32x16_bf16 v[48:63], v[28:31], v[20:23], v[48:63]
    ds_read_b64 v[28:29], v113 offset:23040
    v_exp_f32 v74, v74
    v_exp_f32 v75, v75
    v_exp_f32 v76, v76
    v_exp_f32 v77, v77
    v_cvt_pk_bf16_f32 v44, v72, v73
    v_cvt_pk_bf16_f32 v45, v74, v75
    s_waitcnt lgkmcnt(2)
    v_mfma_f32_32x32x16_bf16 v[80:95], v[32:35], v[40:43], v[80:95]
    v_exp_f32 v78, v78
    v_exp_f32 v79, v79
    s_nop 0
    v_exp_f32 v48, v48
    v_exp_f32 v49, v49
    v_cvt_pk_bf16_f32 v46, v76, v77
    v_cvt_pk_bf16_f32 v47, v78, v79
    v_exp_f32 v50, v50
    v_exp_f32 v51, v51
    v_mfma_f32_32x32x16_bf16 v[80:95], v[36:39], v[44:47], v[80:95]
    s_mov_b64 exec, s[98:99]
    ds_read_b128 v[32:35], v114 offset:20480
    ds_read_b128 v[36:39], v114 offset:21120
    s_mov_b64 exec, -1
    v_exp_f32 v52, v52
    v_exp_f32 v53, v53
    v_cvt_pk_bf16_f32 v40, v48, v49
    v_cvt_pk_bf16_f32 v41, v50, v51
    s_waitcnt lgkmcnt(2)
    v_mfma_f32_32x32x16_bf16 v[64:79], v[24:27], v[16:19], v[96:111]
    ds_read_b128 v[24:27], v112 offset:25600
    v_exp_f32 v54, v54
    v_exp_f32 v55, v55
    v_exp_f32 v56, v56
    v_exp_f32 v57, v57
    v_cvt_pk_bf16_f32 v42, v52, v53
    v_cvt_pk_bf16_f32 v43, v54, v55
    v_mfma_f32_32x32x16_bf16 v[64:79], v[28:31], v[20:23], v[64:79]
    ds_read_b64 v[28:29], v113 offset:25600
    v_exp_f32 v58, v58
    v_exp_f32 v59, v59
    v_exp_f32 v60, v60
    v_exp_f32 v61, v61
    v_cvt_pk_bf16_f32 v44, v56, v57
    v_cvt_pk_bf16_f32 v45, v58, v59
    s_waitcnt lgkmcnt(2)
    v_mfma_f32_32x32x16_bf16 v[80:95], v[32:35], v[40:43], v[80:95]
    v_exp_f32 v62, v62
    v_exp_f32 v63, v63
    s_nop 0
    v_exp_f32 v64, v64
    v_exp_f32 v65, v65
    v_cvt_pk_bf16_f32 v46, v60, v61
    v_cvt_pk_bf16_f32 v47, v62, v63
    v_exp_f32 v66, v66
    v_exp_f32 v67, v67
    v_mfma_f32_32x32x16_bf16 v[80:95], v[36:39], v[44:47], v[80:95]
    s_mov_b64 exec, s[98:99]
    ds_read_b128 v[32:35], v114 offset:23040
    ds_read_b128 v[36:39], v114 offset:23680
    s_mov_b64 exec, -1
    v_exp_f32 v68, v68
    v_exp_f32 v69, v69
    v_cvt_pk_bf16_f32 v40, v64, v65
    v_cvt_pk_bf16_f32 v41, v66, v67
    s_waitcnt lgkmcnt(2)
    v_mfma_f32_32x32x16_bf16 v[48:63], v[24:27], v[16:19], v[96:111]
    ds_read_b128 v[24:27], v112 offset:28160
    v_exp_f32 v70, v70
    v_exp_f32 v71, v71
    v_exp_f32 v72, v72
    v_exp_f32 v73, v73
    v_cvt_pk_bf16_f32 v42, v68, v69
    v_cvt_pk_bf16_f32 v43, v70, v71
    v_mfma_f32_32x32x16_bf16 v[48:63], v[28:31], v[20:23], v[48:63]
    ds_read_b64 v[28:29], v113 offset:28160
    v_exp_f32 v74, v74
    v_exp_f32 v75, v75
    v_exp_f32 v76, v76
    v_exp_f32 v77, v77
    v_cvt_pk_bf16_f32 v44, v72, v73
    v_cvt_pk_bf16_f32 v45, v74, v75
    s_waitcnt lgkmcnt(2)
    v_mfma_f32_32x32x16_bf16 v[80:95], v[32:35], v[40:43], v[80:95]
    v_exp_f32 v78, v78
    v_exp_f32 v79, v79
    s_nop 0
    v_exp_f32 v48, v48
    v_exp_f32 v49, v49
    v_cvt_pk_bf16_f32 v46, v76, v77
    v_cvt_pk_bf16_f32 v47, v78, v79
    v_exp_f32 v50, v50
    v_exp_f32 v51, v51
    v_mfma_f32_32x32x16_bf16 v[80:95], v[36:39], v[44:47], v[80:95]
    s_mov_b64 exec, s[98:99]
    ds_read_b128 v[32:35], v114 offset:25600
    ds_read_b128 v[36:39], v114 offset:26240
    s_mov_b64 exec, -1
    v_exp_f32 v52, v52
    v_exp_f32 v53, v53
    v_cvt_pk_bf16_f32 v40, v48, v49
    v_cvt_pk_bf16_f32 v41, v50, v51
    s_waitcnt lgkmcnt(2)
    v_mfma_f32_32x32x16_bf16 v[64:79], v[24:27], v[16:19], v[96:111]
    ds_read_b128 v[24:27], v112 offset:30720
    v_exp_f32 v54, v54
    v_exp_f32 v55, v55
    v_exp_f32 v56, v56
    v_exp_f32 v57, v57
    v_cvt_pk_bf16_f32 v42, v52, v53
    v_cvt_pk_bf16_f32 v43, v54, v55
    v_mfma_f32_32x32x16_bf16 v[64:79], v[28:31], v[20:23], v[64:79]
    ds_read_b64 v[28:29], v113 offset:30720
    v_exp_f32 v58, v58
    v_exp_f32 v59, v59
    v_exp_f32 v60, v60
    v_exp_f32 v61, v61
    v_cvt_pk_bf16_f32 v44, v56, v57
    v_cvt_pk_bf16_f32 v45, v58, v59
    s_waitcnt lgkmcnt(2)
    v_mfma_f32_32x32x16_bf16 v[80:95], v[32:35], v[40:43], v[80:95]
    v_exp_f32 v62, v62
    v_exp_f32 v63, v63
    s_nop 0
    v_exp_f32 v64, v64
    v_exp_f32 v65, v65
    v_cvt_pk_bf16_f32 v46, v60, v61
    v_cvt_pk_bf16_f32 v47, v62, v63
    v_exp_f32 v66, v66
    v_exp_f32 v67, v67
    v_mfma_f32_32x32x16_bf16 v[80:95], v[36:39], v[44:47], v[80:95]
    s_mov_b64 exec, s[98:99]
    ds_read_b128 v[32:35], v114 offset:28160
    ds_read_b128 v[36:39], v114 offset:28800
    s_mov_b64 exec, -1
    v_exp_f32 v68, v68
    v_exp_f32 v69, v69
    v_cvt_pk_bf16_f32 v40, v64, v65
    v_cvt_pk_bf16_f32 v41, v66, v67
    s_waitcnt lgkmcnt(2)
    v_mfma_f32_32x32x16_bf16 v[48:63], v[24:27], v[16:19], v[96:111]
    ds_read_b128 v[24:27], v112 offset:33280
    v_exp_f32 v70, v70
    v_exp_f32 v71, v71
    v_exp_f32 v72, v72
    v_exp_f32 v73, v73
    v_cvt_pk_bf16_f32 v42, v68, v69
    v_cvt_pk_bf16_f32 v43, v70, v71
    v_mfma_f32_32x32x16_bf16 v[48:63], v[28:31], v[20:23], v[48:63]
    ds_read_b64 v[28:29], v113 offset:33280
    v_exp_f32 v74, v74
    v_exp_f32 v75, v75
    v_exp_f32 v76, v76
    v_exp_f32 v77, v77
    v_cvt_pk_bf16_f32 v44, v72, v73
    v_cvt_pk_bf16_f32 v45, v74, v75
    s_waitcnt lgkmcnt(2)
    v_mfma_f32_32x32x16_bf16 v[80:95], v[32:35], v[40:43], v[80:95]
    v_exp_f32 v78, v78
    v_exp_f32 v79, v79
    s_nop 0
    v_exp_f32 v48, v48
    v_exp_f32 v49, v49
    v_cvt_pk_bf16_f32 v46, v76, v77
    v_cvt_pk_bf16_f32 v47, v78, v79
    v_exp_f32 v50, v50
    v_exp_f32 v51, v51
    v_mfma_f32_32x32x16_bf16 v[80:95], v[36:39], v[44:47], v[80:95]
    s_mov_b64 exec, s[98:99]
    ds_read_b128 v[32:35], v114 offset:30720
    ds_read_b128 v[36:39], v114 offset:31360
    s_mov_b64 exec, -1
    v_exp_f32 v52, v52
    v_exp_f32 v53, v53
    v_cvt_pk_bf16_f32 v40, v48, v49
    v_cvt_pk_bf16_f32 v41, v50, v51
    s_waitcnt lgkmcnt(2)
    v_mfma_f32_32x32x16_bf16 v[64:79], v[24:27], v[16:19], v[96:111]
    ds_read_b128 v[24:27], v112 offset:35840
    v_exp_f32 v54, v54
    v_exp_f32 v55, v55
    v_exp_f32 v56, v56
    v_exp_f32 v57, v57
    v_cvt_pk_bf16_f32 v42, v52, v53
    v_cvt_pk_bf16_f32 v43, v54, v55
    v_mfma_f32_32x32x16_bf16 v[64:79], v[28:31], v[20:23], v[64:79]
    ds_read_b64 v[28:29], v113 offset:35840
    v_exp_f32 v58, v58
    v_exp_f32 v59, v59
    v_exp_f32 v60, v60
    v_exp_f32 v61, v61
    v_cvt_pk_bf16_f32 v44, v56, v57
    v_cvt_pk_bf16_f32 v45, v58, v59
    s_waitcnt lgkmcnt(2)
    v_mfma_f32_32x32x16_bf16 v[80:95], v[32:35], v[40:43], v[80:95]
    v_exp_f32 v62, v62
    v_exp_f32 v63, v63
    s_nop 0
    v_exp_f32 v64, v64
    v_exp_f32 v65, v65
    v_cvt_pk_bf16_f32 v46, v60, v61
    v_cvt_pk_bf16_f32 v47, v62, v63
    v_exp_f32 v66, v66
    v_exp_f32 v67, v67
    v_mfma_f32_32x32x16_bf16 v[80:95], v[36:39], v[44:47], v[80:95]
    s_mov_b64 exec, s[98:99]
    ds_read_b128 v[32:35], v114 offset:33280
    ds_read_b128 v[36:39], v114 offset:33920
    s_mov_b64 exec, -1
    v_exp_f32 v68, v68
    v_exp_f32 v69, v69
    v_cvt_pk_bf16_f32 v40, v64, v65
    v_cvt_pk_bf16_f32 v41, v66, v67
    s_waitcnt lgkmcnt(2)
    v_mfma_f32_32x32x16_bf16 v[48:63], v[24:27], v[16:19], v[96:111]
    ds_read_b128 v[24:27], v112 offset:38400
    v_exp_f32 v70, v70
    v_exp_f32 v71, v71
    v_exp_f32 v72, v72
    v_exp_f32 v73, v73
    v_cvt_pk_bf16_f32 v42, v68, v69
    v_cvt_pk_bf16_f32 v43, v70, v71
    v_mfma_f32_32x32x16_bf16 v[48:63], v[28:31], v[20:23], v[48:63]
    ds_read_b64 v[28:29], v113 offset:38400
    v_exp_f32 v74, v74
    v_exp_f32 v75, v75
    v_exp_f32 v76, v76
    v_exp_f32 v77, v77
    v_cvt_pk_bf16_f32 v44, v72, v73
    v_cvt_pk_bf16_f32 v45, v74, v75
    s_waitcnt lgkmcnt(2)
    v_mfma_f32_32x32x16_bf16 v[80:95], v[32:35], v[40:43], v[80:95]
    v_exp_f32 v78, v78
    v_exp_f32 v79, v79
    s_cmp_eq_u32 s3, 0
    s_cbranch_scc1 adaLN_cond__grouped_kv_mqa__glu_gated_swiglu__prompt_kernel_ool_56
adaLN_cond__grouped_kv_mqa__glu_gated_swiglu__prompt_kernel_ret_57:
    s_cmp_ge_u32 s3, 4
    s_cbranch_scc1 adaLN_cond__grouped_kv_mqa__glu_gated_swiglu__prompt_kernel_kvw_58
    s_waitcnt vmcnt(0)
adaLN_cond__grouped_kv_mqa__glu_gated_swiglu__prompt_kernel_kvw_58:
    s_barrier
    v_exp_f32 v48, v48
    v_exp_f32 v49, v49
    v_cvt_pk_bf16_f32 v46, v76, v77
    v_cvt_pk_bf16_f32 v47, v78, v79
    v_exp_f32 v50, v50
    v_exp_f32 v51, v51
    v_mfma_f32_32x32x16_bf16 v[80:95], v[36:39], v[44:47], v[80:95]
    s_mov_b64 exec, s[98:99]
    ds_read_b128 v[32:35], v114 offset:35840
    ds_read_b128 v[36:39], v114 offset:36480
    s_mov_b64 exec, -1
    v_exp_f32 v52, v52
    v_exp_f32 v53, v53
    v_cvt_pk_bf16_f32 v40, v48, v49
    v_cvt_pk_bf16_f32 v41, v50, v51
    s_waitcnt lgkmcnt(2)
    v_mfma_f32_32x32x16_bf16 v[64:79], v[24:27], v[16:19], v[96:111]
    ds_read_b128 v[24:27], v112 offset:40960
    v_exp_f32 v54, v54
    v_exp_f32 v55, v55
    v_exp_f32 v56, v56
    v_exp_f32 v57, v57
    v_cvt_pk_bf16_f32 v42, v52, v53
    v_cvt_pk_bf16_f32 v43, v54, v55
    v_mfma_f32_32x32x16_bf16 v[64:79], v[28:31], v[20:23], v[64:79]
    ds_read_b64 v[28:29], v113 offset:40960
    v_exp_f32 v58, v58
    v_exp_f32 v59, v59
    v_exp_f32 v60, v60
    v_exp_f32 v61, v61
    v_cvt_pk_bf16_f32 v44, v56, v57
    v_cvt_pk_bf16_f32 v45, v58, v59
    s_waitcnt lgkmcnt(2)
    v_mfma_f32_32x32x16_bf16 v[80:95], v[32:35], v[40:43], v[80:95]
    v_exp_f32 v62, v62
    v_exp_f32 v63, v63
    s_cmp_ge_u32 s3, 4
    s_cbranch_scc1 adaLN_cond__grouped_kv_mqa__glu_gated_swiglu__prompt_kernel_ool_59
adaLN_cond__grouped_kv_mqa__glu_gated_swiglu__prompt_kernel_ret_60:
    v_exp_f32 v64, v64
    v_exp_f32 v65, v65
    v_cvt_pk_bf16_f32 v46, v60, v61
    v_cvt_pk_bf16_f32 v47, v62, v63
    v_exp_f32 v66, v66
    v_exp_f32 v67, v67
    v_mfma_f32_32x32x16_bf16 v[80:95], v[36:39], v[44:47], v[80:95]
    s_mov_b64 exec, s[98:99]
    ds_read_b128 v[32:35], v114 offset:38400
    ds_read_b128 v[36:39], v114 offset:39040
    s_mov_b64 exec, -1
    v_exp_f32 v68, v68
    v_exp_f32 v69, v69
    v_cvt_pk_bf16_f32 v40, v64, v65
    v_cvt_pk_bf16_f32 v41, v66, v67
    s_waitcnt lgkmcnt(2)
    v_mfma_f32_32x32x16_bf16 v[48:63], v[24:27], v[16:19], v[96:111]
    ds_read_b128 v[24:27], v112 offset:43520
    v_exp_f32 v70, v70
    v_exp_f32 v71, v71
    v_exp_f32 v72, v72
    v_exp_f32 v73, v73
    v_cvt_pk_bf16_f32 v42, v68, v69
    v_cvt_pk_bf16_f32 v43, v70, v71
    v_mfma_f32_32x32x16_bf16 v[48:63], v[28:31], v[20:23], v[48:63]
    ds_read_b64 v[28:29], v113 offset:43520
    v_exp_f32 v74, v74
    v_exp_f32 v75, v75
    v_exp_f32 v76, v76
    v_exp_f32 v77, v77
    v_cvt_pk_bf16_f32 v44, v72, v73
    v_cvt_pk_bf16_f32 v45, v74, v75
    s_waitcnt lgkmcnt(2)
    v_mfma_f32_32x32x16_bf16 v[80:95], v[32:35], v[40:43], v[80:95]
    v_exp_f32 v78, v78
    v_exp_f32 v79, v79
    v_add_u32 v112, 40960, v112
    v_add_u32 v113, 40960, v113
    v_add_u32 v114, 40960, v114
    v_exp_f32 v48, v48
    v_exp_f32 v49, v49
    v_cvt_pk_bf16_f32 v46, v76, v77
    v_cvt_pk_bf16_f32 v47, v78, v79
    v_exp_f32 v50, v50
    v_exp_f32 v51, v51
    v_mfma_f32_32x32x16_bf16 v[80:95], v[36:39], v[44:47], v[80:95]
    s_mov_b64 exec, s[98:99]
    ds_read_b128 v[32:35], v114 offset:0
    ds_read_b128 v[36:39], v114 offset:640
    s_mov_b64 exec, -1
    v_exp_f32 v52, v52
    v_exp_f32 v53, v53
    v_cvt_pk_bf16_f32 v40, v48, v49
    v_cvt_pk_bf16_f32 v41, v50, v51
    s_waitcnt lgkmcnt(2)
    v_mfma_f32_32x32x16_bf16 v[64:79], v[24:27], v[16:19], v[96:111]
    ds_read_b128 v[24:27], v112 offset:5120
    v_exp_f32 v54, v54
    v_exp_f32 v55, v55
    v_exp_f32 v56, v56
    v_exp_f32 v57, v57
    v_cvt_pk_bf16_f32 v42, v52, v53
    v_cvt_pk_bf16_f32 v43, v54, v55
    v_mfma_f32_32x32x16_bf16 v[64:79], v[28:31], v[20:23], v[64:79]
    ds_read_b64 v[28:29], v113 offset:5120
    v_exp_f32 v58, v58
    v_exp_f32 v59, v59
    v_exp_f32 v60, v60
    v_exp_f32 v61, v61
    v_cvt_pk_bf16_f32 v44, v56, v57
    v_cvt_pk_bf16_f32 v45, v58, v59
    s_waitcnt lgkmcnt(2)
    v_mfma_f32_32x32x16_bf16 v[80:95], v[32:35], v[40:43], v[80:95]
    v_exp_f32 v62, v62
    v_exp_f32 v63, v63
    s_barrier
    s_cmp_ge_u32 s3, 4
    s_cbranch_scc1 adaLN_cond__grouped_kv_mqa__glu_gated_swiglu__prompt_kernel_kvd_61
    s_add_u32 s97, s96, 122880
    s_sub_u32 s42, s97, 122880
    s_mov_b32 m0, s42
    s_nop 0
    buffer_load_dwordx4 v2, s[24:27], s97 offen sc1 lds
    s_add_u32 s97, s96, 126976
    s_sub_u32 s42, s97, 122880
    s_mov_b32 m0, s42
    s_nop 0
    buffer_load_dwordx4 v2, s[24:27], s97 offen sc1 lds
    s_add_u32 s97, s96, 131072
    s_sub_u32 s42, s97, 122880
    s_mov_b32 m0, s42
    s_nop 0
    buffer_load_dwordx4 v2, s[24:27], s97 offen sc1 lds
    s_add_u32 s97, s96, 135168
    s_sub_u32 s42, s97, 122880
    s_mov_b32 m0, s42
    s_nop 0
    buffer_load_dwordx4 v2, s[24:27], s97 offen sc1 lds
    s_add_u32 s97, s96, 139264
    s_sub_u32 s42, s97, 122880
    s_mov_b32 m0, s42
    s_nop 0
    buffer_load_dwordx4 v2, s[24:27], s97 offen sc1 lds
adaLN_cond__grouped_kv_mqa__glu_gated_swiglu__prompt_kernel_kvd_61:
    v_exp_f32 v64, v64
    v_exp_f32 v65, v65
    v_cvt_pk_bf16_f32 v46, v60, v61
    v_cvt_pk_bf16_f32 v47, v62, v63
    v_exp_f32 v66, v66
    v_exp_f32 v67, v67
    v_mfma_f32_32x32x16_bf16 v[80:95], v[36:39], v[44:47], v[80:95]
    s_mov_b64 exec, s[98:99]
    ds_read_b128 v[32:35], v114 offset:2560
    ds_read_b128 v[36:39], v114 offset:3200
    s_mov_b64 exec, -1
    v_exp_f32 v68, v68
    v_exp_f32 v69, v69
    v_cvt_pk_bf16_f32 v40, v64, v65
    v_cvt_pk_bf16_f32 v41, v66, v67
    s_waitcnt lgkmcnt(2)
    v_mfma_f32_32x32x16_bf16 v[48:63], v[24:27], v[16:19], v[96:111]
    ds_read_b128 v[24:27], v112 offset:7680
    v_exp_f32 v70, v70
    v_exp_f32 v71, v71
    v_exp_f32 v72, v72
    v_exp_f32 v73, v73
    v_cvt_pk_bf16_f32 v42, v68, v69
    v_cvt_pk_bf16_f32 v43, v70, v71
    v_mfma_f32_32x32x16_bf16 v[48:63], v[28:31], v[20:23], v[48:63]
    ds_read_b64 v[28:29], v113 offset:7680
    v_exp_f32 v74, v74
    v_exp_f32 v75, v75
    v_exp_f32 v76, v76
    v_exp_f32 v77, v77
    v_cvt_pk_bf16_f32 v44, v72, v73
    v_cvt_pk_bf16_f32 v45, v74, v75
    s_waitcnt lgkmcnt(2)
    v_mfma_f32_32x32x16_bf16 v[80:95], v[32:35], v[40:43], v[80:95]
    v_exp_f32 v78, v78
    v_exp_f32 v79, v79
    s_cmp_ge_u32 s3, 4
    s_cbranch_scc1 adaLN_cond__grouped_kv_mqa__glu_gated_swiglu__prompt_kernel_kvd_62
    s_add_u32 s97, s96, 143360
    s_sub_u32 s42, s97, 122880
    s_mov_b32 m0, s42
    s_nop 0
    buffer_load_dwordx4 v2, s[24:27], s97 offen sc1 lds
    s_add_u32 s97, s96, 147456
    s_sub_u32 s42, s97, 122880
    s_mov_b32 m0, s42
    s_nop 0
    buffer_load_dwordx4 v2, s[24:27], s97 offen sc1 lds
    s_add_u32 s97, s96, 151552
    s_sub_u32 s42, s97, 122880
    s_mov_b32 m0, s42
    s_nop 0
    buffer_load_dwordx4 v2, s[24:27], s97 offen sc1 lds
    s_add_u32 s97, s96, 155648
    s_sub_u32 s42, s97, 122880
    s_mov_b32 m0, s42
    s_nop 0
    buffer_load_dwordx4 v2, s[24:27], s97 offen sc1 lds
    s_add_u32 s97, s96, 159744
    s_sub_u32 s42, s97, 122880
    s_mov_b32 m0, s42
    s_nop 0
    buffer_load_dwordx4 v2, s[24:27], s97 offen sc1 lds
adaLN_cond__grouped_kv_mqa__glu_gated_swiglu__prompt_kernel_kvd_62:
    v_exp_f32 v48, v48
    v_exp_f32 v49, v49
    v_cvt_pk_bf16_f32 v46, v76, v77
    v_cvt_pk_bf16_f32 v47, v78, v79
    v_exp_f32 v50, v50
    v_exp_f32 v51, v51
    v_mfma_f32_32x32x16_bf16 v[80:95], v[36:39], v[44:47], v[80:95]
    s_mov_b64 exec, s[98:99]
    ds_read_b128 v[32:35], v114 offset:5120
    ds_read_b128 v[36:39], v114 offset:5760
    s_mov_b64 exec, -1
    v_exp_f32 v52, v52
    v_exp_f32 v53, v53
    v_cvt_pk_bf16_f32 v40, v48, v49
    v_cvt_pk_bf16_f32 v41, v50, v51
    s_waitcnt lgkmcnt(2)
    v_mfma_f32_32x32x16_bf16 v[64:79], v[24:27], v[16:19], v[96:111]
    ds_read_b128 v[24:27], v112 offset:10240
    v_exp_f32 v54, v54
    v_exp_f32 v55, v55
    v_exp_f32 v56, v56
    v_exp_f32 v57, v57
    v_cvt_pk_bf16_f32 v42, v52, v53
    v_cvt_pk_bf16_f32 v43, v54, v55
    v_mfma_f32_32x32x16_bf16 v[64:79], v[28:31], v[20:23], v[64:79]
    ds_read_b64 v[28:29], v113 offset:10240
    v_exp_f32 v58, v58
    v_exp_f32 v59, v59
    v_exp_f32 v60, v60
    v_exp_f32 v61, v61
    v_cvt_pk_bf16_f32 v44, v56, v57
    v_cvt_pk_bf16_f32 v45, v58, v59
    s_waitcnt lgkmcnt(2)
    v_mfma_f32_32x32x16_bf16 v[80:95], v[32:35], v[40:43], v[80:95]
    v_exp_f32 v62, v62
    v_exp_f32 v63, v63
    s_cmp_ge_u32 s3, 4
    s_cbranch_scc1 adaLN_cond__grouped_kv_mqa__glu_gated_swiglu__prompt_kernel_ool_63
adaLN_cond__grouped_kv_mqa__glu_gated_swiglu__prompt_kernel_ret_64:
    v_exp_f32 v64, v64
    v_exp_f32 v65, v65
    v_cvt_pk_bf16_f32 v46, v60, v61
    v_cvt_pk_bf16_f32 v47, v62, v63
    v_exp_f32 v66, v66
    v_exp_f32 v67, v67
    v_mfma_f32_32x32x16_bf16 v[80:95], v[36:39], v[44:47], v[80:95]
    s_mov_b64 exec, s[98:99]
    ds_read_b128 v[32:35], v114 offset:7680
    ds_read_b128 v[36:39], v114 offset:8320
    s_mov_b64 exec, -1
    v_exp_f32 v68, v68
    v_exp_f32 v69, v69
    v_cvt_pk_bf16_f32 v40, v64, v65
    v_cvt_pk_bf16_f32 v41, v66, v67
    s_waitcnt lgkmcnt(2)
    v_mfma_f32_32x32x16_bf16 v[48:63], v[24:27], v[16:19], v[96:111]
    ds_read_b128 v[24:27], v112 offset:12800
    v_exp_f32 v70, v70
    v_exp_f32 v71, v71
    v_exp_f32 v72, v72
    v_exp_f32 v73, v73
    v_cvt_pk_bf16_f32 v42, v68, v69
    v_cvt_pk_bf16_f32 v43, v70, v71
    v_mfma_f32_32x32x16_bf16 v[48:63], v[28:31], v[20:23], v[48:63]
    ds_read_b64 v[28:29], v113 offset:12800
    v_exp_f32 v74, v74
    v_exp_f32 v75, v75
    v_exp_f32 v76, v76
    v_exp_f32 v77, v77
    v_cvt_pk_bf16_f32 v44, v72, v73
    v_cvt_pk_bf16_f32 v45, v74, v75
    s_waitcnt lgkmcnt(2)
    v_mfma_f32_32x32x16_bf16 v[80:95], v[32:35], v[40:43], v[80:95]
    v_exp_f32 v78, v78
    v_exp_f32 v79, v79
    s_nop 0
    v_exp_f32 v48, v48
    v_exp_f32 v49, v49
    v_cvt_pk_bf16_f32 v46, v76, v77
    v_cvt_pk_bf16_f32 v47, v78, v79
    v_exp_f32 v50, v50
    v_exp_f32 v51, v51
    v_mfma_f32_32x32x16_bf16 v[80:95], v[36:39], v[44:47], v[80:95]
    s_mov_b64 exec, s[98:99]
    ds_read_b128 v[32:35], v114 offset:10240
    ds_read_b128 v[36:39], v114 offset:10880
    s_mov_b64 exec, -1
    v_exp_f32 v52, v52
    v_exp_f32 v53, v53
    v_cvt_pk_bf16_f32 v40, v48, v49
    v_cvt_pk_bf16_f32 v41, v50, v51
    s_waitcnt lgkmcnt(2)
    v_mfma_f32_32x32x16_bf16 v[64:79], v[24:27], v[16:19], v[96:111]
    ds_read_b128 v[24:27], v112 offset:15360
    v_exp_f32 v54, v54
    v_exp_f32 v55, v55
    v_exp_f32 v56, v56
    v_exp_f32 v57, v57
    v_cvt_pk_bf16_f32 v42, v52, v53
    v_cvt_pk_bf16_f32 v43, v54, v55
    v_mfma_f32_32x32x16_bf16 v[64:79], v[28:31], v[20:23], v[64:79]
    ds_read_b64 v[28:29], v113 offset:15360
    v_exp_f32 v58, v58
    v_exp_f32 v59, v59
    v_exp_f32 v60, v60
    v_exp_f32 v61, v61
    v_cvt_pk_bf16_f32 v44, v56, v57
    v_cvt_pk_bf16_f32 v45, v58, v59
    s_waitcnt lgkmcnt(2)
    v_mfma_f32_32x32x16_bf16 v[80:95], v[32:35], v[40:43], v[80:95]
    v_exp_f32 v62, v62
    v_exp_f32 v63, v63
    s_nop 0
    v_exp_f32 v64, v64
    v_exp_f32 v65, v65
    v_cvt_pk_bf16_f32 v46, v60, v61
    v_cvt_pk_bf16_f32 v47, v62, v63
    v_exp_f32 v66, v66
    v_exp_f32 v67, v67
    v_mfma_f32_32x32x16_bf16 v[80:95], v[36:39], v[44:47], v[80:95]
    s_mov_b64 exec, s[98:99]
    ds_read_b128 v[32:35], v114 offset:12800
    ds_read_b128 v[36:39], v114 offset:13440
    s_mov_b64 exec, -1
    v_exp_f32 v68, v68
    v_exp_f32 v69, v69
    v_cvt_pk_bf16_f32 v40, v64, v65
    v_cvt_pk_bf16_f32 v41, v66, v67
    s_waitcnt lgkmcnt(2)
    v_mfma_f32_32x32x16_bf16 v[48:63], v[24:27], v[16:19], v[96:111]
    ds_read_b128 v[24:27], v112 offset:17920
    v_exp_f32 v70, v70
    v_exp_f32 v71, v71
    v_exp_f32 v72, v72
    v_exp_f32 v73, v73
    v_cvt_pk_bf16_f32 v42, v68, v69
    v_cvt_pk_bf16_f32 v43, v70, v71
    v_mfma_f32_32x32x16_bf16 v[48:63], v[28:31], v[20:23], v[48:63]
    ds_read_b64 v[28:29], v113 offset:17920
    v_exp_f32 v74, v74
    v_exp_f32 v75, v75
    v_exp_f32 v76, v76
    v_exp_f32 v77, v77
    v_cvt_pk_bf16_f32 v44, v72, v73
    v_cvt_pk_bf16_f32 v45, v74, v75
    s_waitcnt lgkmcnt(2)
    v_mfma_f32_32x32x16_bf16 v[80:95], v[32:35], v[40:43], v[80:95]
    v_exp_f32 v78, v78
    v_exp_f32 v79, v79
    s_nop 0
    v_exp_f32 v48, v48
    v_exp_f32 v49, v49
    v_cvt_pk_bf16_f32 v46, v76, v77
    v_cvt_pk_bf16_f32 v47, v78, v79
    v_exp_f32 v50, v50
    v_exp_f32 v51, v51
    v_mfma_f32_32x32x16_bf16 v[80:95], v[36:39], v[44:47], v[80:95]
    s_mov_b64 exec, s[98:99]
    ds_read_b128 v[32:35], v114 offset:15360
    ds_read_b128 v[36:39], v114 offset:16000
    s_mov_b64 exec, -1
    v_exp_f32 v52, v52
    v_exp_f32 v53, v53
    v_cvt_pk_bf16_f32 v40, v48, v49
    v_cvt_pk_bf16_f32 v41, v50, v51
    s_waitcnt lgkmcnt(2)
    v_mfma_f32_32x32x16_bf16 v[64:79], v[24:27], v[16:19], v[96:111]
    ds_read_b128 v[24:27], v112 offset:20480
    v_exp_f32 v54, v54
    v_exp_f32 v55, v55
    v_exp_f32 v56, v56
    v_exp_f32 v57, v57
    v_cvt_pk_bf16_f32 v42, v52, v53
    v_cvt_pk_bf16_f32 v43, v54, v55
    v_mfma_f32_32x32x16_bf16 v[64:79], v[28:31], v[20:23], v[64:79]
    ds_read_b64 v[28:29], v113 offset:20480
    v_exp_f32 v58, v58
    v_exp_f32 v59, v59
    v_exp_f32 v60, v60
    v_exp_f32 v61, v61
    v_cvt_pk_bf16_f32 v44, v56, v57
    v_cvt_pk_bf16_f32 v45, v58, v59
    s_waitcnt lgkmcnt(2)
    v_mfma_f32_32x32x16_bf16 v[80:95], v[32:35], v[40:43], v[80:95]
    v_exp_f32 v62, v62
    v_exp_f32 v63, v63
    s_nop 0
    v_exp_f32 v64, v64
    v_exp_f32 v65, v65
    v_cvt_pk_bf16_f32 v46, v60, v61
    v_cvt_pk_bf16_f32 v47, v62, v63
    v_exp_f32 v66, v66
    v_exp_f32 v67, v67
    v_mfma_f32_32x32x16_bf16 v[80:95], v[36:39], v[44:47], v[80:95]
    s_mov_b64 exec, s[98:99]
    ds_read_b128 v[32:35], v114 offset:17920
    ds_read_b128 v[36:39], v114 offset:18560
    s_mov_b64 exec, -1
    v_exp_f32 v68, v68
    v_exp_f32 v69, v69
    v_cvt_pk_bf16_f32 v40, v64, v65
    v_cvt_pk_bf16_f32 v41, v66, v67
    s_waitcnt lgkmcnt(2)
    v_mfma_f32_32x32x16_bf16 v[48:63], v[24:27], v[16:19], v[96:111]
    ds_read_b128 v[24:27], v112 offset:23040
    v_exp_f32 v70, v70
    v_exp_f32 v71, v71
    v_exp_f32 v72, v72
    v_exp_f32 v73, v73
    v_cvt_pk_bf16_f32 v42, v68, v69
    v_cvt_pk_bf16_f32 v43, v70, v71
    v_mfma_f32_32x32x16_bf16 v[48:63], v[28:31], v[20:23], v[48:63]
    ds_read_b64 v[28:29], v113 offset:23040
    v_exp_f32 v74, v74
    v_exp_f32 v75, v75
    v_exp_f32 v76, v76
    v_exp_f32 v77, v77
    v_cvt_pk_bf16_f32 v44, v72, v73
    v_cvt_pk_bf16_f32 v45, v74, v75
    s_waitcnt lgkmcnt(2)
    v_mfma_f32_32x32x16_bf16 v[80:95], v[32:35], v[40:43], v[80:95]
    v_exp_f32 v78, v78
    v_exp_f32 v79, v79
    s_nop 0
    v_exp_f32 v48, v48
    v_exp_f32 v49, v49
    v_cvt_pk_bf16_f32 v46, v76, v77
    v_cvt_pk_bf16_f32 v47, v78, v79
    v_exp_f32 v50, v50
    v_exp_f32 v51, v51
    v_mfma_f32_32x32x16_bf16 v[80:95], v[36:39], v[44:47], v[80:95]
    s_mov_b64 exec, s[98:99]
    ds_read_b128 v[32:35], v114 offset:20480
    ds_read_b128 v[36:39], v114 offset:21120
    s_mov_b64 exec, -1
    v_exp_f32 v52, v52
    v_exp_f32 v53, v53
    v_cvt_pk_bf16_f32 v40, v48, v49
    v_cvt_pk_bf16_f32 v41, v50, v51
    s_waitcnt lgkmcnt(2)
    v_mfma_f32_32x32x16_bf16 v[64:79], v[24:27], v[16:19], v[96:111]
    ds_read_b128 v[24:27], v112 offset:25600
    v_exp_f32 v54, v54
    v_exp_f32 v55, v55
    v_exp_f32 v56, v56
    v_exp_f32 v57, v57
    v_cvt_pk_bf16_f32 v42, v52, v53
    v_cvt_pk_bf16_f32 v43, v54, v55
    v_mfma_f32_32x32x16_bf16 v[64:79], v[28:31], v[20:23], v[64:79]
    ds_read_b64 v[28:29], v113 offset:25600
    v_exp_f32 v58, v58
    v_exp_f32 v59, v59
    v_exp_f32 v60, v60
    v_exp_f32 v61, v61
    v_cvt_pk_bf16_f32 v44, v56, v57
    v_cvt_pk_bf16_f32 v45, v58, v59
    s_waitcnt lgkmcnt(2)
    v_mfma_f32_32x32x16_bf16 v[80:95], v[32:35], v[40:43], v[80:95]
    v_exp_f32 v62, v62
    v_exp_f32 v63, v63
    s_nop 0
    v_exp_f32 v64, v64
    v_exp_f32 v65, v65
    v_cvt_pk_bf16_f32 v46, v60, v61
    v_cvt_pk_bf16_f32 v47, v62, v63
    v_exp_f32 v66, v66
    v_exp_f32 v67, v67
    v_mfma_f32_32x32x16_bf16 v[80:95], v[36:39], v[44:47], v[80:95]
    s_mov_b64 exec, s[98:99]
    ds_read_b128 v[32:35], v114 offset:23040
    ds_read_b128 v[36:39], v114 offset:23680
    s_mov_b64 exec, -1
    v_exp_f32 v68, v68
    v_exp_f32 v69, v69
    v_cvt_pk_bf16_f32 v40, v64, v65
    v_cvt_pk_bf16_f32 v41, v66, v67
    s_waitcnt lgkmcnt(2)
    v_mfma_f32_32x32x16_bf16 v[48:63], v[24:27], v[16:19], v[96:111]
    ds_read_b128 v[24:27], v112 offset:28160
    v_exp_f32 v70, v70
    v_exp_f32 v71, v71
    v_exp_f32 v72, v72
    v_exp_f32 v73, v73
    v_cvt_pk_bf16_f32 v42, v68, v69
    v_cvt_pk_bf16_f32 v43, v70, v71
    v_mfma_f32_32x32x16_bf16 v[48:63], v[28:31], v[20:23], v[48:63]
    ds_read_b64 v[28:29], v113 offset:28160
    v_exp_f32 v74, v74
    v_exp_f32 v75, v75
    v_exp_f32 v76, v76
    v_exp_f32 v77, v77
    v_cvt_pk_bf16_f32 v44, v72, v73
    v_cvt_pk_bf16_f32 v45, v74, v75
    s_waitcnt lgkmcnt(2)
    v_mfma_f32_32x32x16_bf16 v[80:95], v[32:35], v[40:43], v[80:95]
    v_exp_f32 v78, v78
    v_exp_f32 v79, v79
    s_nop 0
    v_exp_f32 v48, v48
    v_exp_f32 v49, v49
    v_cvt_pk_bf16_f32 v46, v76, v77
    v_cvt_pk_bf16_f32 v47, v78, v79
    v_exp_f32 v50, v50
    v_exp_f32 v51, v51
    v_mfma_f32_32x32x16_bf16 v[80:95], v[36:39], v[44:47], v[80:95]
    s_mov_b64 exec, s[98:99]
    ds_read_b128 v[32:35], v114 offset:25600
    ds_read_b128 v[36:39], v114 offset:26240
    s_mov_b64 exec, -1
    v_exp_f32 v52, v52
    v_exp_f32 v53, v53
    v_cvt_pk_bf16_f32 v40, v48, v49
    v_cvt_pk_bf16_f32 v41, v50, v51
    s_waitcnt lgkmcnt(2)
    v_mfma_f32_32x32x16_bf16 v[64:79], v[24:27], v[16:19], v[96:111]
    ds_read_b128 v[24:27], v112 offset:30720
    v_exp_f32 v54, v54
    v_exp_f32 v55, v55
    v_exp_f32 v56, v56
    v_exp_f32 v57, v57
    v_cvt_pk_bf16_f32 v42, v52, v53
    v_cvt_pk_bf16_f32 v43, v54, v55
    v_mfma_f32_32x32x16_bf16 v[64:79], v[28:31], v[20:23], v[64:79]
    ds_read_b64 v[28:29], v113 offset:30720
    v_exp_f32 v58, v58
    v_exp_f32 v59, v59
    v_exp_f32 v60, v60
    v_exp_f32 v61, v61
    v_cvt_pk_bf16_f32 v44, v56, v57
    v_cvt_pk_bf16_f32 v45, v58, v59
    s_waitcnt lgkmcnt(2)
    v_mfma_f32_32x32x16_bf16 v[80:95], v[32:35], v[40:43], v[80:95]
    v_exp_f32 v62, v62
    v_exp_f32 v63, v63
    s_nop 0
    v_exp_f32 v64, v64
    v_exp_f32 v65, v65
    v_cvt_pk_bf16_f32 v46, v60, v61
    v_cvt_pk_bf16_f32 v47, v62, v63
    v_exp_f32 v66, v66
    v_exp_f32 v67, v67
    v_mfma_f32_32x32x16_bf16 v[80:95], v[36:39], v[44:47], v[80:95]
    s_mov_b64 exec, s[98:99]
    ds_read_b128 v[32:35], v114 offset:28160
    ds_read_b128 v[36:39], v114 offset:28800
    s_mov_b64 exec, -1
    v_exp_f32 v68, v68
    v_exp_f32 v69, v69
    v_cvt_pk_bf16_f32 v40, v64, v65
    v_cvt_pk_bf16_f32 v41, v66, v67
    s_waitcnt lgkmcnt(2)
    v_mfma_f32_32x32x16_bf16 v[48:63], v[24:27], v[16:19], v[96:111]
    ds_read_b128 v[24:27], v112 offset:33280
    v_exp_f32 v70, v70
    v_exp_f32 v71, v71
    v_exp_f32 v72, v72
    v_exp_f32 v73, v73
    v_cvt_pk_bf16_f32 v42, v68, v69
    v_cvt_pk_bf16_f32 v43, v70, v71
    v_mfma_f32_32x32x16_bf16 v[48:63], v[28:31], v[20:23], v[48:63]
    ds_read_b64 v[28:29], v113 offset:33280
    v_exp_f32 v74, v74
    v_exp_f32 v75, v75
    v_exp_f32 v76, v76
    v_exp_f32 v77, v77
    v_cvt_pk_bf16_f32 v44, v72, v73
    v_cvt_pk_bf16_f32 v45, v74, v75
    s_waitcnt lgkmcnt(2)
    v_mfma_f32_32x32x16_bf16 v[80:95], v[32:35], v[40:43], v[80:95]
    v_exp_f32 v78, v78
    v_exp_f32 v79, v79
    s_nop 0
    v_exp_f32 v48, v48
    v_exp_f32 v49, v49
    v_cvt_pk_bf16_f32 v46, v76, v77
    v_cvt_pk_bf16_f32 v47, v78, v79
    v_exp_f32 v50, v50
    v_exp_f32 v51, v51
    v_mfma_f32_32x32x16_bf16 v[80:95], v[36:39], v[44:47], v[80:95]
    s_mov_b64 exec, s[98:99]
    ds_read_b128 v[32:35], v114 offset:30720
    ds_read_b128 v[36:39], v114 offset:31360
    s_mov_b64 exec, -1
    v_exp_f32 v52, v52
    v_exp_f32 v53, v53
    v_cvt_pk_bf16_f32 v40, v48, v49
    v_cvt_pk_bf16_f32 v41, v50, v51
    s_waitcnt lgkmcnt(2)
    v_mfma_f32_32x32x16_bf16 v[64:79], v[24:27], v[16:19], v[96:111]
    ds_read_b128 v[24:27], v112 offset:35840
    v_exp_f32 v54, v54
    v_exp_f32 v55, v55
    v_exp_f32 v56, v56
    v_exp_f32 v57, v57
    v_cvt_pk_bf16_f32 v42, v52, v53
    v_cvt_pk_bf16_f32 v43, v54, v55
    v_mfma_f32_32x32x16_bf16 v[64:79], v[28:31], v[20:23], v[64:79]
    ds_read_b64 v[28:29], v113 offset:35840
    v_exp_f32 v58, v58
    v_exp_f32 v59, v59
    v_exp_f32 v60, v60
    v_exp_f32 v61, v61
    v_cvt_pk_bf16_f32 v44, v56, v57
    v_cvt_pk_bf16_f32 v45, v58, v59
    s_waitcnt lgkmcnt(2)
    v_mfma_f32_32x32x16_bf16 v[80:95], v[32:35], v[40:43], v[80:95]
    v_exp_f32 v62, v62
    v_exp_f32 v63, v63
    s_nop 0
    v_exp_f32 v64, v64
    v_exp_f32 v65, v65
    v_cvt_pk_bf16_f32 v46, v60, v61
    v_cvt_pk_bf16_f32 v47, v62, v63
    v_exp_f32 v66, v66
    v_exp_f32 v67, v67
    v_mfma_f32_32x32x16_bf16 v[80:95], v[36:39], v[44:47], v[80:95]
    s_mov_b64 exec, s[98:99]
    ds_read_b128 v[32:35], v114 offset:33280
    ds_read_b128 v[36:39], v114 offset:33920
    s_mov_b64 exec, -1
    v_exp_f32 v68, v68
    v_exp_f32 v69, v69
    v_cvt_pk_bf16_f32 v40, v64, v65
    v_cvt_pk_bf16_f32 v41, v66, v67
    s_waitcnt lgkmcnt(2)
    v_mfma_f32_32x32x16_bf16 v[48:63], v[24:27], v[16:19], v[96:111]
    ds_read_b128 v[24:27], v112 offset:38400
    v_exp_f32 v70, v70
    v_exp_f32 v71, v71
    v_exp_f32 v72, v72
    v_exp_f32 v73, v73
    v_cvt_pk_bf16_f32 v42, v68, v69
    v_cvt_pk_bf16_f32 v43, v70, v71
    v_mfma_f32_32x32x16_bf16 v[48:63], v[28:31], v[20:23], v[48:63]
    ds_read_b64 v[28:29], v113 offset:38400
    v_exp_f32 v74, v74
    v_exp_f32 v75, v75
    v_exp_f32 v76, v76
    v_exp_f32 v77, v77
    v_cvt_pk_bf16_f32 v44, v72, v73
    v_cvt_pk_bf16_f32 v45, v74, v75
    s_waitcnt lgkmcnt(2)
    v_mfma_f32_32x32x16_bf16 v[80:95], v[32:35], v[40:43], v[80:95]
    v_exp_f32 v78, v78
    v_exp_f32 v79, v79
    s_waitcnt vmcnt(0)
    s_barrier
    s_cmp_eq_u32 s3, 0
    s_cbranch_scc1 adaLN_cond__grouped_kv_mqa__glu_gated_swiglu__prompt_kernel_ool_65
adaLN_cond__grouped_kv_mqa__glu_gated_swiglu__prompt_kernel_ret_66:
    v_exp_f32 v48, v48
    v_exp_f32 v49, v49
    v_cvt_pk_bf16_f32 v46, v76, v77
    v_cvt_pk_bf16_f32 v47, v78, v79
    v_exp_f32 v50, v50
    v_exp_f32 v51, v51
    v_mfma_f32_32x32x16_bf16 v[80:95], v[36:39], v[44:47], v[80:95]
    s_mov_b64 exec, s[98:99]
    ds_read_b128 v[32:35], v114 offset:35840
    ds_read_b128 v[36:39], v114 offset:36480
    s_mov_b64 exec, -1
    v_exp_f32 v52, v52
    v_exp_f32 v53, v53
    v_cvt_pk_bf16_f32 v40, v48, v49
    v_cvt_pk_bf16_f32 v41, v50, v51
    s_waitcnt lgkmcnt(2)
    v_mfma_f32_32x32x16_bf16 v[64:79], v[24:27], v[16:19], v[96:111]
    ds_read_b128 v[24:27], v112 offset:40960
    v_exp_f32 v54, v54
    v_exp_f32 v55, v55
    v_exp_f32 v56, v56
    v_exp_f32 v57, v57
    v_cvt_pk_bf16_f32 v42, v52, v53
    v_cvt_pk_bf16_f32 v43, v54, v55
    v_mfma_f32_32x32x16_bf16 v[64:79], v[28:31], v[20:23], v[64:79]
    ds_read_b64 v[28:29], v113 offset:40960
    v_exp_f32 v58, v58
    v_exp_f32 v59, v59
    v_exp_f32 v60, v60
    v_exp_f32 v61, v61
    v_cvt_pk_bf16_f32 v44, v56, v57
    v_cvt_pk_bf16_f32 v45, v58, v59
    s_waitcnt lgkmcnt(2)
    v_mfma_f32_32x32x16_bf16 v[80:95], v[32:35], v[40:43], v[80:95]
    v_exp_f32 v62, v62
    v_exp_f32 v63, v63
    s_cmp_eq_u32 s3, 0
    s_cbranch_scc1 adaLN_cond__grouped_kv_mqa__glu_gated_swiglu__prompt_kernel_ool_67
adaLN_cond__grouped_kv_mqa__glu_gated_swiglu__prompt_kernel_ret_68:
    v_exp_f32 v64, v64
    v_exp_f32 v65, v65
    v_cvt_pk_bf16_f32 v46, v60, v61
    v_cvt_pk_bf16_f32 v47, v62, v63
    v_exp_f32 v66, v66
    v_exp_f32 v67, v67
    v_mfma_f32_32x32x16_bf16 v[80:95], v[36:39], v[44:47], v[80:95]
    s_mov_b64 exec, s[98:99]
    ds_read_b128 v[32:35], v114 offset:38400
    ds_read_b128 v[36:39], v114 offset:39040
    s_mov_b64 exec, -1
    v_exp_f32 v68, v68
    v_exp_f32 v69, v69
    v_cvt_pk_bf16_f32 v40, v64, v65
    v_cvt_pk_bf16_f32 v41, v66, v67
    s_waitcnt lgkmcnt(2)
    v_mfma_f32_32x32x16_bf16 v[48:63], v[24:27], v[16:19], v[96:111]
    ds_read_b128 v[24:27], v112 offset:43520
    v_exp_f32 v70, v70
    v_exp_f32 v71, v71
    v_exp_f32 v72, v72
    v_exp_f32 v73, v73
    v_cvt_pk_bf16_f32 v42, v68, v69
    v_cvt_pk_bf16_f32 v43, v70, v71
    v_mfma_f32_32x32x16_bf16 v[48:63], v[28:31], v[20:23], v[48:63]
    ds_read_b64 v[28:29], v113 offset:43520
    v_exp_f32 v74, v74
    v_exp_f32 v75, v75
    v_exp_f32 v76, v76
    v_exp_f32 v77, v77
    v_cvt_pk_bf16_f32 v44, v72, v73
    v_cvt_pk_bf16_f32 v45, v74, v75
    s_waitcnt lgkmcnt(2)
    v_mfma_f32_32x32x16_bf16 v[80:95], v[32:35], v[40:43], v[80:95]
    v_exp_f32 v78, v78
    v_exp_f32 v79, v79
    v_add_u32 v112, 40960, v112
    v_add_u32 v113, 40960, v113
    v_add_u32 v114, 40960, v114
    s_cmp_eq_u32 s3, 1
    s_cbranch_scc1 adaLN_cond__grouped_kv_mqa__glu_gated_swiglu__prompt_kernel_ool_69
adaLN_cond__grouped_kv_mqa__glu_gated_swiglu__prompt_kernel_ret_70:
    v_exp_f32 v48, v48
    v_exp_f32 v49, v49
    v_cvt_pk_bf16_f32 v46, v76, v77
    v_cvt_pk_bf16_f32 v47, v78, v79
    v_exp_f32 v50, v50
    v_exp_f32 v51, v51
    v_mfma_f32_32x32x16_bf16 v[80:95], v[36:39], v[44:47], v[80:95]
    s_mov_b64 exec, s[98:99]
    ds_read_b128 v[32:35], v114 offset:0
    ds_read_b128 v[36:39], v114 offset:640
    s_mov_b64 exec, -1
    v_exp_f32 v52, v52
    v_exp_f32 v53, v53
    v_cvt_pk_bf16_f32 v40, v48, v49
    v_cvt_pk_bf16_f32 v41, v50, v51
    s_waitcnt lgkmcnt(2)
    v_mfma_f32_32x32x16_bf16 v[64:79], v[24:27], v[16:19], v[96:111]
    ds_read_b128 v[24:27], v112 offset:5120
    v_exp_f32 v54, v54
    v_exp_f32 v55, v55
    v_exp_f32 v56, v56
    v_exp_f32 v57, v57
    v_cvt_pk_bf16_f32 v42, v52, v53
    v_cvt_pk_bf16_f32 v43, v54, v55
    v_mfma_f32_32x32x16_bf16 v[64:79], v[28:31], v[20:23], v[64:79]
    ds_read_b64 v[28:29], v113 offset:5120
    v_exp_f32 v58, v58
    v_exp_f32 v59, v59
    v_exp_f32 v60, v60
    v_exp_f32 v61, v61
    v_cvt_pk_bf16_f32 v44, v56, v57
    v_cvt_pk_bf16_f32 v45, v58, v59
    s_waitcnt lgkmcnt(2)
    v_mfma_f32_32x32x16_bf16 v[80:95], v[32:35], v[40:43], v[80:95]
    v_exp_f32 v62, v62
    v_exp_f32 v63, v63
    s_cmp_eq_u32 s3, 2
    s_cbranch_scc1 adaLN_cond__grouped_kv_mqa__glu_gated_swiglu__prompt_kernel_ool_71
adaLN_cond__grouped_kv_mqa__glu_gated_swiglu__prompt_kernel_ret_72:
    v_exp_f32 v64, v64
    v_exp_f32 v65, v65
    v_cvt_pk_bf16_f32 v46, v60, v61
    v_cvt_pk_bf16_f32 v47, v62, v63
    v_exp_f32 v66, v66
    v_exp_f32 v67, v67
    v_mfma_f32_32x32x16_bf16 v[80:95], v[36:39], v[44:47], v[80:95]
    s_mov_b64 exec, s[98:99]
    ds_read_b128 v[32:35], v114 offset:2560
    ds_read_b128 v[36:39], v114 offset:3200
    s_mov_b64 exec, -1
    v_exp_f32 v68, v68
    v_exp_f32 v69, v69
    v_cvt_pk_bf16_f32 v40, v64, v65
    v_cvt_pk_bf16_f32 v41, v66, v67
    s_waitcnt lgkmcnt(2)
    v_mfma_f32_32x32x16_bf16 v[48:63], v[24:27], v[16:19], v[96:111]
    ds_read_b128 v[24:27], v112 offset:7680
    v_exp_f32 v70, v70
    v_exp_f32 v71, v71
    v_exp_f32 v72, v72
    v_exp_f32 v73, v73
    v_cvt_pk_bf16_f32 v42, v68, v69
    v_cvt_pk_bf16_f32 v43, v70, v71
    v_mfma_f32_32x32x16_bf16 v[48:63], v[28:31], v[20:23], v[48:63]
    ds_read_b64 v[28:29], v113 offset:7680
    v_exp_f32 v74, v74
    v_exp_f32 v75, v75
    v_exp_f32 v76, v76
    v_exp_f32 v77, v77
    v_cvt_pk_bf16_f32 v44, v72, v73
    v_cvt_pk_bf16_f32 v45, v74, v75
    s_waitcnt lgkmcnt(2)
    v_mfma_f32_32x32x16_bf16 v[80:95], v[32:35], v[40:43], v[80:95]
    v_exp_f32 v78, v78
    v_exp_f32 v79, v79
    s_cmp_eq_u32 s3, 3
    s_cbranch_scc1 adaLN_cond__grouped_kv_mqa__glu_gated_swiglu__prompt_kernel_ool_73
adaLN_cond__grouped_kv_mqa__glu_gated_swiglu__prompt_kernel_ret_74:
    v_exp_f32 v48, v48
    v_exp_f32 v49, v49
    v_cvt_pk_bf16_f32 v46, v76, v77
    v_cvt_pk_bf16_f32 v47, v78, v79
    v_exp_f32 v50, v50
    v_exp_f32 v51, v51
    v_mfma_f32_32x32x16_bf16 v[80:95], v[36:39], v[44:47], v[80:95]
    s_mov_b64 exec, s[98:99]
    ds_read_b128 v[32:35], v114 offset:5120
    ds_read_b128 v[36:39], v114 offset:5760
    s_mov_b64 exec, -1
    v_exp_f32 v52, v52
    v_exp_f32 v53, v53
    v_cvt_pk_bf16_f32 v40, v48, v49
    v_cvt_pk_bf16_f32 v41, v50, v51
    s_waitcnt lgkmcnt(2)
    v_mfma_f32_32x32x16_bf16 v[64:79], v[24:27], v[16:19], v[96:111]
    ds_read_b128 v[24:27], v112 offset:10240
    v_exp_f32 v54, v54
    v_exp_f32 v55, v55
    v_exp_f32 v56, v56
    v_exp_f32 v57, v57
    v_cvt_pk_bf16_f32 v42, v52, v53
    v_cvt_pk_bf16_f32 v43, v54, v55
    v_mfma_f32_32x32x16_bf16 v[64:79], v[28:31], v[20:23], v[64:79]
    ds_read_b64 v[28:29], v113 offset:10240
    v_exp_f32 v58, v58
    v_exp_f32 v59, v59
    v_exp_f32 v60, v60
    v_exp_f32 v61, v61
    v_cvt_pk_bf16_f32 v44, v56, v57
    v_cvt_pk_bf16_f32 v45, v58, v59
    s_waitcnt lgkmcnt(2)
    v_mfma_f32_32x32x16_bf16 v[80:95], v[32:35], v[40:43], v[80:95]
    v_exp_f32 v62, v62
    v_exp_f32 v63, v63
    s_nop 0
    v_exp_f32 v64, v64
    v_exp_f32 v65, v65
    v_cvt_pk_bf16_f32 v46, v60, v61
    v_cvt_pk_bf16_f32 v47, v62, v63
    v_exp_f32 v66, v66
    v_exp_f32 v67, v67
    v_mfma_f32_32x32x16_bf16 v[80:95], v[36:39], v[44:47], v[80:95]
    s_mov_b64 exec, s[98:99]
    ds_read_b128 v[32:35], v114 offset:7680
    ds_read_b128 v[36:39], v114 offset:8320
    s_mov_b64 exec, -1
    v_exp_f32 v68, v68
    v_exp_f32 v69, v69
    v_cvt_pk_bf16_f32 v40, v64, v65
    v_cvt_pk_bf16_f32 v41, v66, v67
    s_waitcnt lgkmcnt(2)
    v_mfma_f32_32x32x16_bf16 v[48:63], v[24:27], v[16:19], v[96:111]
    ds_read_b128 v[24:27], v112 offset:12800
    v_exp_f32 v70, v70
    v_exp_f32 v71, v71
    v_exp_f32 v72, v72
    v_exp_f32 v73, v73
    v_cvt_pk_bf16_f32 v42, v68, v69
    v_cvt_pk_bf16_f32 v43, v70, v71
    v_mfma_f32_32x32x16_bf16 v[48:63], v[28:31], v[20:23], v[48:63]
    ds_read_b64 v[28:29], v113 offset:12800
    v_exp_f32 v74, v74
    v_exp_f32 v75, v75
    v_exp_f32 v76, v76
    v_exp_f32 v77, v77
    v_cvt_pk_bf16_f32 v44, v72, v73
    v_cvt_pk_bf16_f32 v45, v74, v75
    s_waitcnt lgkmcnt(2)
    v_mfma_f32_32x32x16_bf16 v[80:95], v[32:35], v[40:43], v[80:95]
    v_exp_f32 v78, v78
    v_exp_f32 v79, v79
    s_cmp_eq_u32 s3, 0
    s_cbranch_scc1 adaLN_cond__grouped_kv_mqa__glu_gated_swiglu__prompt_kernel_ool_75
adaLN_cond__grouped_kv_mqa__glu_gated_swiglu__prompt_kernel_ret_76:
    v_exp_f32 v48, v48
    v_exp_f32 v49, v49
    v_cvt_pk_bf16_f32 v46, v76, v77
    v_cvt_pk_bf16_f32 v47, v78, v79
    v_exp_f32 v50, v50
    v_exp_f32 v51, v51
    v_mfma_f32_32x32x16_bf16 v[80:95], v[36:39], v[44:47], v[80:95]
    s_mov_b64 exec, s[98:99]
    ds_read_b128 v[32:35], v114 offset:10240
    ds_read_b128 v[36:39], v114 offset:10880
    s_mov_b64 exec, -1
    v_exp_f32 v52, v52
    v_exp_f32 v53, v53
    v_cvt_pk_bf16_f32 v40, v48, v49
    v_cvt_pk_bf16_f32 v41, v50, v51
    s_waitcnt lgkmcnt(2)
    v_mfma_f32_32x32x16_bf16 v[64:79], v[24:27], v[16:19], v[96:111]
    ds_read_b128 v[24:27], v112 offset:15360
    v_exp_f32 v54, v54
    v_exp_f32 v55, v55
    v_exp_f32 v56, v56
    v_exp_f32 v57, v57
    v_cvt_pk_bf16_f32 v42, v52, v53
    v_cvt_pk_bf16_f32 v43, v54, v55
    v_mfma_f32_32x32x16_bf16 v[64:79], v[28:31], v[20:23], v[64:79]
    ds_read_b64 v[28:29], v113 offset:15360
    v_exp_f32 v58, v58
    v_exp_f32 v59, v59
    v_exp_f32 v60, v60
    v_exp_f32 v61, v61
    v_cvt_pk_bf16_f32 v44, v56, v57
    v_cvt_pk_bf16_f32 v45, v58, v59
    s_waitcnt lgkmcnt(2)
    v_mfma_f32_32x32x16_bf16 v[80:95], v[32:35], v[40:43], v[80:95]
    v_exp_f32 v62, v62
    v_exp_f32 v63, v63
    s_cmp_eq_u32 s3, 1
    s_cbranch_scc1 adaLN_cond__grouped_kv_mqa__glu_gated_swiglu__prompt_kernel_ool_77
adaLN_cond__grouped_kv_mqa__glu_gated_swiglu__prompt_kernel_ret_78:
    v_exp_f32 v64, v64
    v_exp_f32 v65, v65
    v_cvt_pk_bf16_f32 v46, v60, v61
    v_cvt_pk_bf16_f32 v47, v62, v63
    v_exp_f32 v66, v66
    v_exp_f32 v67, v67
    v_mfma_f32_32x32x16_bf16 v[80:95], v[36:39], v[44:47], v[80:95]
    s_mov_b64 exec, s[98:99]
    ds_read_b128 v[32:35], v114 offset:12800
    ds_read_b128 v[36:39], v114 offset:13440
    s_mov_b64 exec, -1
    v_exp_f32 v68, v68
    v_exp_f32 v69, v69
    v_cvt_pk_bf16_f32 v40, v64, v65
    v_cvt_pk_bf16_f32 v41, v66, v67
    s_waitcnt lgkmcnt(2)
    v_mfma_f32_32x32x16_bf16 v[48:63], v[24:27], v[16:19], v[96:111]
    ds_read_b128 v[24:27], v112 offset:17920
    v_exp_f32 v70, v70
    v_exp_f32 v71, v71
    v_exp_f32 v72, v72
    v_exp_f32 v73, v73
    v_cvt_pk_bf16_f32 v42, v68, v69
    v_cvt_pk_bf16_f32 v43, v70, v71
    v_mfma_f32_32x32x16_bf16 v[48:63], v[28:31], v[20:23], v[48:63]
    ds_read_b64 v[28:29], v113 offset:17920
    v_exp_f32 v74, v74
    v_exp_f32 v75, v75
    v_exp_f32 v76, v76
    v_exp_f32 v77, v77
    v_cvt_pk_bf16_f32 v44, v72, v73
    v_cvt_pk_bf16_f32 v45, v74, v75
    s_waitcnt lgkmcnt(2)
    v_mfma_f32_32x32x16_bf16 v[80:95], v[32:35], v[40:43], v[80:95]
    v_exp_f32 v78, v78
    v_exp_f32 v79, v79
    s_cmp_eq_u32 s3, 0
    s_cbranch_scc1 adaLN_cond__grouped_kv_mqa__glu_gated_swiglu__prompt_kernel_ool_79
adaLN_cond__grouped_kv_mqa__glu_gated_swiglu__prompt_kernel_ret_80:
    v_exp_f32 v48, v48
    v_exp_f32 v49, v49
    v_cvt_pk_bf16_f32 v46, v76, v77
    v_cvt_pk_bf16_f32 v47, v78, v79
    v_exp_f32 v50, v50
    v_exp_f32 v51, v51
    v_mfma_f32_32x32x16_bf16 v[80:95], v[36:39], v[44:47], v[80:95]
    s_mov_b64 exec, s[98:99]
    ds_read_b128 v[32:35], v114 offset:15360
    ds_read_b128 v[36:39], v114 offset:16000
    s_mov_b64 exec, -1
    v_exp_f32 v52, v52
    v_exp_f32 v53, v53
    v_cvt_pk_bf16_f32 v40, v48, v49
    v_cvt_pk_bf16_f32 v41, v50, v51
    s_waitcnt lgkmcnt(2)
    v_mfma_f32_32x32x16_bf16 v[64:79], v[24:27], v[16:19], v[96:111]
    ds_read_b128 v[24:27], v112 offset:20480
    v_exp_f32 v54, v54
    v_exp_f32 v55, v55
    v_exp_f32 v56, v56
    v_exp_f32 v57, v57
    v_cvt_pk_bf16_f32 v42, v52, v53
    v_cvt_pk_bf16_f32 v43, v54, v55
    v_mfma_f32_32x32x16_bf16 v[64:79], v[28:31], v[20:23], v[64:79]
    ds_read_b64 v[28:29], v113 offset:20480
    v_exp_f32 v58, v58
    v_exp_f32 v59, v59
    v_exp_f32 v60, v60
    v_exp_f32 v61, v61
    v_cvt_pk_bf16_f32 v44, v56, v57
    v_cvt_pk_bf16_f32 v45, v58, v59
    s_waitcnt lgkmcnt(2)
    v_mfma_f32_32x32x16_bf16 v[80:95], v[32:35], v[40:43], v[80:95]
    v_exp_f32 v62, v62
    v_exp_f32 v63, v63
    s_nop 0
    v_exp_f32 v64, v64
    v_exp_f32 v65, v65
    v_cvt_pk_bf16_f32 v46, v60, v61
    v_cvt_pk_bf16_f32 v47, v62, v63
    v_exp_f32 v66, v66
    v_exp_f32 v67, v67
    v_mfma_f32_32x32x16_bf16 v[80:95], v[36:39], v[44:47], v[80:95]
    s_mov_b64 exec, s[98:99]
    ds_read_b128 v[32:35], v114 offset:17920
    ds_read_b128 v[36:39], v114 offset:18560
    s_mov_b64 exec, -1
    v_exp_f32 v68, v68
    v_exp_f32 v69, v69
    v_cvt_pk_bf16_f32 v40, v64, v65
    v_cvt_pk_bf16_f32 v41, v66, v67
    s_waitcnt lgkmcnt(2)
    v_mfma_f32_32x32x16_bf16 v[48:63], v[24:27], v[16:19], v[96:111]
    ds_read_b128 v[24:27], v112 offset:23040
    v_exp_f32 v70, v70
    v_exp_f32 v71, v71
    v_exp_f32 v72, v72
    v_exp_f32 v73, v73
    v_cvt_pk_bf16_f32 v42, v68, v69
    v_cvt_pk_bf16_f32 v43, v70, v71
    v_mfma_f32_32x32x16_bf16 v[48:63], v[28:31], v[20:23], v[48:63]
    ds_read_b64 v[28:29], v113 offset:23040
    v_exp_f32 v74, v74
    v_exp_f32 v75, v75
    v_exp_f32 v76, v76
    v_exp_f32 v77, v77
    v_cvt_pk_bf16_f32 v44, v72, v73
    v_cvt_pk_bf16_f32 v45, v74, v75
    s_waitcnt lgkmcnt(2)
    v_mfma_f32_32x32x16_bf16 v[80:95], v[32:35], v[40:43], v[80:95]
    v_exp_f32 v78, v78
    v_exp_f32 v79, v79
    s_cmp_eq_u32 s3, 0
    s_cbranch_scc1 adaLN_cond__grouped_kv_mqa__glu_gated_swiglu__prompt_kernel_ool_81
adaLN_cond__grouped_kv_mqa__glu_gated_swiglu__prompt_kernel_ret_82:
    v_exp_f32 v48, v48
    v_exp_f32 v49, v49
    v_cvt_pk_bf16_f32 v46, v76, v77
    v_cvt_pk_bf16_f32 v47, v78, v79
    v_exp_f32 v50, v50
    v_exp_f32 v51, v51
    v_mfma_f32_32x32x16_bf16 v[80:95], v[36:39], v[44:47], v[80:95]
    s_mov_b64 exec, s[98:99]
    ds_read_b128 v[32:35], v114 offset:20480
    ds_read_b128 v[36:39], v114 offset:21120
    s_mov_b64 exec, -1
    v_exp_f32 v52, v52
    v_exp_f32 v53, v53
    v_cvt_pk_bf16_f32 v40, v48, v49
    v_cvt_pk_bf16_f32 v41, v50, v51
    s_waitcnt lgkmcnt(2)
    v_mfma_f32_32x32x16_bf16 v[64:79], v[24:27], v[16:19], v[96:111]
    ds_read_b128 v[24:27], v112 offset:25600
    v_exp_f32 v54, v54
    v_exp_f32 v55, v55
    v_exp_f32 v56, v56
    v_exp_f32 v57, v57
    v_cvt_pk_bf16_f32 v42, v52, v53
    v_cvt_pk_bf16_f32 v43, v54, v55
    v_mfma_f32_32x32x16_bf16 v[64:79], v[28:31], v[20:23], v[64:79]
    ds_read_b64 v[28:29], v113 offset:25600
    v_exp_f32 v58, v58
    v_exp_f32 v59, v59
    v_exp_f32 v60, v60
    v_exp_f32 v61, v61
    v_cvt_pk_bf16_f32 v44, v56, v57
    v_cvt_pk_bf16_f32 v45, v58, v59
    s_waitcnt lgkmcnt(2)
    v_mfma_f32_32x32x16_bf16 v[80:95], v[32:35], v[40:43], v[80:95]
    v_exp_f32 v62, v62
    v_exp_f32 v63, v63
    s_cmp_eq_u32 s3, 1
    s_cbranch_scc1 adaLN_cond__grouped_kv_mqa__glu_gated_swiglu__prompt_kernel_ool_83
adaLN_cond__grouped_kv_mqa__glu_gated_swiglu__prompt_kernel_ret_84:
    v_exp_f32 v64, v64
    v_exp_f32 v65, v65
    v_cvt_pk_bf16_f32 v46, v60, v61
    v_cvt_pk_bf16_f32 v47, v62, v63
    v_exp_f32 v66, v66
    v_exp_f32 v67, v67
    v_mfma_f32_32x32x16_bf16 v[80:95], v[36:39], v[44:47], v[80:95]
    s_mov_b64 exec, s[98:99]
    ds_read_b128 v[32:35], v114 offset:23040
    ds_read_b128 v[36:39], v114 offset:23680
    s_mov_b64 exec, -1
    v_exp_f32 v68, v68
    v_exp_f32 v69, v69
    v_cvt_pk_bf16_f32 v40, v64, v65
    v_cvt_pk_bf16_f32 v41, v66, v67
    s_waitcnt lgkmcnt(2)
    v_mfma_f32_32x32x16_bf16 v[48:63], v[24:27], v[16:19], v[96:111]
    ds_read_b128 v[24:27], v112 offset:28160
    v_exp_f32 v70, v70
    v_exp_f32 v71, v71
    v_exp_f32 v72, v72
    v_exp_f32 v73, v73
    v_cvt_pk_bf16_f32 v42, v68, v69
    v_cvt_pk_bf16_f32 v43, v70, v71
    v_mfma_f32_32x32x16_bf16 v[48:63], v[28:31], v[20:23], v[48:63]
    ds_read_b64 v[28:29], v113 offset:28160
    v_exp_f32 v74, v74
    v_exp_f32 v75, v75
    v_exp_f32 v76, v76
    v_exp_f32 v77, v77
    v_cvt_pk_bf16_f32 v44, v72, v73
    v_cvt_pk_bf16_f32 v45, v74, v75
    s_waitcnt lgkmcnt(2)
    v_mfma_f32_32x32x16_bf16 v[80:95], v[32:35], v[40:43], v[80:95]
    v_exp_f32 v78, v78
    v_exp_f32 v79, v79
    s_nop 0
    v_exp_f32 v48, v48
    v_exp_f32 v49, v49
    v_cvt_pk_bf16_f32 v46, v76, v77
    v_cvt_pk_bf16_f32 v47, v78, v79
    v_exp_f32 v50, v50
    v_exp_f32 v51, v51
    v_mfma_f32_32x32x16_bf16 v[80:95], v[36:39], v[44:47], v[80:95]
    s_mov_b64 exec, s[98:99]
    ds_read_b128 v[32:35], v114 offset:25600
    ds_read_b128 v[36:39], v114 offset:26240
    s_mov_b64 exec, -1
    v_exp_f32 v52, v52
    v_exp_f32 v53, v53
    v_cvt_pk_bf16_f32 v40, v48, v49
    v_cvt_pk_bf16_f32 v41, v50, v51
    s_waitcnt lgkmcnt(2)
    v_mfma_f32_32x32x16_bf16 v[64:79], v[24:27], v[16:19], v[96:111]
    ds_read_b128 v[24:27], v112 offset:30720
    v_exp_f32 v54, v54
    v_exp_f32 v55, v55
    v_exp_f32 v56, v56
    v_exp_f32 v57, v57
    v_cvt_pk_bf16_f32 v42, v52, v53
    v_cvt_pk_bf16_f32 v43, v54, v55
    v_mfma_f32_32x32x16_bf16 v[64:79], v[28:31], v[20:23], v[64:79]
    ds_read_b64 v[28:29], v113 offset:30720
    v_exp_f32 v58, v58
    v_exp_f32 v59, v59
    v_exp_f32 v60, v60
    v_exp_f32 v61, v61
    v_cvt_pk_bf16_f32 v44, v56, v57
    v_cvt_pk_bf16_f32 v45, v58, v59
    s_waitcnt lgkmcnt(2)
    v_mfma_f32_32x32x16_bf16 v[80:95], v[32:35], v[40:43], v[80:95]
    v_exp_f32 v62, v62
    v_exp_f32 v63, v63
    s_nop 0
    v_exp_f32 v64, v64
    v_exp_f32 v65, v65
    v_cvt_pk_bf16_f32 v46, v60, v61
    v_cvt_pk_bf16_f32 v47, v62, v63
    v_exp_f32 v66, v66
    v_exp_f32 v67, v67
    v_mfma_f32_32x32x16_bf16 v[80:95], v[36:39], v[44:47], v[80:95]
    s_mov_b64 exec, s[98:99]
    ds_read_b128 v[32:35], v114 offset:28160
    ds_read_b128 v[36:39], v114 offset:28800
    s_mov_b64 exec, -1
    v_exp_f32 v68, v68
    v_exp_f32 v69, v69
    v_cvt_pk_bf16_f32 v40, v64, v65
    v_cvt_pk_bf16_f32 v41, v66, v67
    s_waitcnt lgkmcnt(2)
    v_mfma_f32_32x32x16_bf16 v[48:63], v[24:27], v[16:19], v[96:111]
    ds_read_b128 v[24:27], v112 offset:33280
    v_exp_f32 v70, v70
    v_exp_f32 v71, v71
    v_exp_f32 v72, v72
    v_exp_f32 v73, v73
    v_cvt_pk_bf16_f32 v42, v68, v69
    v_cvt_pk_bf16_f32 v43, v70, v71
    v_mfma_f32_32x32x16_bf16 v[48:63], v[28:31], v[20:23], v[48:63]
    ds_read_b64 v[28:29], v113 offset:33280
    v_exp_f32 v74, v74
    v_exp_f32 v75, v75
    v_exp_f32 v76, v76
    v_exp_f32 v77, v77
    v_cvt_pk_bf16_f32 v44, v72, v73
    v_cvt_pk_bf16_f32 v45, v74, v75
    s_waitcnt lgkmcnt(2)
    v_mfma_f32_32x32x16_bf16 v[80:95], v[32:35], v[40:43], v[80:95]
    v_exp_f32 v78, v78
    v_exp_f32 v79, v79
    s_cmp_eq_u32 s3, 4
    s_cbranch_scc1 adaLN_cond__grouped_kv_mqa__glu_gated_swiglu__prompt_kernel_ool_85
adaLN_cond__grouped_kv_mqa__glu_gated_swiglu__prompt_kernel_ret_86:
    v_exp_f32 v48, v48
    v_exp_f32 v49, v49
    v_cvt_pk_bf16_f32 v46, v76, v77
    v_cvt_pk_bf16_f32 v47, v78, v79
    v_exp_f32 v50, v50
    v_exp_f32 v51, v51
    v_mfma_f32_32x32x16_bf16 v[80:95], v[36:39], v[44:47], v[80:95]
    s_mov_b64 exec, s[98:99]
    ds_read_b128 v[32:35], v114 offset:30720
    ds_read_b128 v[36:39], v114 offset:31360
    s_mov_b64 exec, -1
    v_exp_f32 v52, v52
    v_exp_f32 v53, v53
    v_cvt_pk_bf16_f32 v40, v48, v49
    v_cvt_pk_bf16_f32 v41, v50, v51
    s_waitcnt lgkmcnt(2)
    v_mfma_f32_32x32x16_bf16 v[64:79], v[24:27], v[16:19], v[96:111]
    ds_read_b128 v[24:27], v112 offset:35840
    v_exp_f32 v54, v54
    v_exp_f32 v55, v55
    v_exp_f32 v56, v56
    v_exp_f32 v57, v57
    v_cvt_pk_bf16_f32 v42, v52, v53
    v_cvt_pk_bf16_f32 v43, v54, v55
    v_mfma_f32_32x32x16_bf16 v[64:79], v[28:31], v[20:23], v[64:79]
    ds_read_b64 v[28:29], v113 offset:35840
    v_exp_f32 v58, v58
    v_exp_f32 v59, v59
    v_exp_f32 v60, v60
    v_exp_f32 v61, v61
    v_cvt_pk_bf16_f32 v44, v56, v57
    v_cvt_pk_bf16_f32 v45, v58, v59
    s_waitcnt lgkmcnt(2)
    v_mfma_f32_32x32x16_bf16 v[80:95], v[32:35], v[40:43], v[80:95]
    v_exp_f32 v62, v62
    v_exp_f32 v63, v63
    s_nop 0
    v_exp_f32 v64, v64
    v_exp_f32 v65, v65
    v_cvt_pk_bf16_f32 v46, v60, v61
    v_cvt_pk_bf16_f32 v47, v62, v63
    v_exp_f32 v66, v66
    v_exp_f32 v67, v67
    v_mfma_f32_32x32x16_bf16 v[80:95], v[36:39], v[44:47], v[80:95]
    s_mov_b64 exec, s[98:99]
    ds_read_b128 v[32:35], v114 offset:33280
    ds_read_b128 v[36:39], v114 offset:33920
    s_mov_b64 exec, -1
    v_exp_f32 v68, v68
    v_exp_f32 v69, v69
    v_cvt_pk_bf16_f32 v40, v64, v65
    v_cvt_pk_bf16_f32 v41, v66, v67
    s_waitcnt lgkmcnt(2)
    v_mfma_f32_32x32x16_bf16 v[48:63], v[24:27], v[16:19], v[96:111]
    ds_read_b128 v[24:27], v112 offset:38400
    v_exp_f32 v70, v70
    v_exp_f32 v71, v71
    v_exp_f32 v72, v72
    v_exp_f32 v73, v73
    v_cvt_pk_bf16_f32 v42, v68, v69
    v_cvt_pk_bf16_f32 v43, v70, v71
    v_mfma_f32_32x32x16_bf16 v[48:63], v[28:31], v[20:23], v[48:63]
    ds_read_b64 v[28:29], v113 offset:38400
    v_exp_f32 v74, v74
    v_exp_f32 v75, v75
    v_exp_f32 v76, v76
    v_exp_f32 v77, v77
    v_cvt_pk_bf16_f32 v44, v72, v73
    v_cvt_pk_bf16_f32 v45, v74, v75
    s_waitcnt lgkmcnt(2)
    v_mfma_f32_32x32x16_bf16 v[80:95], v[32:35], v[40:43], v[80:95]
    v_exp_f32 v78, v78
    v_exp_f32 v79, v79
    s_cmp_eq_u32 s3, 5
    s_cbranch_scc1 adaLN_cond__grouped_kv_mqa__glu_gated_swiglu__prompt_kernel_ool_87
adaLN_cond__grouped_kv_mqa__glu_gated_swiglu__prompt_kernel_ret_88:
    s_cmp_eq_u32 s3, 4
    s_cbranch_scc1 adaLN_cond__grouped_kv_mqa__glu_gated_swiglu__prompt_kernel_ool_89
adaLN_cond__grouped_kv_mqa__glu_gated_swiglu__prompt_kernel_ret_90:
    s_barrier
    v_exp_f32 v48, v48
    v_exp_f32 v49, v49
    v_cvt_pk_bf16_f32 v46, v76, v77
    v_cvt_pk_bf16_f32 v47, v78, v79
    v_exp_f32 v50, v50
    v_exp_f32 v51, v51
    v_mfma_f32_32x32x16_bf16 v[80:95], v[36:39], v[44:47], v[80:95]
    s_mov_b64 exec, s[98:99]
    ds_read_b128 v[32:35], v114 offset:35840
    ds_read_b128 v[36:39], v114 offset:36480
    s_mov_b64 exec, -1
    v_exp_f32 v52, v52
    v_exp_f32 v53, v53
    v_cvt_pk_bf16_f32 v40, v48, v49
    v_cvt_pk_bf16_f32 v41, v50, v51
    s_waitcnt lgkmcnt(2)
    v_mfma_f32_32x32x16_bf16 v[64:79], v[24:27], v[16:19], v[96:111]
    ds_read_b128 v[24:27], v208 offset:0
    v_exp_f32 v54, v54
    v_exp_f32 v55, v55
    v_exp_f32 v56, v56
    v_exp_f32 v57, v57
    v_cvt_pk_bf16_f32 v42, v52, v53
    v_cvt_pk_bf16_f32 v43, v54, v55
    v_mfma_f32_32x32x16_bf16 v[64:79], v[28:31], v[20:23], v[64:79]
    ds_read_b64 v[28:29], v209 offset:0
    v_exp_f32 v58, v58
    v_exp_f32 v59, v59
    v_exp_f32 v60, v60
    v_exp_f32 v61, v61
    v_cvt_pk_bf16_f32 v44, v56, v57
    v_cvt_pk_bf16_f32 v45, v58, v59
    s_waitcnt lgkmcnt(2)
    v_mfma_f32_32x32x16_bf16 v[80:95], v[32:35], v[40:43], v[80:95]
    v_exp_f32 v62, v62
    v_exp_f32 v63, v63
    s_add_u32 s66, s3, 0
    s_mul_i32 s67, s66, 40960
    s_add_u32 s67, s67, s64
    s_mul_i32 s68, s66, 5120
    s_add_u32 s68, s68, 40960
    s_mov_b32 m0, s68
    s_nop 0
    buffer_load_dwordx4 v210, s[32:35], s67 offen  lds
    s_mov_b32 s52, s4
    s_mov_b32 s53, s5
    s_mov_b32 s54, 2621440
    s_mov_b32 s55, 0x00020000
    s_mov_b32 s56, s6
    s_mov_b32 s57, s7
    s_mov_b32 s58, 61440
    s_mov_b32 s59, 0x00020000
    v_and_b32 v140, 255, v0
    v_lshrrev_b32 v141, 8, v0
    v_mov_b32 v142, 5120
    v_mov_b32 v143, 10240
    v_cmp_eq_u32 vcc, 0, v141
    s_nop 1
    v_cndmask_b32 v142, v143, v142, vcc
    v_min_u32 v159, 159, v140
    v_lshl_add_u32 v142, v159, 4, v142
    v_mov_b32 v143, 143360
    v_mov_b32 v141, 145920
    v_cndmask_b32 v143, v141, v143, vcc
    v_lshl_add_u32 v143, v140, 4, v143
    v_mov_b32 v141, 1.0
    v_mov_b32 v159, 0
    v_cndmask_b32 v141, v141, v159, vcc
    v_cmp_gt_u32 vcc, 160, v140
    s_nop 0
    s_and_saveexec_b64 s[40:41], vcc
    s_cbranch_execz adaLN_cond__grouped_kv_mqa__glu_gated_swiglu__prompt_kernel_mi_91
    buffer_load_dwordx4 v[144:147], v142, s[56:59], 0 offen sc1
    buffer_load_dwordx4 v[148:151], v142, s[56:59], s15 offen sc1
    buffer_load_dwordx4 v[152:155], v142, s[56:59], s69 offen sc1
    buffer_load_dwordx4 v[156:159], v142, s[56:59], s70 offen sc1
adaLN_cond__grouped_kv_mqa__glu_gated_swiglu__prompt_kernel_mi_91:
    s_mov_b64 exec, s[40:41]
    v_and_b32 v204, 15, v1
    s_and_b32 s42, s3, 3
    s_lshl_b32 s42, s42, 4
    s_add_u32 s42, s42, s36
    v_add_u32 v126, s42, v204
    v_mul_u32_u24 v205, 1280, v126
    v_lshrrev_b32 v128, 4, v1
    v_lshl_add_u32 v127, v128, 3, v205
    s_mul_i32 s42, s37, 160
    buffer_load_dwordx2 v[130:131], v127, s[52:55], s42 offen offset:0
    buffer_load_dwordx2 v[132:133], v127, s[52:55], s42 offen offset:32
    buffer_load_dwordx2 v[134:135], v127, s[52:55], s42 offen offset:64
    buffer_load_dwordx2 v[136:137], v127, s[52:55], s42 offen offset:96
    buffer_load_dwordx2 v[138:139], v127, s[52:55], s42 offen offset:128
    v_exp_f32 v64, v64
    v_exp_f32 v65, v65
    v_cvt_pk_bf16_f32 v46, v60, v61
    v_cvt_pk_bf16_f32 v47, v62, v63
    v_exp_f32 v66, v66
    v_exp_f32 v67, v67
    v_mfma_f32_32x32x16_bf16 v[80:95], v[36:39], v[44:47], v[80:95]
    s_mov_b64 exec, s[98:99]
    ds_read_b128 v[32:35], v114 offset:38400
    ds_read_b128 v[36:39], v114 offset:39040
    s_mov_b64 exec, -1
    v_exp_f32 v68, v68
    v_exp_f32 v69, v69
    v_cvt_pk_bf16_f32 v40, v64, v65
    v_cvt_pk_bf16_f32 v41, v66, v67
    s_waitcnt lgkmcnt(2)
    v_mfma_f32_32x32x16_bf16 v[48:63], v[24:27], v[16:19], v[96:111]
    ds_read_b128 v[24:27], v208 offset:2560
    v_exp_f32 v70, v70
    v_exp_f32 v71, v71
    v_exp_f32 v72, v72
    v_exp_f32 v73, v73
    v_cvt_pk_bf16_f32 v42, v68, v69
    v_cvt_pk_bf16_f32 v43, v70, v71
    v_mfma_f32_32x32x16_bf16 v[48:63], v[28:31], v[20:23], v[48:63]
    ds_read_b64 v[28:29], v209 offset:2560
    v_exp_f32 v74, v74
    v_exp_f32 v75, v75
    v_exp_f32 v76, v76
    v_exp_f32 v77, v77
    v_cvt_pk_bf16_f32 v44, v72, v73
    v_cvt_pk_bf16_f32 v45, v74, v75
    s_waitcnt lgkmcnt(2)
    v_mfma_f32_32x32x16_bf16 v[80:95], v[32:35], v[40:43], v[80:95]
    v_exp_f32 v78, v78
    v_exp_f32 v79, v79
    v_add_u32 v112, 40960, v112
    v_add_u32 v113, 40960, v113
    v_add_u32 v114, 40960, v114
    s_add_u32 s66, s3, 0
    s_mul_i32 s67, s66, 40960
    s_add_u32 s67, s67, s64
    s_mul_i32 s68, s66, 5120
    s_add_u32 s68, s68, 41984
    s_mov_b32 m0, s68
    s_nop 0
    buffer_load_dwordx4 v211, s[32:35], s67 offen  lds
    v_exp_f32 v48, v48
    v_exp_f32 v49, v49
    v_cvt_pk_bf16_f32 v46, v76, v77
    v_cvt_pk_bf16_f32 v47, v78, v79
    v_exp_f32 v50, v50
    v_exp_f32 v51, v51
    v_mfma_f32_32x32x16_bf16 v[80:95], v[36:39], v[44:47], v[80:95]
    s_mov_b64 exec, s[98:99]
    ds_read_b128 v[32:35], v215 offset:0
    ds_read_b128 v[36:39], v215 offset:640
    s_mov_b64 exec, -1
    v_exp_f32 v52, v52
    v_exp_f32 v53, v53
    v_cvt_pk_bf16_f32 v40, v48, v49
    v_cvt_pk_bf16_f32 v41, v50, v51
    s_waitcnt lgkmcnt(2)
    v_mfma_f32_32x32x16_bf16 v[64:79], v[24:27], v[16:19], v[96:111]
    ds_read_b128 v[24:27], v208 offset:5120
    v_exp_f32 v54, v54
    v_exp_f32 v55, v55
    v_exp_f32 v56, v56
    v_exp_f32 v57, v57
    v_cvt_pk_bf16_f32 v42, v52, v53
    v_cvt_pk_bf16_f32 v43, v54, v55
    v_mfma_f32_32x32x16_bf16 v[64:79], v[28:31], v[20:23], v[64:79]
    ds_read_b64 v[28:29], v209 offset:5120
    v_exp_f32 v58, v58
    v_exp_f32 v59, v59
    v_exp_f32 v60, v60
    v_exp_f32 v61, v61
    v_cvt_pk_bf16_f32 v44, v56, v57
    v_cvt_pk_bf16_f32 v45, v58, v59
    s_waitcnt lgkmcnt(2)
    v_mfma_f32_32x32x16_bf16 v[80:95], v[32:35], v[40:43], v[80:95]
    v_exp_f32 v62, v62
    v_exp_f32 v63, v63
    s_add_u32 s66, s3, 0
    s_mul_i32 s67, s66, 40960
    s_add_u32 s67, s67, s64
    s_mul_i32 s68, s66, 5120
    s_add_u32 s68, s68, 43008
    s_mov_b32 m0, s68
    s_nop 0
    buffer_load_dwordx4 v212, s[32:35], s67 offen  lds
    v_exp_f32 v64, v64
    v_exp_f32 v65, v65
    v_cvt_pk_bf16_f32 v46, v60, v61
    v_cvt_pk_bf16_f32 v47, v62, v63
    v_exp_f32 v66, v66
    v_exp_f32 v67, v67
    v_mfma_f32_32x32x16_bf16 v[80:95], v[36:39], v[44:47], v[80:95]
    s_mov_b64 exec, s[98:99]
    ds_read_b128 v[32:35], v215 offset:2560
    ds_read_b128 v[36:39], v215 offset:3200
    s_mov_b64 exec, -1
    v_exp_f32 v68, v68
    v_exp_f32 v69, v69
    v_cvt_pk_bf16_f32 v40, v64, v65
    v_cvt_pk_bf16_f32 v41, v66, v67
    s_waitcnt lgkmcnt(2)
    v_mfma_f32_32x32x16_bf16 v[48:63], v[24:27], v[16:19], v[96:111]
    ds_read_b128 v[24:27], v208 offset:7680
    v_exp_f32 v70, v70
    v_exp_f32 v71, v71
    v_exp_f32 v72, v72
    v_exp_f32 v73, v73
    v_cvt_pk_bf16_f32 v42, v68, v69
    v_cvt_pk_bf16_f32 v43, v70, v71
    v_mfma_f32_32x32x16_bf16 v[48:63], v[28:31], v[20:23], v[48:63]
    ds_read_b64 v[28:29], v209 offset:7680
    v_exp_f32 v74, v74
    v_exp_f32 v75, v75
    v_exp_f32 v76, v76
    v_exp_f32 v77, v77
    v_cvt_pk_bf16_f32 v44, v72, v73
    v_cvt_pk_bf16_f32 v45, v74, v75
    s_waitcnt lgkmcnt(2)
    v_mfma_f32_32x32x16_bf16 v[80:95], v[32:35], v[40:43], v[80:95]
    v_exp_f32 v78, v78
    v_exp_f32 v79, v79
    s_cmp_eq_u32 s3, 5
    s_cbranch_scc1 adaLN_cond__grouped_kv_mqa__glu_gated_swiglu__prompt_kernel_ool_92
adaLN_cond__grouped_kv_mqa__glu_gated_swiglu__prompt_kernel_ret_93:
    s_add_u32 s66, s3, 0
    s_mul_i32 s67, s66, 40960
    s_add_u32 s67, s67, s64
    s_mul_i32 s68, s66, 5120
    s_add_u32 s68, s68, 44032
    s_mov_b32 m0, s68
    s_nop 0
    buffer_load_dwordx4 v213, s[32:35], s67 offen  lds
    v_exp_f32 v48, v48
    v_exp_f32 v49, v49
    v_cvt_pk_bf16_f32 v46, v76, v77
    v_cvt_pk_bf16_f32 v47, v78, v79
    v_exp_f32 v50, v50
    v_exp_f32 v51, v51
    v_mfma_f32_32x32x16_bf16 v[80:95], v[36:39], v[44:47], v[80:95]
    s_mov_b64 exec, s[98:99]
    ds_read_b128 v[32:35], v215 offset:5120
    ds_read_b128 v[36:39], v215 offset:5760
    s_mov_b64 exec, -1
    v_exp_f32 v52, v52
    v_exp_f32 v53, v53
    v_cvt_pk_bf16_f32 v40, v48, v49
    v_cvt_pk_bf16_f32 v41, v50, v51
    s_waitcnt lgkmcnt(2)
    v_mfma_f32_32x32x16_bf16 v[64:79], v[24:27], v[16:19], v[96:111]
    ds_read_b128 v[24:27], v208 offset:10240
    v_exp_f32 v54, v54
    v_exp_f32 v55, v55
    v_exp_f32 v56, v56
    v_exp_f32 v57, v57
    v_cvt_pk_bf16_f32 v42, v52, v53
    v_cvt_pk_bf16_f32 v43, v54, v55
    v_mfma_f32_32x32x16_bf16 v[64:79], v[28:31], v[20:23], v[64:79]
    ds_read_b64 v[28:29], v209 offset:10240
    v_exp_f32 v58, v58
    v_exp_f32 v59, v59
    v_exp_f32 v60, v60
    v_exp_f32 v61, v61
    v_cvt_pk_bf16_f32 v44, v56, v57
    v_cvt_pk_bf16_f32 v45, v58, v59
    s_waitcnt lgkmcnt(2)
    v_mfma_f32_32x32x16_bf16 v[80:95], v[32:35], v[40:43], v[80:95]
    v_exp_f32 v62, v62
    v_exp_f32 v63, v63
    s_add_u32 s66, s3, 0
    s_mul_i32 s67, s66, 40960
    s_add_u32 s67, s67, s64
    s_mul_i32 s68, s66, 5120
    s_add_u32 s68, s68, 45056
    s_mov_b32 m0, s68
    s_nop 0
    buffer_load_dwordx4 v214, s[32:35], s67 offen  lds
    v_exp_f32 v64, v64
    v_exp_f32 v65, v65
    v_cvt_pk_bf16_f32 v46, v60, v61
    v_cvt_pk_bf16_f32 v47, v62, v63
    v_exp_f32 v66, v66
    v_exp_f32 v67, v67
    v_mfma_f32_32x32x16_bf16 v[80:95], v[36:39], v[44:47], v[80:95]
    s_mov_b64 exec, s[98:99]
    ds_read_b128 v[32:35], v215 offset:7680
    ds_read_b128 v[36:39], v215 offset:8320
    s_mov_b64 exec, -1
    v_exp_f32 v68, v68
    v_exp_f32 v69, v69
    v_cvt_pk_bf16_f32 v40, v64, v65
    v_cvt_pk_bf16_f32 v41, v66, v67
    s_waitcnt lgkmcnt(2)
    v_mfma_f32_32x32x16_bf16 v[48:63], v[24:27], v[16:19], v[96:111]
    ds_read_b128 v[24:27], v208 offset:12800
    v_exp_f32 v70, v70
    v_exp_f32 v71, v71
    v_exp_f32 v72, v72
    v_exp_f32 v73, v73
    v_cvt_pk_bf16_f32 v42, v68, v69
    v_cvt_pk_bf16_f32 v43, v70, v71
    v_mfma_f32_32x32x16_bf16 v[48:63], v[28:31], v[20:23], v[48:63]
    ds_read_b64 v[28:29], v209 offset:12800
    v_exp_f32 v74, v74
    v_exp_f32 v75, v75
    v_exp_f32 v76, v76
    v_exp_f32 v77, v77
    v_cvt_pk_bf16_f32 v44, v72, v73
    v_cvt_pk_bf16_f32 v45, v74, v75
    s_waitcnt lgkmcnt(2)
    v_mfma_f32_32x32x16_bf16 v[80:95], v[32:35], v[40:43], v[80:95]
    v_exp_f32 v78, v78
    v_exp_f32 v79, v79
    s_barrier
    s_add_u32 s66, s3, 8
    s_mul_i32 s67, s66, 40960
    s_add_u32 s67, s67, s64
    s_mul_i32 s68, s66, 5120
    s_add_u32 s68, s68, 40960
    s_mov_b32 m0, s68
    s_nop 0
    buffer_load_dwordx4 v210, s[32:35], s67 offen  lds
    v_exp_f32 v48, v48
    v_exp_f32 v49, v49
    v_cvt_pk_bf16_f32 v46, v76, v77
    v_cvt_pk_bf16_f32 v47, v78, v79
    v_exp_f32 v50, v50
    v_exp_f32 v51, v51
    v_mfma_f32_32x32x16_bf16 v[80:95], v[36:39], v[44:47], v[80:95]
    s_mov_b64 exec, s[98:99]
    ds_read_b128 v[32:35], v215 offset:10240
    ds_read_b128 v[36:39], v215 offset:10880
    s_mov_b64 exec, -1
    v_exp_f32 v52, v52
    v_exp_f32 v53, v53
    v_cvt_pk_bf16_f32 v40, v48, v49
    v_cvt_pk_bf16_f32 v41, v50, v51
    s_waitcnt lgkmcnt(2)
    v_mfma_f32_32x32x16_bf16 v[64:79], v[24:27], v[16:19], v[96:111]
    ds_read_b128 v[24:27], v208 offset:15360
    v_exp_f32 v54, v54
    v_exp_f32 v55, v55
    v_exp_f32 v56, v56
    v_exp_f32 v57, v57
    v_cvt_pk_bf16_f32 v42, v52, v53
    v_cvt_pk_bf16_f32 v43, v54, v55
    v_mfma_f32_32x32x16_bf16 v[64:79], v[28:31], v[20:23], v[64:79]
    ds_read_b64 v[28:29], v209 offset:15360
    v_exp_f32 v58, v58
    v_exp_f32 v59, v59
    v_exp_f32 v60, v60
    v_exp_f32 v61, v61
    v_cvt_pk_bf16_f32 v44, v56, v57
    v_cvt_pk_bf16_f32 v45, v58, v59
    s_waitcnt lgkmcnt(2)
    v_mfma_f32_32x32x16_bf16 v[80:95], v[32:35], v[40:43], v[80:95]
    v_exp_f32 v62, v62
    v_exp_f32 v63, v63
    s_cmp_eq_u32 s3, 0
    s_cbranch_scc1 adaLN_cond__grouped_kv_mqa__glu_gated_swiglu__prompt_kernel_ool_94
adaLN_cond__grouped_kv_mqa__glu_gated_swiglu__prompt_kernel_ret_95:
    s_add_u32 s66, s3, 8
    s_mul_i32 s67, s66, 40960
    s_add_u32 s67, s67, s64
    s_mul_i32 s68, s66, 5120
    s_add_u32 s68, s68, 41984
    s_mov_b32 m0, s68
    s_nop 0
    buffer_load_dwordx4 v211, s[32:35], s67 offen  lds
    v_exp_f32 v64, v64
    v_exp_f32 v65, v65
    v_cvt_pk_bf16_f32 v46, v60, v61
    v_cvt_pk_bf16_f32 v47, v62, v63
    v_exp_f32 v66, v66
    v_exp_f32 v67, v67
    v_mfma_f32_32x32x16_bf16 v[80:95], v[36:39], v[44:47], v[80:95]
    s_mov_b64 exec, s[98:99]
    ds_read_b128 v[32:35], v215 offset:12800
    ds_read_b128 v[36:39], v215 offset:13440
    s_mov_b64 exec, -1
    v_exp_f32 v68, v68
    v_exp_f32 v69, v69
    v_cvt_pk_bf16_f32 v40, v64, v65
    v_cvt_pk_bf16_f32 v41, v66, v67
    s_waitcnt lgkmcnt(2)
    v_mfma_f32_32x32x16_bf16 v[48:63], v[24:27], v[16:19], v[96:111]
    ds_read_b128 v[24:27], v208 offset:17920
    v_exp_f32 v70, v70
    v_exp_f32 v71, v71
    v_exp_f32 v72, v72
    v_exp_f32 v73, v73
    v_cvt_pk_bf16_f32 v42, v68, v69
    v_cvt_pk_bf16_f32 v43, v70, v71
    v_mfma_f32_32x32x16_bf16 v[48:63], v[28:31], v[20:23], v[48:63]
    ds_read_b64 v[28:29], v209 offset:17920
    v_exp_f32 v74, v74
    v_exp_f32 v75, v75
    v_exp_f32 v76, v76
    v_exp_f32 v77, v77
    v_cvt_pk_bf16_f32 v44, v72, v73
    v_cvt_pk_bf16_f32 v45, v74, v75
    s_waitcnt lgkmcnt(2)
    v_mfma_f32_32x32x16_bf16 v[80:95], v[32:35], v[40:43], v[80:95]
    v_exp_f32 v78, v78
    v_exp_f32 v79, v79
    s_cmp_eq_u32 s3, 1
    s_cbranch_scc1 adaLN_cond__grouped_kv_mqa__glu_gated_swiglu__prompt_kernel_ool_96
adaLN_cond__grouped_kv_mqa__glu_gated_swiglu__prompt_kernel_ret_97:
    s_add_u32 s66, s3, 8
    s_mul_i32 s67, s66, 40960
    s_add_u32 s67, s67, s64
    s_mul_i32 s68, s66, 5120
    s_add_u32 s68, s68, 43008
    s_mov_b32 m0, s68
    s_nop 0
    buffer_load_dwordx4 v212, s[32:35], s67 offen  lds
    v_exp_f32 v48, v48
    v_exp_f32 v49, v49
    v_cvt_pk_bf16_f32 v46, v76, v77
    v_cvt_pk_bf16_f32 v47, v78, v79
    v_exp_f32 v50, v50
    v_exp_f32 v51, v51
    v_mfma_f32_32x32x16_bf16 v[80:95], v[36:39], v[44:47], v[80:95]
    s_mov_b64 exec, s[98:99]
    ds_read_b128 v[32:35], v215 offset:15360
    ds_read_b128 v[36:39], v215 offset:16000
    s_mov_b64 exec, -1
    v_exp_f32 v52, v52
    v_exp_f32 v53, v53
    v_cvt_pk_bf16_f32 v40, v48, v49
    v_cvt_pk_bf16_f32 v41, v50, v51
    s_waitcnt lgkmcnt(2)
    v_mfma_f32_32x32x16_bf16 v[64:79], v[24:27], v[16:19], v[96:111]
    ds_read_b128 v[24:27], v208 offset:20480
    v_exp_f32 v54, v54
    v_exp_f32 v55, v55
    v_exp_f32 v56, v56
    v_exp_f32 v57, v57
    v_cvt_pk_bf16_f32 v42, v52, v53
    v_cvt_pk_bf16_f32 v43, v54, v55
    v_mfma_f32_32x32x16_bf16 v[64:79], v[28:31], v[20:23], v[64:79]
    ds_read_b64 v[28:29], v209 offset:20480
    v_exp_f32 v58, v58
    v_exp_f32 v59, v59
    v_exp_f32 v60, v60
    v_exp_f32 v61, v61
    v_cvt_pk_bf16_f32 v44, v56, v57
    v_cvt_pk_bf16_f32 v45, v58, v59
    s_waitcnt lgkmcnt(2)
    v_mfma_f32_32x32x16_bf16 v[80:95], v[32:35], v[40:43], v[80:95]
    v_exp_f32 v62, v62
    v_exp_f32 v63, v63
    s_cmp_eq_u32 s3, 2
    s_cbranch_scc1 adaLN_cond__grouped_kv_mqa__glu_gated_swiglu__prompt_kernel_ool_98
adaLN_cond__grouped_kv_mqa__glu_gated_swiglu__prompt_kernel_ret_99:
    s_add_u32 s66, s3, 8
    s_mul_i32 s67, s66, 40960
    s_add_u32 s67, s67, s64
    s_mul_i32 s68, s66, 5120
    s_add_u32 s68, s68, 44032
    s_mov_b32 m0, s68
    s_nop 0
    buffer_load_dwordx4 v213, s[32:35], s67 offen  lds
    v_exp_f32 v64, v64
    v_exp_f32 v65, v65
    v_cvt_pk_bf16_f32 v46, v60, v61
    v_cvt_pk_bf16_f32 v47, v62, v63
    v_exp_f32 v66, v66
    v_exp_f32 v67, v67
    v_mfma_f32_32x32x16_bf16 v[80:95], v[36:39], v[44:47], v[80:95]
    s_mov_b64 exec, s[98:99]
    ds_read_b128 v[32:35], v215 offset:17920
    ds_read_b128 v[36:39], v215 offset:18560
    s_mov_b64 exec, -1
    v_exp_f32 v68, v68
    v_exp_f32 v69, v69
    v_cvt_pk_bf16_f32 v40, v64, v65
    v_cvt_pk_bf16_f32 v41, v66, v67
    s_waitcnt lgkmcnt(2)
    v_mfma_f32_32x32x16_bf16 v[48:63], v[24:27], v[16:19], v[96:111]
    ds_read_b128 v[24:27], v208 offset:23040
    v_exp_f32 v70, v70
    v_exp_f32 v71, v71
    v_exp_f32 v72, v72
    v_exp_f32 v73, v73
    v_cvt_pk_bf16_f32 v42, v68, v69
    v_cvt_pk_bf16_f32 v43, v70, v71
    v_mfma_f32_32x32x16_bf16 v[48:63], v[28:31], v[20:23], v[48:63]
    ds_read_b64 v[28:29], v209 offset:23040
    v_exp_f32 v74, v74
    v_exp_f32 v75, v75
    v_exp_f32 v76, v76
    v_exp_f32 v77, v77
    v_cvt_pk_bf16_f32 v44, v72, v73
    v_cvt_pk_bf16_f32 v45, v74, v75
    s_waitcnt lgkmcnt(2)
    v_mfma_f32_32x32x16_bf16 v[80:95], v[32:35], v[40:43], v[80:95]
    v_exp_f32 v78, v78
    v_exp_f32 v79, v79
    s_cmp_eq_u32 s3, 3
    s_cbranch_scc1 adaLN_cond__grouped_kv_mqa__glu_gated_swiglu__prompt_kernel_ool_100
adaLN_cond__grouped_kv_mqa__glu_gated_swiglu__prompt_kernel_ret_101:
    s_add_u32 s66, s3, 8
    s_mul_i32 s67, s66, 40960
    s_add_u32 s67, s67, s64
    s_mul_i32 s68, s66, 5120
    s_add_u32 s68, s68, 45056
    s_mov_b32 m0, s68
    s_nop 0
    buffer_load_dwordx4 v214, s[32:35], s67 offen  lds
    v_exp_f32 v48, v48
    v_exp_f32 v49, v49
    v_cvt_pk_bf16_f32 v46, v76, v77
    v_cvt_pk_bf16_f32 v47, v78, v79
    v_exp_f32 v50, v50
    v_exp_f32 v51, v51
    v_mfma_f32_32x32x16_bf16 v[80:95], v[36:39], v[44:47], v[80:95]
    s_mov_b64 exec, s[98:99]
    ds_read_b128 v[32:35], v215 offset:20480
    ds_read_b128 v[36:39], v215 offset:21120
    s_mov_b64 exec, -1
    v_exp_f32 v52, v52
    v_exp_f32 v53, v53
    v_cvt_pk_bf16_f32 v40, v48, v49
    v_cvt_pk_bf16_f32 v41, v50, v51
    s_waitcnt lgkmcnt(2)
    v_mfma_f32_32x32x16_bf16 v[64:79], v[24:27], v[16:19], v[96:111]
    ds_read_b128 v[24:27], v208 offset:25600
    v_exp_f32 v54, v54
    v_exp_f32 v55, v55
    v_exp_f32 v56, v56
    v_exp_f32 v57, v57
    v_cvt_pk_bf16_f32 v42, v52, v53
    v_cvt_pk_bf16_f32 v43, v54, v55
    v_mfma_f32_32x32x16_bf16 v[64:79], v[28:31], v[20:23], v[64:79]
    ds_read_b64 v[28:29], v209 offset:25600
    v_exp_f32 v58, v58
    v_exp_f32 v59, v59
    v_exp_f32 v60, v60
    v_exp_f32 v61, v61
    v_cvt_pk_bf16_f32 v44, v56, v57
    v_cvt_pk_bf16_f32 v45, v58, v59
    s_waitcnt lgkmcnt(2)
    v_mfma_f32_32x32x16_bf16 v[80:95], v[32:35], v[40:43], v[80:95]
    v_exp_f32 v62, v62
    v_exp_f32 v63, v63
    s_cmp_eq_u32 s3, 4
    s_cbranch_scc1 adaLN_cond__grouped_kv_mqa__glu_gated_swiglu__prompt_kernel_ool_102
adaLN_cond__grouped_kv_mqa__glu_gated_swiglu__prompt_kernel_ret_103:
    s_cmp_ge_u32 s3, 4
    s_cbranch_scc1 adaLN_cond__grouped_kv_mqa__glu_gated_swiglu__prompt_kernel_dmas_104
    s_add_u32 s66, s3, 16
    s_mul_i32 s67, s66, 40960
    s_add_u32 s67, s67, s64
    s_mul_i32 s68, s66, 5120
    s_add_u32 s68, s68, 40960
    s_mov_b32 m0, s68
    s_nop 0
    buffer_load_dwordx4 v210, s[32:35], s67 offen  lds
adaLN_cond__grouped_kv_mqa__glu_gated_swiglu__prompt_kernel_dmas_104:
    v_exp_f32 v64, v64
    v_exp_f32 v65, v65
    v_cvt_pk_bf16_f32 v46, v60, v61
    v_cvt_pk_bf16_f32 v47, v62, v63
    v_exp_f32 v66, v66
    v_exp_f32 v67, v67
    v_mfma_f32_32x32x16_bf16 v[80:95], v[36:39], v[44:47], v[80:95]
    s_mov_b64 exec, s[98:99]
    ds_read_b128 v[32:35], v215 offset:23040
    ds_read_b128 v[36:39], v215 offset:23680
    s_mov_b64 exec, -1
    v_exp_f32 v68, v68
    v_exp_f32 v69, v69
    v_cvt_pk_bf16_f32 v40, v64, v65
    v_cvt_pk_bf16_f32 v41, v66, v67
    s_waitcnt lgkmcnt(2)
    v_mfma_f32_32x32x16_bf16 v[48:63], v[24:27], v[16:19], v[96:111]
    ds_read_b128 v[24:27], v208 offset:28160
    v_exp_f32 v70, v70
    v_exp_f32 v71, v71
    v_exp_f32 v72, v72
    v_exp_f32 v73, v73
    v_cvt_pk_bf16_f32 v42, v68, v69
    v_cvt_pk_bf16_f32 v43, v70, v71
    v_mfma_f32_32x32x16_bf16 v[48:63], v[28:31], v[20:23], v[48:63]
    ds_read_b64 v[28:29], v209 offset:28160
    v_exp_f32 v74, v74
    v_exp_f32 v75, v75
    v_exp_f32 v76, v76
    v_exp_f32 v77, v77
    v_cvt_pk_bf16_f32 v44, v72, v73
    v_cvt_pk_bf16_f32 v45, v74, v75
    s_waitcnt lgkmcnt(2)
    v_mfma_f32_32x32x16_bf16 v[80:95], v[32:35], v[40:43], v[80:95]
    v_exp_f32 v78, v78
    v_exp_f32 v79, v79
    s_cmp_eq_u32 s3, 5
    s_cbranch_scc1 adaLN_cond__grouped_kv_mqa__glu_gated_swiglu__prompt_kernel_ool_105
adaLN_cond__grouped_kv_mqa__glu_gated_swiglu__prompt_kernel_ret_106:
    s_cmp_ge_u32 s3, 4
    s_cbranch_scc1 adaLN_cond__grouped_kv_mqa__glu_gated_swiglu__prompt_kernel_dmas_107
    s_add_u32 s66, s3, 16
    s_mul_i32 s67, s66, 40960
    s_add_u32 s67, s67, s64
    s_mul_i32 s68, s66, 5120
    s_add_u32 s68, s68, 41984
    s_mov_b32 m0, s68
    s_nop 0
    buffer_load_dwordx4 v211, s[32:35], s67 offen  lds
adaLN_cond__grouped_kv_mqa__glu_gated_swiglu__prompt_kernel_dmas_107:
    v_exp_f32 v48, v48
    v_exp_f32 v49, v49
    v_cvt_pk_bf16_f32 v46, v76, v77
    v_cvt_pk_bf16_f32 v47, v78, v79
    v_exp_f32 v50, v50
    v_exp_f32 v51, v51
    v_mfma_f32_32x32x16_bf16 v[80:95], v[36:39], v[44:47], v[80:95]
    s_mov_b64 exec, s[98:99]
    ds_read_b128 v[32:35], v215 offset:25600
    ds_read_b128 v[36:39], v215 offset:26240
    s_mov_b64 exec, -1
    v_exp_f32 v52, v52
    v_exp_f32 v53, v53
    v_cvt_pk_bf16_f32 v40, v48, v49
    v_cvt_pk_bf16_f32 v41, v50, v51
    s_waitcnt lgkmcnt(2)
    v_mfma_f32_32x32x16_bf16 v[64:79], v[24:27], v[16:19], v[96:111]
    ds_read_b128 v[24:27], v208 offset:30720
    v_exp_f32 v54, v54
    v_exp_f32 v55, v55
    v_exp_f32 v56, v56
    v_exp_f32 v57, v57
    v_cvt_pk_bf16_f32 v42, v52, v53
    v_cvt_pk_bf16_f32 v43, v54, v55
    v_mfma_f32_32x32x16_bf16 v[64:79], v[28:31], v[20:23], v[64:79]
    ds_read_b64 v[28:29], v209 offset:30720
    v_exp_f32 v58, v58
    v_exp_f32 v59, v59
    v_exp_f32 v60, v60
    v_exp_f32 v61, v61
    v_cvt_pk_bf16_f32 v44, v56, v57
    v_cvt_pk_bf16_f32 v45, v58, v59
    s_waitcnt lgkmcnt(2)
    v_mfma_f32_32x32x16_bf16 v[80:95], v[32:35], v[40:43], v[80:95]
    v_exp_f32 v62, v62
    v_exp_f32 v63, v63
    s_cmp_eq_u32 s3, 6
    s_cbranch_scc1 adaLN_cond__grouped_kv_mqa__glu_gated_swiglu__prompt_kernel_ool_108
adaLN_cond__grouped_kv_mqa__glu_gated_swiglu__prompt_kernel_ret_109:
    s_cmp_ge_u32 s3, 4
    s_cbranch_scc1 adaLN_cond__grouped_kv_mqa__glu_gated_swiglu__prompt_kernel_dmas_110
    s_add_u32 s66, s3, 16
    s_mul_i32 s67, s66, 40960
    s_add_u32 s67, s67, s64
    s_mul_i32 s68, s66, 5120
    s_add_u32 s68, s68, 43008
    s_mov_b32 m0, s68
    s_nop 0
    buffer_load_dwordx4 v212, s[32:35], s67 offen  lds
adaLN_cond__grouped_kv_mqa__glu_gated_swiglu__prompt_kernel_dmas_110:
    v_exp_f32 v64, v64
    v_exp_f32 v65, v65
    v_cvt_pk_bf16_f32 v46, v60, v61
    v_cvt_pk_bf16_f32 v47, v62, v63
    v_exp_f32 v66, v66
    v_exp_f32 v67, v67
    v_mfma_f32_32x32x16_bf16 v[80:95], v[36:39], v[44:47], v[80:95]
    s_mov_b64 exec, s[98:99]
    ds_read_b128 v[32:35], v215 offset:28160
    ds_read_b128 v[36:39], v215 offset:28800
    s_mov_b64 exec, -1
    v_exp_f32 v68, v68
    v_exp_f32 v69, v69
    v_cvt_pk_bf16_f32 v40, v64, v65
    v_cvt_pk_bf16_f32 v41, v66, v67
    s_waitcnt lgkmcnt(2)
    v_mfma_f32_32x32x16_bf16 v[48:63], v[24:27], v[16:19], v[96:111]
    ds_read_b128 v[24:27], v208 offset:33280
    v_exp_f32 v70, v70
    v_exp_f32 v71, v71
    v_exp_f32 v72, v72
    v_exp_f32 v73, v73
    v_cvt_pk_bf16_f32 v42, v68, v69
    v_cvt_pk_bf16_f32 v43, v70, v71
    v_mfma_f32_32x32x16_bf16 v[48:63], v[28:31], v[20:23], v[48:63]
    ds_read_b64 v[28:29], v209 offset:33280
    v_exp_f32 v74, v74
    v_exp_f32 v75, v75
    v_exp_f32 v76, v76
    v_exp_f32 v77, v77
    v_cvt_pk_bf16_f32 v44, v72, v73
    v_cvt_pk_bf16_f32 v45, v74, v75
    s_waitcnt lgkmcnt(2)
    v_mfma_f32_32x32x16_bf16 v[80:95], v[32:35], v[40:43], v[80:95]
    v_exp_f32 v78, v78
    v_exp_f32 v79, v79
    s_cmp_eq_u32 s3, 7
    s_cbranch_scc1 adaLN_cond__grouped_kv_mqa__glu_gated_swiglu__prompt_kernel_ool_111
adaLN_cond__grouped_kv_mqa__glu_gated_swiglu__prompt_kernel_ret_112:
    s_cmp_ge_u32 s3, 4
    s_cbranch_scc1 adaLN_cond__grouped_kv_mqa__glu_gated_swiglu__prompt_kernel_dmas_113
    s_add_u32 s66, s3, 16
    s_mul_i32 s67, s66, 40960
    s_add_u32 s67, s67, s64
    s_mul_i32 s68, s66, 5120
    s_add_u32 s68, s68, 44032
    s_mov_b32 m0, s68
    s_nop 0
    buffer_load_dwordx4 v213, s[32:35], s67 offen  lds
adaLN_cond__grouped_kv_mqa__glu_gated_swiglu__prompt_kernel_dmas_113:
    v_exp_f32 v48, v48
    v_exp_f32 v49, v49
    v_cvt_pk_bf16_f32 v46, v76, v77
    v_cvt_pk_bf16_f32 v47, v78, v79
    v_exp_f32 v50, v50
    v_exp_f32 v51, v51
    v_mfma_f32_32x32x16_bf16 v[80:95], v[36:39], v[44:47], v[80:95]
    s_mov_b64 exec, s[98:99]
    ds_read_b128 v[32:35], v215 offset:30720
    ds_read_b128 v[36:39], v215 offset:31360
    s_mov_b64 exec, -1
    v_exp_f32 v52, v52
    v_exp_f32 v53, v53
    v_cvt_pk_bf16_f32 v40, v48, v49
    v_cvt_pk_bf16_f32 v41, v50, v51
    s_waitcnt lgkmcnt(2)
    v_mfma_f32_32x32x16_bf16 v[64:79], v[24:27], v[16:19], v[96:111]
    ds_read_b128 v[24:27], v208 offset:35840
    v_exp_f32 v54, v54
    v_exp_f32 v55, v55
    v_exp_f32 v56, v56
    v_exp_f32 v57, v57
    v_cvt_pk_bf16_f32 v42, v52, v53
    v_cvt_pk_bf16_f32 v43, v54, v55
    v_mfma_f32_32x32x16_bf16 v[64:79], v[28:31], v[20:23], v[64:79]
    ds_read_b64 v[28:29], v209 offset:35840
    v_exp_f32 v58, v58
    v_exp_f32 v59, v59
    v_exp_f32 v60, v60
    v_exp_f32 v61, v61
    v_cvt_pk_bf16_f32 v44, v56, v57
    v_cvt_pk_bf16_f32 v45, v58, v59
    s_waitcnt lgkmcnt(2)
    v_mfma_f32_32x32x16_bf16 v[80:95], v[32:35], v[40:43], v[80:95]
    v_exp_f32 v62, v62
    v_exp_f32 v63, v63
    s_cmp_eq_u32 s3, 0
    s_cbranch_scc1 adaLN_cond__grouped_kv_mqa__glu_gated_swiglu__prompt_kernel_ool_114
adaLN_cond__grouped_kv_mqa__glu_gated_swiglu__prompt_kernel_ret_115:
    s_cmp_ge_u32 s3, 4
    s_cbranch_scc1 adaLN_cond__grouped_kv_mqa__glu_gated_swiglu__prompt_kernel_dmas_116
    s_add_u32 s66, s3, 16
    s_mul_i32 s67, s66, 40960
    s_add_u32 s67, s67, s64
    s_mul_i32 s68, s66, 5120
    s_add_u32 s68, s68, 45056
    s_mov_b32 m0, s68
    s_nop 0
    buffer_load_dwordx4 v214, s[32:35], s67 offen  lds
adaLN_cond__grouped_kv_mqa__glu_gated_swiglu__prompt_kernel_dmas_116:
    v_exp_f32 v64, v64
    v_exp_f32 v65, v65
    v_cvt_pk_bf16_f32 v46, v60, v61
    v_cvt_pk_bf16_f32 v47, v62, v63
    v_exp_f32 v66, v66
    v_exp_f32 v67, v67
    v_mfma_f32_32x32x16_bf16 v[80:95], v[36:39], v[44:47], v[80:95]
    s_mov_b64 exec, s[98:99]
    ds_read_b128 v[32:35], v215 offset:33280
    ds_read_b128 v[36:39], v215 offset:33920
    s_mov_b64 exec, -1
    v_exp_f32 v68, v68
    v_exp_f32 v69, v69
    v_cvt_pk_bf16_f32 v40, v64, v65
    v_cvt_pk_bf16_f32 v41, v66, v67
    s_waitcnt lgkmcnt(2)
    v_mfma_f32_32x32x16_bf16 v[48:63], v[24:27], v[16:19], v[96:111]
    ds_read_b128 v[24:27], v208 offset:38400
    v_exp_f32 v70, v70
    v_exp_f32 v71, v71
    v_exp_f32 v72, v72
    v_exp_f32 v73, v73
    v_cvt_pk_bf16_f32 v42, v68, v69
    v_cvt_pk_bf16_f32 v43, v70, v71
    v_mfma_f32_32x32x16_bf16 v[48:63], v[28:31], v[20:23], v[48:63]
    ds_read_b64 v[28:29], v209 offset:38400
    v_exp_f32 v74, v74
    v_exp_f32 v75, v75
    v_exp_f32 v76, v76
    v_exp_f32 v77, v77
    v_cvt_pk_bf16_f32 v44, v72, v73
    v_cvt_pk_bf16_f32 v45, v74, v75
    s_waitcnt lgkmcnt(2)
    v_mfma_f32_32x32x16_bf16 v[80:95], v[32:35], v[40:43], v[80:95]
    v_exp_f32 v78, v78
    v_exp_f32 v79, v79
    s_cmp_eq_u32 s3, 1
    s_cbranch_scc1 adaLN_cond__grouped_kv_mqa__glu_gated_swiglu__prompt_kernel_ool_117
adaLN_cond__grouped_kv_mqa__glu_gated_swiglu__prompt_kernel_ret_118:
    v_exp_f32 v48, v48
    v_exp_f32 v49, v49
    v_cvt_pk_bf16_f32 v46, v76, v77
    v_cvt_pk_bf16_f32 v47, v78, v79
    v_exp_f32 v50, v50
    v_exp_f32 v51, v51
    v_mfma_f32_32x32x16_bf16 v[80:95], v[36:39], v[44:47], v[80:95]
    s_mov_b64 exec, s[98:99]
    ds_read_b128 v[32:35], v215 offset:35840
    ds_read_b128 v[36:39], v215 offset:36480
    s_mov_b64 exec, -1
    v_exp_f32 v52, v52
    v_exp_f32 v53, v53
    v_cvt_pk_bf16_f32 v40, v48, v49
    v_cvt_pk_bf16_f32 v41, v50, v51
    s_waitcnt lgkmcnt(2)
    v_mfma_f32_32x32x16_bf16 v[64:79], v[24:27], v[16:19], v[96:111]
    v_exp_f32 v54, v54
    v_exp_f32 v55, v55
    v_exp_f32 v56, v56
    v_exp_f32 v57, v57
    v_cvt_pk_bf16_f32 v42, v52, v53
    v_cvt_pk_bf16_f32 v43, v54, v55
    v_mfma_f32_32x32x16_bf16 v[64:79], v[28:31], v[20:23], v[64:79]
    v_exp_f32 v58, v58
    v_exp_f32 v59, v59
    v_exp_f32 v60, v60
    v_exp_f32 v61, v61
    v_cvt_pk_bf16_f32 v44, v56, v57
    v_cvt_pk_bf16_f32 v45, v58, v59
    s_waitcnt lgkmcnt(0)
    v_mfma_f32_32x32x16_bf16 v[80:95], v[32:35], v[40:43], v[80:95]
    v_exp_f32 v62, v62
    v_exp_f32 v63, v63
    s_nop 1
    v_exp_f32 v64, v64
    v_exp_f32 v65, v65
    v_cvt_pk_bf16_f32 v46, v60, v61
    v_cvt_pk_bf16_f32 v47, v62, v63
    v_exp_f32 v66, v66
    v_exp_f32 v67, v67
    v_mfma_f32_32x32x16_bf16 v[80:95], v[36:39], v[44:47], v[80:95]
    s_mov_b64 exec, s[98:99]
    ds_read_b128 v[32:35], v215 offset:38400
    ds_read_b128 v[36:39], v215 offset:39040
    s_mov_b64 exec, -1
    v_exp_f32 v68, v68
    v_exp_f32 v69, v69
    v_cvt_pk_bf16_f32 v40, v64, v65
    v_cvt_pk_bf16_f32 v41, v66, v67
    v_exp_f32 v70, v70
    v_exp_f32 v71, v71
    v_exp_f32 v72, v72
    v_exp_f32 v73, v73
    v_cvt_pk_bf16_f32 v42, v68, v69
    v_cvt_pk_bf16_f32 v43, v70, v71
    v_exp_f32 v74, v74
    v_exp_f32 v75, v75
    v_exp_f32 v76, v76
    v_exp_f32 v77, v77
    v_cvt_pk_bf16_f32 v44, v72, v73
    v_cvt_pk_bf16_f32 v45, v74, v75
    s_waitcnt lgkmcnt(0)
    v_mfma_f32_32x32x16_bf16 v[80:95], v[32:35], v[40:43], v[80:95]
    v_exp_f32 v78, v78
    v_exp_f32 v79, v79
    v_cvt_pk_bf16_f32 v46, v76, v77
    v_cvt_pk_bf16_f32 v47, v78, v79
    s_nop 1
    v_mfma_f32_32x32x16_bf16 v[80:95], v[36:39], v[44:47], v[80:95]
    s_nop 11
    v_mov_b32 v117, v88
    v_mov_b32 v118, v88
    s_nop 1
    v_permlane32_swap_b32 v117, v118
    v_rcp_f32 v117, v118
    s_nop 0
    v_mul_f32 v80, v80, v117
    v_mul_f32 v81, v81, v117
    v_mul_f32 v82, v82, v117
    v_mul_f32 v83, v83, v117
    v_mul_f32 v84, v84, v117
    v_mul_f32 v85, v85, v117
    v_mul_f32 v86, v86, v117
    v_mul_f32 v87, v87, v117
    v_mul_f32 v88, v88, v117
    v_mul_f32 v89, v89, v117
    v_mul_f32 v90, v90, v117
    v_mul_f32 v91, v91, v117
    v_cvt_pk_bf16_f32 v40, v80, v81
    v_cvt_pk_bf16_f32 v41, v82, v83
    v_cvt_pk_bf16_f32 v42, v84, v85
    v_cvt_pk_bf16_f32 v43, v86, v87
    v_cvt_pk_bf16_f32 v44, v88, v89
    v_cvt_pk_bf16_f32 v45, v90, v91
    v_mov_b32 v117, 0x71800000
    v_cmp_nlt_f32 vcc, v118, v117
    s_nop 0
    s_cmp_lg_u64 vcc, 0
    s_cselect_b32 s48, 1, 0
    v_mov_b32 v117, s48
    s_lshl_b32 s49, s3, 2
    s_add_u32 s49, s49, 163000
    v_mov_b32 v119, s49
    s_mov_b64 exec, 1
    ds_write_b32 v119, v117
    s_mov_b64 exec, -1
    v_bfe_u32 v115, v1, 4, 1
    s_lshr_b32 s50, s36, 4
    s_and_b32 s51, s3, 1
    s_lshl_b32 s51, s51, 1
    s_add_u32 s50, s50, s51
    v_add_u32 v115, s50, v115
    v_mul_u32_u24 v115, 20480, v115
    v_and_b32 v116, 15, v1
    v_lshl_add_u32 v115, v116, 4, v115
    s_lshr_b32 s50, s37, 1
    s_mul_i32 s50, s50, 5
    s_and_b32 s51, s37, 1
    s_lshr_b32 s52, s3, 1
    s_lshl_b32 s53, s51, 1
    s_add_u32 s53, s53, s50
    s_lshr_b32 s54, s52, 1
    s_add_u32 s53, s53, s54
    s_lshl_b32 s53, s53, 10
    s_and_b32 s55, s52, 1
    s_lshl_b32 s56, s55, 9
    s_add_u32 s53, s53, s56
    v_lshrrev_b32 v116, 5, v1
    v_lshl_add_u32 v116, v116, 8, v115
    s_cmp_eq_u32 s14, 0
    s_cbranch_scc1 adaLN_cond__grouped_kv_mqa__glu_gated_swiglu__prompt_kernel_ss_119
    buffer_store_dwordx4 v[40:43], v116, s[28:31], s53 offen
    s_branch adaLN_cond__grouped_kv_mqa__glu_gated_swiglu__prompt_kernel_ss_120
adaLN_cond__grouped_kv_mqa__glu_gated_swiglu__prompt_kernel_ss_119:
    buffer_store_dwordx4 v[40:43], v116, s[28:31], s53 offen sc1
adaLN_cond__grouped_kv_mqa__glu_gated_swiglu__prompt_kernel_ss_120:
    s_add_u32 s50, s50, 4
    s_lshl_b32 s50, s50, 10
    s_lshl_b32 s51, s51, 1
    s_add_u32 s51, s51, s54
    s_lshl_b32 s51, s51, 8
    s_add_u32 s50, s50, s51
    s_lshl_b32 s55, s55, 3
    s_add_u32 s50, s50, s55
    s_mov_b64 exec, 0xffffffff
    s_cmp_eq_u32 s14, 0
    s_cbranch_scc1 adaLN_cond__grouped_kv_mqa__glu_gated_swiglu__prompt_kernel_ss_121
    buffer_store_dwordx2 v[44:45], v115, s[28:31], s50 offen
    s_branch adaLN_cond__grouped_kv_mqa__glu_gated_swiglu__prompt_kernel_ss_122
adaLN_cond__grouped_kv_mqa__glu_gated_swiglu__prompt_kernel_ss_121:
    buffer_store_dwordx2 v[44:45], v115, s[28:31], s50 offen sc1
adaLN_cond__grouped_kv_mqa__glu_gated_swiglu__prompt_kernel_ss_122:
    s_mov_b64 exec, -1
    s_waitcnt vmcnt(0)
    s_waitcnt lgkmcnt(0)
    s_barrier
    v_and_b32 v117, 7, v1
    v_lshlrev_b32 v117, 2, v117
    v_add_u32 v117, 163000, v117
    ds_read_b32 v119, v117
    s_waitcnt lgkmcnt(0)
    v_cmp_ne_u32 vcc, 0, v119
    s_nop 0
    s_cbranch_vccz adaLN_cond__grouped_kv_mqa__glu_gated_swiglu__prompt_kernel_attn_ok_123
    s_waitcnt vmcnt(0)
    s_barrier
    s_add_u32 s97, s96, 0
    s_mov_b32 m0, s97
    s_nop 0
    buffer_load_dwordx4 v2, s[24:27], s97 offen sc1 lds
    s_add_u32 s97, s96, 8192
    s_mov_b32 m0, s97
    s_nop 0
    buffer_load_dwordx4 v2, s[24:27], s97 offen sc1 lds
    s_add_u32 s97, s96, 16384
    s_mov_b32 m0, s97
    s_nop 0
    buffer_load_dwordx4 v2, s[24:27], s97 offen sc1 lds
    s_add_u32 s97, s96, 24576
    s_mov_b32 m0, s97
    s_nop 0
    buffer_load_dwordx4 v2, s[24:27], s97 offen sc1 lds
    s_add_u32 s97, s96, 32768
    s_mov_b32 m0, s97
    s_nop 0
    buffer_load_dwordx4 v2, s[24:27], s97 offen sc1 lds
    s_add_u32 s97, s96, 40960
    s_mov_b32 m0, s97
    s_nop 0
    buffer_load_dwordx4 v2, s[24:27], s97 offen sc1 lds
    s_add_u32 s97, s96, 49152
    s_mov_b32 m0, s97
    s_nop 0
    buffer_load_dwordx4 v2, s[24:27], s97 offen sc1 lds
    s_add_u32 s97, s96, 57344
    s_mov_b32 m0, s97
    s_nop 0
    buffer_load_dwordx4 v2, s[24:27], s97 offen sc1 lds
    s_add_u32 s97, s96, 65536
    s_mov_b32 m0, s97
    s_nop 0
    buffer_load_dwordx4 v2, s[24:27], s97 offen sc1 lds
    s_add_u32 s97, s96, 73728
    s_mov_b32 m0, s97
    s_nop 0
    buffer_load_dwordx4 v2, s[24:27], s97 offen sc1 lds
    s_add_u32 s97, s96, 81920
    s_mov_b32 m0, s97
    s_nop 0
    buffer_load_dwordx4 v2, s[24:27], s97 offen sc1 lds
    s_add_u32 s97, s96, 90112
    s_mov_b32 m0, s97
    s_nop 0
    buffer_load_dwordx4 v2, s[24:27], s97 offen sc1 lds
    s_add_u32 s97, s96, 98304
    s_mov_b32 m0, s97
    s_nop 0
    buffer_load_dwordx4 v2, s[24:27], s97 offen sc1 lds
    s_add_u32 s97, s96, 106496
    s_mov_b32 m0, s97
    s_nop 0
    buffer_load_dwordx4 v2, s[24:27], s97 offen sc1 lds
    s_add_u32 s97, s96, 114688
    s_mov_b32 m0, s97
    s_nop 0
    buffer_load_dwordx4 v2, s[24:27], s97 offen sc1 lds
    s_add_u32 s97, s96, 122880
    s_mov_b32 m0, s97
    s_nop 0
    buffer_load_dwordx4 v2, s[24:27], s97 offen sc1 lds
    s_add_u32 s97, s96, 131072
    s_mov_b32 m0, s97
    s_nop 0
    buffer_load_dwordx4 v2, s[24:27], s97 offen sc1 lds
    s_add_u32 s97, s96, 139264
    s_mov_b32 m0, s97
    s_nop 0
    buffer_load_dwordx4 v2, s[24:27], s97 offen sc1 lds
    s_add_u32 s97, s96, 147456
    s_mov_b32 m0, s97
    s_nop 0
    buffer_load_dwordx4 v2, s[24:27], s97 offen sc1 lds
    s_add_u32 s97, s96, 155648
    s_mov_b32 m0, s97
    s_nop 0
    buffer_load_dwordx4 v2, s[24:27], s97 offen sc1 lds
    s_waitcnt vmcnt(0)
    s_barrier
    v_lshlrev_b32 v112, 4, v1
    v_and_b32 v116, 31, v1
    v_lshlrev_b32 v113, 3, v116
    v_add_u32 v113, 1024, v113
    v_lshrrev_b32 v117, 5, v1
    v_mul_u32_u24 v117, 20, v117
    v_add_u32 v117, v117, v116
    v_lshlrev_b32 v114, 4, v117
    v_add_u32 v114, 1280, v114
    v_mov_b32 v115, 0xff800000
    v_mov_b32 v119, v112
    v_mov_b32 v120, v113
    s_mov_b32 s48, 0
adaLN_cond__grouped_kv_mqa__glu_gated_swiglu__prompt_kernel_attn_maxloop_124:
    ds_read_b128 v[24:27], v119
    ds_read_b64 v[28:29], v120
    s_waitcnt lgkmcnt(1)
    v_mfma_f32_32x32x16_bf16 v[48:63], v[24:27], v[16:19], 0
    s_waitcnt lgkmcnt(0)
    v_mfma_f32_32x32x16_bf16 v[48:63], v[28:31], v[20:23], v[48:63]
    s_nop 11
    v_max3_f32 v115, v115, v48, v49
    v_max3_f32 v115, v115, v50, v51
    v_max3_f32 v115, v115, v52, v53
    v_max3_f32 v115, v115, v54, v55
    v_max3_f32 v115, v115, v56, v57
    v_max3_f32 v115, v115, v58, v59
    v_max3_f32 v115, v115, v60, v61
    v_max3_f32 v115, v115, v62, v63
    v_add_u32 v119, 2560, v119
    v_add_u32 v120, 2560, v120
    s_add_u32 s48, s48, 1
    s_cmp_lt_u32 s48, 64
    s_cbranch_scc1 adaLN_cond__grouped_kv_mqa__glu_gated_swiglu__prompt_kernel_attn_maxloop_124
    v_mov_b32 v116, v115
    s_nop 1
    v_permlane32_swap_b32 v115, v116
    v_max_f32 v115, v115, v116
    v_sub_f32 v96, 0, v115
    v_sub_f32 v97, 0, v115
    v_sub_f32 v98, 0, v115
    v_sub_f32 v99, 0, v115
    v_sub_f32 v100, 0, v115
    v_sub_f32 v101, 0, v115
    v_sub_f32 v102, 0, v115
    v_sub_f32 v103, 0, v115
    v_sub_f32 v104, 0, v115
    v_sub_f32 v105, 0, v115
    v_sub_f32 v106, 0, v115
    v_sub_f32 v107, 0, v115
    v_sub_f32 v108, 0, v115
    v_sub_f32 v109, 0, v115
    v_sub_f32 v110, 0, v115
    v_sub_f32 v111, 0, v115
    v_mov_b32 v80, 0
    v_mov_b32 v81, 0
    v_mov_b32 v82, 0
    v_mov_b32 v83, 0
    v_mov_b32 v84, 0
    v_mov_b32 v85, 0
    v_mov_b32 v86, 0
    v_mov_b32 v87, 0
    v_mov_b32 v88, 0
    v_mov_b32 v89, 0
    v_mov_b32 v90, 0
    v_mov_b32 v91, 0
    v_mov_b32 v92, 0
    v_mov_b32 v93, 0
    v_mov_b32 v94, 0
    v_mov_b32 v95, 0
    s_mov_b32 s48, 0
adaLN_cond__grouped_kv_mqa__glu_gated_swiglu__prompt_kernel_attn_redoloop_125:
    ds_read_b128 v[24:27], v112
    ds_read_b64 v[28:29], v113
    s_mov_b64 exec, s[98:99]
    ds_read_b128 v[32:35], v114
    ds_read_b128 v[36:39], v114 offset:640
    s_mov_b64 exec, -1
    s_waitcnt lgkmcnt(3)
    v_mfma_f32_32x32x16_bf16 v[48:63], v[24:27], v[16:19], v[96:111]
    s_waitcnt lgkmcnt(2)
    v_mfma_f32_32x32x16_bf16 v[48:63], v[28:31], v[20:23], v[48:63]
    s_nop 11
    v_exp_f32 v48, v48
    v_exp_f32 v49, v49
    v_exp_f32 v50, v50
    v_exp_f32 v51, v51
    v_exp_f32 v52, v52
    v_exp_f32 v53, v53
    v_exp_f32 v54, v54
    v_exp_f32 v55, v55
    v_exp_f32 v56, v56
    v_exp_f32 v57, v57
    v_exp_f32 v58, v58
    v_exp_f32 v59, v59
    v_exp_f32 v60, v60
    v_exp_f32 v61, v61
    v_exp_f32 v62, v62
    v_exp_f32 v63, v63
    v_cvt_pk_bf16_f32 v40, v48, v49
    v_cvt_pk_bf16_f32 v41, v50, v51
    v_cvt_pk_bf16_f32 v42, v52, v53
    v_cvt_pk_bf16_f32 v43, v54, v55
    v_cvt_pk_bf16_f32 v44, v56, v57
    v_cvt_pk_bf16_f32 v45, v58, v59
    v_cvt_pk_bf16_f32 v46, v60, v61
    v_cvt_pk_bf16_f32 v47, v62, v63
    s_waitcnt lgkmcnt(1)
    v_mfma_f32_32x32x16_bf16 v[80:95], v[32:35], v[40:43], v[80:95]
    s_waitcnt lgkmcnt(0)
    v_mfma_f32_32x32x16_bf16 v[80:95], v[36:39], v[44:47], v[80:95]
    v_add_u32 v112, 2560, v112
    v_add_u32 v113, 2560, v113
    v_add_u32 v114, 2560, v114
    s_add_u32 s48, s48, 1
    s_cmp_lt_u32 s48, 64
    s_cbranch_scc1 adaLN_cond__grouped_kv_mqa__glu_gated_swiglu__prompt_kernel_attn_redoloop_125
    s_nop 5
    v_mov_b32 v117, v88
    v_mov_b32 v118, v88
    s_nop 1
    v_permlane32_swap_b32 v117, v118
    v_rcp_f32 v117, v118
    s_nop 0
    v_mul_f32 v80, v80, v117
    v_mul_f32 v81, v81, v117
    v_mul_f32 v82, v82, v117
    v_mul_f32 v83, v83, v117
    v_mul_f32 v84, v84, v117
    v_mul_f32 v85, v85, v117
    v_mul_f32 v86, v86, v117
    v_mul_f32 v87, v87, v117
    v_mul_f32 v88, v88, v117
    v_mul_f32 v89, v89, v117
    v_mul_f32 v90, v90, v117
    v_mul_f32 v91, v91, v117
    v_cvt_pk_bf16_f32 v40, v80, v81
    v_cvt_pk_bf16_f32 v41, v82, v83
    v_cvt_pk_bf16_f32 v42, v84, v85
    v_cvt_pk_bf16_f32 v43, v86, v87
    v_cvt_pk_bf16_f32 v44, v88, v89
    v_cvt_pk_bf16_f32 v45, v90, v91
    v_bfe_u32 v115, v1, 4, 1
    s_lshr_b32 s50, s36, 4
    s_and_b32 s51, s3, 1
    s_lshl_b32 s51, s51, 1
    s_add_u32 s50, s50, s51
    v_add_u32 v115, s50, v115
    v_mul_u32_u24 v115, 20480, v115
    v_and_b32 v116, 15, v1
    v_lshl_add_u32 v115, v116, 4, v115
    s_lshr_b32 s50, s37, 1
    s_mul_i32 s50, s50, 5
    s_and_b32 s51, s37, 1
    s_lshr_b32 s52, s3, 1
    s_lshl_b32 s53, s51, 1
    s_add_u32 s53, s53, s50
    s_lshr_b32 s54, s52, 1
    s_add_u32 s53, s53, s54
    s_lshl_b32 s53, s53, 10
    s_and_b32 s55, s52, 1
    s_lshl_b32 s56, s55, 9
    s_add_u32 s53, s53, s56
    v_lshrrev_b32 v116, 5, v1
    v_lshl_add_u32 v116, v116, 8, v115
    s_cmp_eq_u32 s14, 0
    s_cbranch_scc1 adaLN_cond__grouped_kv_mqa__glu_gated_swiglu__prompt_kernel_ss_126
    buffer_store_dwordx4 v[40:43], v116, s[28:31], s53 offen
    s_branch adaLN_cond__grouped_kv_mqa__glu_gated_swiglu__prompt_kernel_ss_127
adaLN_cond__grouped_kv_mqa__glu_gated_swiglu__prompt_kernel_ss_126:
    buffer_store_dwordx4 v[40:43], v116, s[28:31], s53 offen sc1
adaLN_cond__grouped_kv_mqa__glu_gated_swiglu__prompt_kernel_ss_127:
    s_add_u32 s50, s50, 4
    s_lshl_b32 s50, s50, 10
    s_lshl_b32 s51, s51, 1
    s_add_u32 s51, s51, s54
    s_lshl_b32 s51, s51, 8
    s_add_u32 s50, s50, s51
    s_lshl_b32 s55, s55, 3
    s_add_u32 s50, s50, s55
    s_mov_b64 exec, 0xffffffff
    s_cmp_eq_u32 s14, 0
    s_cbranch_scc1 adaLN_cond__grouped_kv_mqa__glu_gated_swiglu__prompt_kernel_ss_128
    buffer_store_dwordx2 v[44:45], v115, s[28:31], s50 offen
    s_branch adaLN_cond__grouped_kv_mqa__glu_gated_swiglu__prompt_kernel_ss_129
adaLN_cond__grouped_kv_mqa__glu_gated_swiglu__prompt_kernel_ss_128:
    buffer_store_dwordx2 v[44:45], v115, s[28:31], s50 offen sc1
adaLN_cond__grouped_kv_mqa__glu_gated_swiglu__prompt_kernel_ss_129:
    s_mov_b64 exec, -1
    s_waitcnt vmcnt(0) lgkmcnt(0)
    s_barrier
    s_add_u32 s66, s3, 0
    s_mul_i32 s67, s66, 40960
    s_add_u32 s67, s67, s64
    s_mul_i32 s68, s66, 5120
    s_add_u32 s68, s68, 40960
    s_mov_b32 m0, s68
    s_nop 0
    buffer_load_dwordx4 v210, s[32:35], s67 offen  lds
    s_add_u32 s66, s3, 0
    s_mul_i32 s67, s66, 40960
    s_add_u32 s67, s67, s64
    s_mul_i32 s68, s66, 5120
    s_add_u32 s68, s68, 41984
    s_mov_b32 m0, s68
    s_nop 0
    buffer_load_dwordx4 v211, s[32:35], s67 offen  lds
    s_add_u32 s66, s3, 0
    s_mul_i32 s67, s66, 40960
    s_add_u32 s67, s67, s64
    s_mul_i32 s68, s66, 5120
    s_add_u32 s68, s68, 43008
    s_mov_b32 m0, s68
    s_nop 0
    buffer_load_dwordx4 v212, s[32:35], s67 offen  lds
    s_add_u32 s66, s3, 0
    s_mul_i32 s67, s66, 40960
    s_add_u32 s67, s67, s64
    s_mul_i32 s68, s66, 5120
    s_add_u32 s68, s68, 44032
    s_mov_b32 m0, s68
    s_nop 0
    buffer_load_dwordx4 v213, s[32:35], s67 offen  lds
    s_add_u32 s66, s3, 0
    s_mul_i32 s67, s66, 40960
    s_add_u32 s67, s67, s64
    s_mul_i32 s68, s66, 5120
    s_add_u32 s68, s68, 45056
    s_mov_b32 m0, s68
    s_nop 0
    buffer_load_dwordx4 v214, s[32:35], s67 offen  lds
    s_add_u32 s66, s3, 8
    s_mul_i32 s67, s66, 40960
    s_add_u32 s67, s67, s64
    s_mul_i32 s68, s66, 5120
    s_add_u32 s68, s68, 40960
    s_mov_b32 m0, s68
    s_nop 0
    buffer_load_dwordx4 v210, s[32:35], s67 offen  lds
    s_add_u32 s66, s3, 8
    s_mul_i32 s67, s66, 40960
    s_add_u32 s67, s67, s64
    s_mul_i32 s68, s66, 5120
    s_add_u32 s68, s68, 41984
    s_mov_b32 m0, s68
    s_nop 0
    buffer_load_dwordx4 v211, s[32:35], s67 offen  lds
    s_add_u32 s66, s3, 8
    s_mul_i32 s67, s66, 40960
    s_add_u32 s67, s67, s64
    s_mul_i32 s68, s66, 5120
    s_add_u32 s68, s68, 43008
    s_mov_b32 m0, s68
    s_nop 0
    buffer_load_dwordx4 v212, s[32:35], s67 offen  lds
    s_add_u32 s66, s3, 8
    s_mul_i32 s67, s66, 40960
    s_add_u32 s67, s67, s64
    s_mul_i32 s68, s66, 5120
    s_add_u32 s68, s68, 44032
    s_mov_b32 m0, s68
    s_nop 0
    buffer_load_dwordx4 v213, s[32:35], s67 offen  lds
    s_add_u32 s66, s3, 8
    s_mul_i32 s67, s66, 40960
    s_add_u32 s67, s67, s64
    s_mul_i32 s68, s66, 5120
    s_add_u32 s68, s68, 45056
    s_mov_b32 m0, s68
    s_nop 0
    buffer_load_dwordx4 v214, s[32:35], s67 offen  lds
    s_cmp_ge_u32 s3, 4
    s_cbranch_scc1 adaLN_cond__grouped_kv_mqa__glu_gated_swiglu__prompt_kernel_dmas_130
    s_add_u32 s66, s3, 16
    s_mul_i32 s67, s66, 40960
    s_add_u32 s67, s67, s64
    s_mul_i32 s68, s66, 5120
    s_add_u32 s68, s68, 40960
    s_mov_b32 m0, s68
    s_nop 0
    buffer_load_dwordx4 v210, s[32:35], s67 offen  lds
adaLN_cond__grouped_kv_mqa__glu_gated_swiglu__prompt_kernel_dmas_130:
    s_cmp_ge_u32 s3, 4
    s_cbranch_scc1 adaLN_cond__grouped_kv_mqa__glu_gated_swiglu__prompt_kernel_dmas_131
    s_add_u32 s66, s3, 16
    s_mul_i32 s67, s66, 40960
    s_add_u32 s67, s67, s64
    s_mul_i32 s68, s66, 5120
    s_add_u32 s68, s68, 41984
    s_mov_b32 m0, s68
    s_nop 0
    buffer_load_dwordx4 v211, s[32:35], s67 offen  lds
adaLN_cond__grouped_kv_mqa__glu_gated_swiglu__prompt_kernel_dmas_131:
    s_cmp_ge_u32 s3, 4
    s_cbranch_scc1 adaLN_cond__grouped_kv_mqa__glu_gated_swiglu__prompt_kernel_dmas_132
    s_add_u32 s66, s3, 16
    s_mul_i32 s67, s66, 40960
    s_add_u32 s67, s67, s64
    s_mul_i32 s68, s66, 5120
    s_add_u32 s68, s68, 43008
    s_mov_b32 m0, s68
    s_nop 0
    buffer_load_dwordx4 v212, s[32:35], s67 offen  lds
adaLN_cond__grouped_kv_mqa__glu_gated_swiglu__prompt_kernel_dmas_132:
    s_cmp_ge_u32 s3, 4
    s_cbranch_scc1 adaLN_cond__grouped_kv_mqa__glu_gated_swiglu__prompt_kernel_dmas_133
    s_add_u32 s66, s3, 16
    s_mul_i32 s67, s66, 40960
    s_add_u32 s67, s67, s64
    s_mul_i32 s68, s66, 5120
    s_add_u32 s68, s68, 44032
    s_mov_b32 m0, s68
    s_nop 0
    buffer_load_dwordx4 v213, s[32:35], s67 offen  lds
adaLN_cond__grouped_kv_mqa__glu_gated_swiglu__prompt_kernel_dmas_133:
    s_cmp_ge_u32 s3, 4
    s_cbranch_scc1 adaLN_cond__grouped_kv_mqa__glu_gated_swiglu__prompt_kernel_dmas_134
    s_add_u32 s66, s3, 16
    s_mul_i32 s67, s66, 40960
    s_add_u32 s67, s67, s64
    s_mul_i32 s68, s66, 5120
    s_add_u32 s68, s68, 45056
    s_mov_b32 m0, s68
    s_nop 0
    buffer_load_dwordx4 v214, s[32:35], s67 offen  lds
adaLN_cond__grouped_kv_mqa__glu_gated_swiglu__prompt_kernel_dmas_134:
adaLN_cond__grouped_kv_mqa__glu_gated_swiglu__prompt_kernel_attn_ok_123:
    s_lshr_b32 s40, s36, 6
    s_lshl_b32 s40, s40, 7
    s_add_u32 s40, s40, 16384
    s_lshl_b32 s41, s37, 2
    s_add_u32 s41, s41, s40
    s_cmp_lg_u32 s3, 0
    s_cbranch_scc1 adaLN_cond__grouped_kv_mqa__glu_gated_swiglu__prompt_kernel_flag_135
    v_mov_b32 v2, s71
    v_mov_b32 v3, 0
    s_mov_b64 exec, 1
    s_cmp_eq_u32 s14, 0
    s_cbranch_scc1 adaLN_cond__grouped_kv_mqa__glu_gated_swiglu__prompt_kernel_ss_136
    buffer_store_dword v2, v3, s[60:63], s41 offen
    s_branch adaLN_cond__grouped_kv_mqa__glu_gated_swiglu__prompt_kernel_ss_137
adaLN_cond__grouped_kv_mqa__glu_gated_swiglu__prompt_kernel_ss_136:
    buffer_store_dword v2, v3, s[60:63], s41 offen sc1
adaLN_cond__grouped_kv_mqa__glu_gated_swiglu__prompt_kernel_ss_137:
    s_mov_b64 exec, -1
adaLN_cond__grouped_kv_mqa__glu_gated_swiglu__prompt_kernel_flag_135:
    s_mov_b32 s16, s4
    s_mov_b32 s17, s5
    s_mov_b32 s18, 2621440
    s_mov_b32 s19, 0x00020000
    s_mov_b32 s20, s6
    s_mov_b32 s21, s7
    s_mov_b32 s22, 61440
    s_mov_b32 s23, 0x00020000
    s_add_u32 s32, s6, 11468800
    s_addc_u32 s33, s7, 0
    s_mov_b32 s34, 2621440
    s_mov_b32 s35, 0x00020000
    s_add_u32 s24, s6, 2162688
    s_addc_u32 s25, s7, 0
    s_mov_b32 s26, 4440064
    s_mov_b32 s27, 0x00020000
    v_add_f32 v144, v144, v148
    v_add_f32 v152, v152, v156
    v_add_f32 v144, v144, v152
    v_cvt_pk_bf16_f32 v144, v144, v144
    v_lshlrev_b32 v144, 16, v144
    v_add_f32 v144, v144, v141
    v_cvt_pk_bf16_f32 v144, v144, v144
    v_lshlrev_b32 v144, 16, v144
    v_add_f32 v145, v145, v149
    v_add_f32 v153, v153, v157
    v_add_f32 v145, v145, v153
    v_cvt_pk_bf16_f32 v145, v145, v145
    v_lshlrev_b32 v145, 16, v145
    v_add_f32 v145, v145, v141
    v_cvt_pk_bf16_f32 v145, v145, v145
    v_lshlrev_b32 v145, 16, v145
    v_add_f32 v146, v146, v150
    v_add_f32 v154, v154, v158
    v_add_f32 v146, v146, v154
    v_cvt_pk_bf16_f32 v146, v146, v146
    v_lshlrev_b32 v146, 16, v146
    v_add_f32 v146, v146, v141
    v_cvt_pk_bf16_f32 v146, v146, v146
    v_lshlrev_b32 v146, 16, v146
    v_add_f32 v147, v147, v151
    v_add_f32 v155, v155, v159
    v_add_f32 v147, v147, v155
    v_cvt_pk_bf16_f32 v147, v147, v147
    v_lshlrev_b32 v147, 16, v147
    v_add_f32 v147, v147, v141
    v_cvt_pk_bf16_f32 v147, v147, v147
    v_lshlrev_b32 v147, 16, v147
    v_cmp_gt_u32 vcc, 160, v140
    s_nop 0
    s_and_saveexec_b64 s[40:41], vcc
    s_cbranch_execz adaLN_cond__grouped_kv_mqa__glu_gated_swiglu__prompt_kernel_m2l_138
    ds_write_b128 v143, v[144:147]
adaLN_cond__grouped_kv_mqa__glu_gated_swiglu__prompt_kernel_m2l_138:
    s_mov_b64 exec, s[40:41]
    v_lshrrev_b32 v100, 4, v1
    v_mul_u32_u24 v100, 1280, v100
    v_and_b32 v101, 15, v1
    v_lshl_add_u32 v100, v101, 4, v100
    s_lshr_b32 s41, s3, 2
    s_mul_i32 s41, s41, 5120
    v_add_u32 v124, s41, v100
    v_add_u32 v124, 40960, v124
    v_add_u32 v125, 51200, v124
    s_and_b32 s52, s2, 7
    s_lshl_b32 s52, s52, 8
    s_lshr_b32 s53, s2, 7
    s_lshl_b32 s53, s53, 7
    s_add_u32 s52, s52, s53
    s_bfe_u32 s55, s2, 0x40003
    s_mul_i32 s53, s55, 7
    s_mul_i32 s56, s55, 6
    s_add_u32 s56, s56, 12
    s_cmp_lt_u32 s55, 12
    s_cselect_b32 s53, s53, s56
    s_cselect_b32 s54, 7, 6
    s_add_u32 s56, s6, 14090240
    s_addc_u32 s57, s7, 0
    s_mov_b32 s58, 262144
    s_mov_b32 s59, 0x00020000
    v_and_b32 v250, 15, v1
    v_lshlrev_b32 v250, 4, v250
    v_lshrrev_b32 v251, 5, v1
    v_mul_u32_u24 v251, 27648, v251
    v_add_u32 v250, v250, v251
    v_bfe_u32 v251, v1, 4, 1
    s_mov_b32 s64, 2228224
    v_mul_lo_u32 v251, v251, s64
    v_add_u32 v250, v250, v251
    s_sub_u32 s64, s3, 4
    s_mul_i32 s65, s64, 55296
    s_lshl_b32 s66, s53, 8
    s_add_u32 s65, s65, s66
    s_lshl_b32 s66, s64, 10
    s_and_b32 s55, s3, 3
    v_lshrrev_b32 v101, 1, v128
    v_lshlrev_b32 v101, 5, v101
    v_and_b32 v102, 15, v1
    v_add_u32 v101, v101, v102
    s_and_b32 s42, s55, 1
    s_lshl_b32 s42, s42, 4
    v_add_u32 v101, s42, v101
    v_lshlrev_b32 v101, 4, v101
    v_and_b32 v102, 1, v128
    v_lshl_add_u32 v146, v102, 3, v101
    s_lshr_b32 s42, s36, 5
    s_lshr_b32 s43, s55, 1
    s_add_u32 s42, s42, s43
    s_mul_i32 s42, s42, 40
    s_mul_i32 s43, s37, 5
    s_add_u32 s42, s42, s43
    s_lshl_b32 s50, s42, 10
    v_lshlrev_b32 v147, 4, v128
    s_mul_i32 s43, s37, 320
    v_add_u32 v147, s43, v147
    v_add_u32 v147, 143360, v147
    v_lshlrev_b32 v148, 3, v1
    s_mul_i32 s43, s55, 2560
    s_add_u32 s43, s43, 152064
    v_add_u32 v148, s43, v148
    s_mul_i32 s41, s55, 5120
    v_lshlrev_b32 v149, 4, v1
    v_add_u32 v149, s41, v149
    v_add_u32 v149, 0, v149
    v_lshlrev_b32 v126, 7, v126
    s_lshr_b32 s40, s36, 7
    s_lshl_b32 s40, s40, 7
    s_add_u32 s40, s40, 24576
    s_bfe_u32 s41, s36, 0x10006
    s_lshl_b32 s41, s41, 3
    s_add_u32 s41, s41, s37
    s_lshl_b32 s41, s41, 2
    s_add_u32 s51, s41, s40
    s_waitcnt vmcnt(0)
    s_waitcnt lgkmcnt(0)
    s_lshr_b32 s40, s36, 6
    s_lshl_b32 s40, s40, 7
    s_add_u32 s40, s40, 16384
    v_lshlrev_b32 v100, 4, v1
    s_lshr_b32 s48, s36, 4
    s_add_u32 s48, s48, s55
    s_mul_i32 s48, s48, 20480
    s_lshr_b32 s41, s3, 2
    s_lshl_b32 s41, s41, 10
    s_add_u32 s48, s48, s41
    s_cmp_lg_u32 s3, 0
    s_cbranch_scc1 adaLN_cond__grouped_kv_mqa__glu_gated_swiglu__prompt_kernel_wf_139
    v_mul_u32_u24 v102, 4, v1
    s_mov_b32 s44, 255
    s_mov_b32 s45, 0
    s_mov_b64 exec, s[44:45]
    s_mov_b32 s46, 65536
adaLN_cond__grouped_kv_mqa__glu_gated_swiglu__prompt_kernel_poll_140:
    buffer_load_dword v103, v102, s[60:63], s40 offen sc1
    s_sub_u32 s46, s46, 1
    s_cmp_eq_u32 s46, 0
    s_cbranch_scc1 adaLN_cond__grouped_kv_mqa__glu_gated_swiglu__prompt_kernel_polldone_141
    s_waitcnt vmcnt(0)
    v_cmp_ne_u32 vcc, s71, v103
    s_nop 0
    s_cbranch_vccnz adaLN_cond__grouped_kv_mqa__glu_gated_swiglu__prompt_kernel_poll_140
adaLN_cond__grouped_kv_mqa__glu_gated_swiglu__prompt_kernel_polldone_141:
    s_mov_b64 exec, -1
adaLN_cond__grouped_kv_mqa__glu_gated_swiglu__prompt_kernel_wf_139:
    s_barrier
    buffer_load_dwordx4 v[8:11], v100, s[28:31], s48 offen sc1
    s_add_u32 s48, s48, 2048
    buffer_load_dwordx4 v[12:15], v100, s[28:31], s48 offen sc1
    s_add_u32 s48, s48, 2048
    buffer_load_dwordx4 v[16:19], v100, s[28:31], s48 offen sc1
    s_add_u32 s48, s48, 2048
    buffer_load_dwordx4 v[20:23], v100, s[28:31], s48 offen sc1
    s_add_u32 s48, s48, 2048
    buffer_load_dwordx4 v[24:27], v100, s[28:31], s48 offen sc1
    s_add_u32 s48, s48, 2048
    buffer_load_dwordx4 v[28:31], v100, s[28:31], s48 offen sc1
    s_add_u32 s48, s48, 2048
    buffer_load_dwordx4 v[32:35], v100, s[28:31], s48 offen sc1
    s_add_u32 s48, s48, 2048
    buffer_load_dwordx4 v[36:39], v100, s[28:31], s48 offen sc1
    s_add_u32 s48, s48, 2048
    buffer_load_dwordx4 v[40:43], v100, s[28:31], s48 offen sc1
    s_add_u32 s48, s48, 2048
    buffer_load_dwordx4 v[44:47], v100, s[28:31], s48 offen sc1
    s_add_u32 s48, s48, 2048
    ds_read_b128 v[68:71], v124 offset:0
    ds_read_b128 v[72:75], v124 offset:256
    ds_read_b128 v[76:79], v124 offset:512
    ds_read_b128 v[80:83], v124 offset:768
    ds_read_b128 v[84:87], v124 offset:1024
    ds_read_b128 v[160:163], v124 offset:10240
    ds_read_b128 v[164:167], v124 offset:10496
    ds_read_b128 v[168:171], v124 offset:10752
    ds_read_b128 v[172:175], v124 offset:11008
    ds_read_b128 v[176:179], v124 offset:11264
    s_cmp_lt_u32 s3, 4
    s_cbranch_scc1 adaLN_cond__grouped_kv_mqa__glu_gated_swiglu__prompt_kernel_utl_142
    s_add_u32 s20, s6, 393216
    s_addc_u32 s21, s7, 0
    s_mov_b32 s22, 221184
    s_mov_b32 s23, 0x00020000
    v_subrev_u32 v200, 256, v0
    v_min_u32 v200, 223, v200
    v_lshrrev_b32 v201, 5, v200
    v_add_u32 v201, s53, v201
    v_lshlrev_b32 v201, 4, v201
    v_and_b32 v202, 15, v200
    v_add_u32 v201, v201, v202
    v_bfe_u32 v202, v200, 4, 1
    v_mul_u32_u24 v202, 1728, v202
    v_add_u32 v201, v201, v202
    v_lshlrev_b32 v201, 2, v201
    s_mov_b32 s44, 0
    buffer_load_dword v202, v201, s[20:23], s44 offen sc1
    s_mov_b32 s44, 27648
    buffer_load_dword v203, v201, s[20:23], s44 offen sc1
    s_mov_b32 s44, 55296
    buffer_load_dword v204, v201, s[20:23], s44 offen sc1
    s_mov_b32 s44, 82944
    buffer_load_dword v205, v201, s[20:23], s44 offen sc1
    s_mov_b32 s44, 110592
    buffer_load_dword v206, v201, s[20:23], s44 offen sc1
    s_mov_b32 s44, 138240
    buffer_load_dword v207, v201, s[20:23], s44 offen sc1
    s_mov_b32 s44, 165888
    buffer_load_dword v208, v201, s[20:23], s44 offen sc1
    s_mov_b32 s44, 193536
    buffer_load_dword v209, v201, s[20:23], s44 offen sc1
    s_mov_b32 s44, 13824
    buffer_load_dword v210, v201, s[20:23], s44 offen sc1
    s_mov_b32 s44, 41472
    buffer_load_dword v211, v201, s[20:23], s44 offen sc1
    s_mov_b32 s44, 69120
    buffer_load_dword v212, v201, s[20:23], s44 offen sc1
    s_mov_b32 s44, 96768
    buffer_load_dword v213, v201, s[20:23], s44 offen sc1
    s_mov_b32 s44, 124416
    buffer_load_dword v214, v201, s[20:23], s44 offen sc1
    s_mov_b32 s44, 152064
    buffer_load_dword v215, v201, s[20:23], s44 offen sc1
    s_mov_b32 s44, 179712
    buffer_load_dword v216, v201, s[20:23], s44 offen sc1
    s_mov_b32 s44, 207360
    buffer_load_dword v217, v201, s[20:23], s44 offen sc1
    s_branch adaLN_cond__grouped_kv_mqa__glu_gated_swiglu__prompt_kernel_utl2_143
adaLN_cond__grouped_kv_mqa__glu_gated_swiglu__prompt_kernel_utl_142:
    ds_read_b128 v[180:183], v147 offset:0
    ds_read_b128 v[200:203], v147 offset:2560
    ds_read_b128 v[184:187], v147 offset:64
    ds_read_b128 v[204:207], v147 offset:2624
    ds_read_b128 v[188:191], v147 offset:128
    ds_read_b128 v[208:211], v147 offset:2688
    ds_read_b128 v[192:195], v147 offset:192
    ds_read_b128 v[212:215], v147 offset:2752
    ds_read_b128 v[196:199], v147 offset:256
    ds_read_b128 v[216:219], v147 offset:2816
adaLN_cond__grouped_kv_mqa__glu_gated_swiglu__prompt_kernel_utl2_143:
    ds_read_b128 v[104:107], v124 offset:20480
    ds_read_b128 v[108:111], v124 offset:20736
    ds_read_b128 v[112:115], v124 offset:20992
    ds_read_b128 v[116:119], v124 offset:21248
    ds_read_b128 v[120:123], v124 offset:21504
    s_waitcnt vmcnt(9) lgkmcnt(14)
    v_mfma_f32_16x16x32_bf16 v[48:51], v[68:71], v[8:11], 0
    s_waitcnt lgkmcnt(13)
    v_mfma_f32_16x16x32_bf16 v[52:55], v[72:75], v[8:11], 0
    s_waitcnt lgkmcnt(12)
    v_mfma_f32_16x16x32_bf16 v[56:59], v[76:79], v[8:11], 0
    s_waitcnt lgkmcnt(11)
    v_mfma_f32_16x16x32_bf16 v[60:63], v[80:83], v[8:11], 0
    s_waitcnt lgkmcnt(10)
    v_mfma_f32_16x16x32_bf16 v[64:67], v[84:87], v[8:11], 0
    ds_read_b128 v[68:71], v124 offset:30720
    ds_read_b128 v[72:75], v124 offset:30976
    ds_read_b128 v[76:79], v124 offset:31232
    ds_read_b128 v[80:83], v124 offset:31488
    ds_read_b128 v[84:87], v124 offset:31744
    s_waitcnt vmcnt(8) lgkmcnt(14)
    v_mfma_f32_16x16x32_bf16 v[48:51], v[160:163], v[12:15], v[48:51]
    s_waitcnt lgkmcnt(13)
    v_mfma_f32_16x16x32_bf16 v[52:55], v[164:167], v[12:15], v[52:55]
    s_waitcnt lgkmcnt(12)
    v_mfma_f32_16x16x32_bf16 v[56:59], v[168:171], v[12:15], v[56:59]
    s_waitcnt lgkmcnt(11)
    v_mfma_f32_16x16x32_bf16 v[60:63], v[172:175], v[12:15], v[60:63]
    s_waitcnt lgkmcnt(10)
    v_mfma_f32_16x16x32_bf16 v[64:67], v[176:179], v[12:15], v[64:67]
    ds_read_b128 v[160:163], v124 offset:40960
    ds_read_b128 v[164:167], v124 offset:41216
    ds_read_b128 v[168:171], v124 offset:41472
    ds_read_b128 v[172:175], v124 offset:41728
    ds_read_b128 v[176:179], v124 offset:41984
    s_waitcnt vmcnt(7) lgkmcnt(14)
    v_mfma_f32_16x16x32_bf16 v[48:51], v[104:107], v[16:19], v[48:51]
    s_waitcnt lgkmcnt(13)
    v_mfma_f32_16x16x32_bf16 v[52:55], v[108:111], v[16:19], v[52:55]
    s_waitcnt lgkmcnt(12)
    v_mfma_f32_16x16x32_bf16 v[56:59], v[112:115], v[16:19], v[56:59]
    s_waitcnt lgkmcnt(11)
    v_mfma_f32_16x16x32_bf16 v[60:63], v[116:119], v[16:19], v[60:63]
    s_waitcnt lgkmcnt(10)
    v_mfma_f32_16x16x32_bf16 v[64:67], v[120:123], v[16:19], v[64:67]
    ds_read_b128 v[104:107], v125 offset:0
    ds_read_b128 v[108:111], v125 offset:256
    ds_read_b128 v[112:115], v125 offset:512
    ds_read_b128 v[116:119], v125 offset:768
    ds_read_b128 v[120:123], v125 offset:1024
    s_waitcnt vmcnt(6) lgkmcnt(14)
    v_mfma_f32_16x16x32_bf16 v[48:51], v[68:71], v[20:23], v[48:51]
    s_waitcnt lgkmcnt(13)
    v_mfma_f32_16x16x32_bf16 v[52:55], v[72:75], v[20:23], v[52:55]
    s_waitcnt lgkmcnt(12)
    v_mfma_f32_16x16x32_bf16 v[56:59], v[76:79], v[20:23], v[56:59]
    s_waitcnt lgkmcnt(11)
    v_mfma_f32_16x16x32_bf16 v[60:63], v[80:83], v[20:23], v[60:63]
    s_waitcnt lgkmcnt(10)
    v_mfma_f32_16x16x32_bf16 v[64:67], v[84:87], v[20:23], v[64:67]
    ds_read_b128 v[68:71], v125 offset:10240
    ds_read_b128 v[72:75], v125 offset:10496
    ds_read_b128 v[76:79], v125 offset:10752
    ds_read_b128 v[80:83], v125 offset:11008
    ds_read_b128 v[84:87], v125 offset:11264
    s_waitcnt vmcnt(5) lgkmcnt(14)
    v_mfma_f32_16x16x32_bf16 v[48:51], v[160:163], v[24:27], v[48:51]
    s_waitcnt lgkmcnt(13)
    v_mfma_f32_16x16x32_bf16 v[52:55], v[164:167], v[24:27], v[52:55]
    s_waitcnt lgkmcnt(12)
    v_mfma_f32_16x16x32_bf16 v[56:59], v[168:171], v[24:27], v[56:59]
    s_waitcnt lgkmcnt(11)
    v_mfma_f32_16x16x32_bf16 v[60:63], v[172:175], v[24:27], v[60:63]
    s_waitcnt lgkmcnt(10)
    v_mfma_f32_16x16x32_bf16 v[64:67], v[176:179], v[24:27], v[64:67]
    ds_read_b128 v[160:163], v125 offset:20480
    ds_read_b128 v[164:167], v125 offset:20736
    ds_read_b128 v[168:171], v125 offset:20992
    ds_read_b128 v[172:175], v125 offset:21248
    ds_read_b128 v[176:179], v125 offset:21504
    s_waitcnt vmcnt(4) lgkmcnt(14)
    v_mfma_f32_16x16x32_bf16 v[48:51], v[104:107], v[28:31], v[48:51]
    s_waitcnt lgkmcnt(13)
    v_mfma_f32_16x16x32_bf16 v[52:55], v[108:111], v[28:31], v[52:55]
    s_waitcnt lgkmcnt(12)
    v_mfma_f32_16x16x32_bf16 v[56:59], v[112:115], v[28:31], v[56:59]
    s_waitcnt lgkmcnt(11)
    v_mfma_f32_16x16x32_bf16 v[60:63], v[116:119], v[28:31], v[60:63]
    s_waitcnt lgkmcnt(10)
    v_mfma_f32_16x16x32_bf16 v[64:67], v[120:123], v[28:31], v[64:67]
    ds_read_b128 v[104:107], v125 offset:30720
    ds_read_b128 v[108:111], v125 offset:30976
    ds_read_b128 v[112:115], v125 offset:31232
    ds_read_b128 v[116:119], v125 offset:31488
    ds_read_b128 v[120:123], v125 offset:31744
    s_waitcnt vmcnt(3) lgkmcnt(14)
    v_mfma_f32_16x16x32_bf16 v[48:51], v[68:71], v[32:35], v[48:51]
    s_waitcnt lgkmcnt(13)
    v_mfma_f32_16x16x32_bf16 v[52:55], v[72:75], v[32:35], v[52:55]
    s_waitcnt lgkmcnt(12)
    v_mfma_f32_16x16x32_bf16 v[56:59], v[76:79], v[32:35], v[56:59]
    s_waitcnt lgkmcnt(11)
    v_mfma_f32_16x16x32_bf16 v[60:63], v[80:83], v[32:35], v[60:63]
    s_waitcnt lgkmcnt(10)
    v_mfma_f32_16x16x32_bf16 v[64:67], v[84:87], v[32:35], v[64:67]
    ds_read_b128 v[68:71], v125 offset:40960
    ds_read_b128 v[72:75], v125 offset:41216
    ds_read_b128 v[76:79], v125 offset:41472
    ds_read_b128 v[80:83], v125 offset:41728
    ds_read_b128 v[84:87], v125 offset:41984
    s_waitcnt vmcnt(2) lgkmcnt(14)
    v_mfma_f32_16x16x32_bf16 v[48:51], v[160:163], v[36:39], v[48:51]
    s_waitcnt lgkmcnt(13)
    v_mfma_f32_16x16x32_bf16 v[52:55], v[164:167], v[36:39], v[52:55]
    s_waitcnt lgkmcnt(12)
    v_mfma_f32_16x16x32_bf16 v[56:59], v[168:171], v[36:39], v[56:59]
    s_waitcnt lgkmcnt(11)
    v_mfma_f32_16x16x32_bf16 v[60:63], v[172:175], v[36:39], v[60:63]
    s_waitcnt lgkmcnt(10)
    v_mfma_f32_16x16x32_bf16 v[64:67], v[176:179], v[36:39], v[64:67]
    s_waitcnt vmcnt(1) lgkmcnt(9)
    v_mfma_f32_16x16x32_bf16 v[48:51], v[104:107], v[40:43], v[48:51]
    s_waitcnt lgkmcnt(8)
    v_mfma_f32_16x16x32_bf16 v[52:55], v[108:111], v[40:43], v[52:55]
    s_waitcnt lgkmcnt(7)
    v_mfma_f32_16x16x32_bf16 v[56:59], v[112:115], v[40:43], v[56:59]
    s_waitcnt lgkmcnt(6)
    v_mfma_f32_16x16x32_bf16 v[60:63], v[116:119], v[40:43], v[60:63]
    s_waitcnt lgkmcnt(5)
    v_mfma_f32_16x16x32_bf16 v[64:67], v[120:123], v[40:43], v[64:67]
    s_waitcnt vmcnt(0) lgkmcnt(4)
    v_mfma_f32_16x16x32_bf16 v[48:51], v[68:71], v[44:47], v[48:51]
    s_waitcnt lgkmcnt(3)
    v_mfma_f32_16x16x32_bf16 v[52:55], v[72:75], v[44:47], v[52:55]
    s_waitcnt lgkmcnt(2)
    v_mfma_f32_16x16x32_bf16 v[56:59], v[76:79], v[44:47], v[56:59]
    s_waitcnt lgkmcnt(1)
    v_mfma_f32_16x16x32_bf16 v[60:63], v[80:83], v[44:47], v[60:63]
    s_waitcnt lgkmcnt(0)
    v_mfma_f32_16x16x32_bf16 v[64:67], v[84:87], v[44:47], v[64:67]
    s_cmp_lt_u32 s3, 4
    s_cbranch_scc1 adaLN_cond__grouped_kv_mqa__glu_gated_swiglu__prompt_kernel_dsend_144
    ds_write_b128 v149, v[48:51] offset:0
    ds_write_b128 v149, v[52:55] offset:1024
    ds_write_b128 v149, v[56:59] offset:2048
    s_nop 0
    ds_write_b128 v149, v[60:63] offset:3072
    s_nop 0
    ds_write_b128 v149, v[64:67] offset:4096
    v_mov_b32 v101, 163836
    v_mov_b32 v102, 0
    ds_write_b32 v101, v102
adaLN_cond__grouped_kv_mqa__glu_gated_swiglu__prompt_kernel_dsend_144:
    s_waitcnt lgkmcnt(0)
    s_barrier
    s_cmp_ge_u32 s3, 4
    s_cbranch_scc1 adaLN_cond__grouped_kv_mqa__glu_gated_swiglu__prompt_kernel_dload_146
    s_cmp_eq_u32 s14, 0
    s_cbranch_scc1 adaLN_cond__grouped_kv_mqa__glu_gated_swiglu__prompt_kernel_dslow_147
    ds_read_b128 v[160:163], v149 offset:0
    ds_read_b128 v[164:167], v149 offset:1024
    ds_read_b128 v[168:171], v149 offset:2048
    ds_read_b128 v[172:175], v149 offset:3072
    ds_read_b128 v[176:179], v149 offset:4096
    v_mov_b32 v144, 0
    v_mov_b32 v145, 0
    s_mov_b32 s43, 0x3f803f80
    v_lshlrev_b32 v220, 16, v130
    v_and_b32 v221, 0xffff0000, v130
    v_lshlrev_b32 v222, 16, v131
    v_and_b32 v223, 0xffff0000, v131
    s_waitcnt lgkmcnt(4)
    v_add_f32 v160, v160, v48
    v_add_f32 v161, v161, v49
    v_add_f32 v162, v162, v50
    v_add_f32 v163, v163, v51
    v_fma_f32 v160, v160, v180, v220
    v_fma_f32 v161, v161, v181, v221
    v_fma_f32 v162, v162, v182, v222
    v_fma_f32 v163, v163, v183, v223
    v_cvt_pk_bf16_f32 v130, v160, v161
    v_cvt_pk_bf16_f32 v131, v162, v163
    v_lshlrev_b32 v160, 16, v130
    v_and_b32 v161, 0xffff0000, v130
    v_lshlrev_b32 v162, 16, v131
    v_and_b32 v163, 0xffff0000, v131
    v_mul_f32 v160, v160, v200
    v_mul_f32 v161, v161, v201
    v_mul_f32 v162, v162, v202
    v_mul_f32 v163, v163, v203
    v_cvt_pk_bf16_f32 v180, v160, v161
    v_cvt_pk_bf16_f32 v181, v162, v163
    s_add_u32 s42, s50, 0
    buffer_store_dwordx2 v[180:181], v146, s[32:35], s42 offen
    v_dot2c_f32_bf16 v144, s43, v130
    v_dot2c_f32_bf16 v145, v130, v130
    v_dot2c_f32_bf16 v144, s43, v131
    v_dot2c_f32_bf16 v145, v131, v131
    v_lshlrev_b32 v224, 16, v132
    v_and_b32 v225, 0xffff0000, v132
    v_lshlrev_b32 v226, 16, v133
    v_and_b32 v227, 0xffff0000, v133
    s_waitcnt lgkmcnt(3)
    v_add_f32 v164, v164, v52
    v_add_f32 v165, v165, v53
    v_add_f32 v166, v166, v54
    v_add_f32 v167, v167, v55
    v_fma_f32 v164, v164, v184, v224
    v_fma_f32 v165, v165, v185, v225
    v_fma_f32 v166, v166, v186, v226
    v_fma_f32 v167, v167, v187, v227
    v_cvt_pk_bf16_f32 v132, v164, v165
    v_cvt_pk_bf16_f32 v133, v166, v167
    v_lshlrev_b32 v164, 16, v132
    v_and_b32 v165, 0xffff0000, v132
    v_lshlrev_b32 v166, 16, v133
    v_and_b32 v167, 0xffff0000, v133
    v_mul_f32 v164, v164, v204
    v_mul_f32 v165, v165, v205
    v_mul_f32 v166, v166, v206
    v_mul_f32 v167, v167, v207
    v_cvt_pk_bf16_f32 v184, v164, v165
    v_cvt_pk_bf16_f32 v185, v166, v167
    s_add_u32 s42, s50, 1024
    buffer_store_dwordx2 v[184:185], v146, s[32:35], s42 offen
    v_dot2c_f32_bf16 v144, s43, v132
    v_dot2c_f32_bf16 v145, v132, v132
    v_dot2c_f32_bf16 v144, s43, v133
    v_dot2c_f32_bf16 v145, v133, v133
    v_lshlrev_b32 v220, 16, v134
    v_and_b32 v221, 0xffff0000, v134
    v_lshlrev_b32 v222, 16, v135
    v_and_b32 v223, 0xffff0000, v135
    s_waitcnt lgkmcnt(2)
    v_add_f32 v168, v168, v56
    v_add_f32 v169, v169, v57
    v_add_f32 v170, v170, v58
    v_add_f32 v171, v171, v59
    v_fma_f32 v168, v168, v188, v220
    v_fma_f32 v169, v169, v189, v221
    v_fma_f32 v170, v170, v190, v222
    v_fma_f32 v171, v171, v191, v223
    v_cvt_pk_bf16_f32 v134, v168, v169
    v_cvt_pk_bf16_f32 v135, v170, v171
    v_lshlrev_b32 v168, 16, v134
    v_and_b32 v169, 0xffff0000, v134
    v_lshlrev_b32 v170, 16, v135
    v_and_b32 v171, 0xffff0000, v135
    v_mul_f32 v168, v168, v208
    v_mul_f32 v169, v169, v209
    v_mul_f32 v170, v170, v210
    v_mul_f32 v171, v171, v211
    v_cvt_pk_bf16_f32 v188, v168, v169
    v_cvt_pk_bf16_f32 v189, v170, v171
    s_add_u32 s42, s50, 2048
    buffer_store_dwordx2 v[188:189], v146, s[32:35], s42 offen
    v_dot2c_f32_bf16 v144, s43, v134
    v_dot2c_f32_bf16 v145, v134, v134
    v_dot2c_f32_bf16 v144, s43, v135
    v_dot2c_f32_bf16 v145, v135, v135
    v_lshlrev_b32 v224, 16, v136
    v_and_b32 v225, 0xffff0000, v136
    v_lshlrev_b32 v226, 16, v137
    v_and_b32 v227, 0xffff0000, v137
    s_waitcnt lgkmcnt(1)
    v_add_f32 v172, v172, v60
    v_add_f32 v173, v173, v61
    v_add_f32 v174, v174, v62
    v_add_f32 v175, v175, v63
    v_fma_f32 v172, v172, v192, v224
    v_fma_f32 v173, v173, v193, v225
    v_fma_f32 v174, v174, v194, v226
    v_fma_f32 v175, v175, v195, v227
    v_cvt_pk_bf16_f32 v136, v172, v173
    v_cvt_pk_bf16_f32 v137, v174, v175
    v_lshlrev_b32 v172, 16, v136
    v_and_b32 v173, 0xffff0000, v136
    v_lshlrev_b32 v174, 16, v137
    v_and_b32 v175, 0xffff0000, v137
    v_mul_f32 v172, v172, v212
    v_mul_f32 v173, v173, v213
    v_mul_f32 v174, v174, v214
    v_mul_f32 v175, v175, v215
    v_cvt_pk_bf16_f32 v192, v172, v173
    v_cvt_pk_bf16_f32 v193, v174, v175
    s_add_u32 s42, s50, 3072
    buffer_store_dwordx2 v[192:193], v146, s[32:35], s42 offen
    v_dot2c_f32_bf16 v144, s43, v136
    v_dot2c_f32_bf16 v145, v136, v136
    v_dot2c_f32_bf16 v144, s43, v137
    v_dot2c_f32_bf16 v145, v137, v137
    v_lshlrev_b32 v220, 16, v138
    v_and_b32 v221, 0xffff0000, v138
    v_lshlrev_b32 v222, 16, v139
    v_and_b32 v223, 0xffff0000, v139
    s_waitcnt lgkmcnt(0)
    v_add_f32 v176, v176, v64
    v_add_f32 v177, v177, v65
    v_add_f32 v178, v178, v66
    v_add_f32 v179, v179, v67
    v_fma_f32 v176, v176, v196, v220
    v_fma_f32 v177, v177, v197, v221
    v_fma_f32 v178, v178, v198, v222
    v_fma_f32 v179, v179, v199, v223
    v_cvt_pk_bf16_f32 v138, v176, v177
    v_cvt_pk_bf16_f32 v139, v178, v179
    v_lshlrev_b32 v176, 16, v138
    v_and_b32 v177, 0xffff0000, v138
    v_lshlrev_b32 v178, 16, v139
    v_and_b32 v179, 0xffff0000, v139
    v_mul_f32 v176, v176, v216
    v_mul_f32 v177, v177, v217
    v_mul_f32 v178, v178, v218
    v_mul_f32 v179, v179, v219
    v_cvt_pk_bf16_f32 v196, v176, v177
    v_cvt_pk_bf16_f32 v197, v178, v179
    s_add_u32 s42, s50, 4096
    buffer_store_dwordx2 v[196:197], v146, s[32:35], s42 offen
    v_dot2c_f32_bf16 v144, s43, v138
    v_dot2c_f32_bf16 v145, v138, v138
    v_dot2c_f32_bf16 v144, s43, v139
    v_dot2c_f32_bf16 v145, v139, v139
    s_nop 1
    v_mov_b32 v101, v144
    s_nop 1
    v_permlane32_swap_b32 v144, v101
    v_add_f32 v144, v144, v101
    v_mov_b32 v101, v144
    s_nop 1
    v_permlane16_swap_b32 v144, v101
    v_add_f32 v144, v144, v101
    v_mov_b32 v101, v145
    s_nop 1
    v_permlane32_swap_b32 v145, v101
    v_add_f32 v145, v145, v101
    v_mov_b32 v101, v145
    s_nop 1
    v_permlane16_swap_b32 v145, v101
    v_add_f32 v145, v145, v101
    v_mov_b32 v146, 0
    v_mov_b32 v147, 0
    s_lshl_b32 s40, s37, 4
    s_mov_b64 exec, 0xffff
    buffer_store_dwordx4 v[144:147], v126, s[56:59], s40 offen
    s_mov_b64 exec, -1
    ds_write_b64 v148, v[130:131] offset:0
    ds_write_b64 v148, v[132:133] offset:512
    ds_write_b64 v148, v[134:135] offset:1024
    ds_write_b64 v148, v[136:137] offset:1536
    ds_write_b64 v148, v[138:139] offset:2048
    s_waitcnt vmcnt(0)
    v_mov_b32 v101, 163836
    v_mov_b32 v102, 1
    s_mov_b64 exec, 1
    ds_add_rtn_u32 v103, v101, v102
    s_waitcnt lgkmcnt(0)
    v_readfirstlane_b32 s43, v103
    s_mov_b64 exec, -1
    s_cmp_lg_u32 s43, 3
    s_cbranch_scc1 adaLN_cond__grouped_kv_mqa__glu_gated_swiglu__prompt_kernel_djoin_145
    v_mov_b32 v101, s71
    v_mov_b32 v102, 0
    s_mov_b64 exec, 1
    buffer_store_dword v101, v102, s[60:63], s51 offen
    s_mov_b64 exec, -1
    s_branch adaLN_cond__grouped_kv_mqa__glu_gated_swiglu__prompt_kernel_djoin_145
adaLN_cond__grouped_kv_mqa__glu_gated_swiglu__prompt_kernel_dslow_147:
    ds_read_b128 v[160:163], v149 offset:0
    ds_read_b128 v[164:167], v149 offset:1024
    ds_read_b128 v[168:171], v149 offset:2048
    ds_read_b128 v[172:175], v149 offset:3072
    ds_read_b128 v[176:179], v149 offset:4096
    v_mov_b32 v144, 0
    v_mov_b32 v145, 0
    s_mov_b32 s43, 0x3f803f80
    v_lshlrev_b32 v220, 16, v130
    v_and_b32 v221, 0xffff0000, v130
    v_lshlrev_b32 v222, 16, v131
    v_and_b32 v223, 0xffff0000, v131
    s_waitcnt lgkmcnt(4)
    v_add_f32 v160, v160, v48
    v_add_f32 v161, v161, v49
    v_add_f32 v162, v162, v50
    v_add_f32 v163, v163, v51
    v_fma_f32 v160, v160, v180, v220
    v_fma_f32 v161, v161, v181, v221
    v_fma_f32 v162, v162, v182, v222
    v_fma_f32 v163, v163, v183, v223
    v_cvt_pk_bf16_f32 v130, v160, v161
    v_cvt_pk_bf16_f32 v131, v162, v163
    v_lshlrev_b32 v160, 16, v130
    v_and_b32 v161, 0xffff0000, v130
    v_lshlrev_b32 v162, 16, v131
    v_and_b32 v163, 0xffff0000, v131
    v_mul_f32 v160, v160, v200
    v_mul_f32 v161, v161, v201
    v_mul_f32 v162, v162, v202
    v_mul_f32 v163, v163, v203
    v_cvt_pk_bf16_f32 v180, v160, v161
    v_cvt_pk_bf16_f32 v181, v162, v163
    s_add_u32 s42, s50, 0
    buffer_store_dwordx2 v[180:181], v146, s[32:35], s42 offen sc1
    v_dot2c_f32_bf16 v144, s43, v130
    v_dot2c_f32_bf16 v145, v130, v130
    v_dot2c_f32_bf16 v144, s43, v131
    v_dot2c_f32_bf16 v145, v131, v131
    v_lshlrev_b32 v224, 16, v132
    v_and_b32 v225, 0xffff0000, v132
    v_lshlrev_b32 v226, 16, v133
    v_and_b32 v227, 0xffff0000, v133
    s_waitcnt lgkmcnt(3)
    v_add_f32 v164, v164, v52
    v_add_f32 v165, v165, v53
    v_add_f32 v166, v166, v54
    v_add_f32 v167, v167, v55
    v_fma_f32 v164, v164, v184, v224
    v_fma_f32 v165, v165, v185, v225
    v_fma_f32 v166, v166, v186, v226
    v_fma_f32 v167, v167, v187, v227
    v_cvt_pk_bf16_f32 v132, v164, v165
    v_cvt_pk_bf16_f32 v133, v166, v167
    v_lshlrev_b32 v164, 16, v132
    v_and_b32 v165, 0xffff0000, v132
    v_lshlrev_b32 v166, 16, v133
    v_and_b32 v167, 0xffff0000, v133
    v_mul_f32 v164, v164, v204
    v_mul_f32 v165, v165, v205
    v_mul_f32 v166, v166, v206
    v_mul_f32 v167, v167, v207
    v_cvt_pk_bf16_f32 v184, v164, v165
    v_cvt_pk_bf16_f32 v185, v166, v167
    s_add_u32 s42, s50, 1024
    buffer_store_dwordx2 v[184:185], v146, s[32:35], s42 offen sc1
    v_dot2c_f32_bf16 v144, s43, v132
    v_dot2c_f32_bf16 v145, v132, v132
    v_dot2c_f32_bf16 v144, s43, v133
    v_dot2c_f32_bf16 v145, v133, v133
    v_lshlrev_b32 v220, 16, v134
    v_and_b32 v221, 0xffff0000, v134
    v_lshlrev_b32 v222, 16, v135
    v_and_b32 v223, 0xffff0000, v135
    s_waitcnt lgkmcnt(2)
    v_add_f32 v168, v168, v56
    v_add_f32 v169, v169, v57
    v_add_f32 v170, v170, v58
    v_add_f32 v171, v171, v59
    v_fma_f32 v168, v168, v188, v220
    v_fma_f32 v169, v169, v189, v221
    v_fma_f32 v170, v170, v190, v222
    v_fma_f32 v171, v171, v191, v223
    v_cvt_pk_bf16_f32 v134, v168, v169
    v_cvt_pk_bf16_f32 v135, v170, v171
    v_lshlrev_b32 v168, 16, v134
    v_and_b32 v169, 0xffff0000, v134
    v_lshlrev_b32 v170, 16, v135
    v_and_b32 v171, 0xffff0000, v135
    v_mul_f32 v168, v168, v208
    v_mul_f32 v169, v169, v209
    v_mul_f32 v170, v170, v210
    v_mul_f32 v171, v171, v211
    v_cvt_pk_bf16_f32 v188, v168, v169
    v_cvt_pk_bf16_f32 v189, v170, v171
    s_add_u32 s42, s50, 2048
    buffer_store_dwordx2 v[188:189], v146, s[32:35], s42 offen sc1
    v_dot2c_f32_bf16 v144, s43, v134
    v_dot2c_f32_bf16 v145, v134, v134
    v_dot2c_f32_bf16 v144, s43, v135
    v_dot2c_f32_bf16 v145, v135, v135
    v_lshlrev_b32 v224, 16, v136
    v_and_b32 v225, 0xffff0000, v136
    v_lshlrev_b32 v226, 16, v137
    v_and_b32 v227, 0xffff0000, v137
    s_waitcnt lgkmcnt(1)
    v_add_f32 v172, v172, v60
    v_add_f32 v173, v173, v61
    v_add_f32 v174, v174, v62
    v_add_f32 v175, v175, v63
    v_fma_f32 v172, v172, v192, v224
    v_fma_f32 v173, v173, v193, v225
    v_fma_f32 v174, v174, v194, v226
    v_fma_f32 v175, v175, v195, v227
    v_cvt_pk_bf16_f32 v136, v172, v173
    v_cvt_pk_bf16_f32 v137, v174, v175
    v_lshlrev_b32 v172, 16, v136
    v_and_b32 v173, 0xffff0000, v136
    v_lshlrev_b32 v174, 16, v137
    v_and_b32 v175, 0xffff0000, v137
    v_mul_f32 v172, v172, v212
    v_mul_f32 v173, v173, v213
    v_mul_f32 v174, v174, v214
    v_mul_f32 v175, v175, v215
    v_cvt_pk_bf16_f32 v192, v172, v173
    v_cvt_pk_bf16_f32 v193, v174, v175
    s_add_u32 s42, s50, 3072
    buffer_store_dwordx2 v[192:193], v146, s[32:35], s42 offen sc1
    v_dot2c_f32_bf16 v144, s43, v136
    v_dot2c_f32_bf16 v145, v136, v136
    v_dot2c_f32_bf16 v144, s43, v137
    v_dot2c_f32_bf16 v145, v137, v137
    v_lshlrev_b32 v220, 16, v138
    v_and_b32 v221, 0xffff0000, v138
    v_lshlrev_b32 v222, 16, v139
    v_and_b32 v223, 0xffff0000, v139
    s_waitcnt lgkmcnt(0)
    v_add_f32 v176, v176, v64
    v_add_f32 v177, v177, v65
    v_add_f32 v178, v178, v66
    v_add_f32 v179, v179, v67
    v_fma_f32 v176, v176, v196, v220
    v_fma_f32 v177, v177, v197, v221
    v_fma_f32 v178, v178, v198, v222
    v_fma_f32 v179, v179, v199, v223
    v_cvt_pk_bf16_f32 v138, v176, v177
    v_cvt_pk_bf16_f32 v139, v178, v179
    v_lshlrev_b32 v176, 16, v138
    v_and_b32 v177, 0xffff0000, v138
    v_lshlrev_b32 v178, 16, v139
    v_and_b32 v179, 0xffff0000, v139
    v_mul_f32 v176, v176, v216
    v_mul_f32 v177, v177, v217
    v_mul_f32 v178, v178, v218
    v_mul_f32 v179, v179, v219
    v_cvt_pk_bf16_f32 v196, v176, v177
    v_cvt_pk_bf16_f32 v197, v178, v179
    s_add_u32 s42, s50, 4096
    buffer_store_dwordx2 v[196:197], v146, s[32:35], s42 offen sc1
    v_dot2c_f32_bf16 v144, s43, v138
    v_dot2c_f32_bf16 v145, v138, v138
    v_dot2c_f32_bf16 v144, s43, v139
    v_dot2c_f32_bf16 v145, v139, v139
    s_nop 1
    v_mov_b32 v101, v144
    s_nop 1
    v_permlane32_swap_b32 v144, v101
    v_add_f32 v144, v144, v101
    v_mov_b32 v101, v144
    s_nop 1
    v_permlane16_swap_b32 v144, v101
    v_add_f32 v144, v144, v101
    v_mov_b32 v101, v145
    s_nop 1
    v_permlane32_swap_b32 v145, v101
    v_add_f32 v145, v145, v101
    v_mov_b32 v101, v145
    s_nop 1
    v_permlane16_swap_b32 v145, v101
    v_add_f32 v145, v145, v101
    v_mov_b32 v146, 0
    v_mov_b32 v147, 0
    s_lshl_b32 s40, s37, 4
    s_mov_b64 exec, 0xffff
    buffer_store_dwordx4 v[144:147], v126, s[56:59], s40 offen sc1
    s_mov_b64 exec, -1
    ds_write_b64 v148, v[130:131] offset:0
    ds_write_b64 v148, v[132:133] offset:512
    ds_write_b64 v148, v[134:135] offset:1024
    ds_write_b64 v148, v[136:137] offset:1536
    ds_write_b64 v148, v[138:139] offset:2048
    s_waitcnt vmcnt(0)
    v_mov_b32 v101, 163836
    v_mov_b32 v102, 1
    s_mov_b64 exec, 1
    ds_add_rtn_u32 v103, v101, v102
    s_waitcnt lgkmcnt(0)
    v_readfirstlane_b32 s43, v103
    s_mov_b64 exec, -1
    s_cmp_lg_u32 s43, 3
    s_cbranch_scc1 adaLN_cond__grouped_kv_mqa__glu_gated_swiglu__prompt_kernel_djoin_145
    v_mov_b32 v101, s71
    v_mov_b32 v102, 0
    s_mov_b64 exec, 1
    buffer_store_dword v101, v102, s[60:63], s51 offen sc1
    s_mov_b64 exec, -1
    s_branch adaLN_cond__grouped_kv_mqa__glu_gated_swiglu__prompt_kernel_djoin_145
adaLN_cond__grouped_kv_mqa__glu_gated_swiglu__prompt_kernel_dload_146:
    s_add_u32 s67, s65, 0
    s_add_u32 m0, s66, 20480
    s_nop 0
    buffer_load_dwordx4 v250, s[24:27], s67 offen lds
    s_add_u32 s67, s65, 221184
    s_add_u32 m0, s66, 24576
    s_nop 0
    buffer_load_dwordx4 v250, s[24:27], s67 offen lds
    s_add_u32 s67, s65, 442368
    s_add_u32 m0, s66, 28672
    s_nop 0
    buffer_load_dwordx4 v250, s[24:27], s67 offen lds
    s_add_u32 s67, s65, 663552
    s_add_u32 m0, s66, 32768
    s_nop 0
    buffer_load_dwordx4 v250, s[24:27], s67 offen lds
    s_add_u32 s67, s65, 884736
    s_add_u32 m0, s66, 36864
    s_nop 0
    buffer_load_dwordx4 v250, s[24:27], s67 offen lds
    s_add_u32 s67, s65, 256
    s_add_u32 m0, s66, 40960
    s_nop 0
    buffer_load_dwordx4 v250, s[24:27], s67 offen lds
    s_add_u32 s67, s65, 221440
    s_add_u32 m0, s66, 45056
    s_nop 0
    buffer_load_dwordx4 v250, s[24:27], s67 offen lds
    s_add_u32 s67, s65, 442624
    s_add_u32 m0, s66, 49152
    s_nop 0
    buffer_load_dwordx4 v250, s[24:27], s67 offen lds
    s_add_u32 s67, s65, 663808
    s_add_u32 m0, s66, 53248
    s_nop 0
    buffer_load_dwordx4 v250, s[24:27], s67 offen lds
    s_add_u32 s67, s65, 884992
    s_add_u32 m0, s66, 57344
    s_nop 0
    buffer_load_dwordx4 v250, s[24:27], s67 offen lds
    s_add_u32 s67, s65, 1105920
    s_add_u32 m0, s66, 61440
    s_nop 0
    buffer_load_dwordx4 v250, s[24:27], s67 offen lds
    s_add_u32 s67, s65, 1327104
    s_add_u32 m0, s66, 65536
    s_nop 0
    buffer_load_dwordx4 v250, s[24:27], s67 offen lds
    s_add_u32 s67, s65, 1548288
    s_add_u32 m0, s66, 69632
    s_nop 0
    buffer_load_dwordx4 v250, s[24:27], s67 offen lds
    s_add_u32 s67, s65, 1769472
    s_add_u32 m0, s66, 73728
    s_nop 0
    buffer_load_dwordx4 v250, s[24:27], s67 offen lds
    s_add_u32 s67, s65, 1990656
    s_add_u32 m0, s66, 77824
    s_nop 0
    buffer_load_dwordx4 v250, s[24:27], s67 offen lds
    s_add_u32 s67, s65, 1106176
    s_add_u32 m0, s66, 81920
    s_nop 0
    buffer_load_dwordx4 v250, s[24:27], s67 offen lds
    s_add_u32 s67, s65, 1327360
    s_add_u32 m0, s66, 86016
    s_nop 0
    buffer_load_dwordx4 v250, s[24:27], s67 offen lds
    s_add_u32 s67, s65, 1548544
    s_add_u32 m0, s66, 90112
    s_nop 0
    buffer_load_dwordx4 v250, s[24:27], s67 offen lds
    s_add_u32 s67, s65, 1769728
    s_add_u32 m0, s66, 94208
    s_nop 0
    buffer_load_dwordx4 v250, s[24:27], s67 offen lds
    s_add_u32 s67, s65, 1990912
    s_add_u32 m0, s66, 98304
    s_nop 0
    buffer_load_dwordx4 v250, s[24:27], s67 offen lds
    v_add_f32 v202, v202, v206
    v_add_f32 v203, v203, v207
    v_add_f32 v204, v204, v208
    v_add_f32 v205, v205, v209
    v_add_f32 v202, v202, v203
    v_add_f32 v204, v204, v205
    v_add_f32 v202, v202, v204
    v_add_f32 v210, v210, v214
    v_add_f32 v211, v211, v215
    v_add_f32 v212, v212, v216
    v_add_f32 v213, v213, v217
    v_add_f32 v210, v210, v211
    v_add_f32 v212, v212, v213
    v_add_f32 v210, v210, v212
    v_cvt_pk_bf16_f32 v218, v202, v202
    v_lshlrev_b32 v218, 16, v218
    v_sub_f32 v222, v202, v218
    v_cvt_pk_bf16_f32 v219, v222, v222
    v_lshlrev_b32 v219, 16, v219
    v_cvt_pk_bf16_f32 v220, v210, v210
    v_lshlrev_b32 v220, 16, v220
    v_sub_f32 v222, v210, v220
    v_cvt_pk_bf16_f32 v221, v222, v222
    v_lshlrev_b32 v221, 16, v221
    v_cvt_pk_bf16_f32 v224, v218, v218
    v_cvt_pk_bf16_f32 v225, v219, v220
    v_cvt_pk_bf16_f32 v226, v220, v221
    v_mov_b32 v227, 0
    v_lshlrev_b32 v200, 4, v200
    v_add_u32 v200, 148480, v200
    ds_write_b128 v200, v[224:227]
    s_add_u32 s67, s65, 512
    s_add_u32 m0, s66, 102400
    s_nop 0
    buffer_load_dwordx4 v250, s[24:27], s67 offen lds
    s_add_u32 s67, s65, 221696
    s_add_u32 m0, s66, 106496
    s_nop 0
    buffer_load_dwordx4 v250, s[24:27], s67 offen lds
    s_add_u32 s67, s65, 442880
    s_add_u32 m0, s66, 110592
    s_nop 0
    buffer_load_dwordx4 v250, s[24:27], s67 offen lds
    s_add_u32 s67, s65, 664064
    s_add_u32 m0, s66, 114688
    s_nop 0
    buffer_load_dwordx4 v250, s[24:27], s67 offen lds
    s_add_u32 s67, s65, 885248
    s_add_u32 m0, s66, 118784
    s_nop 0
    buffer_load_dwordx4 v250, s[24:27], s67 offen lds
    s_add_u32 s67, s65, 1106432
    s_add_u32 m0, s66, 122880
    s_nop 0
    buffer_load_dwordx4 v250, s[24:27], s67 offen lds
    s_add_u32 s67, s65, 1327616
    s_add_u32 m0, s66, 126976
    s_nop 0
    buffer_load_dwordx4 v250, s[24:27], s67 offen lds
    s_add_u32 s67, s65, 1548800
    s_add_u32 m0, s66, 131072
    s_nop 0
    buffer_load_dwordx4 v250, s[24:27], s67 offen lds
    s_add_u32 s67, s65, 1769984
    s_add_u32 m0, s66, 135168
    s_nop 0
    buffer_load_dwordx4 v250, s[24:27], s67 offen lds
    s_add_u32 s67, s65, 1991168
    s_add_u32 m0, s66, 139264
    s_nop 0
    buffer_load_dwordx4 v250, s[24:27], s67 offen lds
adaLN_cond__grouped_kv_mqa__glu_gated_swiglu__prompt_kernel_djoin_145:
    s_waitcnt lgkmcnt(0)
    s_add_u32 s20, s6, 16973824
    s_addc_u32 s21, s7, 0
    s_mov_b32 s22, 7077888
    s_mov_b32 s23, 0x00020000
    s_add_u32 s16, s6, 6619136
    s_addc_u32 s17, s7, 0
    s_mov_b32 s18, 2211840
    s_mov_b32 s19, 0x00020000
    s_lshr_b32 s40, s52, 7
    s_lshl_b32 s40, s40, 7
    s_add_u32 s40, s40, 24576
    s_mul_i32 s48, s37, 1280
    s_cmp_ge_u32 s3, 4
    s_cbranch_scc1 adaLN_cond__grouped_kv_mqa__glu_gated_swiglu__prompt_kernel_e_loader_149
    v_mul_u32_u24 v2, 4, v1
    s_mov_b32 s44, 65535
    s_mov_b32 s45, 0
    s_mov_b64 exec, s[44:45]
    s_mov_b32 s46, 65536
adaLN_cond__grouped_kv_mqa__glu_gated_swiglu__prompt_kernel_poll_150:
    buffer_load_dword v3, v2, s[60:63], s40 offen sc1
    s_sub_u32 s46, s46, 1
    s_cmp_eq_u32 s46, 0
    s_cbranch_scc1 adaLN_cond__grouped_kv_mqa__glu_gated_swiglu__prompt_kernel_polldone_151
    s_waitcnt vmcnt(0)
    v_cmp_ne_u32 vcc, s71, v3
    s_nop 0
    s_cbranch_vccnz adaLN_cond__grouped_kv_mqa__glu_gated_swiglu__prompt_kernel_poll_150
adaLN_cond__grouped_kv_mqa__glu_gated_swiglu__prompt_kernel_polldone_151:
    s_mov_b64 exec, -1
    s_cmp_eq_u32 s14, 0
    s_cbranch_scc1 adaLN_cond__grouped_kv_mqa__glu_gated_swiglu__prompt_kernel_e_slow_152
    v_lshlrev_b32 v2, 4, v1
    s_lshr_b32 s42, s52, 5
    s_add_u32 s42, s42, s3
    s_mul_i32 s42, s42, 40960
    s_add_u32 s46, s42, 0
    buffer_load_dwordx4 v[96:99], v2, s[32:35], s46 offen offset:0 sc1
    s_add_u32 s46, s42, 0
    buffer_load_dwordx4 v[100:103], v2, s[32:35], s46 offen offset:1024 sc1
    s_add_u32 s46, s42, 0
    buffer_load_dwordx4 v[104:107], v2, s[32:35], s46 offen offset:2048 sc1
    s_add_u32 s46, s42, 0
    buffer_load_dwordx4 v[108:111], v2, s[32:35], s46 offen offset:3072 sc1
    s_add_u32 s46, s42, 4096
    buffer_load_dwordx4 v[112:115], v2, s[32:35], s46 offen offset:0 sc1
    s_add_u32 s46, s42, 4096
    buffer_load_dwordx4 v[116:119], v2, s[32:35], s46 offen offset:1024 sc1
    v_and_b32 v92, 31, v1
    s_lshl_b32 s43, s3, 5
    s_add_u32 s43, s43, s52
    v_add_u32 v92, s43, v92
    v_lshlrev_b32 v92, 7, v92
    v_lshrrev_b32 v93, 5, v1
    v_lshl_add_u32 v94, v93, 6, v92
    s_waitcnt vmcnt(6)
    v_add_u32 v3, 61440, v2
    v_add_u32 v95, 122880, v2
    v_and_b32 v4, 31, v1
    v_lshlrev_b32 v4, 4, v4
    v_add_u32 v4, 148480, v4
    v_lshrrev_b32 v92, 5, v1
    v_bfe_u32 v93, v1, 4, 1
    v_mul_u32_u24 v93, 55296, v93
    v_lshl_add_u32 v93, v92, 8, v93
    v_and_b32 v92, 15, v1
    v_lshl_add_u32 v5, v92, 4, v93
    s_lshr_b32 s44, s52, 4
    s_lshl_b32 s43, s3, 1
    s_add_u32 s44, s44, s43
    s_mul_i32 s44, s44, 55296
    s_lshl_b32 s43, s53, 9
    s_add_u32 s44, s44, s43
    s_barrier
    ds_read_b128 v[16:19], v2 offset:20480
    ds_read_b128 v[20:23], v2 offset:40960
    ds_read_b128 v[24:27], v2 offset:21504
    ds_read_b128 v[28:31], v2 offset:41984
    ds_read_b128 v[32:35], v2 offset:22528
    ds_read_b128 v[36:39], v2 offset:43008
    ds_read_b128 v[40:43], v2 offset:23552
    s_add_u32 s46, s42, 4096
    buffer_load_dwordx4 v[120:123], v2, s[32:35], s46 offen offset:2048 sc1
    s_add_u32 s46, s42, 4096
    buffer_load_dwordx4 v[124:127], v2, s[32:35], s46 offen offset:3072 sc1
    s_waitcnt vmcnt(7) lgkmcnt(5)
    v_mfma_f32_32x32x16_bf16 v[44:59], v[16:19], v[96:99], 0
    ds_read_b128 v[16:19], v2 offset:44032
    v_mfma_f32_32x32x16_bf16 v[60:75], v[20:23], v[96:99], 0
    ds_read_b128 v[20:23], v2 offset:24576
    s_add_u32 s46, s42, 8192
    buffer_load_dwordx4 v[128:131], v2, s[32:35], s46 offen offset:0 sc1
    s_add_u32 s46, s42, 8192
    buffer_load_dwordx4 v[132:135], v2, s[32:35], s46 offen offset:1024 sc1
    s_waitcnt vmcnt(8) lgkmcnt(5)
    v_mfma_f32_32x32x16_bf16 v[44:59], v[24:27], v[100:103], v[44:59]
    ds_read_b128 v[24:27], v2 offset:45056
    v_mfma_f32_32x32x16_bf16 v[60:75], v[28:31], v[100:103], v[60:75]
    ds_read_b128 v[28:31], v2 offset:25600
    s_add_u32 s46, s42, 8192
    buffer_load_dwordx4 v[136:139], v2, s[32:35], s46 offen offset:2048 sc1
    s_add_u32 s46, s42, 8192
    buffer_load_dwordx4 v[140:143], v2, s[32:35], s46 offen offset:3072 sc1
    s_waitcnt vmcnt(9) lgkmcnt(5)
    v_mfma_f32_32x32x16_bf16 v[44:59], v[32:35], v[104:107], v[44:59]
    ds_read_b128 v[32:35], v2 offset:46080
    v_mfma_f32_32x32x16_bf16 v[60:75], v[36:39], v[104:107], v[60:75]
    ds_read_b128 v[36:39], v2 offset:26624
    s_add_u32 s46, s42, 12288
    buffer_load_dwordx4 v[144:147], v2, s[32:35], s46 offen offset:0 sc1
    s_add_u32 s46, s42, 12288
    buffer_load_dwordx4 v[148:151], v2, s[32:35], s46 offen offset:1024 sc1
    buffer_load_dwordx4 v[76:79], v94, s[56:59], 0 offen offset:0 sc1
    buffer_load_dwordx4 v[80:83], v94, s[56:59], 0 offen offset:16 sc1
    buffer_load_dwordx4 v[84:87], v94, s[56:59], 0 offen offset:32 sc1
    buffer_load_dwordx4 v[88:91], v94, s[56:59], 0 offen offset:48 sc1
    s_waitcnt vmcnt(14) lgkmcnt(5)
    v_mfma_f32_32x32x16_bf16 v[44:59], v[40:43], v[108:111], v[44:59]
    ds_read_b128 v[40:43], v2 offset:47104
    v_mfma_f32_32x32x16_bf16 v[60:75], v[16:19], v[108:111], v[60:75]
    ds_read_b128 v[16:19], v2 offset:27648
    s_add_u32 s46, s42, 12288
    buffer_load_dwordx4 v[152:155], v2, s[32:35], s46 offen offset:2048 sc1
    s_add_u32 s46, s42, 12288
    buffer_load_dwordx4 v[156:159], v2, s[32:35], s46 offen offset:3072 sc1
    s_waitcnt vmcnt(15) lgkmcnt(5)
    v_mfma_f32_32x32x16_bf16 v[44:59], v[20:23], v[112:115], v[44:59]
    ds_read_b128 v[20:23], v2 offset:48128
    v_mfma_f32_32x32x16_bf16 v[60:75], v[24:27], v[112:115], v[60:75]
    ds_read_b128 v[24:27], v2 offset:28672
    s_add_u32 s46, s42, 16384
    buffer_load_dwordx4 v[160:163], v2, s[32:35], s46 offen offset:0 sc1
    s_add_u32 s46, s42, 16384
    buffer_load_dwordx4 v[164:167], v2, s[32:35], s46 offen offset:1024 sc1
    s_waitcnt vmcnt(16) lgkmcnt(5)
    v_mfma_f32_32x32x16_bf16 v[44:59], v[28:31], v[116:119], v[44:59]
    ds_read_b128 v[28:31], v2 offset:49152
    v_mfma_f32_32x32x16_bf16 v[60:75], v[32:35], v[116:119], v[60:75]
    ds_read_b128 v[32:35], v2 offset:29696
    s_add_u32 s46, s42, 16384
    buffer_load_dwordx4 v[168:171], v2, s[32:35], s46 offen offset:2048 sc1
    s_add_u32 s46, s42, 16384
    buffer_load_dwordx4 v[172:175], v2, s[32:35], s46 offen offset:3072 sc1
    s_waitcnt vmcnt(17) lgkmcnt(5)
    v_mfma_f32_32x32x16_bf16 v[44:59], v[36:39], v[120:123], v[44:59]
    ds_read_b128 v[36:39], v2 offset:50176
    v_mfma_f32_32x32x16_bf16 v[60:75], v[40:43], v[120:123], v[60:75]
    ds_read_b128 v[40:43], v2 offset:30720
    s_add_u32 s46, s42, 20480
    buffer_load_dwordx4 v[176:179], v2, s[32:35], s46 offen offset:0 sc1
    s_add_u32 s46, s42, 20480
    buffer_load_dwordx4 v[180:183], v2, s[32:35], s46 offen offset:1024 sc1
    s_waitcnt vmcnt(18) lgkmcnt(5)
    v_mfma_f32_32x32x16_bf16 v[44:59], v[16:19], v[124:127], v[44:59]
    ds_read_b128 v[16:19], v2 offset:51200
    v_mfma_f32_32x32x16_bf16 v[60:75], v[20:23], v[124:127], v[60:75]
    ds_read_b128 v[20:23], v2 offset:31744
    s_add_u32 s46, s42, 20480
    buffer_load_dwordx4 v[184:187], v2, s[32:35], s46 offen offset:2048 sc1
    s_add_u32 s46, s42, 20480
    buffer_load_dwordx4 v[188:191], v2, s[32:35], s46 offen offset:3072 sc1
    s_waitcnt vmcnt(19) lgkmcnt(5)
    v_mfma_f32_32x32x16_bf16 v[44:59], v[24:27], v[128:131], v[44:59]
    ds_read_b128 v[24:27], v2 offset:52224
    v_mfma_f32_32x32x16_bf16 v[60:75], v[28:31], v[128:131], v[60:75]
    ds_read_b128 v[28:31], v2 offset:32768
    s_add_u32 s46, s42, 24576
    buffer_load_dwordx4 v[192:195], v2, s[32:35], s46 offen offset:0 sc1
    s_add_u32 s46, s42, 24576
    buffer_load_dwordx4 v[196:199], v2, s[32:35], s46 offen offset:1024 sc1
    s_waitcnt vmcnt(20) lgkmcnt(5)
    v_mfma_f32_32x32x16_bf16 v[44:59], v[32:35], v[132:135], v[44:59]
    ds_read_b128 v[32:35], v2 offset:53248
    v_mfma_f32_32x32x16_bf16 v[60:75], v[36:39], v[132:135], v[60:75]
    ds_read_b128 v[36:39], v2 offset:33792
    s_add_u32 s46, s42, 24576
    buffer_load_dwordx4 v[200:203], v2, s[32:35], s46 offen offset:2048 sc1
    s_waitcnt vmcnt(20) lgkmcnt(5)
    v_mfma_f32_32x32x16_bf16 v[44:59], v[40:43], v[136:139], v[44:59]
    ds_read_b128 v[40:43], v2 offset:54272
    v_mfma_f32_32x32x16_bf16 v[60:75], v[16:19], v[136:139], v[60:75]
    ds_read_b128 v[16:19], v2 offset:34816
    s_add_u32 s46, s42, 24576
    buffer_load_dwordx4 v[204:207], v2, s[32:35], s46 offen offset:3072 sc1
    s_waitcnt vmcnt(20) lgkmcnt(5)
    v_mfma_f32_32x32x16_bf16 v[44:59], v[20:23], v[140:143], v[44:59]
    ds_read_b128 v[20:23], v2 offset:55296
    v_mfma_f32_32x32x16_bf16 v[60:75], v[24:27], v[140:143], v[60:75]
    s_waitcnt vmcnt(16)
    v_add_f32 v76, v76, v80
    v_add_f32 v77, v77, v81
    v_add_f32 v78, v78, v82
    ds_read_b128 v[24:27], v2 offset:35840
    s_add_u32 s46, s42, 28672
    buffer_load_dwordx4 v[208:211], v2, s[32:35], s46 offen offset:0 sc1
    s_waitcnt lgkmcnt(5)
    v_mfma_f32_32x32x16_bf16 v[44:59], v[28:31], v[144:147], v[44:59]
    v_add_f32 v79, v79, v83
    s_waitcnt vmcnt(16)
    v_add_f32 v76, v76, v84
    v_add_f32 v77, v77, v85
    v_add_f32 v78, v78, v86
    ds_read_b128 v[28:31], v2 offset:56320
    v_mfma_f32_32x32x16_bf16 v[60:75], v[32:35], v[144:147], v[60:75]
    v_add_f32 v79, v79, v87
    s_waitcnt vmcnt(15)
    v_add_f32 v76, v76, v88
    v_add_f32 v77, v77, v89
    ds_read_b128 v[32:35], v2 offset:36864
    s_add_u32 s46, s42, 28672
    buffer_load_dwordx4 v[212:215], v2, s[32:35], s46 offen offset:1024 sc1
    s_waitcnt lgkmcnt(5)
    v_mfma_f32_32x32x16_bf16 v[44:59], v[36:39], v[148:151], v[44:59]
    v_add_f32 v78, v78, v90
    v_add_f32 v79, v79, v91
    v_add_f32 v76, v76, v78
    ds_read_b128 v[36:39], v2 offset:57344
    v_mfma_f32_32x32x16_bf16 v[60:75], v[40:43], v[148:151], v[60:75]
    v_add_f32 v77, v77, v79
    v_mov_b32 v80, v76
    s_nop 1
    v_permlane32_swap_b32 v76, v80
    v_add_f32 v76, v76, v80
    ds_read_b128 v[40:43], v2 offset:37888
    s_add_u32 s46, s42, 28672
    buffer_load_dwordx4 v[216:219], v2, s[32:35], s46 offen offset:2048 sc1
    s_waitcnt vmcnt(16) lgkmcnt(5)
    v_mfma_f32_32x32x16_bf16 v[44:59], v[16:19], v[152:155], v[44:59]
    v_mov_b32 v80, v77
    s_nop 1
    v_permlane32_swap_b32 v77, v80
    v_add_f32 v77, v77, v80
    ds_read_b128 v[16:19], v2 offset:58368
    v_mfma_f32_32x32x16_bf16 v[60:75], v[20:23], v[152:155], v[60:75]
    v_mul_f32 v76, 0x3acccccd, v76
    v_mov_b32 v78, 0x3727c5ac
    v_fmac_f32 v78, 0x3acccccd, v77
    v_fma_f32 v78, -v76, v76, v78
    ds_read_b128 v[20:23], v2 offset:38912
    s_add_u32 s46, s42, 28672
    buffer_load_dwordx4 v[220:223], v2, s[32:35], s46 offen offset:3072 sc1
    s_waitcnt vmcnt(16) lgkmcnt(5)
    v_mfma_f32_32x32x16_bf16 v[44:59], v[24:27], v[156:159], v[44:59]
    v_max_f32 v78, 0x3727c5ac, v78
    v_rsq_f32 v79, v78
    v_sub_f32 v76, 0, v76
    ds_read_b128 v[24:27], v2 offset:59392
    v_mfma_f32_32x32x16_bf16 v[60:75], v[28:31], v[156:159], v[60:75]
    v_mul_f32 v78, v78, v79
    v_mul_f32 v6, 0xbfb8aa3b, v79
    v_mul_f32 v7, v79, v79
    ds_read_b128 v[28:31], v2 offset:39936
    s_add_u32 s46, s42, 32768
    buffer_load_dwordx4 v[224:227], v2, s[32:35], s46 offen offset:0 sc1
    s_waitcnt vmcnt(16) lgkmcnt(5)
    v_mfma_f32_32x32x16_bf16 v[44:59], v[32:35], v[160:163], v[44:59]
    v_cvt_pk_bf16_f32 v80, v76, v76
    v_lshlrev_b32 v80, 16, v80
    v_sub_f32 v81, v76, v80
    v_cvt_pk_bf16_f32 v82, v78, v78
    ds_read_b128 v[32:35], v2 offset:60416
    v_mfma_f32_32x32x16_bf16 v[60:75], v[36:39], v[160:163], v[60:75]
    v_lshlrev_b32 v82, 16, v82
    v_sub_f32 v83, v78, v82
    v_cvt_pk_bf16_f32 v12, v80, v81
    ds_read_b128 v[36:39], v3 offset:0
    s_add_u32 s46, s42, 32768
    buffer_load_dwordx4 v[228:231], v2, s[32:35], s46 offen offset:1024 sc1
    s_waitcnt vmcnt(16) lgkmcnt(5)
    v_mfma_f32_32x32x16_bf16 v[44:59], v[40:43], v[164:167], v[44:59]
    v_cvt_pk_bf16_f32 v13, v80, v82
    v_cvt_pk_bf16_f32 v14, v83, v82
    v_mov_b32 v15, 0
    v_cmp_gt_u32 vcc, 32, v1
    ds_read_b128 v[40:43], v3 offset:20480
    v_mfma_f32_32x32x16_bf16 v[60:75], v[16:19], v[164:167], v[60:75]
    v_cndmask_b32 v12, 0, v12, vcc
    v_cndmask_b32 v13, 0, v13, vcc
    v_cndmask_b32 v14, 0, v14, vcc
    ds_read_b128 v[16:19], v3 offset:1024
    s_add_u32 s46, s42, 32768
    buffer_load_dwordx4 v[232:235], v2, s[32:35], s46 offen offset:2048 sc1
    s_waitcnt vmcnt(16) lgkmcnt(5)
    v_mfma_f32_32x32x16_bf16 v[44:59], v[20:23], v[168:171], v[44:59]
    ds_read_b128 v[20:23], v3 offset:21504
    v_mfma_f32_32x32x16_bf16 v[60:75], v[24:27], v[168:171], v[60:75]
    ds_read_b128 v[24:27], v3 offset:2048
    s_add_u32 s46, s42, 32768
    buffer_load_dwordx4 v[236:239], v2, s[32:35], s46 offen offset:3072 sc1
    s_waitcnt vmcnt(16) lgkmcnt(5)
    v_mfma_f32_32x32x16_bf16 v[44:59], v[28:31], v[172:175], v[44:59]
    ds_read_b128 v[28:31], v3 offset:22528
    v_mfma_f32_32x32x16_bf16 v[60:75], v[32:35], v[172:175], v[60:75]
    s_barrier
    ds_read_b128 v[32:35], v3 offset:3072
    s_add_u32 s46, s42, 36864
    buffer_load_dwordx4 v[240:243], v2, s[32:35], s46 offen offset:0 sc1
    s_waitcnt vmcnt(16) lgkmcnt(5)
    v_mfma_f32_32x32x16_bf16 v[44:59], v[36:39], v[176:179], v[44:59]
    ds_read_b128 v[36:39], v3 offset:23552
    v_mfma_f32_32x32x16_bf16 v[60:75], v[40:43], v[176:179], v[60:75]
    ds_read_b128 v[40:43], v3 offset:4096
    s_add_u32 s46, s42, 36864
    buffer_load_dwordx4 v[244:247], v2, s[32:35], s46 offen offset:1024 sc1
    s_waitcnt vmcnt(16) lgkmcnt(5)
    v_mfma_f32_32x32x16_bf16 v[44:59], v[16:19], v[180:183], v[44:59]
    ds_read_b128 v[16:19], v3 offset:24576
    v_mfma_f32_32x32x16_bf16 v[60:75], v[20:23], v[180:183], v[60:75]
    ds_read_b128 v[20:23], v3 offset:5120
    s_add_u32 s46, s42, 36864
    buffer_load_dwordx4 v[248:251], v2, s[32:35], s46 offen offset:2048 sc1
    s_waitcnt vmcnt(16) lgkmcnt(5)
    v_mfma_f32_32x32x16_bf16 v[44:59], v[24:27], v[184:187], v[44:59]
    ds_read_b128 v[24:27], v3 offset:25600
    v_mfma_f32_32x32x16_bf16 v[60:75], v[28:31], v[184:187], v[60:75]
    ds_read_b128 v[28:31], v3 offset:6144
    s_add_u32 s46, s42, 36864
    buffer_load_dwordx4 v[252:255], v2, s[32:35], s46 offen offset:3072 sc1
    s_waitcnt vmcnt(16) lgkmcnt(5)
    v_mfma_f32_32x32x16_bf16 v[44:59], v[32:35], v[188:191], v[44:59]
    ds_read_b128 v[32:35], v3 offset:26624
    v_mfma_f32_32x32x16_bf16 v[60:75], v[36:39], v[188:191], v[60:75]
    ds_read_b128 v[36:39], v3 offset:7168
    s_waitcnt vmcnt(15) lgkmcnt(5)
    v_mfma_f32_32x32x16_bf16 v[44:59], v[40:43], v[192:195], v[44:59]
    ds_read_b128 v[40:43], v3 offset:27648
    v_mfma_f32_32x32x16_bf16 v[60:75], v[16:19], v[192:195], v[60:75]
    ds_read_b128 v[16:19], v3 offset:8192
    s_waitcnt vmcnt(14) lgkmcnt(5)
    v_mfma_f32_32x32x16_bf16 v[44:59], v[20:23], v[196:199], v[44:59]
    ds_read_b128 v[20:23], v3 offset:28672
    v_mfma_f32_32x32x16_bf16 v[60:75], v[24:27], v[196:199], v[60:75]
    ds_read_b128 v[24:27], v3 offset:9216
    s_waitcnt vmcnt(13) lgkmcnt(5)
    v_mfma_f32_32x32x16_bf16 v[44:59], v[28:31], v[200:203], v[44:59]
    ds_read_b128 v[28:31], v3 offset:29696
    v_mfma_f32_32x32x16_bf16 v[60:75], v[32:35], v[200:203], v[60:75]
    ds_read_b128 v[32:35], v3 offset:10240
    s_waitcnt vmcnt(12) lgkmcnt(5)
    v_mfma_f32_32x32x16_bf16 v[44:59], v[36:39], v[204:207], v[44:59]
    ds_read_b128 v[36:39], v3 offset:30720
    v_mfma_f32_32x32x16_bf16 v[60:75], v[40:43], v[204:207], v[60:75]
    ds_read_b128 v[40:43], v3 offset:11264
    s_waitcnt vmcnt(11) lgkmcnt(5)
    v_mfma_f32_32x32x16_bf16 v[44:59], v[16:19], v[208:211], v[44:59]
    ds_read_b128 v[16:19], v3 offset:31744
    v_mfma_f32_32x32x16_bf16 v[60:75], v[20:23], v[208:211], v[60:75]
    ds_read_b128 v[20:23], v3 offset:12288
    s_waitcnt vmcnt(10) lgkmcnt(5)
    v_mfma_f32_32x32x16_bf16 v[44:59], v[24:27], v[212:215], v[44:59]
    ds_read_b128 v[24:27], v3 offset:32768
    v_mfma_f32_32x32x16_bf16 v[60:75], v[28:31], v[212:215], v[60:75]
    ds_read_b128 v[28:31], v3 offset:13312
    s_waitcnt vmcnt(9) lgkmcnt(5)
    v_mfma_f32_32x32x16_bf16 v[44:59], v[32:35], v[216:219], v[44:59]
    ds_read_b128 v[32:35], v3 offset:33792
    v_mfma_f32_32x32x16_bf16 v[60:75], v[36:39], v[216:219], v[60:75]
    ds_read_b128 v[36:39], v3 offset:14336
    s_waitcnt vmcnt(8) lgkmcnt(5)
    v_mfma_f32_32x32x16_bf16 v[44:59], v[40:43], v[220:223], v[44:59]
    ds_read_b128 v[40:43], v3 offset:34816
    v_mfma_f32_32x32x16_bf16 v[60:75], v[16:19], v[220:223], v[60:75]
    ds_read_b128 v[16:19], v3 offset:15360
    s_waitcnt vmcnt(7) lgkmcnt(5)
    v_mfma_f32_32x32x16_bf16 v[44:59], v[20:23], v[224:227], v[44:59]
    ds_read_b128 v[20:23], v3 offset:35840
    v_mfma_f32_32x32x16_bf16 v[60:75], v[24:27], v[224:227], v[60:75]
    ds_read_b128 v[24:27], v3 offset:16384
    s_waitcnt vmcnt(6) lgkmcnt(5)
    v_mfma_f32_32x32x16_bf16 v[44:59], v[28:31], v[228:231], v[44:59]
    ds_read_b128 v[28:31], v3 offset:36864
    v_mfma_f32_32x32x16_bf16 v[60:75], v[32:35], v[228:231], v[60:75]
    ds_read_b128 v[32:35], v3 offset:17408
    s_waitcnt vmcnt(5) lgkmcnt(5)
    v_mfma_f32_32x32x16_bf16 v[44:59], v[36:39], v[232:235], v[44:59]
    ds_read_b128 v[36:39], v3 offset:37888
    v_mfma_f32_32x32x16_bf16 v[60:75], v[40:43], v[232:235], v[60:75]
    ds_read_b128 v[40:43], v3 offset:18432
    s_waitcnt vmcnt(4) lgkmcnt(5)
    v_mfma_f32_32x32x16_bf16 v[44:59], v[16:19], v[236:239], v[44:59]
    ds_read_b128 v[16:19], v3 offset:38912
    v_mfma_f32_32x32x16_bf16 v[60:75], v[20:23], v[236:239], v[60:75]
    ds_read_b128 v[20:23], v3 offset:19456
    s_waitcnt vmcnt(3) lgkmcnt(5)
    v_mfma_f32_32x32x16_bf16 v[44:59], v[24:27], v[240:243], v[44:59]
    ds_read_b128 v[24:27], v3 offset:39936
    v_mfma_f32_32x32x16_bf16 v[60:75], v[28:31], v[240:243], v[60:75]
    ds_read_b128 v[28:31], v4 offset:0
    s_waitcnt vmcnt(2) lgkmcnt(5)
    v_mfma_f32_32x32x16_bf16 v[44:59], v[32:35], v[244:247], v[44:59]
    ds_read_b128 v[32:35], v4 offset:512
    v_mfma_f32_32x32x16_bf16 v[60:75], v[36:39], v[244:247], v[60:75]
    ds_read_b128 v[36:39], v3 offset:40960
    s_waitcnt vmcnt(1) lgkmcnt(5)
    v_mfma_f32_32x32x16_bf16 v[44:59], v[40:43], v[248:251], v[44:59]
    ds_read_b128 v[40:43], v3 offset:41984
    v_mfma_f32_32x32x16_bf16 v[60:75], v[16:19], v[248:251], v[60:75]
    ds_read_b128 v[16:19], v3 offset:43008
    s_waitcnt vmcnt(0) lgkmcnt(5)
    v_mfma_f32_32x32x16_bf16 v[44:59], v[20:23], v[252:255], v[44:59]
    ds_read_b128 v[20:23], v3 offset:44032
    v_mfma_f32_32x32x16_bf16 v[60:75], v[24:27], v[252:255], v[60:75]
    ds_read_b128 v[24:27], v3 offset:45056
    s_waitcnt lgkmcnt(5)
    v_mfma_f32_32x32x16_bf16 v[44:59], v[28:31], v[12:15], v[44:59]
    ds_read_b128 v[28:31], v3 offset:46080
    v_mfma_f32_32x32x16_bf16 v[60:75], v[32:35], v[12:15], v[60:75]
    s_barrier
    ds_read_b128 v[32:35], v3 offset:47104
    s_waitcnt lgkmcnt(5)
    v_mfma_f32_32x32x16_bf16 v[76:91], v[36:39], v[96:99], 0
    ds_read_b128 v[36:39], v3 offset:48128
    v_mfma_f32_32x32x16_bf16 v[76:91], v[40:43], v[100:103], v[76:91]
    ds_read_b128 v[40:43], v3 offset:49152
    s_waitcnt lgkmcnt(5)
    v_mfma_f32_32x32x16_bf16 v[76:91], v[16:19], v[104:107], v[76:91]
    ds_read_b128 v[16:19], v3 offset:50176
    v_mfma_f32_32x32x16_bf16 v[76:91], v[20:23], v[108:111], v[76:91]
    v_mul_f32 v8, v44, v6
    v_mul_f32 v9, v45, v6
    v_mul_f32 v10, v46, v6
    v_mul_f32 v11, v47, v6
    v_mul_f32 v44, v44, v52
    v_mul_f32 v45, v45, v53
    ds_read_b128 v[20:23], v3 offset:51200
    s_waitcnt lgkmcnt(5)
    v_mfma_f32_32x32x16_bf16 v[76:91], v[24:27], v[112:115], v[76:91]
    v_mul_f32 v46, v46, v54
    v_mul_f32 v47, v47, v55
    v_exp_f32 v8, v8
    v_exp_f32 v9, v9
    ds_read_b128 v[24:27], v3 offset:52224
    v_mfma_f32_32x32x16_bf16 v[76:91], v[28:31], v[116:119], v[76:91]
    v_exp_f32 v10, v10
    v_exp_f32 v11, v11
    v_mul_f32 v44, v44, v7
    v_mul_f32 v45, v45, v7
    ds_read_b128 v[28:31], v3 offset:53248
    s_waitcnt lgkmcnt(5)
    v_mfma_f32_32x32x16_bf16 v[76:91], v[32:35], v[120:123], v[76:91]
    v_mul_f32 v46, v46, v7
    v_mul_f32 v47, v47, v7
    v_add_f32 v8, 1.0, v8
    v_add_f32 v9, 1.0, v9
    v_add_f32 v10, 1.0, v10
    v_add_f32 v11, 1.0, v11
    ds_read_b128 v[32:35], v3 offset:54272
    v_mfma_f32_32x32x16_bf16 v[76:91], v[36:39], v[124:127], v[76:91]
    v_rcp_f32 v8, v8
    v_rcp_f32 v9, v9
    v_rcp_f32 v10, v10
    ds_read_b128 v[36:39], v3 offset:55296
    s_waitcnt lgkmcnt(5)
    v_mfma_f32_32x32x16_bf16 v[76:91], v[40:43], v[128:131], v[76:91]
    v_rcp_f32 v11, v11
    v_mul_f32 v44, v44, v8
    v_mul_f32 v45, v45, v9
    v_mul_f32 v46, v46, v10
    ds_read_b128 v[40:43], v3 offset:56320
    v_mfma_f32_32x32x16_bf16 v[76:91], v[16:19], v[132:135], v[76:91]
    v_mul_f32 v47, v47, v11
    v_mul_f32 v8, v48, v6
    v_mul_f32 v9, v49, v6
    v_mul_f32 v10, v50, v6
    v_mul_f32 v11, v51, v6
    v_mul_f32 v48, v48, v56
    v_mul_f32 v49, v49, v57
    ds_read_b128 v[16:19], v3 offset:57344
    s_waitcnt lgkmcnt(5)
    v_mfma_f32_32x32x16_bf16 v[76:91], v[20:23], v[136:139], v[76:91]
    v_mul_f32 v50, v50, v58
    v_mul_f32 v51, v51, v59
    v_exp_f32 v8, v8
    ds_read_b128 v[20:23], v3 offset:58368
    v_mfma_f32_32x32x16_bf16 v[76:91], v[24:27], v[140:143], v[76:91]
    v_exp_f32 v9, v9
    v_exp_f32 v10, v10
    v_exp_f32 v11, v11
    v_mul_f32 v48, v48, v7
    v_mul_f32 v49, v49, v7
    ds_read_b128 v[24:27], v3 offset:59392
    s_waitcnt lgkmcnt(5)
    v_mfma_f32_32x32x16_bf16 v[76:91], v[28:31], v[144:147], v[76:91]
    v_mul_f32 v50, v50, v7
    v_mul_f32 v51, v51, v7
    v_add_f32 v8, 1.0, v8
    v_add_f32 v9, 1.0, v9
    v_add_f32 v10, 1.0, v10
    v_add_f32 v11, 1.0, v11
    ds_read_b128 v[28:31], v3 offset:60416
    v_mfma_f32_32x32x16_bf16 v[76:91], v[32:35], v[148:151], v[76:91]
    v_rcp_f32 v8, v8
    v_rcp_f32 v9, v9
    ds_read_b128 v[32:35], v95 offset:0
    s_waitcnt lgkmcnt(5)
    v_mfma_f32_32x32x16_bf16 v[76:91], v[36:39], v[152:155], v[76:91]
    v_rcp_f32 v10, v10
    v_rcp_f32 v11, v11
    v_mul_f32 v48, v48, v8
    v_mul_f32 v49, v49, v9
    v_mul_f32 v50, v50, v10
    v_mul_f32 v51, v51, v11
    ds_read_b128 v[36:39], v2 offset:0
    v_mfma_f32_32x32x16_bf16 v[76:91], v[40:43], v[156:159], v[76:91]
    v_cvt_pk_bf16_f32 v52, v44, v45
    v_cvt_pk_bf16_f32 v53, v46, v47
    v_cvt_pk_bf16_f32 v54, v48, v49
    v_cvt_pk_bf16_f32 v55, v50, v51
    s_add_u32 s45, s44, 0
    buffer_store_dwordx4 v[52:55], v5, s[20:23], s45 offen
    ds_read_b128 v[40:43], v95 offset:1024
    s_waitcnt lgkmcnt(5)
    v_mfma_f32_32x32x16_bf16 v[76:91], v[16:19], v[160:163], v[76:91]
    ds_read_b128 v[16:19], v2 offset:1024
    v_mfma_f32_32x32x16_bf16 v[76:91], v[20:23], v[164:167], v[76:91]
    ds_read_b128 v[20:23], v95 offset:2048
    s_waitcnt lgkmcnt(5)
    v_mfma_f32_32x32x16_bf16 v[76:91], v[24:27], v[168:171], v[76:91]
    ds_read_b128 v[24:27], v2 offset:2048
    v_mfma_f32_32x32x16_bf16 v[76:91], v[28:31], v[172:175], v[76:91]
    s_barrier
    ds_read_b128 v[28:31], v95 offset:3072
    s_waitcnt lgkmcnt(5)
    v_mfma_f32_32x32x16_bf16 v[76:91], v[32:35], v[176:179], v[76:91]
    ds_read_b128 v[32:35], v2 offset:3072
    v_mfma_f32_32x32x16_bf16 v[44:59], v[36:39], v[96:99], 0
    ds_read_b128 v[36:39], v95 offset:4096
    s_waitcnt lgkmcnt(5)
    v_mfma_f32_32x32x16_bf16 v[76:91], v[40:43], v[180:183], v[76:91]
    ds_read_b128 v[40:43], v2 offset:4096
    v_mfma_f32_32x32x16_bf16 v[44:59], v[16:19], v[100:103], v[44:59]
    v_mul_f32 v8, v60, v6
    v_mul_f32 v9, v61, v6
    ds_read_b128 v[16:19], v95 offset:5120
    s_waitcnt lgkmcnt(5)
    v_mfma_f32_32x32x16_bf16 v[76:91], v[20:23], v[184:187], v[76:91]
    v_mul_f32 v10, v62, v6
    v_mul_f32 v11, v63, v6
    ds_read_b128 v[20:23], v2 offset:5120
    v_mfma_f32_32x32x16_bf16 v[44:59], v[24:27], v[104:107], v[44:59]
    v_mul_f32 v60, v60, v68
    v_mul_f32 v61, v61, v69
    v_mul_f32 v62, v62, v70
    ds_read_b128 v[24:27], v95 offset:6144
    s_waitcnt lgkmcnt(5)
    v_mfma_f32_32x32x16_bf16 v[76:91], v[28:31], v[188:191], v[76:91]
    v_mul_f32 v63, v63, v71
    ds_read_b128 v[28:31], v2 offset:6144
    v_mfma_f32_32x32x16_bf16 v[44:59], v[32:35], v[108:111], v[44:59]
    v_exp_f32 v8, v8
    ds_read_b128 v[32:35], v95 offset:7168
    s_waitcnt lgkmcnt(5)
    v_mfma_f32_32x32x16_bf16 v[76:91], v[36:39], v[192:195], v[76:91]
    v_exp_f32 v9, v9
    v_exp_f32 v10, v10
    ds_read_b128 v[36:39], v2 offset:7168
    v_mfma_f32_32x32x16_bf16 v[44:59], v[40:43], v[112:115], v[44:59]
    v_exp_f32 v11, v11
    ds_read_b128 v[40:43], v95 offset:8192
    s_waitcnt lgkmcnt(5)
    v_mfma_f32_32x32x16_bf16 v[76:91], v[16:19], v[196:199], v[76:91]
    v_mul_f32 v60, v60, v7
    v_mul_f32 v61, v61, v7
    ds_read_b128 v[16:19], v2 offset:8192
    v_mfma_f32_32x32x16_bf16 v[44:59], v[20:23], v[116:119], v[44:59]
    v_mul_f32 v62, v62, v7
    v_mul_f32 v63, v63, v7
    ds_read_b128 v[20:23], v95 offset:9216
    s_waitcnt lgkmcnt(5)
    v_mfma_f32_32x32x16_bf16 v[76:91], v[24:27], v[200:203], v[76:91]
    v_add_f32 v8, 1.0, v8
    v_add_f32 v9, 1.0, v9
    v_add_f32 v10, 1.0, v10
    ds_read_b128 v[24:27], v2 offset:9216
    v_mfma_f32_32x32x16_bf16 v[44:59], v[28:31], v[120:123], v[44:59]
    v_add_f32 v11, 1.0, v11
    ds_read_b128 v[28:31], v95 offset:10240
    s_waitcnt lgkmcnt(5)
    v_mfma_f32_32x32x16_bf16 v[76:91], v[32:35], v[204:207], v[76:91]
    v_rcp_f32 v8, v8
    ds_read_b128 v[32:35], v2 offset:10240
    v_mfma_f32_32x32x16_bf16 v[44:59], v[36:39], v[124:127], v[44:59]
    v_rcp_f32 v9, v9
    v_rcp_f32 v10, v10
    ds_read_b128 v[36:39], v95 offset:11264
    s_waitcnt lgkmcnt(5)
    v_mfma_f32_32x32x16_bf16 v[76:91], v[40:43], v[208:211], v[76:91]
    v_rcp_f32 v11, v11
    ds_read_b128 v[40:43], v2 offset:11264
    v_mfma_f32_32x32x16_bf16 v[44:59], v[16:19], v[128:131], v[44:59]
    v_mul_f32 v60, v60, v8
    v_mul_f32 v61, v61, v9
    ds_read_b128 v[16:19], v95 offset:12288
    s_waitcnt lgkmcnt(5)
    v_mfma_f32_32x32x16_bf16 v[76:91], v[20:23], v[212:215], v[76:91]
    v_mul_f32 v62, v62, v10
    v_mul_f32 v63, v63, v11
    ds_read_b128 v[20:23], v2 offset:12288
    v_mfma_f32_32x32x16_bf16 v[44:59], v[24:27], v[132:135], v[44:59]
    v_mul_f32 v8, v64, v6
    v_mul_f32 v9, v65, v6
    v_mul_f32 v10, v66, v6
    ds_read_b128 v[24:27], v95 offset:13312
    s_waitcnt lgkmcnt(5)
    v_mfma_f32_32x32x16_bf16 v[76:91], v[28:31], v[216:219], v[76:91]
    v_mul_f32 v11, v67, v6
    v_mul_f32 v64, v64, v72
    ds_read_b128 v[28:31], v2 offset:13312
    v_mfma_f32_32x32x16_bf16 v[44:59], v[32:35], v[136:139], v[44:59]
    v_mul_f32 v65, v65, v73
    v_mul_f32 v66, v66, v74
    ds_read_b128 v[32:35], v95 offset:14336
    s_waitcnt lgkmcnt(5)
    v_mfma_f32_32x32x16_bf16 v[76:91], v[36:39], v[220:223], v[76:91]
    v_mul_f32 v67, v67, v75
    v_exp_f32 v8, v8
    ds_read_b128 v[36:39], v2 offset:14336
    v_mfma_f32_32x32x16_bf16 v[44:59], v[40:43], v[140:143], v[44:59]
    v_exp_f32 v9, v9
    ds_read_b128 v[40:43], v95 offset:15360
    s_waitcnt lgkmcnt(5)
    v_mfma_f32_32x32x16_bf16 v[76:91], v[16:19], v[224:227], v[76:91]
    v_exp_f32 v10, v10
    ds_read_b128 v[16:19], v2 offset:15360
    v_mfma_f32_32x32x16_bf16 v[44:59], v[20:23], v[144:147], v[44:59]
    v_exp_f32 v11, v11
    ds_read_b128 v[20:23], v95 offset:16384
    s_waitcnt lgkmcnt(5)
    v_mfma_f32_32x32x16_bf16 v[76:91], v[24:27], v[228:231], v[76:91]
    v_mul_f32 v64, v64, v7
    v_mul_f32 v65, v65, v7
    v_mul_f32 v66, v66, v7
    ds_read_b128 v[24:27], v2 offset:16384
    v_mfma_f32_32x32x16_bf16 v[44:59], v[28:31], v[148:151], v[44:59]
    v_mul_f32 v67, v67, v7
    v_add_f32 v8, 1.0, v8
    ds_read_b128 v[28:31], v95 offset:17408
    s_waitcnt lgkmcnt(5)
    v_mfma_f32_32x32x16_bf16 v[76:91], v[32:35], v[232:235], v[76:91]
    v_add_f32 v9, 1.0, v9
    v_add_f32 v10, 1.0, v10
    ds_read_b128 v[32:35], v2 offset:17408
    v_mfma_f32_32x32x16_bf16 v[44:59], v[36:39], v[152:155], v[44:59]
    v_add_f32 v11, 1.0, v11
    v_rcp_f32 v8, v8
    ds_read_b128 v[36:39], v95 offset:18432
    s_waitcnt lgkmcnt(5)
    v_mfma_f32_32x32x16_bf16 v[76:91], v[40:43], v[236:239], v[76:91]
    v_rcp_f32 v9, v9
    ds_read_b128 v[40:43], v2 offset:18432
    v_mfma_f32_32x32x16_bf16 v[44:59], v[16:19], v[156:159], v[44:59]
    v_rcp_f32 v10, v10
    ds_read_b128 v[16:19], v95 offset:19456
    s_waitcnt lgkmcnt(5)
    v_mfma_f32_32x32x16_bf16 v[76:91], v[20:23], v[240:243], v[76:91]
    v_rcp_f32 v11, v11
    ds_read_b128 v[20:23], v2 offset:19456
    v_mfma_f32_32x32x16_bf16 v[44:59], v[24:27], v[160:163], v[44:59]
    v_mul_f32 v64, v64, v8
    v_mul_f32 v65, v65, v9
    v_mul_f32 v66, v66, v10
    ds_read_b128 v[24:27], v4 offset:1024
    s_waitcnt lgkmcnt(5)
    v_mfma_f32_32x32x16_bf16 v[76:91], v[28:31], v[244:247], v[76:91]
    v_mul_f32 v67, v67, v11
    v_cvt_pk_bf16_f32 v68, v60, v61
    ds_read_b128 v[28:31], v2 offset:20480
    v_mfma_f32_32x32x16_bf16 v[44:59], v[32:35], v[164:167], v[44:59]
    v_cvt_pk_bf16_f32 v69, v62, v63
    v_cvt_pk_bf16_f32 v70, v64, v65
    ds_read_b128 v[32:35], v2 offset:40960
    s_waitcnt lgkmcnt(5)
    v_mfma_f32_32x32x16_bf16 v[76:91], v[36:39], v[248:251], v[76:91]
    v_cvt_pk_bf16_f32 v71, v66, v67
    s_add_u32 s45, s44, 512
    buffer_store_dwordx4 v[68:71], v5, s[20:23], s45 offen
    ds_read_b128 v[36:39], v2 offset:21504
    v_mfma_f32_32x32x16_bf16 v[44:59], v[40:43], v[168:171], v[44:59]
    ds_read_b128 v[40:43], v2 offset:41984
    s_waitcnt lgkmcnt(5)
    v_mfma_f32_32x32x16_bf16 v[76:91], v[16:19], v[252:255], v[76:91]
    ds_read_b128 v[16:19], v2 offset:22528
    v_mfma_f32_32x32x16_bf16 v[44:59], v[20:23], v[172:175], v[44:59]
    ds_read_b128 v[20:23], v2 offset:43008
    s_waitcnt lgkmcnt(5)
    v_mfma_f32_32x32x16_bf16 v[76:91], v[24:27], v[12:15], v[76:91]
    s_barrier
    ds_read_b128 v[24:27], v2 offset:23552
    v_mfma_f32_32x32x16_bf16 v[44:59], v[28:31], v[176:179], v[44:59]
    ds_read_b128 v[28:31], v2 offset:44032
    s_waitcnt lgkmcnt(5)
    v_mfma_f32_32x32x16_bf16 v[60:75], v[32:35], v[96:99], 0
    ds_read_b128 v[32:35], v2 offset:24576
    v_mfma_f32_32x32x16_bf16 v[44:59], v[36:39], v[180:183], v[44:59]
    ds_read_b128 v[36:39], v2 offset:45056
    s_waitcnt lgkmcnt(5)
    v_mfma_f32_32x32x16_bf16 v[60:75], v[40:43], v[100:103], v[60:75]
    s_nop 0
    v_mul_f32 v8, v76, v6
    v_mul_f32 v9, v77, v6
    ds_read_b128 v[40:43], v2 offset:25600
    v_mfma_f32_32x32x16_bf16 v[44:59], v[16:19], v[184:187], v[44:59]
    v_mul_f32 v10, v78, v6
    v_mul_f32 v11, v79, v6
    ds_read_b128 v[16:19], v2 offset:46080
    s_waitcnt lgkmcnt(5)
    v_mfma_f32_32x32x16_bf16 v[60:75], v[20:23], v[104:107], v[60:75]
    v_mul_f32 v76, v76, v84
    v_mul_f32 v77, v77, v85
    v_mul_f32 v78, v78, v86
    ds_read_b128 v[20:23], v2 offset:26624
    v_mfma_f32_32x32x16_bf16 v[44:59], v[24:27], v[188:191], v[44:59]
    v_mul_f32 v79, v79, v87
    ds_read_b128 v[24:27], v2 offset:47104
    s_waitcnt lgkmcnt(5)
    v_mfma_f32_32x32x16_bf16 v[60:75], v[28:31], v[108:111], v[60:75]
    v_exp_f32 v8, v8
    ds_read_b128 v[28:31], v2 offset:27648
    v_mfma_f32_32x32x16_bf16 v[44:59], v[32:35], v[192:195], v[44:59]
    v_exp_f32 v9, v9
    v_exp_f32 v10, v10
    ds_read_b128 v[32:35], v2 offset:48128
    s_waitcnt lgkmcnt(5)
    v_mfma_f32_32x32x16_bf16 v[60:75], v[36:39], v[112:115], v[60:75]
    v_exp_f32 v11, v11
    ds_read_b128 v[36:39], v2 offset:28672
    v_mfma_f32_32x32x16_bf16 v[44:59], v[40:43], v[196:199], v[44:59]
    v_mul_f32 v76, v76, v7
    v_mul_f32 v77, v77, v7
    ds_read_b128 v[40:43], v2 offset:49152
    s_waitcnt lgkmcnt(5)
    v_mfma_f32_32x32x16_bf16 v[60:75], v[16:19], v[116:119], v[60:75]
    v_mul_f32 v78, v78, v7
    v_mul_f32 v79, v79, v7
    ds_read_b128 v[16:19], v2 offset:29696
    v_mfma_f32_32x32x16_bf16 v[44:59], v[20:23], v[200:203], v[44:59]
    v_add_f32 v8, 1.0, v8
    v_add_f32 v9, 1.0, v9
    v_add_f32 v10, 1.0, v10
    ds_read_b128 v[20:23], v2 offset:50176
    s_waitcnt lgkmcnt(5)
    v_mfma_f32_32x32x16_bf16 v[60:75], v[24:27], v[120:123], v[60:75]
    v_add_f32 v11, 1.0, v11
    ds_read_b128 v[24:27], v2 offset:30720
    v_mfma_f32_32x32x16_bf16 v[44:59], v[28:31], v[204:207], v[44:59]
    v_rcp_f32 v8, v8
    ds_read_b128 v[28:31], v2 offset:51200
    s_waitcnt lgkmcnt(5)
    v_mfma_f32_32x32x16_bf16 v[60:75], v[32:35], v[124:127], v[60:75]
    v_rcp_f32 v9, v9
    v_rcp_f32 v10, v10
    ds_read_b128 v[32:35], v2 offset:31744
    v_mfma_f32_32x32x16_bf16 v[44:59], v[36:39], v[208:211], v[44:59]
    v_rcp_f32 v11, v11
    ds_read_b128 v[36:39], v2 offset:52224
    s_waitcnt lgkmcnt(5)
    v_mfma_f32_32x32x16_bf16 v[60:75], v[40:43], v[128:131], v[60:75]
    v_mul_f32 v76, v76, v8
    v_mul_f32 v77, v77, v9
    ds_read_b128 v[40:43], v2 offset:32768
    v_mfma_f32_32x32x16_bf16 v[44:59], v[16:19], v[212:215], v[44:59]
    v_mul_f32 v78, v78, v10
    v_mul_f32 v79, v79, v11
    ds_read_b128 v[16:19], v2 offset:53248
    s_waitcnt lgkmcnt(5)
    v_mfma_f32_32x32x16_bf16 v[60:75], v[20:23], v[132:135], v[60:75]
    v_mul_f32 v8, v80, v6
    v_mul_f32 v9, v81, v6
    v_mul_f32 v10, v82, v6
    ds_read_b128 v[20:23], v2 offset:33792
    v_mfma_f32_32x32x16_bf16 v[44:59], v[24:27], v[216:219], v[44:59]
    v_mul_f32 v11, v83, v6
    v_mul_f32 v80, v80, v88
    ds_read_b128 v[24:27], v2 offset:54272
    s_waitcnt lgkmcnt(5)
    v_mfma_f32_32x32x16_bf16 v[60:75], v[28:31], v[136:139], v[60:75]
    v_mul_f32 v81, v81, v89
    v_mul_f32 v82, v82, v90
    ds_read_b128 v[28:31], v2 offset:34816
    v_mfma_f32_32x32x16_bf16 v[44:59], v[32:35], v[220:223], v[44:59]
    v_mul_f32 v83, v83, v91
    v_exp_f32 v8, v8
    ds_read_b128 v[32:35], v2 offset:55296
    s_waitcnt lgkmcnt(5)
    v_mfma_f32_32x32x16_bf16 v[60:75], v[36:39], v[140:143], v[60:75]
    v_exp_f32 v9, v9
    ds_read_b128 v[36:39], v2 offset:35840
    v_mfma_f32_32x32x16_bf16 v[44:59], v[40:43], v[224:227], v[44:59]
    v_exp_f32 v10, v10
    ds_read_b128 v[40:43], v2 offset:56320
    s_waitcnt lgkmcnt(5)
    v_mfma_f32_32x32x16_bf16 v[60:75], v[16:19], v[144:147], v[60:75]
    v_exp_f32 v11, v11
    ds_read_b128 v[16:19], v2 offset:36864
    v_mfma_f32_32x32x16_bf16 v[44:59], v[20:23], v[228:231], v[44:59]
    v_mul_f32 v80, v80, v7
    v_mul_f32 v81, v81, v7
    v_mul_f32 v82, v82, v7
    ds_read_b128 v[20:23], v2 offset:57344
    s_waitcnt lgkmcnt(5)
    v_mfma_f32_32x32x16_bf16 v[60:75], v[24:27], v[148:151], v[60:75]
    v_mul_f32 v83, v83, v7
    v_add_f32 v8, 1.0, v8
    ds_read_b128 v[24:27], v2 offset:37888
    v_mfma_f32_32x32x16_bf16 v[44:59], v[28:31], v[232:235], v[44:59]
    v_add_f32 v9, 1.0, v9
    v_add_f32 v10, 1.0, v10
    ds_read_b128 v[28:31], v2 offset:58368
    s_waitcnt lgkmcnt(5)
    v_mfma_f32_32x32x16_bf16 v[60:75], v[32:35], v[152:155], v[60:75]
    v_add_f32 v11, 1.0, v11
    v_rcp_f32 v8, v8
    ds_read_b128 v[32:35], v2 offset:38912
    v_mfma_f32_32x32x16_bf16 v[44:59], v[36:39], v[236:239], v[44:59]
    v_rcp_f32 v9, v9
    ds_read_b128 v[36:39], v2 offset:59392
    s_waitcnt lgkmcnt(5)
    v_mfma_f32_32x32x16_bf16 v[60:75], v[40:43], v[156:159], v[60:75]
    v_rcp_f32 v10, v10
    ds_read_b128 v[40:43], v2 offset:39936
    v_mfma_f32_32x32x16_bf16 v[44:59], v[16:19], v[240:243], v[44:59]
    v_rcp_f32 v11, v11
    ds_read_b128 v[16:19], v2 offset:60416
    s_waitcnt lgkmcnt(5)
    v_mfma_f32_32x32x16_bf16 v[60:75], v[20:23], v[160:163], v[60:75]
    v_mul_f32 v80, v80, v8
    v_mul_f32 v81, v81, v9
    v_mul_f32 v82, v82, v10
    ds_read_b128 v[20:23], v4 offset:1536
    v_mfma_f32_32x32x16_bf16 v[44:59], v[24:27], v[244:247], v[44:59]
    v_mul_f32 v83, v83, v11
    v_cvt_pk_bf16_f32 v84, v76, v77
    ds_read_b128 v[24:27], v3 offset:0
    s_waitcnt lgkmcnt(5)
    v_mfma_f32_32x32x16_bf16 v[60:75], v[28:31], v[164:167], v[60:75]
    v_cvt_pk_bf16_f32 v85, v78, v79
    v_cvt_pk_bf16_f32 v86, v80, v81
    ds_read_b128 v[28:31], v3 offset:20480
    v_mfma_f32_32x32x16_bf16 v[44:59], v[32:35], v[248:251], v[44:59]
    v_cvt_pk_bf16_f32 v87, v82, v83
    s_add_u32 s45, s44, 1024
    buffer_store_dwordx4 v[84:87], v5, s[20:23], s45 offen
    ds_read_b128 v[32:35], v3 offset:1024
    s_waitcnt lgkmcnt(5)
    v_mfma_f32_32x32x16_bf16 v[60:75], v[36:39], v[168:171], v[60:75]
    ds_read_b128 v[36:39], v3 offset:21504
    v_mfma_f32_32x32x16_bf16 v[44:59], v[40:43], v[252:255], v[44:59]
    ds_read_b128 v[40:43], v3 offset:2048
    s_waitcnt lgkmcnt(5)
    v_mfma_f32_32x32x16_bf16 v[60:75], v[16:19], v[172:175], v[60:75]
    ds_read_b128 v[16:19], v3 offset:22528
    v_mfma_f32_32x32x16_bf16 v[44:59], v[20:23], v[12:15], v[44:59]
    s_barrier
    ds_read_b128 v[20:23], v3 offset:3072
    s_waitcnt lgkmcnt(5)
    v_mfma_f32_32x32x16_bf16 v[60:75], v[24:27], v[176:179], v[60:75]
    ds_read_b128 v[24:27], v3 offset:23552
    v_mfma_f32_32x32x16_bf16 v[76:91], v[28:31], v[96:99], 0
    ds_read_b128 v[28:31], v3 offset:4096
    s_waitcnt lgkmcnt(5)
    v_mfma_f32_32x32x16_bf16 v[60:75], v[32:35], v[180:183], v[60:75]
    ds_read_b128 v[32:35], v3 offset:24576
    v_mfma_f32_32x32x16_bf16 v[76:91], v[36:39], v[100:103], v[76:91]
    s_nop 0
    v_mul_f32 v8, v44, v6
    v_mul_f32 v9, v45, v6
    ds_read_b128 v[36:39], v3 offset:5120
    s_waitcnt lgkmcnt(5)
    v_mfma_f32_32x32x16_bf16 v[60:75], v[40:43], v[184:187], v[60:75]
    v_mul_f32 v10, v46, v6
    v_mul_f32 v11, v47, v6
    ds_read_b128 v[40:43], v3 offset:25600
    v_mfma_f32_32x32x16_bf16 v[76:91], v[16:19], v[104:107], v[76:91]
    v_mul_f32 v44, v44, v52
    v_mul_f32 v45, v45, v53
    v_mul_f32 v46, v46, v54
    ds_read_b128 v[16:19], v3 offset:6144
    s_waitcnt lgkmcnt(5)
    v_mfma_f32_32x32x16_bf16 v[60:75], v[20:23], v[188:191], v[60:75]
    v_mul_f32 v47, v47, v55
    ds_read_b128 v[20:23], v3 offset:26624
    v_mfma_f32_32x32x16_bf16 v[76:91], v[24:27], v[108:111], v[76:91]
    v_exp_f32 v8, v8
    ds_read_b128 v[24:27], v3 offset:7168
    s_waitcnt lgkmcnt(5)
    v_mfma_f32_32x32x16_bf16 v[60:75], v[28:31], v[192:195], v[60:75]
    v_exp_f32 v9, v9
    v_exp_f32 v10, v10
    ds_read_b128 v[28:31], v3 offset:27648
    v_mfma_f32_32x32x16_bf16 v[76:91], v[32:35], v[112:115], v[76:91]
    v_exp_f32 v11, v11
    ds_read_b128 v[32:35], v3 offset:8192
    s_waitcnt lgkmcnt(5)
    v_mfma_f32_32x32x16_bf16 v[60:75], v[36:39], v[196:199], v[60:75]
    v_mul_f32 v44, v44, v7
    v_mul_f32 v45, v45, v7
    ds_read_b128 v[36:39], v3 offset:28672
    v_mfma_f32_32x32x16_bf16 v[76:91], v[40:43], v[116:119], v[76:91]
    v_mul_f32 v46, v46, v7
    v_mul_f32 v47, v47, v7
    ds_read_b128 v[40:43], v3 offset:9216
    s_waitcnt lgkmcnt(5)
    v_mfma_f32_32x32x16_bf16 v[60:75], v[16:19], v[200:203], v[60:75]
    v_add_f32 v8, 1.0, v8
    v_add_f32 v9, 1.0, v9
    v_add_f32 v10, 1.0, v10
    ds_read_b128 v[16:19], v3 offset:29696
    v_mfma_f32_32x32x16_bf16 v[76:91], v[20:23], v[120:123], v[76:91]
    v_add_f32 v11, 1.0, v11
    ds_read_b128 v[20:23], v3 offset:10240
    s_waitcnt lgkmcnt(5)
    v_mfma_f32_32x32x16_bf16 v[60:75], v[24:27], v[204:207], v[60:75]
    v_rcp_f32 v8, v8
    ds_read_b128 v[24:27], v3 offset:30720
    v_mfma_f32_32x32x16_bf16 v[76:91], v[28:31], v[124:127], v[76:91]
    v_rcp_f32 v9, v9
    v_rcp_f32 v10, v10
    ds_read_b128 v[28:31], v3 offset:11264
    s_waitcnt lgkmcnt(5)
    v_mfma_f32_32x32x16_bf16 v[60:75], v[32:35], v[208:211], v[60:75]
    v_rcp_f32 v11, v11
    ds_read_b128 v[32:35], v3 offset:31744
    v_mfma_f32_32x32x16_bf16 v[76:91], v[36:39], v[128:131], v[76:91]
    v_mul_f32 v44, v44, v8
    v_mul_f32 v45, v45, v9
    ds_read_b128 v[36:39], v3 offset:12288
    s_waitcnt lgkmcnt(5)
    v_mfma_f32_32x32x16_bf16 v[60:75], v[40:43], v[212:215], v[60:75]
    v_mul_f32 v46, v46, v10
    v_mul_f32 v47, v47, v11
    ds_read_b128 v[40:43], v3 offset:32768
    v_mfma_f32_32x32x16_bf16 v[76:91], v[16:19], v[132:135], v[76:91]
    v_mul_f32 v8, v48, v6
    v_mul_f32 v9, v49, v6
    v_mul_f32 v10, v50, v6
    ds_read_b128 v[16:19], v3 offset:13312
    s_waitcnt lgkmcnt(5)
    v_mfma_f32_32x32x16_bf16 v[60:75], v[20:23], v[216:219], v[60:75]
    v_mul_f32 v11, v51, v6
    v_mul_f32 v48, v48, v56
    ds_read_b128 v[20:23], v3 offset:33792
    v_mfma_f32_32x32x16_bf16 v[76:91], v[24:27], v[136:139], v[76:91]
    v_mul_f32 v49, v49, v57
    v_mul_f32 v50, v50, v58
    ds_read_b128 v[24:27], v3 offset:14336
    s_waitcnt lgkmcnt(5)
    v_mfma_f32_32x32x16_bf16 v[60:75], v[28:31], v[220:223], v[60:75]
    v_mul_f32 v51, v51, v59
    v_exp_f32 v8, v8
    ds_read_b128 v[28:31], v3 offset:34816
    v_mfma_f32_32x32x16_bf16 v[76:91], v[32:35], v[140:143], v[76:91]
    v_exp_f32 v9, v9
    ds_read_b128 v[32:35], v3 offset:15360
    s_waitcnt lgkmcnt(5)
    v_mfma_f32_32x32x16_bf16 v[60:75], v[36:39], v[224:227], v[60:75]
    v_exp_f32 v10, v10
    ds_read_b128 v[36:39], v3 offset:35840
    v_mfma_f32_32x32x16_bf16 v[76:91], v[40:43], v[144:147], v[76:91]
    v_exp_f32 v11, v11
    ds_read_b128 v[40:43], v3 offset:16384
    s_waitcnt lgkmcnt(5)
    v_mfma_f32_32x32x16_bf16 v[60:75], v[16:19], v[228:231], v[60:75]
    v_mul_f32 v48, v48, v7
    v_mul_f32 v49, v49, v7
    v_mul_f32 v50, v50, v7
    ds_read_b128 v[16:19], v3 offset:36864
    v_mfma_f32_32x32x16_bf16 v[76:91], v[20:23], v[148:151], v[76:91]
    v_mul_f32 v51, v51, v7
    v_add_f32 v8, 1.0, v8
    ds_read_b128 v[20:23], v3 offset:17408
    s_waitcnt lgkmcnt(5)
    v_mfma_f32_32x32x16_bf16 v[60:75], v[24:27], v[232:235], v[60:75]
    v_add_f32 v9, 1.0, v9
    v_add_f32 v10, 1.0, v10
    ds_read_b128 v[24:27], v3 offset:37888
    v_mfma_f32_32x32x16_bf16 v[76:91], v[28:31], v[152:155], v[76:91]
    v_add_f32 v11, 1.0, v11
    v_rcp_f32 v8, v8
    ds_read_b128 v[28:31], v3 offset:18432
    s_waitcnt lgkmcnt(5)
    v_mfma_f32_32x32x16_bf16 v[60:75], v[32:35], v[236:239], v[60:75]
    v_rcp_f32 v9, v9
    ds_read_b128 v[32:35], v3 offset:38912
    v_mfma_f32_32x32x16_bf16 v[76:91], v[36:39], v[156:159], v[76:91]
    v_rcp_f32 v10, v10
    ds_read_b128 v[36:39], v3 offset:19456
    s_waitcnt lgkmcnt(5)
    v_mfma_f32_32x32x16_bf16 v[60:75], v[40:43], v[240:243], v[60:75]
    v_rcp_f32 v11, v11
    ds_read_b128 v[40:43], v3 offset:39936
    v_mfma_f32_32x32x16_bf16 v[76:91], v[16:19], v[160:163], v[76:91]
    v_mul_f32 v48, v48, v8
    v_mul_f32 v49, v49, v9
    v_mul_f32 v50, v50, v10
    ds_read_b128 v[16:19], v4 offset:2048
    s_waitcnt lgkmcnt(5)
    v_mfma_f32_32x32x16_bf16 v[60:75], v[20:23], v[244:247], v[60:75]
    v_mul_f32 v51, v51, v11
    v_cvt_pk_bf16_f32 v52, v44, v45
    v_mfma_f32_32x32x16_bf16 v[76:91], v[24:27], v[164:167], v[76:91]
    v_cvt_pk_bf16_f32 v53, v46, v47
    v_cvt_pk_bf16_f32 v54, v48, v49
    s_waitcnt lgkmcnt(3)
    v_mfma_f32_32x32x16_bf16 v[60:75], v[28:31], v[248:251], v[60:75]
    v_cvt_pk_bf16_f32 v55, v50, v51
    s_add_u32 s45, s44, 1536
    buffer_store_dwordx4 v[52:55], v5, s[20:23], s45 offen
    v_mfma_f32_32x32x16_bf16 v[76:91], v[32:35], v[168:171], v[76:91]
    s_waitcnt lgkmcnt(1)
    v_mfma_f32_32x32x16_bf16 v[60:75], v[36:39], v[252:255], v[60:75]
    v_mfma_f32_32x32x16_bf16 v[76:91], v[40:43], v[172:175], v[76:91]
    s_waitcnt lgkmcnt(0)
    v_mfma_f32_32x32x16_bf16 v[60:75], v[16:19], v[12:15], v[60:75]
    s_cmp_eq_u32 s54, 6
    s_cbranch_scc1 adaLN_cond__grouped_kv_mqa__glu_gated_swiglu__prompt_kernel_e_tail6_153
    s_barrier
    ds_read_b128 v[20:23], v3 offset:40960
    ds_read_b128 v[24:27], v95 offset:0
    ds_read_b128 v[28:31], v3 offset:41984
    ds_read_b128 v[32:35], v95 offset:1024
    ds_read_b128 v[36:39], v3 offset:43008
    ds_read_b128 v[40:43], v95 offset:2048
    ds_read_b128 v[16:19], v3 offset:44032
    s_waitcnt lgkmcnt(6)
    v_mfma_f32_32x32x16_bf16 v[76:91], v[20:23], v[176:179], v[76:91]
    ds_read_b128 v[20:23], v95 offset:3072
    s_waitcnt lgkmcnt(5)
    v_mfma_f32_32x32x16_bf16 v[44:59], v[24:27], v[96:99], 0
    ds_read_b128 v[24:27], v3 offset:45056
    v_mfma_f32_32x32x16_bf16 v[76:91], v[28:31], v[180:183], v[76:91]
    ds_read_b128 v[28:31], v95 offset:4096
    s_waitcnt lgkmcnt(5)
    v_mfma_f32_32x32x16_bf16 v[44:59], v[32:35], v[100:103], v[44:59]
    v_mul_f32 v8, v60, v6
    v_mul_f32 v9, v61, v6
    ds_read_b128 v[32:35], v3 offset:46080
    v_mfma_f32_32x32x16_bf16 v[76:91], v[36:39], v[184:187], v[76:91]
    v_mul_f32 v10, v62, v6
    v_mul_f32 v11, v63, v6
    ds_read_b128 v[36:39], v95 offset:5120
    s_waitcnt lgkmcnt(5)
    v_mfma_f32_32x32x16_bf16 v[44:59], v[40:43], v[104:107], v[44:59]
    v_mul_f32 v60, v60, v68
    v_mul_f32 v61, v61, v69
    v_mul_f32 v62, v62, v70
    ds_read_b128 v[40:43], v3 offset:47104
    v_mfma_f32_32x32x16_bf16 v[76:91], v[16:19], v[188:191], v[76:91]
    v_mul_f32 v63, v63, v71
    ds_read_b128 v[16:19], v95 offset:6144
    s_waitcnt lgkmcnt(5)
    v_mfma_f32_32x32x16_bf16 v[44:59], v[20:23], v[108:111], v[44:59]
    v_exp_f32 v8, v8
    ds_read_b128 v[20:23], v3 offset:48128
    v_mfma_f32_32x32x16_bf16 v[76:91], v[24:27], v[192:195], v[76:91]
    v_exp_f32 v9, v9
    v_exp_f32 v10, v10
    ds_read_b128 v[24:27], v95 offset:7168
    s_waitcnt lgkmcnt(5)
    v_mfma_f32_32x32x16_bf16 v[44:59], v[28:31], v[112:115], v[44:59]
    v_exp_f32 v11, v11
    ds_read_b128 v[28:31], v3 offset:49152
    v_mfma_f32_32x32x16_bf16 v[76:91], v[32:35], v[196:199], v[76:91]
    v_mul_f32 v60, v60, v7
    v_mul_f32 v61, v61, v7
    ds_read_b128 v[32:35], v95 offset:8192
    s_waitcnt lgkmcnt(5)
    v_mfma_f32_32x32x16_bf16 v[44:59], v[36:39], v[116:119], v[44:59]
    v_mul_f32 v62, v62, v7
    v_mul_f32 v63, v63, v7
    ds_read_b128 v[36:39], v3 offset:50176
    v_mfma_f32_32x32x16_bf16 v[76:91], v[40:43], v[200:203], v[76:91]
    v_add_f32 v8, 1.0, v8
    v_add_f32 v9, 1.0, v9
    v_add_f32 v10, 1.0, v10
    ds_read_b128 v[40:43], v95 offset:9216
    s_waitcnt lgkmcnt(5)
    v_mfma_f32_32x32x16_bf16 v[44:59], v[16:19], v[120:123], v[44:59]
    v_add_f32 v11, 1.0, v11
    ds_read_b128 v[16:19], v3 offset:51200
    v_mfma_f32_32x32x16_bf16 v[76:91], v[20:23], v[204:207], v[76:91]
    v_rcp_f32 v8, v8
    ds_read_b128 v[20:23], v95 offset:10240
    s_waitcnt lgkmcnt(5)
    v_mfma_f32_32x32x16_bf16 v[44:59], v[24:27], v[124:127], v[44:59]
    v_rcp_f32 v9, v9
    v_rcp_f32 v10, v10
    ds_read_b128 v[24:27], v3 offset:52224
    v_mfma_f32_32x32x16_bf16 v[76:91], v[28:31], v[208:211], v[76:91]
    v_rcp_f32 v11, v11
    ds_read_b128 v[28:31], v95 offset:11264
    s_waitcnt lgkmcnt(5)
    v_mfma_f32_32x32x16_bf16 v[44:59], v[32:35], v[128:131], v[44:59]
    v_mul_f32 v60, v60, v8
    v_mul_f32 v61, v61, v9
    ds_read_b128 v[32:35], v3 offset:53248
    v_mfma_f32_32x32x16_bf16 v[76:91], v[36:39], v[212:215], v[76:91]
    v_mul_f32 v62, v62, v10
    v_mul_f32 v63, v63, v11
    ds_read_b128 v[36:39], v95 offset:12288
    s_waitcnt lgkmcnt(5)
    v_mfma_f32_32x32x16_bf16 v[44:59], v[40:43], v[132:135], v[44:59]
    v_mul_f32 v8, v64, v6
    v_mul_f32 v9, v65, v6
    v_mul_f32 v10, v66, v6
    ds_read_b128 v[40:43], v3 offset:54272
    v_mfma_f32_32x32x16_bf16 v[76:91], v[16:19], v[216:219], v[76:91]
    v_mul_f32 v11, v67, v6
    v_mul_f32 v64, v64, v72
    ds_read_b128 v[16:19], v95 offset:13312
    s_waitcnt lgkmcnt(5)
    v_mfma_f32_32x32x16_bf16 v[44:59], v[20:23], v[136:139], v[44:59]
    v_mul_f32 v65, v65, v73
    v_mul_f32 v66, v66, v74
    ds_read_b128 v[20:23], v3 offset:55296
    v_mfma_f32_32x32x16_bf16 v[76:91], v[24:27], v[220:223], v[76:91]
    v_mul_f32 v67, v67, v75
    v_exp_f32 v8, v8
    ds_read_b128 v[24:27], v95 offset:14336
    s_waitcnt lgkmcnt(5)
    v_mfma_f32_32x32x16_bf16 v[44:59], v[28:31], v[140:143], v[44:59]
    v_exp_f32 v9, v9
    ds_read_b128 v[28:31], v3 offset:56320
    v_mfma_f32_32x32x16_bf16 v[76:91], v[32:35], v[224:227], v[76:91]
    v_exp_f32 v10, v10
    ds_read_b128 v[32:35], v95 offset:15360
    s_waitcnt lgkmcnt(5)
    v_mfma_f32_32x32x16_bf16 v[44:59], v[36:39], v[144:147], v[44:59]
    v_exp_f32 v11, v11
    ds_read_b128 v[36:39], v3 offset:57344
    v_mfma_f32_32x32x16_bf16 v[76:91], v[40:43], v[228:231], v[76:91]
    v_mul_f32 v64, v64, v7
    v_mul_f32 v65, v65, v7
    v_mul_f32 v66, v66, v7
    ds_read_b128 v[40:43], v95 offset:16384
    s_waitcnt lgkmcnt(5)
    v_mfma_f32_32x32x16_bf16 v[44:59], v[16:19], v[148:151], v[44:59]
    v_mul_f32 v67, v67, v7
    v_add_f32 v8, 1.0, v8
    ds_read_b128 v[16:19], v3 offset:58368
    v_mfma_f32_32x32x16_bf16 v[76:91], v[20:23], v[232:235], v[76:91]
    v_add_f32 v9, 1.0, v9
    v_add_f32 v10, 1.0, v10
    ds_read_b128 v[20:23], v95 offset:17408
    s_waitcnt lgkmcnt(5)
    v_mfma_f32_32x32x16_bf16 v[44:59], v[24:27], v[152:155], v[44:59]
    v_add_f32 v11, 1.0, v11
    v_rcp_f32 v8, v8
    ds_read_b128 v[24:27], v3 offset:59392
    v_mfma_f32_32x32x16_bf16 v[76:91], v[28:31], v[236:239], v[76:91]
    v_rcp_f32 v9, v9
    ds_read_b128 v[28:31], v95 offset:18432
    s_waitcnt lgkmcnt(5)
    v_mfma_f32_32x32x16_bf16 v[44:59], v[32:35], v[156:159], v[44:59]
    v_rcp_f32 v10, v10
    ds_read_b128 v[32:35], v3 offset:60416
    v_mfma_f32_32x32x16_bf16 v[76:91], v[36:39], v[240:243], v[76:91]
    v_rcp_f32 v11, v11
    ds_read_b128 v[36:39], v95 offset:19456
    s_waitcnt lgkmcnt(5)
    v_mfma_f32_32x32x16_bf16 v[44:59], v[40:43], v[160:163], v[44:59]
    v_mul_f32 v64, v64, v8
    v_mul_f32 v65, v65, v9
    v_mul_f32 v66, v66, v10
    ds_read_b128 v[40:43], v4 offset:2560
    v_mfma_f32_32x32x16_bf16 v[76:91], v[16:19], v[244:247], v[76:91]
    v_mul_f32 v67, v67, v11
    v_cvt_pk_bf16_f32 v68, v60, v61
    ds_read_b128 v[16:19], v2 offset:0
    s_waitcnt lgkmcnt(5)
    v_mfma_f32_32x32x16_bf16 v[44:59], v[20:23], v[164:167], v[44:59]
    v_cvt_pk_bf16_f32 v69, v62, v63
    v_cvt_pk_bf16_f32 v70, v64, v65
    ds_read_b128 v[20:23], v2 offset:1024
    v_mfma_f32_32x32x16_bf16 v[76:91], v[24:27], v[248:251], v[76:91]
    v_cvt_pk_bf16_f32 v71, v66, v67
    s_add_u32 s45, s44, 2048
    buffer_store_dwordx4 v[68:71], v5, s[20:23], s45 offen
    ds_read_b128 v[24:27], v2 offset:2048
    s_waitcnt lgkmcnt(5)
    v_mfma_f32_32x32x16_bf16 v[44:59], v[28:31], v[168:171], v[44:59]
    ds_read_b128 v[28:31], v2 offset:3072
    v_mfma_f32_32x32x16_bf16 v[76:91], v[32:35], v[252:255], v[76:91]
    ds_read_b128 v[32:35], v2 offset:4096
    s_waitcnt lgkmcnt(5)
    v_mfma_f32_32x32x16_bf16 v[44:59], v[36:39], v[172:175], v[44:59]
    ds_read_b128 v[36:39], v2 offset:5120
    v_mfma_f32_32x32x16_bf16 v[76:91], v[40:43], v[12:15], v[76:91]
    s_barrier
    ds_read_b128 v[40:43], v2 offset:6144
    s_waitcnt lgkmcnt(5)
    v_mfma_f32_32x32x16_bf16 v[44:59], v[16:19], v[176:179], v[44:59]
    ds_read_b128 v[16:19], v2 offset:7168
    v_mfma_f32_32x32x16_bf16 v[44:59], v[20:23], v[180:183], v[44:59]
    ds_read_b128 v[20:23], v2 offset:8192
    s_waitcnt lgkmcnt(5)
    v_mfma_f32_32x32x16_bf16 v[44:59], v[24:27], v[184:187], v[44:59]
    ds_read_b128 v[24:27], v2 offset:9216
    v_mfma_f32_32x32x16_bf16 v[44:59], v[28:31], v[188:191], v[44:59]
    s_nop 0
    v_mul_f32 v8, v76, v6
    v_mul_f32 v9, v77, v6
    v_mul_f32 v10, v78, v6
    v_mul_f32 v11, v79, v6
    v_mul_f32 v76, v76, v84
    ds_read_b128 v[28:31], v2 offset:10240
    s_waitcnt lgkmcnt(5)
    v_mfma_f32_32x32x16_bf16 v[44:59], v[32:35], v[192:195], v[44:59]
    v_mul_f32 v77, v77, v85
    v_mul_f32 v78, v78, v86
    v_mul_f32 v79, v79, v87
    v_exp_f32 v8, v8
    ds_read_b128 v[32:35], v2 offset:11264
    v_mfma_f32_32x32x16_bf16 v[44:59], v[36:39], v[196:199], v[44:59]
    v_exp_f32 v9, v9
    v_exp_f32 v10, v10
    v_exp_f32 v11, v11
    ds_read_b128 v[36:39], v2 offset:12288
    s_waitcnt lgkmcnt(5)
    v_mfma_f32_32x32x16_bf16 v[44:59], v[40:43], v[200:203], v[44:59]
    v_mul_f32 v76, v76, v7
    v_mul_f32 v77, v77, v7
    v_mul_f32 v78, v78, v7
    v_mul_f32 v79, v79, v7
    v_add_f32 v8, 1.0, v8
    v_add_f32 v9, 1.0, v9
    ds_read_b128 v[40:43], v2 offset:13312
    v_mfma_f32_32x32x16_bf16 v[44:59], v[16:19], v[204:207], v[44:59]
    v_add_f32 v10, 1.0, v10
    v_add_f32 v11, 1.0, v11
    v_rcp_f32 v8, v8
    v_rcp_f32 v9, v9
    ds_read_b128 v[16:19], v2 offset:14336
    s_waitcnt lgkmcnt(5)
    v_mfma_f32_32x32x16_bf16 v[44:59], v[20:23], v[208:211], v[44:59]
    v_rcp_f32 v10, v10
    v_rcp_f32 v11, v11
    v_mul_f32 v76, v76, v8
    ds_read_b128 v[20:23], v2 offset:15360
    v_mfma_f32_32x32x16_bf16 v[44:59], v[24:27], v[212:215], v[44:59]
    v_mul_f32 v77, v77, v9
    v_mul_f32 v78, v78, v10
    v_mul_f32 v79, v79, v11
    v_mul_f32 v8, v80, v6
    v_mul_f32 v9, v81, v6
    v_mul_f32 v10, v82, v6
    ds_read_b128 v[24:27], v2 offset:16384
    s_waitcnt lgkmcnt(5)
    v_mfma_f32_32x32x16_bf16 v[44:59], v[28:31], v[216:219], v[44:59]
    v_mul_f32 v11, v83, v6
    v_mul_f32 v80, v80, v88
    v_mul_f32 v81, v81, v89
    v_mul_f32 v82, v82, v90
    v_mul_f32 v83, v83, v91
    ds_read_b128 v[28:31], v2 offset:17408
    v_mfma_f32_32x32x16_bf16 v[44:59], v[32:35], v[220:223], v[44:59]
    v_exp_f32 v8, v8
    v_exp_f32 v9, v9
    v_exp_f32 v10, v10
    ds_read_b128 v[32:35], v2 offset:18432
    s_waitcnt lgkmcnt(5)
    v_mfma_f32_32x32x16_bf16 v[44:59], v[36:39], v[224:227], v[44:59]
    v_exp_f32 v11, v11
    v_mul_f32 v80, v80, v7
    v_mul_f32 v81, v81, v7
    v_mul_f32 v82, v82, v7
    ds_read_b128 v[36:39], v2 offset:19456
    v_mfma_f32_32x32x16_bf16 v[44:59], v[40:43], v[228:231], v[44:59]
    v_mul_f32 v83, v83, v7
    v_add_f32 v8, 1.0, v8
    v_add_f32 v9, 1.0, v9
    v_add_f32 v10, 1.0, v10
    v_add_f32 v11, 1.0, v11
    ds_read_b128 v[40:43], v4 offset:3072
    s_waitcnt lgkmcnt(5)
    v_mfma_f32_32x32x16_bf16 v[44:59], v[16:19], v[232:235], v[44:59]
    v_rcp_f32 v8, v8
    v_rcp_f32 v9, v9
    v_rcp_f32 v10, v10
    v_mfma_f32_32x32x16_bf16 v[44:59], v[20:23], v[236:239], v[44:59]
    v_rcp_f32 v11, v11
    v_mul_f32 v80, v80, v8
    v_mul_f32 v81, v81, v9
    v_mul_f32 v82, v82, v10
    v_mul_f32 v83, v83, v11
    s_waitcnt lgkmcnt(3)
    v_mfma_f32_32x32x16_bf16 v[44:59], v[24:27], v[240:243], v[44:59]
    v_cvt_pk_bf16_f32 v84, v76, v77
    v_cvt_pk_bf16_f32 v85, v78, v79
    v_cvt_pk_bf16_f32 v86, v80, v81
    v_cvt_pk_bf16_f32 v87, v82, v83
    s_add_u32 s45, s44, 2560
    buffer_store_dwordx4 v[84:87], v5, s[20:23], s45 offen
    v_mfma_f32_32x32x16_bf16 v[44:59], v[28:31], v[244:247], v[44:59]
    s_waitcnt lgkmcnt(1)
    v_mfma_f32_32x32x16_bf16 v[44:59], v[32:35], v[248:251], v[44:59]
    v_mfma_f32_32x32x16_bf16 v[44:59], v[36:39], v[252:255], v[44:59]
    s_waitcnt lgkmcnt(0)
    v_mfma_f32_32x32x16_bf16 v[44:59], v[40:43], v[12:15], v[44:59]
    s_nop 11
    v_mul_f32 v8, v44, v6
    v_mul_f32 v9, v45, v6
    v_mul_f32 v10, v46, v6
    v_mul_f32 v11, v47, v6
    v_mul_f32 v44, v44, v52
    v_mul_f32 v45, v45, v53
    v_mul_f32 v46, v46, v54
    v_mul_f32 v47, v47, v55
    v_exp_f32 v8, v8
    v_exp_f32 v9, v9
    v_exp_f32 v10, v10
    v_exp_f32 v11, v11
    v_mul_f32 v44, v44, v7
    v_mul_f32 v45, v45, v7
    v_mul_f32 v46, v46, v7
    v_mul_f32 v47, v47, v7
    v_add_f32 v8, 1.0, v8
    v_add_f32 v9, 1.0, v9
    v_add_f32 v10, 1.0, v10
    v_add_f32 v11, 1.0, v11
    v_rcp_f32 v8, v8
    v_rcp_f32 v9, v9
    v_rcp_f32 v10, v10
    v_rcp_f32 v11, v11
    v_mul_f32 v44, v44, v8
    v_mul_f32 v45, v45, v9
    v_mul_f32 v46, v46, v10
    v_mul_f32 v47, v47, v11
    v_mul_f32 v8, v48, v6
    v_mul_f32 v9, v49, v6
    v_mul_f32 v10, v50, v6
    v_mul_f32 v11, v51, v6
    v_mul_f32 v48, v48, v56
    v_mul_f32 v49, v49, v57
    v_mul_f32 v50, v50, v58
    v_mul_f32 v51, v51, v59
    v_exp_f32 v8, v8
    v_exp_f32 v9, v9
    v_exp_f32 v10, v10
    v_exp_f32 v11, v11
    v_mul_f32 v48, v48, v7
    v_mul_f32 v49, v49, v7
    v_mul_f32 v50, v50, v7
    v_mul_f32 v51, v51, v7
    v_add_f32 v8, 1.0, v8
    v_add_f32 v9, 1.0, v9
    v_add_f32 v10, 1.0, v10
    v_add_f32 v11, 1.0, v11
    v_rcp_f32 v8, v8
    v_rcp_f32 v9, v9
    v_rcp_f32 v10, v10
    v_rcp_f32 v11, v11
    v_mul_f32 v48, v48, v8
    v_mul_f32 v49, v49, v9
    v_mul_f32 v50, v50, v10
    v_mul_f32 v51, v51, v11
    v_cvt_pk_bf16_f32 v52, v44, v45
    v_cvt_pk_bf16_f32 v53, v46, v47
    v_cvt_pk_bf16_f32 v54, v48, v49
    v_cvt_pk_bf16_f32 v55, v50, v51
    s_add_u32 s45, s44, 3072
    buffer_store_dwordx4 v[52:55], v5, s[20:23], s45 offen
    s_branch adaLN_cond__grouped_kv_mqa__glu_gated_swiglu__prompt_kernel_e_done_148
adaLN_cond__grouped_kv_mqa__glu_gated_swiglu__prompt_kernel_e_tail6_153:
    s_barrier
    ds_read_b128 v[20:23], v3 offset:40960
    ds_read_b128 v[24:27], v3 offset:41984
    ds_read_b128 v[28:31], v3 offset:43008
    ds_read_b128 v[32:35], v3 offset:44032
    ds_read_b128 v[36:39], v3 offset:45056
    ds_read_b128 v[40:43], v3 offset:46080
    ds_read_b128 v[16:19], v3 offset:47104
    s_waitcnt lgkmcnt(6)
    v_mfma_f32_32x32x16_bf16 v[76:91], v[20:23], v[176:179], v[76:91]
    ds_read_b128 v[20:23], v3 offset:48128
    s_waitcnt lgkmcnt(5)
    v_mfma_f32_32x32x16_bf16 v[76:91], v[24:27], v[180:183], v[76:91]
    ds_read_b128 v[24:27], v3 offset:49152
    v_mfma_f32_32x32x16_bf16 v[76:91], v[28:31], v[184:187], v[76:91]
    ds_read_b128 v[28:31], v3 offset:50176
    s_waitcnt lgkmcnt(5)
    v_mfma_f32_32x32x16_bf16 v[76:91], v[32:35], v[188:191], v[76:91]
    v_mul_f32 v8, v60, v6
    v_mul_f32 v9, v61, v6
    v_mul_f32 v10, v62, v6
    v_mul_f32 v11, v63, v6
    v_mul_f32 v60, v60, v68
    ds_read_b128 v[32:35], v3 offset:51200
    v_mfma_f32_32x32x16_bf16 v[76:91], v[36:39], v[192:195], v[76:91]
    v_mul_f32 v61, v61, v69
    v_mul_f32 v62, v62, v70
    v_mul_f32 v63, v63, v71
    v_exp_f32 v8, v8
    ds_read_b128 v[36:39], v3 offset:52224
    s_waitcnt lgkmcnt(5)
    v_mfma_f32_32x32x16_bf16 v[76:91], v[40:43], v[196:199], v[76:91]
    v_exp_f32 v9, v9
    v_exp_f32 v10, v10
    v_exp_f32 v11, v11
    ds_read_b128 v[40:43], v3 offset:53248
    v_mfma_f32_32x32x16_bf16 v[76:91], v[16:19], v[200:203], v[76:91]
    v_mul_f32 v60, v60, v7
    v_mul_f32 v61, v61, v7
    v_mul_f32 v62, v62, v7
    v_mul_f32 v63, v63, v7
    v_add_f32 v8, 1.0, v8
    v_add_f32 v9, 1.0, v9
    ds_read_b128 v[16:19], v3 offset:54272
    s_waitcnt lgkmcnt(5)
    v_mfma_f32_32x32x16_bf16 v[76:91], v[20:23], v[204:207], v[76:91]
    v_add_f32 v10, 1.0, v10
    v_add_f32 v11, 1.0, v11
    v_rcp_f32 v8, v8
    v_rcp_f32 v9, v9
    ds_read_b128 v[20:23], v3 offset:55296
    v_mfma_f32_32x32x16_bf16 v[76:91], v[24:27], v[208:211], v[76:91]
    v_rcp_f32 v10, v10
    v_rcp_f32 v11, v11
    v_mul_f32 v60, v60, v8
    ds_read_b128 v[24:27], v3 offset:56320
    s_waitcnt lgkmcnt(5)
    v_mfma_f32_32x32x16_bf16 v[76:91], v[28:31], v[212:215], v[76:91]
    v_mul_f32 v61, v61, v9
    v_mul_f32 v62, v62, v10
    v_mul_f32 v63, v63, v11
    v_mul_f32 v8, v64, v6
    v_mul_f32 v9, v65, v6
    v_mul_f32 v10, v66, v6
    ds_read_b128 v[28:31], v3 offset:57344
    v_mfma_f32_32x32x16_bf16 v[76:91], v[32:35], v[216:219], v[76:91]
    v_mul_f32 v11, v67, v6
    v_mul_f32 v64, v64, v72
    v_mul_f32 v65, v65, v73
    v_mul_f32 v66, v66, v74
    v_mul_f32 v67, v67, v75
    ds_read_b128 v[32:35], v3 offset:58368
    s_waitcnt lgkmcnt(5)
    v_mfma_f32_32x32x16_bf16 v[76:91], v[36:39], v[220:223], v[76:91]
    v_exp_f32 v8, v8
    v_exp_f32 v9, v9
    v_exp_f32 v10, v10
    ds_read_b128 v[36:39], v3 offset:59392
    v_mfma_f32_32x32x16_bf16 v[76:91], v[40:43], v[224:227], v[76:91]
    v_exp_f32 v11, v11
    v_mul_f32 v64, v64, v7
    v_mul_f32 v65, v65, v7
    v_mul_f32 v66, v66, v7
    ds_read_b128 v[40:43], v3 offset:60416
    s_waitcnt lgkmcnt(5)
    v_mfma_f32_32x32x16_bf16 v[76:91], v[16:19], v[228:231], v[76:91]
    v_mul_f32 v67, v67, v7
    v_add_f32 v8, 1.0, v8
    v_add_f32 v9, 1.0, v9
    v_add_f32 v10, 1.0, v10
    v_add_f32 v11, 1.0, v11
    ds_read_b128 v[16:19], v4 offset:2560
    v_mfma_f32_32x32x16_bf16 v[76:91], v[20:23], v[232:235], v[76:91]
    v_rcp_f32 v8, v8
    v_rcp_f32 v9, v9
    v_rcp_f32 v10, v10
    s_waitcnt lgkmcnt(4)
    v_mfma_f32_32x32x16_bf16 v[76:91], v[24:27], v[236:239], v[76:91]
    v_rcp_f32 v11, v11
    v_mul_f32 v64, v64, v8
    v_mul_f32 v65, v65, v9
    v_mul_f32 v66, v66, v10
    v_mul_f32 v67, v67, v11
    v_mfma_f32_32x32x16_bf16 v[76:91], v[28:31], v[240:243], v[76:91]
    v_cvt_pk_bf16_f32 v68, v60, v61
    v_cvt_pk_bf16_f32 v69, v62, v63
    v_cvt_pk_bf16_f32 v70, v64, v65
    v_cvt_pk_bf16_f32 v71, v66, v67
    s_add_u32 s45, s44, 2048
    buffer_store_dwordx4 v[68:71], v5, s[20:23], s45 offen
    s_waitcnt lgkmcnt(2)
    v_mfma_f32_32x32x16_bf16 v[76:91], v[32:35], v[244:247], v[76:91]
    v_mfma_f32_32x32x16_bf16 v[76:91], v[36:39], v[248:251], v[76:91]
    s_waitcnt lgkmcnt(0)
    v_mfma_f32_32x32x16_bf16 v[76:91], v[40:43], v[252:255], v[76:91]
    v_mfma_f32_32x32x16_bf16 v[76:91], v[16:19], v[12:15], v[76:91]
    s_nop 11
    v_mul_f32 v8, v76, v6
    v_mul_f32 v9, v77, v6
    v_mul_f32 v10, v78, v6
    v_mul_f32 v11, v79, v6
    v_mul_f32 v76, v76, v84
    v_mul_f32 v77, v77, v85
    v_mul_f32 v78, v78, v86
    v_mul_f32 v79, v79, v87
    v_exp_f32 v8, v8
    v_exp_f32 v9, v9
    v_exp_f32 v10, v10
    v_exp_f32 v11, v11
    v_mul_f32 v76, v76, v7
    v_mul_f32 v77, v77, v7
    v_mul_f32 v78, v78, v7
    v_mul_f32 v79, v79, v7
    v_add_f32 v8, 1.0, v8
    v_add_f32 v9, 1.0, v9
    v_add_f32 v10, 1.0, v10
    v_add_f32 v11, 1.0, v11
    v_rcp_f32 v8, v8
    v_rcp_f32 v9, v9
    v_rcp_f32 v10, v10
    v_rcp_f32 v11, v11
    v_mul_f32 v76, v76, v8
    v_mul_f32 v77, v77, v9
    v_mul_f32 v78, v78, v10
    v_mul_f32 v79, v79, v11
    v_mul_f32 v8, v80, v6
    v_mul_f32 v9, v81, v6
    v_mul_f32 v10, v82, v6
    v_mul_f32 v11, v83, v6
    v_mul_f32 v80, v80, v88
    v_mul_f32 v81, v81, v89
    v_mul_f32 v82, v82, v90
    v_mul_f32 v83, v83, v91
    v_exp_f32 v8, v8
    v_exp_f32 v9, v9
    v_exp_f32 v10, v10
    v_exp_f32 v11, v11
    v_mul_f32 v80, v80, v7
    v_mul_f32 v81, v81, v7
    v_mul_f32 v82, v82, v7
    v_mul_f32 v83, v83, v7
    v_add_f32 v8, 1.0, v8
    v_add_f32 v9, 1.0, v9
    v_add_f32 v10, 1.0, v10
    v_add_f32 v11, 1.0, v11
    v_rcp_f32 v8, v8
    v_rcp_f32 v9, v9
    v_rcp_f32 v10, v10
    v_rcp_f32 v11, v11
    v_mul_f32 v80, v80, v8
    v_mul_f32 v81, v81, v9
    v_mul_f32 v82, v82, v10
    v_mul_f32 v83, v83, v11
    v_cvt_pk_bf16_f32 v84, v76, v77
    v_cvt_pk_bf16_f32 v85, v78, v79
    v_cvt_pk_bf16_f32 v86, v80, v81
    v_cvt_pk_bf16_f32 v87, v82, v83
    s_add_u32 s45, s44, 2560
    buffer_store_dwordx4 v[84:87], v5, s[20:23], s45 offen
    s_branch adaLN_cond__grouped_kv_mqa__glu_gated_swiglu__prompt_kernel_e_done_148
adaLN_cond__grouped_kv_mqa__glu_gated_swiglu__prompt_kernel_e_slow_152:
    v_lshlrev_b32 v2, 4, v1
    s_lshr_b32 s42, s52, 5
    s_add_u32 s42, s42, s3
    s_mul_i32 s42, s42, 40960
    s_add_u32 s46, s42, 0
    buffer_load_dwordx4 v[96:99], v2, s[32:35], s46 offen offset:0 sc1
    s_add_u32 s46, s42, 0
    buffer_load_dwordx4 v[100:103], v2, s[32:35], s46 offen offset:1024 sc1
    s_add_u32 s46, s42, 0
    buffer_load_dwordx4 v[104:107], v2, s[32:35], s46 offen offset:2048 sc1
    s_add_u32 s46, s42, 0
    buffer_load_dwordx4 v[108:111], v2, s[32:35], s46 offen offset:3072 sc1
    s_add_u32 s46, s42, 4096
    buffer_load_dwordx4 v[112:115], v2, s[32:35], s46 offen offset:0 sc1
    s_add_u32 s46, s42, 4096
    buffer_load_dwordx4 v[116:119], v2, s[32:35], s46 offen offset:1024 sc1
    v_and_b32 v92, 31, v1
    s_lshl_b32 s43, s3, 5
    s_add_u32 s43, s43, s52
    v_add_u32 v92, s43, v92
    v_lshlrev_b32 v92, 7, v92
    v_lshrrev_b32 v93, 5, v1
    v_lshl_add_u32 v94, v93, 6, v92
    s_waitcnt vmcnt(6)
    v_add_u32 v3, 61440, v2
    v_add_u32 v95, 122880, v2
    v_and_b32 v4, 31, v1
    v_lshlrev_b32 v4, 4, v4
    v_add_u32 v4, 148480, v4
    v_lshrrev_b32 v92, 5, v1
    v_bfe_u32 v93, v1, 4, 1
    v_mul_u32_u24 v93, 55296, v93
    v_lshl_add_u32 v93, v92, 8, v93
    v_and_b32 v92, 15, v1
    v_lshl_add_u32 v5, v92, 4, v93
    s_lshr_b32 s44, s52, 4
    s_lshl_b32 s43, s3, 1
    s_add_u32 s44, s44, s43
    s_mul_i32 s44, s44, 55296
    s_lshl_b32 s43, s53, 9
    s_add_u32 s44, s44, s43
    s_barrier
    ds_read_b128 v[16:19], v2 offset:20480
    ds_read_b128 v[20:23], v2 offset:40960
    ds_read_b128 v[24:27], v2 offset:21504
    ds_read_b128 v[28:31], v2 offset:41984
    ds_read_b128 v[32:35], v2 offset:22528
    ds_read_b128 v[36:39], v2 offset:43008
    ds_read_b128 v[40:43], v2 offset:23552
    s_add_u32 s46, s42, 4096
    buffer_load_dwordx4 v[120:123], v2, s[32:35], s46 offen offset:2048 sc1
    s_add_u32 s46, s42, 4096
    buffer_load_dwordx4 v[124:127], v2, s[32:35], s46 offen offset:3072 sc1
    s_waitcnt vmcnt(7) lgkmcnt(5)
    v_mfma_f32_32x32x16_bf16 v[44:59], v[16:19], v[96:99], 0
    ds_read_b128 v[16:19], v2 offset:44032
    v_mfma_f32_32x32x16_bf16 v[60:75], v[20:23], v[96:99], 0
    ds_read_b128 v[20:23], v2 offset:24576
    s_add_u32 s46, s42, 8192
    buffer_load_dwordx4 v[128:131], v2, s[32:35], s46 offen offset:0 sc1
    s_add_u32 s46, s42, 8192
    buffer_load_dwordx4 v[132:135], v2, s[32:35], s46 offen offset:1024 sc1
    s_waitcnt vmcnt(8) lgkmcnt(5)
    v_mfma_f32_32x32x16_bf16 v[44:59], v[24:27], v[100:103], v[44:59]
    ds_read_b128 v[24:27], v2 offset:45056
    v_mfma_f32_32x32x16_bf16 v[60:75], v[28:31], v[100:103], v[60:75]
    ds_read_b128 v[28:31], v2 offset:25600
    s_add_u32 s46, s42, 8192
    buffer_load_dwordx4 v[136:139], v2, s[32:35], s46 offen offset:2048 sc1
    s_add_u32 s46, s42, 8192
    buffer_load_dwordx4 v[140:143], v2, s[32:35], s46 offen offset:3072 sc1
    s_waitcnt vmcnt(9) lgkmcnt(5)
    v_mfma_f32_32x32x16_bf16 v[44:59], v[32:35], v[104:107], v[44:59]
    ds_read_b128 v[32:35], v2 offset:46080
    v_mfma_f32_32x32x16_bf16 v[60:75], v[36:39], v[104:107], v[60:75]
    ds_read_b128 v[36:39], v2 offset:26624
    s_add_u32 s46, s42, 12288
    buffer_load_dwordx4 v[144:147], v2, s[32:35], s46 offen offset:0 sc1
    s_add_u32 s46, s42, 12288
    buffer_load_dwordx4 v[148:151], v2, s[32:35], s46 offen offset:1024 sc1
    buffer_load_dwordx4 v[76:79], v94, s[56:59], 0 offen offset:0 sc1
    buffer_load_dwordx4 v[80:83], v94, s[56:59], 0 offen offset:16 sc1
    buffer_load_dwordx4 v[84:87], v94, s[56:59], 0 offen offset:32 sc1
    buffer_load_dwordx4 v[88:91], v94, s[56:59], 0 offen offset:48 sc1
    s_waitcnt vmcnt(14) lgkmcnt(5)
    v_mfma_f32_32x32x16_bf16 v[44:59], v[40:43], v[108:111], v[44:59]
    ds_read_b128 v[40:43], v2 offset:47104
    v_mfma_f32_32x32x16_bf16 v[60:75], v[16:19], v[108:111], v[60:75]
    ds_read_b128 v[16:19], v2 offset:27648
    s_add_u32 s46, s42, 12288
    buffer_load_dwordx4 v[152:155], v2, s[32:35], s46 offen offset:2048 sc1
    s_add_u32 s46, s42, 12288
    buffer_load_dwordx4 v[156:159], v2, s[32:35], s46 offen offset:3072 sc1
    s_waitcnt vmcnt(15) lgkmcnt(5)
    v_mfma_f32_32x32x16_bf16 v[44:59], v[20:23], v[112:115], v[44:59]
    ds_read_b128 v[20:23], v2 offset:48128
    v_mfma_f32_32x32x16_bf16 v[60:75], v[24:27], v[112:115], v[60:75]
    ds_read_b128 v[24:27], v2 offset:28672
    s_add_u32 s46, s42, 16384
    buffer_load_dwordx4 v[160:163], v2, s[32:35], s46 offen offset:0 sc1
    s_add_u32 s46, s42, 16384
    buffer_load_dwordx4 v[164:167], v2, s[32:35], s46 offen offset:1024 sc1
    s_waitcnt vmcnt(16) lgkmcnt(5)
    v_mfma_f32_32x32x16_bf16 v[44:59], v[28:31], v[116:119], v[44:59]
    ds_read_b128 v[28:31], v2 offset:49152
    v_mfma_f32_32x32x16_bf16 v[60:75], v[32:35], v[116:119], v[60:75]
    ds_read_b128 v[32:35], v2 offset:29696
    s_add_u32 s46, s42, 16384
    buffer_load_dwordx4 v[168:171], v2, s[32:35], s46 offen offset:2048 sc1
    s_add_u32 s46, s42, 16384
    buffer_load_dwordx4 v[172:175], v2, s[32:35], s46 offen offset:3072 sc1
    s_waitcnt vmcnt(17) lgkmcnt(5)
    v_mfma_f32_32x32x16_bf16 v[44:59], v[36:39], v[120:123], v[44:59]
    ds_read_b128 v[36:39], v2 offset:50176
    v_mfma_f32_32x32x16_bf16 v[60:75], v[40:43], v[120:123], v[60:75]
    ds_read_b128 v[40:43], v2 offset:30720
    s_add_u32 s46, s42, 20480
    buffer_load_dwordx4 v[176:179], v2, s[32:35], s46 offen offset:0 sc1
    s_add_u32 s46, s42, 20480
    buffer_load_dwordx4 v[180:183], v2, s[32:35], s46 offen offset:1024 sc1
    s_waitcnt vmcnt(18) lgkmcnt(5)
    v_mfma_f32_32x32x16_bf16 v[44:59], v[16:19], v[124:127], v[44:59]
    ds_read_b128 v[16:19], v2 offset:51200
    v_mfma_f32_32x32x16_bf16 v[60:75], v[20:23], v[124:127], v[60:75]
    ds_read_b128 v[20:23], v2 offset:31744
    s_add_u32 s46, s42, 20480
    buffer_load_dwordx4 v[184:187], v2, s[32:35], s46 offen offset:2048 sc1
    s_add_u32 s46, s42, 20480
    buffer_load_dwordx4 v[188:191], v2, s[32:35], s46 offen offset:3072 sc1
    s_waitcnt vmcnt(19) lgkmcnt(5)
    v_mfma_f32_32x32x16_bf16 v[44:59], v[24:27], v[128:131], v[44:59]
    ds_read_b128 v[24:27], v2 offset:52224
    v_mfma_f32_32x32x16_bf16 v[60:75], v[28:31], v[128:131], v[60:75]
    ds_read_b128 v[28:31], v2 offset:32768
    s_add_u32 s46, s42, 24576
    buffer_load_dwordx4 v[192:195], v2, s[32:35], s46 offen offset:0 sc1
    s_add_u32 s46, s42, 24576
    buffer_load_dwordx4 v[196:199], v2, s[32:35], s46 offen offset:1024 sc1
    s_waitcnt vmcnt(20) lgkmcnt(5)
    v_mfma_f32_32x32x16_bf16 v[44:59], v[32:35], v[132:135], v[44:59]
    ds_read_b128 v[32:35], v2 offset:53248
    v_mfma_f32_32x32x16_bf16 v[60:75], v[36:39], v[132:135], v[60:75]
    ds_read_b128 v[36:39], v2 offset:33792
    s_add_u32 s46, s42, 24576
    buffer_load_dwordx4 v[200:203], v2, s[32:35], s46 offen offset:2048 sc1
    s_waitcnt vmcnt(20) lgkmcnt(5)
    v_mfma_f32_32x32x16_bf16 v[44:59], v[40:43], v[136:139], v[44:59]
    ds_read_b128 v[40:43], v2 offset:54272
    v_mfma_f32_32x32x16_bf16 v[60:75], v[16:19], v[136:139], v[60:75]
    ds_read_b128 v[16:19], v2 offset:34816
    s_add_u32 s46, s42, 24576
    buffer_load_dwordx4 v[204:207], v2, s[32:35], s46 offen offset:3072 sc1
    s_waitcnt vmcnt(20) lgkmcnt(5)
    v_mfma_f32_32x32x16_bf16 v[44:59], v[20:23], v[140:143], v[44:59]
    ds_read_b128 v[20:23], v2 offset:55296
    v_mfma_f32_32x32x16_bf16 v[60:75], v[24:27], v[140:143], v[60:75]
    s_waitcnt vmcnt(16)
    v_add_f32 v76, v76, v80
    v_add_f32 v77, v77, v81
    v_add_f32 v78, v78, v82
    ds_read_b128 v[24:27], v2 offset:35840
    s_add_u32 s46, s42, 28672
    buffer_load_dwordx4 v[208:211], v2, s[32:35], s46 offen offset:0 sc1
    s_waitcnt lgkmcnt(5)
    v_mfma_f32_32x32x16_bf16 v[44:59], v[28:31], v[144:147], v[44:59]
    v_add_f32 v79, v79, v83
    s_waitcnt vmcnt(16)
    v_add_f32 v76, v76, v84
    v_add_f32 v77, v77, v85
    v_add_f32 v78, v78, v86
    ds_read_b128 v[28:31], v2 offset:56320
    v_mfma_f32_32x32x16_bf16 v[60:75], v[32:35], v[144:147], v[60:75]
    v_add_f32 v79, v79, v87
    s_waitcnt vmcnt(15)
    v_add_f32 v76, v76, v88
    v_add_f32 v77, v77, v89
    ds_read_b128 v[32:35], v2 offset:36864
    s_add_u32 s46, s42, 28672
    buffer_load_dwordx4 v[212:215], v2, s[32:35], s46 offen offset:1024 sc1
    s_waitcnt lgkmcnt(5)
    v_mfma_f32_32x32x16_bf16 v[44:59], v[36:39], v[148:151], v[44:59]
    v_add_f32 v78, v78, v90
    v_add_f32 v79, v79, v91
    v_add_f32 v76, v76, v78
    ds_read_b128 v[36:39], v2 offset:57344
    v_mfma_f32_32x32x16_bf16 v[60:75], v[40:43], v[148:151], v[60:75]
    v_add_f32 v77, v77, v79
    v_mov_b32 v80, v76
    s_nop 1
    v_permlane32_swap_b32 v76, v80
    v_add_f32 v76, v76, v80
    ds_read_b128 v[40:43], v2 offset:37888
    s_add_u32 s46, s42, 28672
    buffer_load_dwordx4 v[216:219], v2, s[32:35], s46 offen offset:2048 sc1
    s_waitcnt vmcnt(16) lgkmcnt(5)
    v_mfma_f32_32x32x16_bf16 v[44:59], v[16:19], v[152:155], v[44:59]
    v_mov_b32 v80, v77
    s_nop 1
    v_permlane32_swap_b32 v77, v80
    v_add_f32 v77, v77, v80
    ds_read_b128 v[16:19], v2 offset:58368
    v_mfma_f32_32x32x16_bf16 v[60:75], v[20:23], v[152:155], v[60:75]
    v_mul_f32 v76, 0x3acccccd, v76
    v_mov_b32 v78, 0x3727c5ac
    v_fmac_f32 v78, 0x3acccccd, v77
    v_fma_f32 v78, -v76, v76, v78
    ds_read_b128 v[20:23], v2 offset:38912
    s_add_u32 s46, s42, 28672
    buffer_load_dwordx4 v[220:223], v2, s[32:35], s46 offen offset:3072 sc1
    s_waitcnt vmcnt(16) lgkmcnt(5)
    v_mfma_f32_32x32x16_bf16 v[44:59], v[24:27], v[156:159], v[44:59]
    v_max_f32 v78, 0x3727c5ac, v78
    v_rsq_f32 v79, v78
    v_sub_f32 v76, 0, v76
    ds_read_b128 v[24:27], v2 offset:59392
    v_mfma_f32_32x32x16_bf16 v[60:75], v[28:31], v[156:159], v[60:75]
    v_mul_f32 v78, v78, v79
    v_mul_f32 v6, 0xbfb8aa3b, v79
    v_mul_f32 v7, v79, v79
    ds_read_b128 v[28:31], v2 offset:39936
    s_add_u32 s46, s42, 32768
    buffer_load_dwordx4 v[224:227], v2, s[32:35], s46 offen offset:0 sc1
    s_waitcnt vmcnt(16) lgkmcnt(5)
    v_mfma_f32_32x32x16_bf16 v[44:59], v[32:35], v[160:163], v[44:59]
    v_cvt_pk_bf16_f32 v80, v76, v76
    v_lshlrev_b32 v80, 16, v80
    v_sub_f32 v81, v76, v80
    v_cvt_pk_bf16_f32 v82, v78, v78
    ds_read_b128 v[32:35], v2 offset:60416
    v_mfma_f32_32x32x16_bf16 v[60:75], v[36:39], v[160:163], v[60:75]
    v_lshlrev_b32 v82, 16, v82
    v_sub_f32 v83, v78, v82
    v_cvt_pk_bf16_f32 v12, v80, v81
    ds_read_b128 v[36:39], v3 offset:0
    s_add_u32 s46, s42, 32768
    buffer_load_dwordx4 v[228:231], v2, s[32:35], s46 offen offset:1024 sc1
    s_waitcnt vmcnt(16) lgkmcnt(5)
    v_mfma_f32_32x32x16_bf16 v[44:59], v[40:43], v[164:167], v[44:59]
    v_cvt_pk_bf16_f32 v13, v80, v82
    v_cvt_pk_bf16_f32 v14, v83, v82
    v_mov_b32 v15, 0
    v_cmp_gt_u32 vcc, 32, v1
    ds_read_b128 v[40:43], v3 offset:20480
    v_mfma_f32_32x32x16_bf16 v[60:75], v[16:19], v[164:167], v[60:75]
    v_cndmask_b32 v12, 0, v12, vcc
    v_cndmask_b32 v13, 0, v13, vcc
    v_cndmask_b32 v14, 0, v14, vcc
    ds_read_b128 v[16:19], v3 offset:1024
    s_add_u32 s46, s42, 32768
    buffer_load_dwordx4 v[232:235], v2, s[32:35], s46 offen offset:2048 sc1
    s_waitcnt vmcnt(16) lgkmcnt(5)
    v_mfma_f32_32x32x16_bf16 v[44:59], v[20:23], v[168:171], v[44:59]
    ds_read_b128 v[20:23], v3 offset:21504
    v_mfma_f32_32x32x16_bf16 v[60:75], v[24:27], v[168:171], v[60:75]
    ds_read_b128 v[24:27], v3 offset:2048
    s_add_u32 s46, s42, 32768
    buffer_load_dwordx4 v[236:239], v2, s[32:35], s46 offen offset:3072 sc1
    s_waitcnt vmcnt(16) lgkmcnt(5)
    v_mfma_f32_32x32x16_bf16 v[44:59], v[28:31], v[172:175], v[44:59]
    ds_read_b128 v[28:31], v3 offset:22528
    v_mfma_f32_32x32x16_bf16 v[60:75], v[32:35], v[172:175], v[60:75]
    s_barrier
    ds_read_b128 v[32:35], v3 offset:3072
    s_add_u32 s46, s42, 36864
    buffer_load_dwordx4 v[240:243], v2, s[32:35], s46 offen offset:0 sc1
    s_waitcnt vmcnt(16) lgkmcnt(5)
    v_mfma_f32_32x32x16_bf16 v[44:59], v[36:39], v[176:179], v[44:59]
    ds_read_b128 v[36:39], v3 offset:23552
    v_mfma_f32_32x32x16_bf16 v[60:75], v[40:43], v[176:179], v[60:75]
    ds_read_b128 v[40:43], v3 offset:4096
    s_add_u32 s46, s42, 36864
    buffer_load_dwordx4 v[244:247], v2, s[32:35], s46 offen offset:1024 sc1
    s_waitcnt vmcnt(16) lgkmcnt(5)
    v_mfma_f32_32x32x16_bf16 v[44:59], v[16:19], v[180:183], v[44:59]
    ds_read_b128 v[16:19], v3 offset:24576
    v_mfma_f32_32x32x16_bf16 v[60:75], v[20:23], v[180:183], v[60:75]
    ds_read_b128 v[20:23], v3 offset:5120
    s_add_u32 s46, s42, 36864
    buffer_load_dwordx4 v[248:251], v2, s[32:35], s46 offen offset:2048 sc1
    s_waitcnt vmcnt(16) lgkmcnt(5)
    v_mfma_f32_32x32x16_bf16 v[44:59], v[24:27], v[184:187], v[44:59]
    ds_read_b128 v[24:27], v3 offset:25600
    v_mfma_f32_32x32x16_bf16 v[60:75], v[28:31], v[184:187], v[60:75]
    ds_read_b128 v[28:31], v3 offset:6144
    s_add_u32 s46, s42, 36864
    buffer_load_dwordx4 v[252:255], v2, s[32:35], s46 offen offset:3072 sc1
    s_waitcnt vmcnt(16) lgkmcnt(5)
    v_mfma_f32_32x32x16_bf16 v[44:59], v[32:35], v[188:191], v[44:59]
    ds_read_b128 v[32:35], v3 offset:26624
    v_mfma_f32_32x32x16_bf16 v[60:75], v[36:39], v[188:191], v[60:75]
    ds_read_b128 v[36:39], v3 offset:7168
    s_waitcnt vmcnt(15) lgkmcnt(5)
    v_mfma_f32_32x32x16_bf16 v[44:59], v[40:43], v[192:195], v[44:59]
    ds_read_b128 v[40:43], v3 offset:27648
    v_mfma_f32_32x32x16_bf16 v[60:75], v[16:19], v[192:195], v[60:75]
    ds_read_b128 v[16:19], v3 offset:8192
    s_waitcnt vmcnt(14) lgkmcnt(5)
    v_mfma_f32_32x32x16_bf16 v[44:59], v[20:23], v[196:199], v[44:59]
    ds_read_b128 v[20:23], v3 offset:28672
    v_mfma_f32_32x32x16_bf16 v[60:75], v[24:27], v[196:199], v[60:75]
    ds_read_b128 v[24:27], v3 offset:9216
    s_waitcnt vmcnt(13) lgkmcnt(5)
    v_mfma_f32_32x32x16_bf16 v[44:59], v[28:31], v[200:203], v[44:59]
    ds_read_b128 v[28:31], v3 offset:29696
    v_mfma_f32_32x32x16_bf16 v[60:75], v[32:35], v[200:203], v[60:75]
    ds_read_b128 v[32:35], v3 offset:10240
    s_waitcnt vmcnt(12) lgkmcnt(5)
    v_mfma_f32_32x32x16_bf16 v[44:59], v[36:39], v[204:207], v[44:59]
    ds_read_b128 v[36:39], v3 offset:30720
    v_mfma_f32_32x32x16_bf16 v[60:75], v[40:43], v[204:207], v[60:75]
    ds_read_b128 v[40:43], v3 offset:11264
    s_waitcnt vmcnt(11) lgkmcnt(5)
    v_mfma_f32_32x32x16_bf16 v[44:59], v[16:19], v[208:211], v[44:59]
    ds_read_b128 v[16:19], v3 offset:31744
    v_mfma_f32_32x32x16_bf16 v[60:75], v[20:23], v[208:211], v[60:75]
    ds_read_b128 v[20:23], v3 offset:12288
    s_waitcnt vmcnt(10) lgkmcnt(5)
    v_mfma_f32_32x32x16_bf16 v[44:59], v[24:27], v[212:215], v[44:59]
    ds_read_b128 v[24:27], v3 offset:32768
    v_mfma_f32_32x32x16_bf16 v[60:75], v[28:31], v[212:215], v[60:75]
    ds_read_b128 v[28:31], v3 offset:13312
    s_waitcnt vmcnt(9) lgkmcnt(5)
    v_mfma_f32_32x32x16_bf16 v[44:59], v[32:35], v[216:219], v[44:59]
    ds_read_b128 v[32:35], v3 offset:33792
    v_mfma_f32_32x32x16_bf16 v[60:75], v[36:39], v[216:219], v[60:75]
    ds_read_b128 v[36:39], v3 offset:14336
    s_waitcnt vmcnt(8) lgkmcnt(5)
    v_mfma_f32_32x32x16_bf16 v[44:59], v[40:43], v[220:223], v[44:59]
    ds_read_b128 v[40:43], v3 offset:34816
    v_mfma_f32_32x32x16_bf16 v[60:75], v[16:19], v[220:223], v[60:75]
    ds_read_b128 v[16:19], v3 offset:15360
    s_waitcnt vmcnt(7) lgkmcnt(5)
    v_mfma_f32_32x32x16_bf16 v[44:59], v[20:23], v[224:227], v[44:59]
    ds_read_b128 v[20:23], v3 offset:35840
    v_mfma_f32_32x32x16_bf16 v[60:75], v[24:27], v[224:227], v[60:75]
    ds_read_b128 v[24:27], v3 offset:16384
    s_waitcnt vmcnt(6) lgkmcnt(5)
    v_mfma_f32_32x32x16_bf16 v[44:59], v[28:31], v[228:231], v[44:59]
    ds_read_b128 v[28:31], v3 offset:36864
    v_mfma_f32_32x32x16_bf16 v[60:75], v[32:35], v[228:231], v[60:75]
    ds_read_b128 v[32:35], v3 offset:17408
    s_waitcnt vmcnt(5) lgkmcnt(5)
    v_mfma_f32_32x32x16_bf16 v[44:59], v[36:39], v[232:235], v[44:59]
    ds_read_b128 v[36:39], v3 offset:37888
    v_mfma_f32_32x32x16_bf16 v[60:75], v[40:43], v[232:235], v[60:75]
    ds_read_b128 v[40:43], v3 offset:18432
    s_waitcnt vmcnt(4) lgkmcnt(5)
    v_mfma_f32_32x32x16_bf16 v[44:59], v[16:19], v[236:239], v[44:59]
    ds_read_b128 v[16:19], v3 offset:38912
    v_mfma_f32_32x32x16_bf16 v[60:75], v[20:23], v[236:239], v[60:75]
    ds_read_b128 v[20:23], v3 offset:19456
    s_waitcnt vmcnt(3) lgkmcnt(5)
    v_mfma_f32_32x32x16_bf16 v[44:59], v[24:27], v[240:243], v[44:59]
    ds_read_b128 v[24:27], v3 offset:39936
    v_mfma_f32_32x32x16_bf16 v[60:75], v[28:31], v[240:243], v[60:75]
    ds_read_b128 v[28:31], v4 offset:0
    s_waitcnt vmcnt(2) lgkmcnt(5)
    v_mfma_f32_32x32x16_bf16 v[44:59], v[32:35], v[244:247], v[44:59]
    ds_read_b128 v[32:35], v4 offset:512
    v_mfma_f32_32x32x16_bf16 v[60:75], v[36:39], v[244:247], v[60:75]
    ds_read_b128 v[36:39], v3 offset:40960
    s_waitcnt vmcnt(1) lgkmcnt(5)
    v_mfma_f32_32x32x16_bf16 v[44:59], v[40:43], v[248:251], v[44:59]
    ds_read_b128 v[40:43], v3 offset:41984
    v_mfma_f32_32x32x16_bf16 v[60:75], v[16:19], v[248:251], v[60:75]
    ds_read_b128 v[16:19], v3 offset:43008
    s_waitcnt vmcnt(0) lgkmcnt(5)
    v_mfma_f32_32x32x16_bf16 v[44:59], v[20:23], v[252:255], v[44:59]
    ds_read_b128 v[20:23], v3 offset:44032
    v_mfma_f32_32x32x16_bf16 v[60:75], v[24:27], v[252:255], v[60:75]
    ds_read_b128 v[24:27], v3 offset:45056
    s_waitcnt lgkmcnt(5)
    v_mfma_f32_32x32x16_bf16 v[44:59], v[28:31], v[12:15], v[44:59]
    ds_read_b128 v[28:31], v3 offset:46080
    v_mfma_f32_32x32x16_bf16 v[60:75], v[32:35], v[12:15], v[60:75]
    s_barrier
    ds_read_b128 v[32:35], v3 offset:47104
    s_waitcnt lgkmcnt(5)
    v_mfma_f32_32x32x16_bf16 v[76:91], v[36:39], v[96:99], 0
    ds_read_b128 v[36:39], v3 offset:48128
    v_mfma_f32_32x32x16_bf16 v[76:91], v[40:43], v[100:103], v[76:91]
    ds_read_b128 v[40:43], v3 offset:49152
    s_waitcnt lgkmcnt(5)
    v_mfma_f32_32x32x16_bf16 v[76:91], v[16:19], v[104:107], v[76:91]
    ds_read_b128 v[16:19], v3 offset:50176
    v_mfma_f32_32x32x16_bf16 v[76:91], v[20:23], v[108:111], v[76:91]
    v_mul_f32 v8, v44, v6
    v_mul_f32 v9, v45, v6
    v_mul_f32 v10, v46, v6
    v_mul_f32 v11, v47, v6
    v_mul_f32 v44, v44, v52
    v_mul_f32 v45, v45, v53
    ds_read_b128 v[20:23], v3 offset:51200
    s_waitcnt lgkmcnt(5)
    v_mfma_f32_32x32x16_bf16 v[76:91], v[24:27], v[112:115], v[76:91]
    v_mul_f32 v46, v46, v54
    v_mul_f32 v47, v47, v55
    v_exp_f32 v8, v8
    v_exp_f32 v9, v9
    ds_read_b128 v[24:27], v3 offset:52224
    v_mfma_f32_32x32x16_bf16 v[76:91], v[28:31], v[116:119], v[76:91]
    v_exp_f32 v10, v10
    v_exp_f32 v11, v11
    v_mul_f32 v44, v44, v7
    v_mul_f32 v45, v45, v7
    ds_read_b128 v[28:31], v3 offset:53248
    s_waitcnt lgkmcnt(5)
    v_mfma_f32_32x32x16_bf16 v[76:91], v[32:35], v[120:123], v[76:91]
    v_mul_f32 v46, v46, v7
    v_mul_f32 v47, v47, v7
    v_add_f32 v8, 1.0, v8
    v_add_f32 v9, 1.0, v9
    v_add_f32 v10, 1.0, v10
    v_add_f32 v11, 1.0, v11
    ds_read_b128 v[32:35], v3 offset:54272
    v_mfma_f32_32x32x16_bf16 v[76:91], v[36:39], v[124:127], v[76:91]
    v_rcp_f32 v8, v8
    v_rcp_f32 v9, v9
    v_rcp_f32 v10, v10
    ds_read_b128 v[36:39], v3 offset:55296
    s_waitcnt lgkmcnt(5)
    v_mfma_f32_32x32x16_bf16 v[76:91], v[40:43], v[128:131], v[76:91]
    v_rcp_f32 v11, v11
    v_mul_f32 v44, v44, v8
    v_mul_f32 v45, v45, v9
    v_mul_f32 v46, v46, v10
    ds_read_b128 v[40:43], v3 offset:56320
    v_mfma_f32_32x32x16_bf16 v[76:91], v[16:19], v[132:135], v[76:91]
    v_mul_f32 v47, v47, v11
    v_mul_f32 v8, v48, v6
    v_mul_f32 v9, v49, v6
    v_mul_f32 v10, v50, v6
    v_mul_f32 v11, v51, v6
    v_mul_f32 v48, v48, v56
    v_mul_f32 v49, v49, v57
    ds_read_b128 v[16:19], v3 offset:57344
    s_waitcnt lgkmcnt(5)
    v_mfma_f32_32x32x16_bf16 v[76:91], v[20:23], v[136:139], v[76:91]
    v_mul_f32 v50, v50, v58
    v_mul_f32 v51, v51, v59
    v_exp_f32 v8, v8
    ds_read_b128 v[20:23], v3 offset:58368
    v_mfma_f32_32x32x16_bf16 v[76:91], v[24:27], v[140:143], v[76:91]
    v_exp_f32 v9, v9
    v_exp_f32 v10, v10
    v_exp_f32 v11, v11
    v_mul_f32 v48, v48, v7
    v_mul_f32 v49, v49, v7
    ds_read_b128 v[24:27], v3 offset:59392
    s_waitcnt lgkmcnt(5)
    v_mfma_f32_32x32x16_bf16 v[76:91], v[28:31], v[144:147], v[76:91]
    v_mul_f32 v50, v50, v7
    v_mul_f32 v51, v51, v7
    v_add_f32 v8, 1.0, v8
    v_add_f32 v9, 1.0, v9
    v_add_f32 v10, 1.0, v10
    v_add_f32 v11, 1.0, v11
    ds_read_b128 v[28:31], v3 offset:60416
    v_mfma_f32_32x32x16_bf16 v[76:91], v[32:35], v[148:151], v[76:91]
    v_rcp_f32 v8, v8
    v_rcp_f32 v9, v9
    ds_read_b128 v[32:35], v95 offset:0
    s_waitcnt lgkmcnt(5)
    v_mfma_f32_32x32x16_bf16 v[76:91], v[36:39], v[152:155], v[76:91]
    v_rcp_f32 v10, v10
    v_rcp_f32 v11, v11
    v_mul_f32 v48, v48, v8
    v_mul_f32 v49, v49, v9
    v_mul_f32 v50, v50, v10
    v_mul_f32 v51, v51, v11
    ds_read_b128 v[36:39], v2 offset:0
    v_mfma_f32_32x32x16_bf16 v[76:91], v[40:43], v[156:159], v[76:91]
    v_cvt_pk_bf16_f32 v52, v44, v45
    v_cvt_pk_bf16_f32 v53, v46, v47
    v_cvt_pk_bf16_f32 v54, v48, v49
    v_cvt_pk_bf16_f32 v55, v50, v51
    s_add_u32 s45, s44, 0
    buffer_store_dwordx4 v[52:55], v5, s[20:23], s45 offen sc1
    ds_read_b128 v[40:43], v95 offset:1024
    s_waitcnt lgkmcnt(5)
    v_mfma_f32_32x32x16_bf16 v[76:91], v[16:19], v[160:163], v[76:91]
    ds_read_b128 v[16:19], v2 offset:1024
    v_mfma_f32_32x32x16_bf16 v[76:91], v[20:23], v[164:167], v[76:91]
    ds_read_b128 v[20:23], v95 offset:2048
    s_waitcnt lgkmcnt(5)
    v_mfma_f32_32x32x16_bf16 v[76:91], v[24:27], v[168:171], v[76:91]
    ds_read_b128 v[24:27], v2 offset:2048
    v_mfma_f32_32x32x16_bf16 v[76:91], v[28:31], v[172:175], v[76:91]
    s_barrier
    ds_read_b128 v[28:31], v95 offset:3072
    s_waitcnt lgkmcnt(5)
    v_mfma_f32_32x32x16_bf16 v[76:91], v[32:35], v[176:179], v[76:91]
    ds_read_b128 v[32:35], v2 offset:3072
    v_mfma_f32_32x32x16_bf16 v[44:59], v[36:39], v[96:99], 0
    ds_read_b128 v[36:39], v95 offset:4096
    s_waitcnt lgkmcnt(5)
    v_mfma_f32_32x32x16_bf16 v[76:91], v[40:43], v[180:183], v[76:91]
    ds_read_b128 v[40:43], v2 offset:4096
    v_mfma_f32_32x32x16_bf16 v[44:59], v[16:19], v[100:103], v[44:59]
    v_mul_f32 v8, v60, v6
    v_mul_f32 v9, v61, v6
    ds_read_b128 v[16:19], v95 offset:5120
    s_waitcnt lgkmcnt(5)
    v_mfma_f32_32x32x16_bf16 v[76:91], v[20:23], v[184:187], v[76:91]
    v_mul_f32 v10, v62, v6
    v_mul_f32 v11, v63, v6
    ds_read_b128 v[20:23], v2 offset:5120
    v_mfma_f32_32x32x16_bf16 v[44:59], v[24:27], v[104:107], v[44:59]
    v_mul_f32 v60, v60, v68
    v_mul_f32 v61, v61, v69
    v_mul_f32 v62, v62, v70
    ds_read_b128 v[24:27], v95 offset:6144
    s_waitcnt lgkmcnt(5)
    v_mfma_f32_32x32x16_bf16 v[76:91], v[28:31], v[188:191], v[76:91]
    v_mul_f32 v63, v63, v71
    ds_read_b128 v[28:31], v2 offset:6144
    v_mfma_f32_32x32x16_bf16 v[44:59], v[32:35], v[108:111], v[44:59]
    v_exp_f32 v8, v8
    ds_read_b128 v[32:35], v95 offset:7168
    s_waitcnt lgkmcnt(5)
    v_mfma_f32_32x32x16_bf16 v[76:91], v[36:39], v[192:195], v[76:91]
    v_exp_f32 v9, v9
    v_exp_f32 v10, v10
    ds_read_b128 v[36:39], v2 offset:7168
    v_mfma_f32_32x32x16_bf16 v[44:59], v[40:43], v[112:115], v[44:59]
    v_exp_f32 v11, v11
    ds_read_b128 v[40:43], v95 offset:8192
    s_waitcnt lgkmcnt(5)
    v_mfma_f32_32x32x16_bf16 v[76:91], v[16:19], v[196:199], v[76:91]
    v_mul_f32 v60, v60, v7
    v_mul_f32 v61, v61, v7
    ds_read_b128 v[16:19], v2 offset:8192
    v_mfma_f32_32x32x16_bf16 v[44:59], v[20:23], v[116:119], v[44:59]
    v_mul_f32 v62, v62, v7
    v_mul_f32 v63, v63, v7
    ds_read_b128 v[20:23], v95 offset:9216
    s_waitcnt lgkmcnt(5)
    v_mfma_f32_32x32x16_bf16 v[76:91], v[24:27], v[200:203], v[76:91]
    v_add_f32 v8, 1.0, v8
    v_add_f32 v9, 1.0, v9
    v_add_f32 v10, 1.0, v10
    ds_read_b128 v[24:27], v2 offset:9216
    v_mfma_f32_32x32x16_bf16 v[44:59], v[28:31], v[120:123], v[44:59]
    v_add_f32 v11, 1.0, v11
    ds_read_b128 v[28:31], v95 offset:10240
    s_waitcnt lgkmcnt(5)
    v_mfma_f32_32x32x16_bf16 v[76:91], v[32:35], v[204:207], v[76:91]
    v_rcp_f32 v8, v8
    ds_read_b128 v[32:35], v2 offset:10240
    v_mfma_f32_32x32x16_bf16 v[44:59], v[36:39], v[124:127], v[44:59]
    v_rcp_f32 v9, v9
    v_rcp_f32 v10, v10
    ds_read_b128 v[36:39], v95 offset:11264
    s_waitcnt lgkmcnt(5)
    v_mfma_f32_32x32x16_bf16 v[76:91], v[40:43], v[208:211], v[76:91]
    v_rcp_f32 v11, v11
    ds_read_b128 v[40:43], v2 offset:11264
    v_mfma_f32_32x32x16_bf16 v[44:59], v[16:19], v[128:131], v[44:59]
    v_mul_f32 v60, v60, v8
    v_mul_f32 v61, v61, v9
    ds_read_b128 v[16:19], v95 offset:12288
    s_waitcnt lgkmcnt(5)
    v_mfma_f32_32x32x16_bf16 v[76:91], v[20:23], v[212:215], v[76:91]
    v_mul_f32 v62, v62, v10
    v_mul_f32 v63, v63, v11
    ds_read_b128 v[20:23], v2 offset:12288
    v_mfma_f32_32x32x16_bf16 v[44:59], v[24:27], v[132:135], v[44:59]
    v_mul_f32 v8, v64, v6
    v_mul_f32 v9, v65, v6
    v_mul_f32 v10, v66, v6
    ds_read_b128 v[24:27], v95 offset:13312
    s_waitcnt lgkmcnt(5)
    v_mfma_f32_32x32x16_bf16 v[76:91], v[28:31], v[216:219], v[76:91]
    v_mul_f32 v11, v67, v6
    v_mul_f32 v64, v64, v72
    ds_read_b128 v[28:31], v2 offset:13312
    v_mfma_f32_32x32x16_bf16 v[44:59], v[32:35], v[136:139], v[44:59]
    v_mul_f32 v65, v65, v73
    v_mul_f32 v66, v66, v74
    ds_read_b128 v[32:35], v95 offset:14336
    s_waitcnt lgkmcnt(5)
    v_mfma_f32_32x32x16_bf16 v[76:91], v[36:39], v[220:223], v[76:91]
    v_mul_f32 v67, v67, v75
    v_exp_f32 v8, v8
    ds_read_b128 v[36:39], v2 offset:14336
    v_mfma_f32_32x32x16_bf16 v[44:59], v[40:43], v[140:143], v[44:59]
    v_exp_f32 v9, v9
    ds_read_b128 v[40:43], v95 offset:15360
    s_waitcnt lgkmcnt(5)
    v_mfma_f32_32x32x16_bf16 v[76:91], v[16:19], v[224:227], v[76:91]
    v_exp_f32 v10, v10
    ds_read_b128 v[16:19], v2 offset:15360
    v_mfma_f32_32x32x16_bf16 v[44:59], v[20:23], v[144:147], v[44:59]
    v_exp_f32 v11, v11
    ds_read_b128 v[20:23], v95 offset:16384
    s_waitcnt lgkmcnt(5)
    v_mfma_f32_32x32x16_bf16 v[76:91], v[24:27], v[228:231], v[76:91]
    v_mul_f32 v64, v64, v7
    v_mul_f32 v65, v65, v7
    v_mul_f32 v66, v66, v7
    ds_read_b128 v[24:27], v2 offset:16384
    v_mfma_f32_32x32x16_bf16 v[44:59], v[28:31], v[148:151], v[44:59]
    v_mul_f32 v67, v67, v7
    v_add_f32 v8, 1.0, v8
    ds_read_b128 v[28:31], v95 offset:17408
    s_waitcnt lgkmcnt(5)
    v_mfma_f32_32x32x16_bf16 v[76:91], v[32:35], v[232:235], v[76:91]
    v_add_f32 v9, 1.0, v9
    v_add_f32 v10, 1.0, v10
    ds_read_b128 v[32:35], v2 offset:17408
    v_mfma_f32_32x32x16_bf16 v[44:59], v[36:39], v[152:155], v[44:59]
    v_add_f32 v11, 1.0, v11
    v_rcp_f32 v8, v8
    ds_read_b128 v[36:39], v95 offset:18432
    s_waitcnt lgkmcnt(5)
    v_mfma_f32_32x32x16_bf16 v[76:91], v[40:43], v[236:239], v[76:91]
    v_rcp_f32 v9, v9
    ds_read_b128 v[40:43], v2 offset:18432
    v_mfma_f32_32x32x16_bf16 v[44:59], v[16:19], v[156:159], v[44:59]
    v_rcp_f32 v10, v10
    ds_read_b128 v[16:19], v95 offset:19456
    s_waitcnt lgkmcnt(5)
    v_mfma_f32_32x32x16_bf16 v[76:91], v[20:23], v[240:243], v[76:91]
    v_rcp_f32 v11, v11
    ds_read_b128 v[20:23], v2 offset:19456
    v_mfma_f32_32x32x16_bf16 v[44:59], v[24:27], v[160:163], v[44:59]
    v_mul_f32 v64, v64, v8
    v_mul_f32 v65, v65, v9
    v_mul_f32 v66, v66, v10
    ds_read_b128 v[24:27], v4 offset:1024
    s_waitcnt lgkmcnt(5)
    v_mfma_f32_32x32x16_bf16 v[76:91], v[28:31], v[244:247], v[76:91]
    v_mul_f32 v67, v67, v11
    v_cvt_pk_bf16_f32 v68, v60, v61
    ds_read_b128 v[28:31], v2 offset:20480
    v_mfma_f32_32x32x16_bf16 v[44:59], v[32:35], v[164:167], v[44:59]
    v_cvt_pk_bf16_f32 v69, v62, v63
    v_cvt_pk_bf16_f32 v70, v64, v65
    ds_read_b128 v[32:35], v2 offset:40960
    s_waitcnt lgkmcnt(5)
    v_mfma_f32_32x32x16_bf16 v[76:91], v[36:39], v[248:251], v[76:91]
    v_cvt_pk_bf16_f32 v71, v66, v67
    s_add_u32 s45, s44, 512
    buffer_store_dwordx4 v[68:71], v5, s[20:23], s45 offen sc1
    ds_read_b128 v[36:39], v2 offset:21504
    v_mfma_f32_32x32x16_bf16 v[44:59], v[40:43], v[168:171], v[44:59]
    ds_read_b128 v[40:43], v2 offset:41984
    s_waitcnt lgkmcnt(5)
    v_mfma_f32_32x32x16_bf16 v[76:91], v[16:19], v[252:255], v[76:91]
    ds_read_b128 v[16:19], v2 offset:22528
    v_mfma_f32_32x32x16_bf16 v[44:59], v[20:23], v[172:175], v[44:59]
    ds_read_b128 v[20:23], v2 offset:43008
    s_waitcnt lgkmcnt(5)
    v_mfma_f32_32x32x16_bf16 v[76:91], v[24:27], v[12:15], v[76:91]
    s_barrier
    ds_read_b128 v[24:27], v2 offset:23552
    v_mfma_f32_32x32x16_bf16 v[44:59], v[28:31], v[176:179], v[44:59]
    ds_read_b128 v[28:31], v2 offset:44032
    s_waitcnt lgkmcnt(5)
    v_mfma_f32_32x32x16_bf16 v[60:75], v[32:35], v[96:99], 0
    ds_read_b128 v[32:35], v2 offset:24576
    v_mfma_f32_32x32x16_bf16 v[44:59], v[36:39], v[180:183], v[44:59]
    ds_read_b128 v[36:39], v2 offset:45056
    s_waitcnt lgkmcnt(5)
    v_mfma_f32_32x32x16_bf16 v[60:75], v[40:43], v[100:103], v[60:75]
    s_nop 0
    v_mul_f32 v8, v76, v6
    v_mul_f32 v9, v77, v6
    ds_read_b128 v[40:43], v2 offset:25600
    v_mfma_f32_32x32x16_bf16 v[44:59], v[16:19], v[184:187], v[44:59]
    v_mul_f32 v10, v78, v6
    v_mul_f32 v11, v79, v6
    ds_read_b128 v[16:19], v2 offset:46080
    s_waitcnt lgkmcnt(5)
    v_mfma_f32_32x32x16_bf16 v[60:75], v[20:23], v[104:107], v[60:75]
    v_mul_f32 v76, v76, v84
    v_mul_f32 v77, v77, v85
    v_mul_f32 v78, v78, v86
    ds_read_b128 v[20:23], v2 offset:26624
    v_mfma_f32_32x32x16_bf16 v[44:59], v[24:27], v[188:191], v[44:59]
    v_mul_f32 v79, v79, v87
    ds_read_b128 v[24:27], v2 offset:47104
    s_waitcnt lgkmcnt(5)
    v_mfma_f32_32x32x16_bf16 v[60:75], v[28:31], v[108:111], v[60:75]
    v_exp_f32 v8, v8
    ds_read_b128 v[28:31], v2 offset:27648
    v_mfma_f32_32x32x16_bf16 v[44:59], v[32:35], v[192:195], v[44:59]
    v_exp_f32 v9, v9
    v_exp_f32 v10, v10
    ds_read_b128 v[32:35], v2 offset:48128
    s_waitcnt lgkmcnt(5)
    v_mfma_f32_32x32x16_bf16 v[60:75], v[36:39], v[112:115], v[60:75]
    v_exp_f32 v11, v11
    ds_read_b128 v[36:39], v2 offset:28672
    v_mfma_f32_32x32x16_bf16 v[44:59], v[40:43], v[196:199], v[44:59]
    v_mul_f32 v76, v76, v7
    v_mul_f32 v77, v77, v7
    ds_read_b128 v[40:43], v2 offset:49152
    s_waitcnt lgkmcnt(5)
    v_mfma_f32_32x32x16_bf16 v[60:75], v[16:19], v[116:119], v[60:75]
    v_mul_f32 v78, v78, v7
    v_mul_f32 v79, v79, v7
    ds_read_b128 v[16:19], v2 offset:29696
    v_mfma_f32_32x32x16_bf16 v[44:59], v[20:23], v[200:203], v[44:59]
    v_add_f32 v8, 1.0, v8
    v_add_f32 v9, 1.0, v9
    v_add_f32 v10, 1.0, v10
    ds_read_b128 v[20:23], v2 offset:50176
    s_waitcnt lgkmcnt(5)
    v_mfma_f32_32x32x16_bf16 v[60:75], v[24:27], v[120:123], v[60:75]
    v_add_f32 v11, 1.0, v11
    ds_read_b128 v[24:27], v2 offset:30720
    v_mfma_f32_32x32x16_bf16 v[44:59], v[28:31], v[204:207], v[44:59]
    v_rcp_f32 v8, v8
    ds_read_b128 v[28:31], v2 offset:51200
    s_waitcnt lgkmcnt(5)
    v_mfma_f32_32x32x16_bf16 v[60:75], v[32:35], v[124:127], v[60:75]
    v_rcp_f32 v9, v9
    v_rcp_f32 v10, v10
    ds_read_b128 v[32:35], v2 offset:31744
    v_mfma_f32_32x32x16_bf16 v[44:59], v[36:39], v[208:211], v[44:59]
    v_rcp_f32 v11, v11
    ds_read_b128 v[36:39], v2 offset:52224
    s_waitcnt lgkmcnt(5)
    v_mfma_f32_32x32x16_bf16 v[60:75], v[40:43], v[128:131], v[60:75]
    v_mul_f32 v76, v76, v8
    v_mul_f32 v77, v77, v9
    ds_read_b128 v[40:43], v2 offset:32768
    v_mfma_f32_32x32x16_bf16 v[44:59], v[16:19], v[212:215], v[44:59]
    v_mul_f32 v78, v78, v10
    v_mul_f32 v79, v79, v11
    ds_read_b128 v[16:19], v2 offset:53248
    s_waitcnt lgkmcnt(5)
    v_mfma_f32_32x32x16_bf16 v[60:75], v[20:23], v[132:135], v[60:75]
    v_mul_f32 v8, v80, v6
    v_mul_f32 v9, v81, v6
    v_mul_f32 v10, v82, v6
    ds_read_b128 v[20:23], v2 offset:33792
    v_mfma_f32_32x32x16_bf16 v[44:59], v[24:27], v[216:219], v[44:59]
    v_mul_f32 v11, v83, v6
    v_mul_f32 v80, v80, v88
    ds_read_b128 v[24:27], v2 offset:54272
    s_waitcnt lgkmcnt(5)
    v_mfma_f32_32x32x16_bf16 v[60:75], v[28:31], v[136:139], v[60:75]
    v_mul_f32 v81, v81, v89
    v_mul_f32 v82, v82, v90
    ds_read_b128 v[28:31], v2 offset:34816
    v_mfma_f32_32x32x16_bf16 v[44:59], v[32:35], v[220:223], v[44:59]
    v_mul_f32 v83, v83, v91
    v_exp_f32 v8, v8
    ds_read_b128 v[32:35], v2 offset:55296
    s_waitcnt lgkmcnt(5)
    v_mfma_f32_32x32x16_bf16 v[60:75], v[36:39], v[140:143], v[60:75]
    v_exp_f32 v9, v9
    ds_read_b128 v[36:39], v2 offset:35840
    v_mfma_f32_32x32x16_bf16 v[44:59], v[40:43], v[224:227], v[44:59]
    v_exp_f32 v10, v10
    ds_read_b128 v[40:43], v2 offset:56320
    s_waitcnt lgkmcnt(5)
    v_mfma_f32_32x32x16_bf16 v[60:75], v[16:19], v[144:147], v[60:75]
    v_exp_f32 v11, v11
    ds_read_b128 v[16:19], v2 offset:36864
    v_mfma_f32_32x32x16_bf16 v[44:59], v[20:23], v[228:231], v[44:59]
    v_mul_f32 v80, v80, v7
    v_mul_f32 v81, v81, v7
    v_mul_f32 v82, v82, v7
    ds_read_b128 v[20:23], v2 offset:57344
    s_waitcnt lgkmcnt(5)
    v_mfma_f32_32x32x16_bf16 v[60:75], v[24:27], v[148:151], v[60:75]
    v_mul_f32 v83, v83, v7
    v_add_f32 v8, 1.0, v8
    ds_read_b128 v[24:27], v2 offset:37888
    v_mfma_f32_32x32x16_bf16 v[44:59], v[28:31], v[232:235], v[44:59]
    v_add_f32 v9, 1.0, v9
    v_add_f32 v10, 1.0, v10
    ds_read_b128 v[28:31], v2 offset:58368
    s_waitcnt lgkmcnt(5)
    v_mfma_f32_32x32x16_bf16 v[60:75], v[32:35], v[152:155], v[60:75]
    v_add_f32 v11, 1.0, v11
    v_rcp_f32 v8, v8
    ds_read_b128 v[32:35], v2 offset:38912
    v_mfma_f32_32x32x16_bf16 v[44:59], v[36:39], v[236:239], v[44:59]
    v_rcp_f32 v9, v9
    ds_read_b128 v[36:39], v2 offset:59392
    s_waitcnt lgkmcnt(5)
    v_mfma_f32_32x32x16_bf16 v[60:75], v[40:43], v[156:159], v[60:75]
    v_rcp_f32 v10, v10
    ds_read_b128 v[40:43], v2 offset:39936
    v_mfma_f32_32x32x16_bf16 v[44:59], v[16:19], v[240:243], v[44:59]
    v_rcp_f32 v11, v11
    ds_read_b128 v[16:19], v2 offset:60416
    s_waitcnt lgkmcnt(5)
    v_mfma_f32_32x32x16_bf16 v[60:75], v[20:23], v[160:163], v[60:75]
    v_mul_f32 v80, v80, v8
    v_mul_f32 v81, v81, v9
    v_mul_f32 v82, v82, v10
    ds_read_b128 v[20:23], v4 offset:1536
    v_mfma_f32_32x32x16_bf16 v[44:59], v[24:27], v[244:247], v[44:59]
    v_mul_f32 v83, v83, v11
    v_cvt_pk_bf16_f32 v84, v76, v77
    ds_read_b128 v[24:27], v3 offset:0
    s_waitcnt lgkmcnt(5)
    v_mfma_f32_32x32x16_bf16 v[60:75], v[28:31], v[164:167], v[60:75]
    v_cvt_pk_bf16_f32 v85, v78, v79
    v_cvt_pk_bf16_f32 v86, v80, v81
    ds_read_b128 v[28:31], v3 offset:20480
    v_mfma_f32_32x32x16_bf16 v[44:59], v[32:35], v[248:251], v[44:59]
    v_cvt_pk_bf16_f32 v87, v82, v83
    s_add_u32 s45, s44, 1024
    buffer_store_dwordx4 v[84:87], v5, s[20:23], s45 offen sc1
    ds_read_b128 v[32:35], v3 offset:1024
    s_waitcnt lgkmcnt(5)
    v_mfma_f32_32x32x16_bf16 v[60:75], v[36:39], v[168:171], v[60:75]
    ds_read_b128 v[36:39], v3 offset:21504
    v_mfma_f32_32x32x16_bf16 v[44:59], v[40:43], v[252:255], v[44:59]
    ds_read_b128 v[40:43], v3 offset:2048
    s_waitcnt lgkmcnt(5)
    v_mfma_f32_32x32x16_bf16 v[60:75], v[16:19], v[172:175], v[60:75]
    ds_read_b128 v[16:19], v3 offset:22528
    v_mfma_f32_32x32x16_bf16 v[44:59], v[20:23], v[12:15], v[44:59]
    s_barrier
    ds_read_b128 v[20:23], v3 offset:3072
    s_waitcnt lgkmcnt(5)
    v_mfma_f32_32x32x16_bf16 v[60:75], v[24:27], v[176:179], v[60:75]
    ds_read_b128 v[24:27], v3 offset:23552
    v_mfma_f32_32x32x16_bf16 v[76:91], v[28:31], v[96:99], 0
    ds_read_b128 v[28:31], v3 offset:4096
    s_waitcnt lgkmcnt(5)
    v_mfma_f32_32x32x16_bf16 v[60:75], v[32:35], v[180:183], v[60:75]
    ds_read_b128 v[32:35], v3 offset:24576
    v_mfma_f32_32x32x16_bf16 v[76:91], v[36:39], v[100:103], v[76:91]
    s_nop 0
    v_mul_f32 v8, v44, v6
    v_mul_f32 v9, v45, v6
    ds_read_b128 v[36:39], v3 offset:5120
    s_waitcnt lgkmcnt(5)
    v_mfma_f32_32x32x16_bf16 v[60:75], v[40:43], v[184:187], v[60:75]
    v_mul_f32 v10, v46, v6
    v_mul_f32 v11, v47, v6
    ds_read_b128 v[40:43], v3 offset:25600
    v_mfma_f32_32x32x16_bf16 v[76:91], v[16:19], v[104:107], v[76:91]
    v_mul_f32 v44, v44, v52
    v_mul_f32 v45, v45, v53
    v_mul_f32 v46, v46, v54
    ds_read_b128 v[16:19], v3 offset:6144
    s_waitcnt lgkmcnt(5)
    v_mfma_f32_32x32x16_bf16 v[60:75], v[20:23], v[188:191], v[60:75]
    v_mul_f32 v47, v47, v55
    ds_read_b128 v[20:23], v3 offset:26624
    v_mfma_f32_32x32x16_bf16 v[76:91], v[24:27], v[108:111], v[76:91]
    v_exp_f32 v8, v8
    ds_read_b128 v[24:27], v3 offset:7168
    s_waitcnt lgkmcnt(5)
    v_mfma_f32_32x32x16_bf16 v[60:75], v[28:31], v[192:195], v[60:75]
    v_exp_f32 v9, v9
    v_exp_f32 v10, v10
    ds_read_b128 v[28:31], v3 offset:27648
    v_mfma_f32_32x32x16_bf16 v[76:91], v[32:35], v[112:115], v[76:91]
    v_exp_f32 v11, v11
    ds_read_b128 v[32:35], v3 offset:8192
    s_waitcnt lgkmcnt(5)
    v_mfma_f32_32x32x16_bf16 v[60:75], v[36:39], v[196:199], v[60:75]
    v_mul_f32 v44, v44, v7
    v_mul_f32 v45, v45, v7
    ds_read_b128 v[36:39], v3 offset:28672
    v_mfma_f32_32x32x16_bf16 v[76:91], v[40:43], v[116:119], v[76:91]
    v_mul_f32 v46, v46, v7
    v_mul_f32 v47, v47, v7
    ds_read_b128 v[40:43], v3 offset:9216
    s_waitcnt lgkmcnt(5)
    v_mfma_f32_32x32x16_bf16 v[60:75], v[16:19], v[200:203], v[60:75]
    v_add_f32 v8, 1.0, v8
    v_add_f32 v9, 1.0, v9
    v_add_f32 v10, 1.0, v10
    ds_read_b128 v[16:19], v3 offset:29696
    v_mfma_f32_32x32x16_bf16 v[76:91], v[20:23], v[120:123], v[76:91]
    v_add_f32 v11, 1.0, v11
    ds_read_b128 v[20:23], v3 offset:10240
    s_waitcnt lgkmcnt(5)
    v_mfma_f32_32x32x16_bf16 v[60:75], v[24:27], v[204:207], v[60:75]
    v_rcp_f32 v8, v8
    ds_read_b128 v[24:27], v3 offset:30720
    v_mfma_f32_32x32x16_bf16 v[76:91], v[28:31], v[124:127], v[76:91]
    v_rcp_f32 v9, v9
    v_rcp_f32 v10, v10
    ds_read_b128 v[28:31], v3 offset:11264
    s_waitcnt lgkmcnt(5)
    v_mfma_f32_32x32x16_bf16 v[60:75], v[32:35], v[208:211], v[60:75]
    v_rcp_f32 v11, v11
    ds_read_b128 v[32:35], v3 offset:31744
    v_mfma_f32_32x32x16_bf16 v[76:91], v[36:39], v[128:131], v[76:91]
    v_mul_f32 v44, v44, v8
    v_mul_f32 v45, v45, v9
    ds_read_b128 v[36:39], v3 offset:12288
    s_waitcnt lgkmcnt(5)
    v_mfma_f32_32x32x16_bf16 v[60:75], v[40:43], v[212:215], v[60:75]
    v_mul_f32 v46, v46, v10
    v_mul_f32 v47, v47, v11
    ds_read_b128 v[40:43], v3 offset:32768
    v_mfma_f32_32x32x16_bf16 v[76:91], v[16:19], v[132:135], v[76:91]
    v_mul_f32 v8, v48, v6
    v_mul_f32 v9, v49, v6
    v_mul_f32 v10, v50, v6
    ds_read_b128 v[16:19], v3 offset:13312
    s_waitcnt lgkmcnt(5)
    v_mfma_f32_32x32x16_bf16 v[60:75], v[20:23], v[216:219], v[60:75]
    v_mul_f32 v11, v51, v6
    v_mul_f32 v48, v48, v56
    ds_read_b128 v[20:23], v3 offset:33792
    v_mfma_f32_32x32x16_bf16 v[76:91], v[24:27], v[136:139], v[76:91]
    v_mul_f32 v49, v49, v57
    v_mul_f32 v50, v50, v58
    ds_read_b128 v[24:27], v3 offset:14336
    s_waitcnt lgkmcnt(5)
    v_mfma_f32_32x32x16_bf16 v[60:75], v[28:31], v[220:223], v[60:75]
    v_mul_f32 v51, v51, v59
    v_exp_f32 v8, v8
    ds_read_b128 v[28:31], v3 offset:34816
    v_mfma_f32_32x32x16_bf16 v[76:91], v[32:35], v[140:143], v[76:91]
    v_exp_f32 v9, v9
    ds_read_b128 v[32:35], v3 offset:15360
    s_waitcnt lgkmcnt(5)
    v_mfma_f32_32x32x16_bf16 v[60:75], v[36:39], v[224:227], v[60:75]
    v_exp_f32 v10, v10
    ds_read_b128 v[36:39], v3 offset:35840
    v_mfma_f32_32x32x16_bf16 v[76:91], v[40:43], v[144:147], v[76:91]
    v_exp_f32 v11, v11
    ds_read_b128 v[40:43], v3 offset:16384
    s_waitcnt lgkmcnt(5)
    v_mfma_f32_32x32x16_bf16 v[60:75], v[16:19], v[228:231], v[60:75]
    v_mul_f32 v48, v48, v7
    v_mul_f32 v49, v49, v7
    v_mul_f32 v50, v50, v7
    ds_read_b128 v[16:19], v3 offset:36864
    v_mfma_f32_32x32x16_bf16 v[76:91], v[20:23], v[148:151], v[76:91]
    v_mul_f32 v51, v51, v7
    v_add_f32 v8, 1.0, v8
    ds_read_b128 v[20:23], v3 offset:17408
    s_waitcnt lgkmcnt(5)
    v_mfma_f32_32x32x16_bf16 v[60:75], v[24:27], v[232:235], v[60:75]
    v_add_f32 v9, 1.0, v9
    v_add_f32 v10, 1.0, v10
    ds_read_b128 v[24:27], v3 offset:37888
    v_mfma_f32_32x32x16_bf16 v[76:91], v[28:31], v[152:155], v[76:91]
    v_add_f32 v11, 1.0, v11
    v_rcp_f32 v8, v8
    ds_read_b128 v[28:31], v3 offset:18432
    s_waitcnt lgkmcnt(5)
    v_mfma_f32_32x32x16_bf16 v[60:75], v[32:35], v[236:239], v[60:75]
    v_rcp_f32 v9, v9
    ds_read_b128 v[32:35], v3 offset:38912
    v_mfma_f32_32x32x16_bf16 v[76:91], v[36:39], v[156:159], v[76:91]
    v_rcp_f32 v10, v10
    ds_read_b128 v[36:39], v3 offset:19456
    s_waitcnt lgkmcnt(5)
    v_mfma_f32_32x32x16_bf16 v[60:75], v[40:43], v[240:243], v[60:75]
    v_rcp_f32 v11, v11
    ds_read_b128 v[40:43], v3 offset:39936
    v_mfma_f32_32x32x16_bf16 v[76:91], v[16:19], v[160:163], v[76:91]
    v_mul_f32 v48, v48, v8
    v_mul_f32 v49, v49, v9
    v_mul_f32 v50, v50, v10
    ds_read_b128 v[16:19], v4 offset:2048
    s_waitcnt lgkmcnt(5)
    v_mfma_f32_32x32x16_bf16 v[60:75], v[20:23], v[244:247], v[60:75]
    v_mul_f32 v51, v51, v11
    v_cvt_pk_bf16_f32 v52, v44, v45
    v_mfma_f32_32x32x16_bf16 v[76:91], v[24:27], v[164:167], v[76:91]
    v_cvt_pk_bf16_f32 v53, v46, v47
    v_cvt_pk_bf16_f32 v54, v48, v49
    s_waitcnt lgkmcnt(3)
    v_mfma_f32_32x32x16_bf16 v[60:75], v[28:31], v[248:251], v[60:75]
    v_cvt_pk_bf16_f32 v55, v50, v51
    s_add_u32 s45, s44, 1536
    buffer_store_dwordx4 v[52:55], v5, s[20:23], s45 offen sc1
    v_mfma_f32_32x32x16_bf16 v[76:91], v[32:35], v[168:171], v[76:91]
    s_waitcnt lgkmcnt(1)
    v_mfma_f32_32x32x16_bf16 v[60:75], v[36:39], v[252:255], v[60:75]
    v_mfma_f32_32x32x16_bf16 v[76:91], v[40:43], v[172:175], v[76:91]
    s_waitcnt lgkmcnt(0)
    v_mfma_f32_32x32x16_bf16 v[60:75], v[16:19], v[12:15], v[60:75]
    s_cmp_eq_u32 s54, 6
    s_cbranch_scc1 adaLN_cond__grouped_kv_mqa__glu_gated_swiglu__prompt_kernel_e_tail6_154
    s_barrier
    ds_read_b128 v[20:23], v3 offset:40960
    ds_read_b128 v[24:27], v95 offset:0
    ds_read_b128 v[28:31], v3 offset:41984
    ds_read_b128 v[32:35], v95 offset:1024
    ds_read_b128 v[36:39], v3 offset:43008
    ds_read_b128 v[40:43], v95 offset:2048
    ds_read_b128 v[16:19], v3 offset:44032
    s_waitcnt lgkmcnt(6)
    v_mfma_f32_32x32x16_bf16 v[76:91], v[20:23], v[176:179], v[76:91]
    ds_read_b128 v[20:23], v95 offset:3072
    s_waitcnt lgkmcnt(5)
    v_mfma_f32_32x32x16_bf16 v[44:59], v[24:27], v[96:99], 0
    ds_read_b128 v[24:27], v3 offset:45056
    v_mfma_f32_32x32x16_bf16 v[76:91], v[28:31], v[180:183], v[76:91]
    ds_read_b128 v[28:31], v95 offset:4096
    s_waitcnt lgkmcnt(5)
    v_mfma_f32_32x32x16_bf16 v[44:59], v[32:35], v[100:103], v[44:59]
    v_mul_f32 v8, v60, v6
    v_mul_f32 v9, v61, v6
    ds_read_b128 v[32:35], v3 offset:46080
    v_mfma_f32_32x32x16_bf16 v[76:91], v[36:39], v[184:187], v[76:91]
    v_mul_f32 v10, v62, v6
    v_mul_f32 v11, v63, v6
    ds_read_b128 v[36:39], v95 offset:5120
    s_waitcnt lgkmcnt(5)
    v_mfma_f32_32x32x16_bf16 v[44:59], v[40:43], v[104:107], v[44:59]
    v_mul_f32 v60, v60, v68
    v_mul_f32 v61, v61, v69
    v_mul_f32 v62, v62, v70
    ds_read_b128 v[40:43], v3 offset:47104
    v_mfma_f32_32x32x16_bf16 v[76:91], v[16:19], v[188:191], v[76:91]
    v_mul_f32 v63, v63, v71
    ds_read_b128 v[16:19], v95 offset:6144
    s_waitcnt lgkmcnt(5)
    v_mfma_f32_32x32x16_bf16 v[44:59], v[20:23], v[108:111], v[44:59]
    v_exp_f32 v8, v8
    ds_read_b128 v[20:23], v3 offset:48128
    v_mfma_f32_32x32x16_bf16 v[76:91], v[24:27], v[192:195], v[76:91]
    v_exp_f32 v9, v9
    v_exp_f32 v10, v10
    ds_read_b128 v[24:27], v95 offset:7168
    s_waitcnt lgkmcnt(5)
    v_mfma_f32_32x32x16_bf16 v[44:59], v[28:31], v[112:115], v[44:59]
    v_exp_f32 v11, v11
    ds_read_b128 v[28:31], v3 offset:49152
    v_mfma_f32_32x32x16_bf16 v[76:91], v[32:35], v[196:199], v[76:91]
    v_mul_f32 v60, v60, v7
    v_mul_f32 v61, v61, v7
    ds_read_b128 v[32:35], v95 offset:8192
    s_waitcnt lgkmcnt(5)
    v_mfma_f32_32x32x16_bf16 v[44:59], v[36:39], v[116:119], v[44:59]
    v_mul_f32 v62, v62, v7
    v_mul_f32 v63, v63, v7
    ds_read_b128 v[36:39], v3 offset:50176
    v_mfma_f32_32x32x16_bf16 v[76:91], v[40:43], v[200:203], v[76:91]
    v_add_f32 v8, 1.0, v8
    v_add_f32 v9, 1.0, v9
    v_add_f32 v10, 1.0, v10
    ds_read_b128 v[40:43], v95 offset:9216
    s_waitcnt lgkmcnt(5)
    v_mfma_f32_32x32x16_bf16 v[44:59], v[16:19], v[120:123], v[44:59]
    v_add_f32 v11, 1.0, v11
    ds_read_b128 v[16:19], v3 offset:51200
    v_mfma_f32_32x32x16_bf16 v[76:91], v[20:23], v[204:207], v[76:91]
    v_rcp_f32 v8, v8
    ds_read_b128 v[20:23], v95 offset:10240
    s_waitcnt lgkmcnt(5)
    v_mfma_f32_32x32x16_bf16 v[44:59], v[24:27], v[124:127], v[44:59]
    v_rcp_f32 v9, v9
    v_rcp_f32 v10, v10
    ds_read_b128 v[24:27], v3 offset:52224
    v_mfma_f32_32x32x16_bf16 v[76:91], v[28:31], v[208:211], v[76:91]
    v_rcp_f32 v11, v11
    ds_read_b128 v[28:31], v95 offset:11264
    s_waitcnt lgkmcnt(5)
    v_mfma_f32_32x32x16_bf16 v[44:59], v[32:35], v[128:131], v[44:59]
    v_mul_f32 v60, v60, v8
    v_mul_f32 v61, v61, v9
    ds_read_b128 v[32:35], v3 offset:53248
    v_mfma_f32_32x32x16_bf16 v[76:91], v[36:39], v[212:215], v[76:91]
    v_mul_f32 v62, v62, v10
    v_mul_f32 v63, v63, v11
    ds_read_b128 v[36:39], v95 offset:12288
    s_waitcnt lgkmcnt(5)
    v_mfma_f32_32x32x16_bf16 v[44:59], v[40:43], v[132:135], v[44:59]
    v_mul_f32 v8, v64, v6
    v_mul_f32 v9, v65, v6
    v_mul_f32 v10, v66, v6
    ds_read_b128 v[40:43], v3 offset:54272
    v_mfma_f32_32x32x16_bf16 v[76:91], v[16:19], v[216:219], v[76:91]
    v_mul_f32 v11, v67, v6
    v_mul_f32 v64, v64, v72
    ds_read_b128 v[16:19], v95 offset:13312
    s_waitcnt lgkmcnt(5)
    v_mfma_f32_32x32x16_bf16 v[44:59], v[20:23], v[136:139], v[44:59]
    v_mul_f32 v65, v65, v73
    v_mul_f32 v66, v66, v74
    ds_read_b128 v[20:23], v3 offset:55296
    v_mfma_f32_32x32x16_bf16 v[76:91], v[24:27], v[220:223], v[76:91]
    v_mul_f32 v67, v67, v75
    v_exp_f32 v8, v8
    ds_read_b128 v[24:27], v95 offset:14336
    s_waitcnt lgkmcnt(5)
    v_mfma_f32_32x32x16_bf16 v[44:59], v[28:31], v[140:143], v[44:59]
    v_exp_f32 v9, v9
    ds_read_b128 v[28:31], v3 offset:56320
    v_mfma_f32_32x32x16_bf16 v[76:91], v[32:35], v[224:227], v[76:91]
    v_exp_f32 v10, v10
    ds_read_b128 v[32:35], v95 offset:15360
    s_waitcnt lgkmcnt(5)
    v_mfma_f32_32x32x16_bf16 v[44:59], v[36:39], v[144:147], v[44:59]
    v_exp_f32 v11, v11
    ds_read_b128 v[36:39], v3 offset:57344
    v_mfma_f32_32x32x16_bf16 v[76:91], v[40:43], v[228:231], v[76:91]
    v_mul_f32 v64, v64, v7
    v_mul_f32 v65, v65, v7
    v_mul_f32 v66, v66, v7
    ds_read_b128 v[40:43], v95 offset:16384
    s_waitcnt lgkmcnt(5)
    v_mfma_f32_32x32x16_bf16 v[44:59], v[16:19], v[148:151], v[44:59]
    v_mul_f32 v67, v67, v7
    v_add_f32 v8, 1.0, v8
    ds_read_b128 v[16:19], v3 offset:58368
    v_mfma_f32_32x32x16_bf16 v[76:91], v[20:23], v[232:235], v[76:91]
    v_add_f32 v9, 1.0, v9
    v_add_f32 v10, 1.0, v10
    ds_read_b128 v[20:23], v95 offset:17408
    s_waitcnt lgkmcnt(5)
    v_mfma_f32_32x32x16_bf16 v[44:59], v[24:27], v[152:155], v[44:59]
    v_add_f32 v11, 1.0, v11
    v_rcp_f32 v8, v8
    ds_read_b128 v[24:27], v3 offset:59392
    v_mfma_f32_32x32x16_bf16 v[76:91], v[28:31], v[236:239], v[76:91]
    v_rcp_f32 v9, v9
    ds_read_b128 v[28:31], v95 offset:18432
    s_waitcnt lgkmcnt(5)
    v_mfma_f32_32x32x16_bf16 v[44:59], v[32:35], v[156:159], v[44:59]
    v_rcp_f32 v10, v10
    ds_read_b128 v[32:35], v3 offset:60416
    v_mfma_f32_32x32x16_bf16 v[76:91], v[36:39], v[240:243], v[76:91]
    v_rcp_f32 v11, v11
    ds_read_b128 v[36:39], v95 offset:19456
    s_waitcnt lgkmcnt(5)
    v_mfma_f32_32x32x16_bf16 v[44:59], v[40:43], v[160:163], v[44:59]
    v_mul_f32 v64, v64, v8
    v_mul_f32 v65, v65, v9
    v_mul_f32 v66, v66, v10
    ds_read_b128 v[40:43], v4 offset:2560
    v_mfma_f32_32x32x16_bf16 v[76:91], v[16:19], v[244:247], v[76:91]
    v_mul_f32 v67, v67, v11
    v_cvt_pk_bf16_f32 v68, v60, v61
    ds_read_b128 v[16:19], v2 offset:0
    s_waitcnt lgkmcnt(5)
    v_mfma_f32_32x32x16_bf16 v[44:59], v[20:23], v[164:167], v[44:59]
    v_cvt_pk_bf16_f32 v69, v62, v63
    v_cvt_pk_bf16_f32 v70, v64, v65
    ds_read_b128 v[20:23], v2 offset:1024
    v_mfma_f32_32x32x16_bf16 v[76:91], v[24:27], v[248:251], v[76:91]
    v_cvt_pk_bf16_f32 v71, v66, v67
    s_add_u32 s45, s44, 2048
    buffer_store_dwordx4 v[68:71], v5, s[20:23], s45 offen sc1
    ds_read_b128 v[24:27], v2 offset:2048
    s_waitcnt lgkmcnt(5)
    v_mfma_f32_32x32x16_bf16 v[44:59], v[28:31], v[168:171], v[44:59]
    ds_read_b128 v[28:31], v2 offset:3072
    v_mfma_f32_32x32x16_bf16 v[76:91], v[32:35], v[252:255], v[76:91]
    ds_read_b128 v[32:35], v2 offset:4096
    s_waitcnt lgkmcnt(5)
    v_mfma_f32_32x32x16_bf16 v[44:59], v[36:39], v[172:175], v[44:59]
    ds_read_b128 v[36:39], v2 offset:5120
    v_mfma_f32_32x32x16_bf16 v[76:91], v[40:43], v[12:15], v[76:91]
    s_barrier
    ds_read_b128 v[40:43], v2 offset:6144
    s_waitcnt lgkmcnt(5)
    v_mfma_f32_32x32x16_bf16 v[44:59], v[16:19], v[176:179], v[44:59]
    ds_read_b128 v[16:19], v2 offset:7168
    v_mfma_f32_32x32x16_bf16 v[44:59], v[20:23], v[180:183], v[44:59]
    ds_read_b128 v[20:23], v2 offset:8192
    s_waitcnt lgkmcnt(5)
    v_mfma_f32_32x32x16_bf16 v[44:59], v[24:27], v[184:187], v[44:59]
    ds_read_b128 v[24:27], v2 offset:9216
    v_mfma_f32_32x32x16_bf16 v[44:59], v[28:31], v[188:191], v[44:59]
    s_nop 0
    v_mul_f32 v8, v76, v6
    v_mul_f32 v9, v77, v6
    v_mul_f32 v10, v78, v6
    v_mul_f32 v11, v79, v6
    v_mul_f32 v76, v76, v84
    ds_read_b128 v[28:31], v2 offset:10240
    s_waitcnt lgkmcnt(5)
    v_mfma_f32_32x32x16_bf16 v[44:59], v[32:35], v[192:195], v[44:59]
    v_mul_f32 v77, v77, v85
    v_mul_f32 v78, v78, v86
    v_mul_f32 v79, v79, v87
    v_exp_f32 v8, v8
    ds_read_b128 v[32:35], v2 offset:11264
    v_mfma_f32_32x32x16_bf16 v[44:59], v[36:39], v[196:199], v[44:59]
    v_exp_f32 v9, v9
    v_exp_f32 v10, v10
    v_exp_f32 v11, v11
    ds_read_b128 v[36:39], v2 offset:12288
    s_waitcnt lgkmcnt(5)
    v_mfma_f32_32x32x16_bf16 v[44:59], v[40:43], v[200:203], v[44:59]
    v_mul_f32 v76, v76, v7
    v_mul_f32 v77, v77, v7
    v_mul_f32 v78, v78, v7
    v_mul_f32 v79, v79, v7
    v_add_f32 v8, 1.0, v8
    v_add_f32 v9, 1.0, v9
    ds_read_b128 v[40:43], v2 offset:13312
    v_mfma_f32_32x32x16_bf16 v[44:59], v[16:19], v[204:207], v[44:59]
    v_add_f32 v10, 1.0, v10
    v_add_f32 v11, 1.0, v11
    v_rcp_f32 v8, v8
    v_rcp_f32 v9, v9
    ds_read_b128 v[16:19], v2 offset:14336
    s_waitcnt lgkmcnt(5)
    v_mfma_f32_32x32x16_bf16 v[44:59], v[20:23], v[208:211], v[44:59]
    v_rcp_f32 v10, v10
    v_rcp_f32 v11, v11
    v_mul_f32 v76, v76, v8
    ds_read_b128 v[20:23], v2 offset:15360
    v_mfma_f32_32x32x16_bf16 v[44:59], v[24:27], v[212:215], v[44:59]
    v_mul_f32 v77, v77, v9
    v_mul_f32 v78, v78, v10
    v_mul_f32 v79, v79, v11
    v_mul_f32 v8, v80, v6
    v_mul_f32 v9, v81, v6
    v_mul_f32 v10, v82, v6
    ds_read_b128 v[24:27], v2 offset:16384
    s_waitcnt lgkmcnt(5)
    v_mfma_f32_32x32x16_bf16 v[44:59], v[28:31], v[216:219], v[44:59]
    v_mul_f32 v11, v83, v6
    v_mul_f32 v80, v80, v88
    v_mul_f32 v81, v81, v89
    v_mul_f32 v82, v82, v90
    v_mul_f32 v83, v83, v91
    ds_read_b128 v[28:31], v2 offset:17408
    v_mfma_f32_32x32x16_bf16 v[44:59], v[32:35], v[220:223], v[44:59]
    v_exp_f32 v8, v8
    v_exp_f32 v9, v9
    v_exp_f32 v10, v10
    ds_read_b128 v[32:35], v2 offset:18432
    s_waitcnt lgkmcnt(5)
    v_mfma_f32_32x32x16_bf16 v[44:59], v[36:39], v[224:227], v[44:59]
    v_exp_f32 v11, v11
    v_mul_f32 v80, v80, v7
    v_mul_f32 v81, v81, v7
    v_mul_f32 v82, v82, v7
    ds_read_b128 v[36:39], v2 offset:19456
    v_mfma_f32_32x32x16_bf16 v[44:59], v[40:43], v[228:231], v[44:59]
    v_mul_f32 v83, v83, v7
    v_add_f32 v8, 1.0, v8
    v_add_f32 v9, 1.0, v9
    v_add_f32 v10, 1.0, v10
    v_add_f32 v11, 1.0, v11
    ds_read_b128 v[40:43], v4 offset:3072
    s_waitcnt lgkmcnt(5)
    v_mfma_f32_32x32x16_bf16 v[44:59], v[16:19], v[232:235], v[44:59]
    v_rcp_f32 v8, v8
    v_rcp_f32 v9, v9
    v_rcp_f32 v10, v10
    v_mfma_f32_32x32x16_bf16 v[44:59], v[20:23], v[236:239], v[44:59]
    v_rcp_f32 v11, v11
    v_mul_f32 v80, v80, v8
    v_mul_f32 v81, v81, v9
    v_mul_f32 v82, v82, v10
    v_mul_f32 v83, v83, v11
    s_waitcnt lgkmcnt(3)
    v_mfma_f32_32x32x16_bf16 v[44:59], v[24:27], v[240:243], v[44:59]
    v_cvt_pk_bf16_f32 v84, v76, v77
    v_cvt_pk_bf16_f32 v85, v78, v79
    v_cvt_pk_bf16_f32 v86, v80, v81
    v_cvt_pk_bf16_f32 v87, v82, v83
    s_add_u32 s45, s44, 2560
    buffer_store_dwordx4 v[84:87], v5, s[20:23], s45 offen sc1
    v_mfma_f32_32x32x16_bf16 v[44:59], v[28:31], v[244:247], v[44:59]
    s_waitcnt lgkmcnt(1)
    v_mfma_f32_32x32x16_bf16 v[44:59], v[32:35], v[248:251], v[44:59]
    v_mfma_f32_32x32x16_bf16 v[44:59], v[36:39], v[252:255], v[44:59]
    s_waitcnt lgkmcnt(0)
    v_mfma_f32_32x32x16_bf16 v[44:59], v[40:43], v[12:15], v[44:59]
    s_nop 11
    v_mul_f32 v8, v44, v6
    v_mul_f32 v9, v45, v6
    v_mul_f32 v10, v46, v6
    v_mul_f32 v11, v47, v6
    v_mul_f32 v44, v44, v52
    v_mul_f32 v45, v45, v53
    v_mul_f32 v46, v46, v54
    v_mul_f32 v47, v47, v55
    v_exp_f32 v8, v8
    v_exp_f32 v9, v9
    v_exp_f32 v10, v10
    v_exp_f32 v11, v11
    v_mul_f32 v44, v44, v7
    v_mul_f32 v45, v45, v7
    v_mul_f32 v46, v46, v7
    v_mul_f32 v47, v47, v7
    v_add_f32 v8, 1.0, v8
    v_add_f32 v9, 1.0, v9
    v_add_f32 v10, 1.0, v10
    v_add_f32 v11, 1.0, v11
    v_rcp_f32 v8, v8
    v_rcp_f32 v9, v9
    v_rcp_f32 v10, v10
    v_rcp_f32 v11, v11
    v_mul_f32 v44, v44, v8
    v_mul_f32 v45, v45, v9
    v_mul_f32 v46, v46, v10
    v_mul_f32 v47, v47, v11
    v_mul_f32 v8, v48, v6
    v_mul_f32 v9, v49, v6
    v_mul_f32 v10, v50, v6
    v_mul_f32 v11, v51, v6
    v_mul_f32 v48, v48, v56
    v_mul_f32 v49, v49, v57
    v_mul_f32 v50, v50, v58
    v_mul_f32 v51, v51, v59
    v_exp_f32 v8, v8
    v_exp_f32 v9, v9
    v_exp_f32 v10, v10
    v_exp_f32 v11, v11
    v_mul_f32 v48, v48, v7
    v_mul_f32 v49, v49, v7
    v_mul_f32 v50, v50, v7
    v_mul_f32 v51, v51, v7
    v_add_f32 v8, 1.0, v8
    v_add_f32 v9, 1.0, v9
    v_add_f32 v10, 1.0, v10
    v_add_f32 v11, 1.0, v11
    v_rcp_f32 v8, v8
    v_rcp_f32 v9, v9
    v_rcp_f32 v10, v10
    v_rcp_f32 v11, v11
    v_mul_f32 v48, v48, v8
    v_mul_f32 v49, v49, v9
    v_mul_f32 v50, v50, v10
    v_mul_f32 v51, v51, v11
    v_cvt_pk_bf16_f32 v52, v44, v45
    v_cvt_pk_bf16_f32 v53, v46, v47
    v_cvt_pk_bf16_f32 v54, v48, v49
    v_cvt_pk_bf16_f32 v55, v50, v51
    s_add_u32 s45, s44, 3072
    buffer_store_dwordx4 v[52:55], v5, s[20:23], s45 offen sc1
    s_branch adaLN_cond__grouped_kv_mqa__glu_gated_swiglu__prompt_kernel_e_done_148
adaLN_cond__grouped_kv_mqa__glu_gated_swiglu__prompt_kernel_e_tail6_154:
    s_barrier
    ds_read_b128 v[20:23], v3 offset:40960
    ds_read_b128 v[24:27], v3 offset:41984
    ds_read_b128 v[28:31], v3 offset:43008
    ds_read_b128 v[32:35], v3 offset:44032
    ds_read_b128 v[36:39], v3 offset:45056
    ds_read_b128 v[40:43], v3 offset:46080
    ds_read_b128 v[16:19], v3 offset:47104
    s_waitcnt lgkmcnt(6)
    v_mfma_f32_32x32x16_bf16 v[76:91], v[20:23], v[176:179], v[76:91]
    ds_read_b128 v[20:23], v3 offset:48128
    s_waitcnt lgkmcnt(5)
    v_mfma_f32_32x32x16_bf16 v[76:91], v[24:27], v[180:183], v[76:91]
    ds_read_b128 v[24:27], v3 offset:49152
    v_mfma_f32_32x32x16_bf16 v[76:91], v[28:31], v[184:187], v[76:91]
    ds_read_b128 v[28:31], v3 offset:50176
    s_waitcnt lgkmcnt(5)
    v_mfma_f32_32x32x16_bf16 v[76:91], v[32:35], v[188:191], v[76:91]
    v_mul_f32 v8, v60, v6
    v_mul_f32 v9, v61, v6
    v_mul_f32 v10, v62, v6
    v_mul_f32 v11, v63, v6
    v_mul_f32 v60, v60, v68
    ds_read_b128 v[32:35], v3 offset:51200
    v_mfma_f32_32x32x16_bf16 v[76:91], v[36:39], v[192:195], v[76:91]
    v_mul_f32 v61, v61, v69
    v_mul_f32 v62, v62, v70
    v_mul_f32 v63, v63, v71
    v_exp_f32 v8, v8
    ds_read_b128 v[36:39], v3 offset:52224
    s_waitcnt lgkmcnt(5)
    v_mfma_f32_32x32x16_bf16 v[76:91], v[40:43], v[196:199], v[76:91]
    v_exp_f32 v9, v9
    v_exp_f32 v10, v10
    v_exp_f32 v11, v11
    ds_read_b128 v[40:43], v3 offset:53248
    v_mfma_f32_32x32x16_bf16 v[76:91], v[16:19], v[200:203], v[76:91]
    v_mul_f32 v60, v60, v7
    v_mul_f32 v61, v61, v7
    v_mul_f32 v62, v62, v7
    v_mul_f32 v63, v63, v7
    v_add_f32 v8, 1.0, v8
    v_add_f32 v9, 1.0, v9
    ds_read_b128 v[16:19], v3 offset:54272
    s_waitcnt lgkmcnt(5)
    v_mfma_f32_32x32x16_bf16 v[76:91], v[20:23], v[204:207], v[76:91]
    v_add_f32 v10, 1.0, v10
    v_add_f32 v11, 1.0, v11
    v_rcp_f32 v8, v8
    v_rcp_f32 v9, v9
    ds_read_b128 v[20:23], v3 offset:55296
    v_mfma_f32_32x32x16_bf16 v[76:91], v[24:27], v[208:211], v[76:91]
    v_rcp_f32 v10, v10
    v_rcp_f32 v11, v11
    v_mul_f32 v60, v60, v8
    ds_read_b128 v[24:27], v3 offset:56320
    s_waitcnt lgkmcnt(5)
    v_mfma_f32_32x32x16_bf16 v[76:91], v[28:31], v[212:215], v[76:91]
    v_mul_f32 v61, v61, v9
    v_mul_f32 v62, v62, v10
    v_mul_f32 v63, v63, v11
    v_mul_f32 v8, v64, v6
    v_mul_f32 v9, v65, v6
    v_mul_f32 v10, v66, v6
    ds_read_b128 v[28:31], v3 offset:57344
    v_mfma_f32_32x32x16_bf16 v[76:91], v[32:35], v[216:219], v[76:91]
    v_mul_f32 v11, v67, v6
    v_mul_f32 v64, v64, v72
    v_mul_f32 v65, v65, v73
    v_mul_f32 v66, v66, v74
    v_mul_f32 v67, v67, v75
    ds_read_b128 v[32:35], v3 offset:58368
    s_waitcnt lgkmcnt(5)
    v_mfma_f32_32x32x16_bf16 v[76:91], v[36:39], v[220:223], v[76:91]
    v_exp_f32 v8, v8
    v_exp_f32 v9, v9
    v_exp_f32 v10, v10
    ds_read_b128 v[36:39], v3 offset:59392
    v_mfma_f32_32x32x16_bf16 v[76:91], v[40:43], v[224:227], v[76:91]
    v_exp_f32 v11, v11
    v_mul_f32 v64, v64, v7
    v_mul_f32 v65, v65, v7
    v_mul_f32 v66, v66, v7
    ds_read_b128 v[40:43], v3 offset:60416
    s_waitcnt lgkmcnt(5)
    v_mfma_f32_32x32x16_bf16 v[76:91], v[16:19], v[228:231], v[76:91]
    v_mul_f32 v67, v67, v7
    v_add_f32 v8, 1.0, v8
    v_add_f32 v9, 1.0, v9
    v_add_f32 v10, 1.0, v10
    v_add_f32 v11, 1.0, v11
    ds_read_b128 v[16:19], v4 offset:2560
    v_mfma_f32_32x32x16_bf16 v[76:91], v[20:23], v[232:235], v[76:91]
    v_rcp_f32 v8, v8
    v_rcp_f32 v9, v9
    v_rcp_f32 v10, v10
    s_waitcnt lgkmcnt(4)
    v_mfma_f32_32x32x16_bf16 v[76:91], v[24:27], v[236:239], v[76:91]
    v_rcp_f32 v11, v11
    v_mul_f32 v64, v64, v8
    v_mul_f32 v65, v65, v9
    v_mul_f32 v66, v66, v10
    v_mul_f32 v67, v67, v11
    v_mfma_f32_32x32x16_bf16 v[76:91], v[28:31], v[240:243], v[76:91]
    v_cvt_pk_bf16_f32 v68, v60, v61
    v_cvt_pk_bf16_f32 v69, v62, v63
    v_cvt_pk_bf16_f32 v70, v64, v65
    v_cvt_pk_bf16_f32 v71, v66, v67
    s_add_u32 s45, s44, 2048
    buffer_store_dwordx4 v[68:71], v5, s[20:23], s45 offen sc1
    s_waitcnt lgkmcnt(2)
    v_mfma_f32_32x32x16_bf16 v[76:91], v[32:35], v[244:247], v[76:91]
    v_mfma_f32_32x32x16_bf16 v[76:91], v[36:39], v[248:251], v[76:91]
    s_waitcnt lgkmcnt(0)
    v_mfma_f32_32x32x16_bf16 v[76:91], v[40:43], v[252:255], v[76:91]
    v_mfma_f32_32x32x16_bf16 v[76:91], v[16:19], v[12:15], v[76:91]
    s_nop 11
    v_mul_f32 v8, v76, v6
    v_mul_f32 v9, v77, v6
    v_mul_f32 v10, v78, v6
    v_mul_f32 v11, v79, v6
    v_mul_f32 v76, v76, v84
    v_mul_f32 v77, v77, v85
    v_mul_f32 v78, v78, v86
    v_mul_f32 v79, v79, v87
    v_exp_f32 v8, v8
    v_exp_f32 v9, v9
    v_exp_f32 v10, v10
    v_exp_f32 v11, v11
    v_mul_f32 v76, v76, v7
    v_mul_f32 v77, v77, v7
    v_mul_f32 v78, v78, v7
    v_mul_f32 v79, v79, v7
    v_add_f32 v8, 1.0, v8
    v_add_f32 v9, 1.0, v9
    v_add_f32 v10, 1.0, v10
    v_add_f32 v11, 1.0, v11
    v_rcp_f32 v8, v8
    v_rcp_f32 v9, v9
    v_rcp_f32 v10, v10
    v_rcp_f32 v11, v11
    v_mul_f32 v76, v76, v8
    v_mul_f32 v77, v77, v9
    v_mul_f32 v78, v78, v10
    v_mul_f32 v79, v79, v11
    v_mul_f32 v8, v80, v6
    v_mul_f32 v9, v81, v6
    v_mul_f32 v10, v82, v6
    v_mul_f32 v11, v83, v6
    v_mul_f32 v80, v80, v88
    v_mul_f32 v81, v81, v89
    v_mul_f32 v82, v82, v90
    v_mul_f32 v83, v83, v91
    v_exp_f32 v8, v8
    v_exp_f32 v9, v9
    v_exp_f32 v10, v10
    v_exp_f32 v11, v11
    v_mul_f32 v80, v80, v7
    v_mul_f32 v81, v81, v7
    v_mul_f32 v82, v82, v7
    v_mul_f32 v83, v83, v7
    v_add_f32 v8, 1.0, v8
    v_add_f32 v9, 1.0, v9
    v_add_f32 v10, 1.0, v10
    v_add_f32 v11, 1.0, v11
    v_rcp_f32 v8, v8
    v_rcp_f32 v9, v9
    v_rcp_f32 v10, v10
    v_rcp_f32 v11, v11
    v_mul_f32 v80, v80, v8
    v_mul_f32 v81, v81, v9
    v_mul_f32 v82, v82, v10
    v_mul_f32 v83, v83, v11
    v_cvt_pk_bf16_f32 v84, v76, v77
    v_cvt_pk_bf16_f32 v85, v78, v79
    v_cvt_pk_bf16_f32 v86, v80, v81
    v_cvt_pk_bf16_f32 v87, v82, v83
    s_add_u32 s45, s44, 2560
    buffer_store_dwordx4 v[84:87], v5, s[20:23], s45 offen sc1
    s_branch adaLN_cond__grouped_kv_mqa__glu_gated_swiglu__prompt_kernel_e_done_148
adaLN_cond__grouped_kv_mqa__glu_gated_swiglu__prompt_kernel_e_loader_149:
    s_mov_b32 s40, 52429
    s_mov_b32 s41, 8960
    v_add_u32 v10, 0, v1
    v_mul_u32_u24 v11, s40, v10
    v_lshrrev_b32 v11, 22, v11
    v_mul_u32_u24 v11, s41, v11
    v_lshl_add_u32 v2, v10, 4, v11
    v_add_u32 v10, 64, v1
    v_mul_u32_u24 v11, s40, v10
    v_lshrrev_b32 v11, 22, v11
    v_mul_u32_u24 v11, s41, v11
    v_lshl_add_u32 v3, v10, 4, v11
    v_add_u32 v10, 128, v1
    v_mul_u32_u24 v11, s40, v10
    v_lshrrev_b32 v11, 22, v11
    v_mul_u32_u24 v11, s41, v11
    v_lshl_add_u32 v4, v10, 4, v11
    v_add_u32 v10, 192, v1
    v_mul_u32_u24 v11, s40, v10
    v_lshrrev_b32 v11, 22, v11
    v_mul_u32_u24 v11, s41, v11
    v_lshl_add_u32 v5, v10, 4, v11
    v_add_u32 v10, 256, v1
    v_mul_u32_u24 v11, s40, v10
    v_lshrrev_b32 v11, 22, v11
    v_mul_u32_u24 v11, s41, v11
    v_lshl_add_u32 v6, v10, 4, v11
    s_and_b32 s40, s3, 3
    s_waitcnt vmcnt(10)
    s_barrier
    s_add_u32 s67, s65, 768
    s_add_u32 m0, s66, 0
    s_nop 0
    buffer_load_dwordx4 v250, s[24:27], s67 offen lds
    s_add_u32 s67, s65, 221952
    s_add_u32 m0, s66, 4096
    s_nop 0
    buffer_load_dwordx4 v250, s[24:27], s67 offen lds
    s_add_u32 s67, s65, 443136
    s_add_u32 m0, s66, 8192
    s_nop 0
    buffer_load_dwordx4 v250, s[24:27], s67 offen lds
    s_add_u32 s67, s65, 664320
    s_add_u32 m0, s66, 12288
    s_nop 0
    buffer_load_dwordx4 v250, s[24:27], s67 offen lds
    s_add_u32 s67, s65, 885504
    s_add_u32 m0, s66, 16384
    s_nop 0
    buffer_load_dwordx4 v250, s[24:27], s67 offen lds
    s_waitcnt vmcnt(10)
    s_barrier
    s_add_u32 s67, s65, 1106688
    s_add_u32 m0, s66, 20480
    s_nop 0
    buffer_load_dwordx4 v250, s[24:27], s67 offen lds
    s_add_u32 s67, s65, 1327872
    s_add_u32 m0, s66, 24576
    s_nop 0
    buffer_load_dwordx4 v250, s[24:27], s67 offen lds
    s_add_u32 s67, s65, 1549056
    s_add_u32 m0, s66, 28672
    s_nop 0
    buffer_load_dwordx4 v250, s[24:27], s67 offen lds
    s_add_u32 s67, s65, 1770240
    s_add_u32 m0, s66, 32768
    s_nop 0
    buffer_load_dwordx4 v250, s[24:27], s67 offen lds
    s_add_u32 s67, s65, 1991424
    s_add_u32 m0, s66, 36864
    s_nop 0
    buffer_load_dwordx4 v250, s[24:27], s67 offen lds
    s_add_u32 s67, s65, 1024
    s_add_u32 m0, s66, 40960
    s_nop 0
    buffer_load_dwordx4 v250, s[24:27], s67 offen lds
    s_add_u32 s67, s65, 222208
    s_add_u32 m0, s66, 45056
    s_nop 0
    buffer_load_dwordx4 v250, s[24:27], s67 offen lds
    s_add_u32 s67, s65, 443392
    s_add_u32 m0, s66, 49152
    s_nop 0
    buffer_load_dwordx4 v250, s[24:27], s67 offen lds
    s_add_u32 s67, s65, 664576
    s_add_u32 m0, s66, 53248
    s_nop 0
    buffer_load_dwordx4 v250, s[24:27], s67 offen lds
    s_add_u32 s67, s65, 885760
    s_add_u32 m0, s66, 57344
    s_nop 0
    buffer_load_dwordx4 v250, s[24:27], s67 offen lds
    s_waitcnt vmcnt(10)
    s_barrier
    s_add_u32 s67, s65, 1106944
    s_add_u32 m0, s66, 61440
    s_nop 0
    buffer_load_dwordx4 v250, s[24:27], s67 offen lds
    s_add_u32 s67, s65, 1328128
    s_add_u32 m0, s66, 65536
    s_nop 0
    buffer_load_dwordx4 v250, s[24:27], s67 offen lds
    s_add_u32 s67, s65, 1549312
    s_add_u32 m0, s66, 69632
    s_nop 0
    buffer_load_dwordx4 v250, s[24:27], s67 offen lds
    s_add_u32 s67, s65, 1770496
    s_add_u32 m0, s66, 73728
    s_nop 0
    buffer_load_dwordx4 v250, s[24:27], s67 offen lds
    s_add_u32 s67, s65, 1991680
    s_add_u32 m0, s66, 77824
    s_nop 0
    buffer_load_dwordx4 v250, s[24:27], s67 offen lds
    s_add_u32 s67, s65, 1280
    s_add_u32 m0, s66, 81920
    s_nop 0
    buffer_load_dwordx4 v250, s[24:27], s67 offen lds
    s_add_u32 s67, s65, 222464
    s_add_u32 m0, s66, 86016
    s_nop 0
    buffer_load_dwordx4 v250, s[24:27], s67 offen lds
    s_add_u32 s67, s65, 443648
    s_add_u32 m0, s66, 90112
    s_nop 0
    buffer_load_dwordx4 v250, s[24:27], s67 offen lds
    s_add_u32 s67, s65, 664832
    s_add_u32 m0, s66, 94208
    s_nop 0
    buffer_load_dwordx4 v250, s[24:27], s67 offen lds
    s_add_u32 s67, s65, 886016
    s_add_u32 m0, s66, 98304
    s_nop 0
    buffer_load_dwordx4 v250, s[24:27], s67 offen lds
    s_waitcnt vmcnt(10)
    s_barrier
    s_add_u32 s67, s65, 1107200
    s_add_u32 m0, s66, 102400
    s_nop 0
    buffer_load_dwordx4 v250, s[24:27], s67 offen lds
    s_add_u32 s67, s65, 1328384
    s_add_u32 m0, s66, 106496
    s_nop 0
    buffer_load_dwordx4 v250, s[24:27], s67 offen lds
    s_add_u32 s67, s65, 1549568
    s_add_u32 m0, s66, 110592
    s_nop 0
    buffer_load_dwordx4 v250, s[24:27], s67 offen lds
    s_add_u32 s67, s65, 1770752
    s_add_u32 m0, s66, 114688
    s_nop 0
    buffer_load_dwordx4 v250, s[24:27], s67 offen lds
    s_add_u32 s67, s65, 1991936
    s_add_u32 m0, s66, 118784
    s_nop 0
    buffer_load_dwordx4 v250, s[24:27], s67 offen lds
    s_waitcnt vmcnt(5)
    s_barrier
    s_cmp_eq_u32 s54, 6
    s_cbranch_scc1 adaLN_cond__grouped_kv_mqa__glu_gated_swiglu__prompt_kernel_ldskip_156
    s_add_u32 s67, s65, 1536
    s_add_u32 m0, s66, 122880
    s_nop 0
    buffer_load_dwordx4 v250, s[24:27], s67 offen lds
    s_add_u32 s67, s65, 222720
    s_add_u32 m0, s66, 126976
    s_nop 0
    buffer_load_dwordx4 v250, s[24:27], s67 offen lds
    s_add_u32 s67, s65, 443904
    s_add_u32 m0, s66, 131072
    s_nop 0
    buffer_load_dwordx4 v250, s[24:27], s67 offen lds
    s_add_u32 s67, s65, 665088
    s_add_u32 m0, s66, 135168
    s_nop 0
    buffer_load_dwordx4 v250, s[24:27], s67 offen lds
    s_add_u32 s67, s65, 886272
    s_add_u32 m0, s66, 139264
    s_nop 0
    buffer_load_dwordx4 v250, s[24:27], s67 offen lds
adaLN_cond__grouped_kv_mqa__glu_gated_swiglu__prompt_kernel_ldskip_156:
    s_cmp_eq_u32 s54, 6
    s_cbranch_scc1 adaLN_cond__grouped_kv_mqa__glu_gated_swiglu__prompt_kernel_ldskip_157
    s_add_u32 s67, s65, 1107456
    s_add_u32 m0, s66, 0
    s_nop 0
    buffer_load_dwordx4 v250, s[24:27], s67 offen lds
    s_add_u32 s67, s65, 1328640
    s_add_u32 m0, s66, 4096
    s_nop 0
    buffer_load_dwordx4 v250, s[24:27], s67 offen lds
    s_add_u32 s67, s65, 1549824
    s_add_u32 m0, s66, 8192
    s_nop 0
    buffer_load_dwordx4 v250, s[24:27], s67 offen lds
    s_add_u32 s67, s65, 1771008
    s_add_u32 m0, s66, 12288
    s_nop 0
    buffer_load_dwordx4 v250, s[24:27], s67 offen lds
    s_add_u32 s67, s65, 1992192
    s_add_u32 m0, s66, 16384
    s_nop 0
    buffer_load_dwordx4 v250, s[24:27], s67 offen lds
adaLN_cond__grouped_kv_mqa__glu_gated_swiglu__prompt_kernel_ldskip_157:
    s_waitcnt vmcnt(0)
    s_barrier
    s_mul_i32 s46, s40, 5120
    s_add_u32 s46, s46, 20480
    s_add_u32 s44, s40, 0
    s_mul_i32 s45, s44, 40960
    s_add_u32 s45, s45, s48
    s_mov_b32 m0, s46
    s_nop 0
    buffer_load_dwordx4 v2, s[16:19], s45 offen  lds
    s_add_u32 s46, s46, 1024
    s_mov_b32 m0, s46
    s_nop 0
    buffer_load_dwordx4 v3, s[16:19], s45 offen  lds
    s_add_u32 s46, s46, 1024
    s_mov_b32 m0, s46
    s_nop 0
    buffer_load_dwordx4 v4, s[16:19], s45 offen  lds
    s_add_u32 s46, s46, 1024
    s_mov_b32 m0, s46
    s_nop 0
    buffer_load_dwordx4 v5, s[16:19], s45 offen  lds
    s_add_u32 s46, s46, 1024
    s_mov_b32 m0, s46
    s_nop 0
    buffer_load_dwordx4 v6, s[16:19], s45 offen  lds
    s_mul_i32 s46, s40, 5120
    s_add_u32 s46, s46, 40960
    s_add_u32 s44, s40, 4
    s_mul_i32 s45, s44, 40960
    s_add_u32 s45, s45, s48
    s_mov_b32 m0, s46
    s_nop 0
    buffer_load_dwordx4 v2, s[16:19], s45 offen  lds
    s_add_u32 s46, s46, 1024
    s_mov_b32 m0, s46
    s_nop 0
    buffer_load_dwordx4 v3, s[16:19], s45 offen  lds
    s_add_u32 s46, s46, 1024
    s_mov_b32 m0, s46
    s_nop 0
    buffer_load_dwordx4 v4, s[16:19], s45 offen  lds
    s_add_u32 s46, s46, 1024
    s_mov_b32 m0, s46
    s_nop 0
    buffer_load_dwordx4 v5, s[16:19], s45 offen  lds
    s_add_u32 s46, s46, 1024
    s_mov_b32 m0, s46
    s_nop 0
    buffer_load_dwordx4 v6, s[16:19], s45 offen  lds
    s_cmp_eq_u32 s54, 6
    s_cbranch_scc1 adaLN_cond__grouped_kv_mqa__glu_gated_swiglu__prompt_kernel_ld6_155
    s_barrier
    s_mul_i32 s46, s40, 5120
    s_add_u32 s46, s46, 61440
    s_add_u32 s44, s40, 8
    s_mul_i32 s45, s44, 40960
    s_add_u32 s45, s45, s48
    s_mov_b32 m0, s46
    s_nop 0
    buffer_load_dwordx4 v2, s[16:19], s45 offen  lds
    s_add_u32 s46, s46, 1024
    s_mov_b32 m0, s46
    s_nop 0
    buffer_load_dwordx4 v3, s[16:19], s45 offen  lds
    s_add_u32 s46, s46, 1024
    s_mov_b32 m0, s46
    s_nop 0
    buffer_load_dwordx4 v4, s[16:19], s45 offen  lds
    s_add_u32 s46, s46, 1024
    s_mov_b32 m0, s46
    s_nop 0
    buffer_load_dwordx4 v5, s[16:19], s45 offen  lds
    s_add_u32 s46, s46, 1024
    s_mov_b32 m0, s46
    s_nop 0
    buffer_load_dwordx4 v6, s[16:19], s45 offen  lds
    s_mul_i32 s46, s40, 5120
    s_add_u32 s46, s46, 81920
    s_add_u32 s44, s40, 12
    s_mul_i32 s45, s44, 40960
    s_add_u32 s45, s45, s48
    s_mov_b32 m0, s46
    s_nop 0
    buffer_load_dwordx4 v2, s[16:19], s45 offen  lds
    s_add_u32 s46, s46, 1024
    s_mov_b32 m0, s46
    s_nop 0
    buffer_load_dwordx4 v3, s[16:19], s45 offen  lds
    s_add_u32 s46, s46, 1024
    s_mov_b32 m0, s46
    s_nop 0
    buffer_load_dwordx4 v4, s[16:19], s45 offen  lds
    s_add_u32 s46, s46, 1024
    s_mov_b32 m0, s46
    s_nop 0
    buffer_load_dwordx4 v5, s[16:19], s45 offen  lds
    s_add_u32 s46, s46, 1024
    s_mov_b32 m0, s46
    s_nop 0
    buffer_load_dwordx4 v6, s[16:19], s45 offen  lds
    s_barrier
    s_branch adaLN_cond__grouped_kv_mqa__glu_gated_swiglu__prompt_kernel_e_done_148
adaLN_cond__grouped_kv_mqa__glu_gated_swiglu__prompt_kernel_ld6_155:
    s_barrier
    s_mul_i32 s46, s40, 5120
    s_add_u32 s46, s46, 61440
    s_add_u32 s44, s40, 8
    s_mul_i32 s45, s44, 40960
    s_add_u32 s45, s45, s48
    s_mov_b32 m0, s46
    s_nop 0
    buffer_load_dwordx4 v2, s[16:19], s45 offen  lds
    s_add_u32 s46, s46, 1024
    s_mov_b32 m0, s46
    s_nop 0
    buffer_load_dwordx4 v3, s[16:19], s45 offen  lds
    s_add_u32 s46, s46, 1024
    s_mov_b32 m0, s46
    s_nop 0
    buffer_load_dwordx4 v4, s[16:19], s45 offen  lds
    s_add_u32 s46, s46, 1024
    s_mov_b32 m0, s46
    s_nop 0
    buffer_load_dwordx4 v5, s[16:19], s45 offen  lds
    s_add_u32 s46, s46, 1024
    s_mov_b32 m0, s46
    s_nop 0
    buffer_load_dwordx4 v6, s[16:19], s45 offen  lds
    s_mul_i32 s46, s40, 5120
    s_add_u32 s46, s46, 81920
    s_add_u32 s44, s40, 12
    s_mul_i32 s45, s44, 40960
    s_add_u32 s45, s45, s48
    s_mov_b32 m0, s46
    s_nop 0
    buffer_load_dwordx4 v2, s[16:19], s45 offen  lds
    s_add_u32 s46, s46, 1024
    s_mov_b32 m0, s46
    s_nop 0
    buffer_load_dwordx4 v3, s[16:19], s45 offen  lds
    s_add_u32 s46, s46, 1024
    s_mov_b32 m0, s46
    s_nop 0
    buffer_load_dwordx4 v4, s[16:19], s45 offen  lds
    s_add_u32 s46, s46, 1024
    s_mov_b32 m0, s46
    s_nop 0
    buffer_load_dwordx4 v5, s[16:19], s45 offen  lds
    s_add_u32 s46, s46, 1024
    s_mov_b32 m0, s46
    s_nop 0
    buffer_load_dwordx4 v6, s[16:19], s45 offen  lds
adaLN_cond__grouped_kv_mqa__glu_gated_swiglu__prompt_kernel_e_done_148:
    s_mov_b32 s28, s8
    s_mov_b32 s29, s9
    s_mov_b32 s30, 2621440
    s_mov_b32 s31, 0x00020000
    s_mov_b32 s32, s6
    s_mov_b32 s33, s7
    s_mov_b32 s34, 61440
    s_mov_b32 s35, 0x00020000
    s_waitcnt vmcnt(0)
    s_waitcnt lgkmcnt(0)
    s_barrier
    s_lshr_b32 s40, s52, 7
    s_lshl_b32 s40, s40, 7
    s_add_u32 s40, s40, 32768
    s_bfe_u32 s41, s2, 0x40003
    s_lshl_b32 s41, s41, 2
    s_add_u32 s41, s41, s40
    s_cmp_lg_u32 s3, 0
    s_cbranch_scc1 adaLN_cond__grouped_kv_mqa__glu_gated_swiglu__prompt_kernel_flag_158
    v_mov_b32 v116, s71
    v_mov_b32 v117, 0
    s_mov_b64 exec, 1
    s_cmp_eq_u32 s14, 0
    s_cbranch_scc1 adaLN_cond__grouped_kv_mqa__glu_gated_swiglu__prompt_kernel_ss_159
    buffer_store_dword v116, v117, s[60:63], s41 offen
    s_branch adaLN_cond__grouped_kv_mqa__glu_gated_swiglu__prompt_kernel_ss_160
adaLN_cond__grouped_kv_mqa__glu_gated_swiglu__prompt_kernel_ss_159:
    buffer_store_dword v116, v117, s[60:63], s41 offen sc1
adaLN_cond__grouped_kv_mqa__glu_gated_swiglu__prompt_kernel_ss_160:
    s_mov_b64 exec, -1
adaLN_cond__grouped_kv_mqa__glu_gated_swiglu__prompt_kernel_flag_158:
    s_mov_b32 s40, 52429
    s_mov_b32 s41, 8960
    v_add_u32 v116, 0, v1
    v_mul_u32_u24 v117, s40, v116
    v_lshrrev_b32 v117, 22, v117
    v_mul_u32_u24 v117, s41, v117
    v_lshl_add_u32 v2, v116, 4, v117
    v_add_u32 v116, 64, v1
    v_mul_u32_u24 v117, s40, v116
    v_lshrrev_b32 v117, 22, v117
    v_mul_u32_u24 v117, s41, v117
    v_lshl_add_u32 v3, v116, 4, v117
    v_add_u32 v116, 128, v1
    v_mul_u32_u24 v117, s40, v116
    v_lshrrev_b32 v117, 22, v117
    v_mul_u32_u24 v117, s41, v117
    v_lshl_add_u32 v4, v116, 4, v117
    v_add_u32 v116, 192, v1
    v_mul_u32_u24 v117, s40, v116
    v_lshrrev_b32 v117, 22, v117
    v_mul_u32_u24 v117, s41, v117
    v_lshl_add_u32 v5, v116, 4, v117
    v_add_u32 v116, 256, v1
    v_mul_u32_u24 v117, s40, v116
    v_lshrrev_b32 v117, 22, v117
    v_mul_u32_u24 v117, s41, v117
    v_lshl_add_u32 v6, v116, 4, v117
    v_and_b32 v120, 255, v0
    v_lshrrev_b32 v121, 8, v0
    v_mov_b32 v122, 12800
    v_mov_b32 v123, 12800
    v_cmp_eq_u32 vcc, 0, v121
    s_nop 1
    v_cndmask_b32 v122, v123, v122, vcc
    v_min_u32 v139, 159, v120
    v_lshl_add_u32 v122, v139, 4, v122
    v_mov_b32 v123, 143360
    v_mov_b32 v121, 143360
    v_cndmask_b32 v123, v121, v123, vcc
    v_lshl_add_u32 v123, v120, 4, v123
    v_mov_b32 v121, 0
    v_mov_b32 v139, 0
    v_cndmask_b32 v121, v121, v139, vcc
    v_cmp_gt_u32 vcc, 160, v0
    s_nop 0
    s_and_saveexec_b64 s[50:51], vcc
    s_cbranch_execz adaLN_cond__grouped_kv_mqa__glu_gated_swiglu__prompt_kernel_mi_161
    buffer_load_dwordx4 v[124:127], v122, s[32:35], 0 offen sc1
    buffer_load_dwordx4 v[128:131], v122, s[32:35], s15 offen sc1
    buffer_load_dwordx4 v[132:135], v122, s[32:35], s69 offen sc1
    buffer_load_dwordx4 v[136:139], v122, s[32:35], s70 offen sc1
adaLN_cond__grouped_kv_mqa__glu_gated_swiglu__prompt_kernel_mi_161:
    s_mov_b64 exec, s[50:51]
    s_lshr_b32 s41, s3, 2
    s_cmp_lg_u32 s41, 0
    s_cbranch_scc1 adaLN_cond__grouped_kv_mqa__glu_gated_swiglu__prompt_kernel_f2dma_162
    s_and_b32 s41, s3, 3
    s_mul_i32 s44, s41, 5120
    s_add_u32 s44, s44, 102400
    s_add_u32 s42, s41, 16
    s_mul_i32 s43, s42, 40960
    s_add_u32 s43, s43, s48
    s_mov_b32 m0, s44
    s_nop 0
    buffer_load_dwordx4 v2, s[16:19], s43 offen  lds
    s_add_u32 s44, s44, 1024
    s_mov_b32 m0, s44
    s_nop 0
    buffer_load_dwordx4 v3, s[16:19], s43 offen  lds
    s_add_u32 s44, s44, 1024
    s_mov_b32 m0, s44
    s_nop 0
    buffer_load_dwordx4 v4, s[16:19], s43 offen  lds
    s_add_u32 s44, s44, 1024
    s_mov_b32 m0, s44
    s_nop 0
    buffer_load_dwordx4 v5, s[16:19], s43 offen  lds
    s_add_u32 s44, s44, 1024
    s_mov_b32 m0, s44
    s_nop 0
    buffer_load_dwordx4 v6, s[16:19], s43 offen  lds
adaLN_cond__grouped_kv_mqa__glu_gated_swiglu__prompt_kernel_f2dma_162:
    s_lshr_b32 s41, s3, 2
    s_cmp_lg_u32 s41, 1
    s_cbranch_scc1 adaLN_cond__grouped_kv_mqa__glu_gated_swiglu__prompt_kernel_f2dma_163
    s_and_b32 s41, s3, 3
    s_mul_i32 s44, s41, 5120
    s_add_u32 s44, s44, 122880
    s_add_u32 s42, s41, 20
    s_mul_i32 s43, s42, 40960
    s_add_u32 s43, s43, s48
    s_mov_b32 m0, s44
    s_nop 0
    buffer_load_dwordx4 v2, s[16:19], s43 offen  lds
    s_add_u32 s44, s44, 1024
    s_mov_b32 m0, s44
    s_nop 0
    buffer_load_dwordx4 v3, s[16:19], s43 offen  lds
    s_add_u32 s44, s44, 1024
    s_mov_b32 m0, s44
    s_nop 0
    buffer_load_dwordx4 v4, s[16:19], s43 offen  lds
    s_add_u32 s44, s44, 1024
    s_mov_b32 m0, s44
    s_nop 0
    buffer_load_dwordx4 v5, s[16:19], s43 offen  lds
    s_add_u32 s44, s44, 1024
    s_mov_b32 m0, s44
    s_nop 0
    buffer_load_dwordx4 v6, s[16:19], s43 offen  lds
adaLN_cond__grouped_kv_mqa__glu_gated_swiglu__prompt_kernel_f2dma_163:
    v_lshlrev_b32 v7, 4, v1
    s_lshr_b32 s49, s36, 4
    s_and_b32 s41, s3, 3
    s_add_u32 s49, s49, s41
    s_mul_i32 s49, s49, 55296
    s_lshr_b32 s41, s3, 2
    s_lshl_b32 s41, s41, 10
    s_add_u32 s49, s49, s41
    v_lshrrev_b32 v116, 4, v1
    v_mul_u32_u24 v116, 1280, v116
    v_and_b32 v117, 15, v1
    v_lshl_add_u32 v116, v117, 4, v116
    s_lshr_b32 s41, s3, 2
    s_mul_i32 s41, s41, 5120
    v_add_u32 v140, s41, v116
    v_add_u32 v141, 61440, v140
    v_add_u32 v142, 122880, v140
    s_waitcnt vmcnt(2)
    v_add_f32 v124, v124, v128
    s_waitcnt vmcnt(0)
    v_add_f32 v132, v132, v136
    v_add_f32 v124, v124, v132
    v_cvt_pk_bf16_f32 v124, v124, v124
    v_lshlrev_b32 v124, 16, v124
    v_add_f32 v124, v124, v121
    v_cvt_pk_bf16_f32 v124, v124, v124
    v_lshlrev_b32 v124, 16, v124
    v_add_f32 v125, v125, v129
    v_add_f32 v133, v133, v137
    v_add_f32 v125, v125, v133
    v_cvt_pk_bf16_f32 v125, v125, v125
    v_lshlrev_b32 v125, 16, v125
    v_add_f32 v125, v125, v121
    v_cvt_pk_bf16_f32 v125, v125, v125
    v_lshlrev_b32 v125, 16, v125
    v_add_f32 v126, v126, v130
    v_add_f32 v134, v134, v138
    v_add_f32 v126, v126, v134
    v_cvt_pk_bf16_f32 v126, v126, v126
    v_lshlrev_b32 v126, 16, v126
    v_add_f32 v126, v126, v121
    v_cvt_pk_bf16_f32 v126, v126, v126
    v_lshlrev_b32 v126, 16, v126
    v_add_f32 v127, v127, v131
    v_add_f32 v135, v135, v139
    v_add_f32 v127, v127, v135
    v_cvt_pk_bf16_f32 v127, v127, v127
    v_lshlrev_b32 v127, 16, v127
    v_add_f32 v127, v127, v121
    v_cvt_pk_bf16_f32 v127, v127, v127
    v_lshlrev_b32 v127, 16, v127
    v_cmp_gt_u32 vcc, 160, v0
    s_nop 0
    s_and_saveexec_b64 s[50:51], vcc
    s_cbranch_execz adaLN_cond__grouped_kv_mqa__glu_gated_swiglu__prompt_kernel_m2l_164
    ds_write_b128 v123, v[124:127]
adaLN_cond__grouped_kv_mqa__glu_gated_swiglu__prompt_kernel_m2l_164:
    s_mov_b64 exec, s[50:51]
    s_waitcnt lgkmcnt(0)
    s_lshr_b32 s40, s36, 7
    s_lshl_b32 s40, s40, 7
    s_add_u32 s40, s40, 32768
    s_cmp_lg_u32 s3, 0
    s_cbranch_scc1 adaLN_cond__grouped_kv_mqa__glu_gated_swiglu__prompt_kernel_wf_165
    v_mul_u32_u24 v116, 4, v1
    s_mov_b32 s44, 65535
    s_mov_b32 s45, 0
    s_mov_b64 exec, s[44:45]
    s_mov_b32 s46, 65536
adaLN_cond__grouped_kv_mqa__glu_gated_swiglu__prompt_kernel_poll_166:
    buffer_load_dword v117, v116, s[60:63], s40 offen sc1
    s_sub_u32 s46, s46, 1
    s_cmp_eq_u32 s46, 0
    s_cbranch_scc1 adaLN_cond__grouped_kv_mqa__glu_gated_swiglu__prompt_kernel_polldone_167
    s_waitcnt vmcnt(0)
    v_cmp_ne_u32 vcc, s71, v117
    s_nop 0
    s_cbranch_vccnz adaLN_cond__grouped_kv_mqa__glu_gated_swiglu__prompt_kernel_poll_166
adaLN_cond__grouped_kv_mqa__glu_gated_swiglu__prompt_kernel_polldone_167:
    s_mov_b64 exec, -1
adaLN_cond__grouped_kv_mqa__glu_gated_swiglu__prompt_kernel_wf_165:
    s_barrier
    s_add_u32 s46, s49, 0
    buffer_load_dwordx4 v[8:11], v7, s[20:23], s46 offen sc1
    s_add_u32 s46, s49, 2048
    buffer_load_dwordx4 v[12:15], v7, s[20:23], s46 offen sc1
    s_add_u32 s46, s49, 4096
    buffer_load_dwordx4 v[16:19], v7, s[20:23], s46 offen sc1
    s_add_u32 s46, s49, 6144
    buffer_load_dwordx4 v[20:23], v7, s[20:23], s46 offen sc1
    s_add_u32 s46, s49, 8192
    buffer_load_dwordx4 v[24:27], v7, s[20:23], s46 offen sc1
    s_add_u32 s46, s49, 10240
    buffer_load_dwordx4 v[28:31], v7, s[20:23], s46 offen sc1
    s_add_u32 s46, s49, 12288
    buffer_load_dwordx4 v[32:35], v7, s[20:23], s46 offen sc1
    s_add_u32 s46, s49, 14336
    buffer_load_dwordx4 v[36:39], v7, s[20:23], s46 offen sc1
    s_add_u32 s46, s49, 16384
    buffer_load_dwordx4 v[40:43], v7, s[20:23], s46 offen sc1
    s_add_u32 s46, s49, 18432
    buffer_load_dwordx4 v[44:47], v7, s[20:23], s46 offen sc1
    s_barrier
    ds_read_b128 v[180:183], v140 offset:20480
    ds_read_b128 v[184:187], v140 offset:20736
    ds_read_b128 v[188:191], v140 offset:20992
    ds_read_b128 v[192:195], v140 offset:21248
    ds_read_b128 v[196:199], v140 offset:21504
    ds_read_b128 v[200:203], v140 offset:30720
    ds_read_b128 v[204:207], v140 offset:30976
    ds_read_b128 v[208:211], v140 offset:31232
    ds_read_b128 v[212:215], v140 offset:31488
    ds_read_b128 v[216:219], v140 offset:31744
    s_barrier
    s_lshr_b32 s41, s3, 2
    s_cmp_lg_u32 s41, 0
    s_cbranch_scc1 adaLN_cond__grouped_kv_mqa__glu_gated_swiglu__prompt_kernel_f2dma_168
    s_and_b32 s41, s3, 3
    s_mul_i32 s44, s41, 5120
    s_add_u32 s44, s44, 0
    s_add_u32 s42, s41, 24
    s_mul_i32 s43, s42, 40960
    s_add_u32 s43, s43, s48
    s_mov_b32 m0, s44
    s_nop 0
    buffer_load_dwordx4 v2, s[16:19], s43 offen  lds
    s_add_u32 s44, s44, 1024
    s_mov_b32 m0, s44
    s_nop 0
    buffer_load_dwordx4 v3, s[16:19], s43 offen  lds
    s_add_u32 s44, s44, 1024
    s_mov_b32 m0, s44
    s_nop 0
    buffer_load_dwordx4 v4, s[16:19], s43 offen  lds
    s_add_u32 s44, s44, 1024
    s_mov_b32 m0, s44
    s_nop 0
    buffer_load_dwordx4 v5, s[16:19], s43 offen  lds
    s_add_u32 s44, s44, 1024
    s_mov_b32 m0, s44
    s_nop 0
    buffer_load_dwordx4 v6, s[16:19], s43 offen  lds
adaLN_cond__grouped_kv_mqa__glu_gated_swiglu__prompt_kernel_f2dma_168:
    ds_read_b128 v[220:223], v140 offset:40960
    ds_read_b128 v[224:227], v140 offset:41216
    ds_read_b128 v[228:231], v140 offset:41472
    ds_read_b128 v[232:235], v140 offset:41728
    ds_read_b128 v[236:239], v140 offset:41984
    s_add_u32 s46, s49, 20480
    buffer_load_dwordx4 v[48:51], v7, s[20:23], s46 offen sc1
    s_waitcnt vmcnt(10) lgkmcnt(14)
    v_mfma_f32_16x16x32_bf16 v[56:59], v[180:183], v[8:11], 0
    s_waitcnt lgkmcnt(13)
    v_mfma_f32_16x16x32_bf16 v[60:63], v[184:187], v[8:11], 0
    s_waitcnt lgkmcnt(12)
    v_mfma_f32_16x16x32_bf16 v[64:67], v[188:191], v[8:11], 0
    s_waitcnt lgkmcnt(11)
    v_mfma_f32_16x16x32_bf16 v[68:71], v[192:195], v[8:11], 0
    s_waitcnt lgkmcnt(10)
    v_mfma_f32_16x16x32_bf16 v[72:75], v[196:199], v[8:11], 0
    ds_read_b128 v[180:183], v140 offset:51200
    ds_read_b128 v[184:187], v140 offset:51456
    ds_read_b128 v[188:191], v140 offset:51712
    ds_read_b128 v[192:195], v140 offset:51968
    ds_read_b128 v[196:199], v140 offset:52224
    s_add_u32 s46, s49, 22528
    buffer_load_dwordx4 v[52:55], v7, s[20:23], s46 offen sc1
    s_waitcnt vmcnt(10) lgkmcnt(14)
    v_mfma_f32_16x16x32_bf16 v[56:59], v[200:203], v[12:15], v[56:59]
    s_waitcnt lgkmcnt(13)
    v_mfma_f32_16x16x32_bf16 v[60:63], v[204:207], v[12:15], v[60:63]
    s_waitcnt lgkmcnt(12)
    v_mfma_f32_16x16x32_bf16 v[64:67], v[208:211], v[12:15], v[64:67]
    s_waitcnt lgkmcnt(11)
    v_mfma_f32_16x16x32_bf16 v[68:71], v[212:215], v[12:15], v[68:71]
    s_waitcnt lgkmcnt(10)
    v_mfma_f32_16x16x32_bf16 v[72:75], v[216:219], v[12:15], v[72:75]
    ds_read_b128 v[200:203], v141 offset:0
    ds_read_b128 v[204:207], v141 offset:256
    ds_read_b128 v[208:211], v141 offset:512
    ds_read_b128 v[212:215], v141 offset:768
    ds_read_b128 v[216:219], v141 offset:1024
    s_add_u32 s46, s49, 24576
    buffer_load_dwordx4 v[8:11], v7, s[20:23], s46 offen sc1
    s_waitcnt vmcnt(10) lgkmcnt(14)
    v_mfma_f32_16x16x32_bf16 v[56:59], v[220:223], v[16:19], v[56:59]
    s_waitcnt lgkmcnt(13)
    v_mfma_f32_16x16x32_bf16 v[60:63], v[224:227], v[16:19], v[60:63]
    s_waitcnt lgkmcnt(12)
    v_mfma_f32_16x16x32_bf16 v[64:67], v[228:231], v[16:19], v[64:67]
    s_waitcnt lgkmcnt(11)
    v_mfma_f32_16x16x32_bf16 v[68:71], v[232:235], v[16:19], v[68:71]
    s_waitcnt lgkmcnt(10)
    v_mfma_f32_16x16x32_bf16 v[72:75], v[236:239], v[16:19], v[72:75]
    ds_read_b128 v[220:223], v141 offset:10240
    ds_read_b128 v[224:227], v141 offset:10496
    ds_read_b128 v[228:231], v141 offset:10752
    ds_read_b128 v[232:235], v141 offset:11008
    ds_read_b128 v[236:239], v141 offset:11264
    s_add_u32 s46, s49, 26624
    buffer_load_dwordx4 v[12:15], v7, s[20:23], s46 offen sc1
    s_waitcnt vmcnt(10) lgkmcnt(14)
    v_mfma_f32_16x16x32_bf16 v[56:59], v[180:183], v[20:23], v[56:59]
    s_waitcnt lgkmcnt(13)
    v_mfma_f32_16x16x32_bf16 v[60:63], v[184:187], v[20:23], v[60:63]
    s_waitcnt lgkmcnt(12)
    v_mfma_f32_16x16x32_bf16 v[64:67], v[188:191], v[20:23], v[64:67]
    s_waitcnt lgkmcnt(11)
    v_mfma_f32_16x16x32_bf16 v[68:71], v[192:195], v[20:23], v[68:71]
    s_waitcnt lgkmcnt(10)
    v_mfma_f32_16x16x32_bf16 v[72:75], v[196:199], v[20:23], v[72:75]
    s_barrier
    s_lshr_b32 s41, s3, 2
    s_cmp_lg_u32 s41, 1
    s_cbranch_scc1 adaLN_cond__grouped_kv_mqa__glu_gated_swiglu__prompt_kernel_f2dma_169
    s_and_b32 s41, s3, 3
    s_mul_i32 s44, s41, 5120
    s_add_u32 s44, s44, 20480
    s_add_u32 s42, s41, 28
    s_mul_i32 s43, s42, 40960
    s_add_u32 s43, s43, s48
    s_mov_b32 m0, s44
    s_nop 0
    buffer_load_dwordx4 v2, s[16:19], s43 offen  lds
    s_add_u32 s44, s44, 1024
    s_mov_b32 m0, s44
    s_nop 0
    buffer_load_dwordx4 v3, s[16:19], s43 offen  lds
    s_add_u32 s44, s44, 1024
    s_mov_b32 m0, s44
    s_nop 0
    buffer_load_dwordx4 v4, s[16:19], s43 offen  lds
    s_add_u32 s44, s44, 1024
    s_mov_b32 m0, s44
    s_nop 0
    buffer_load_dwordx4 v5, s[16:19], s43 offen  lds
    s_add_u32 s44, s44, 1024
    s_mov_b32 m0, s44
    s_nop 0
    buffer_load_dwordx4 v6, s[16:19], s43 offen  lds
adaLN_cond__grouped_kv_mqa__glu_gated_swiglu__prompt_kernel_f2dma_169:
    s_lshr_b32 s41, s3, 2
    s_cmp_lg_u32 s41, 0
    s_cbranch_scc1 adaLN_cond__grouped_kv_mqa__glu_gated_swiglu__prompt_kernel_f2dma_170
    s_and_b32 s41, s3, 3
    s_mul_i32 s44, s41, 5120
    s_add_u32 s44, s44, 40960
    s_add_u32 s42, s41, 32
    s_mul_i32 s43, s42, 40960
    s_add_u32 s43, s43, s48
    s_mov_b32 m0, s44
    s_nop 0
    buffer_load_dwordx4 v2, s[16:19], s43 offen  lds
    s_add_u32 s44, s44, 1024
    s_mov_b32 m0, s44
    s_nop 0
    buffer_load_dwordx4 v3, s[16:19], s43 offen  lds
    s_add_u32 s44, s44, 1024
    s_mov_b32 m0, s44
    s_nop 0
    buffer_load_dwordx4 v4, s[16:19], s43 offen  lds
    s_add_u32 s44, s44, 1024
    s_mov_b32 m0, s44
    s_nop 0
    buffer_load_dwordx4 v5, s[16:19], s43 offen  lds
    s_add_u32 s44, s44, 1024
    s_mov_b32 m0, s44
    s_nop 0
    buffer_load_dwordx4 v6, s[16:19], s43 offen  lds
adaLN_cond__grouped_kv_mqa__glu_gated_swiglu__prompt_kernel_f2dma_170:
    ds_read_b128 v[180:183], v141 offset:20480
    ds_read_b128 v[184:187], v141 offset:20736
    ds_read_b128 v[188:191], v141 offset:20992
    ds_read_b128 v[192:195], v141 offset:21248
    ds_read_b128 v[196:199], v141 offset:21504
    s_add_u32 s46, s49, 28672
    buffer_load_dwordx4 v[16:19], v7, s[20:23], s46 offen sc1
    s_waitcnt vmcnt(10) lgkmcnt(14)
    v_mfma_f32_16x16x32_bf16 v[56:59], v[200:203], v[24:27], v[56:59]
    s_waitcnt lgkmcnt(13)
    v_mfma_f32_16x16x32_bf16 v[60:63], v[204:207], v[24:27], v[60:63]
    s_waitcnt lgkmcnt(12)
    v_mfma_f32_16x16x32_bf16 v[64:67], v[208:211], v[24:27], v[64:67]
    s_waitcnt lgkmcnt(11)
    v_mfma_f32_16x16x32_bf16 v[68:71], v[212:215], v[24:27], v[68:71]
    s_waitcnt lgkmcnt(10)
    v_mfma_f32_16x16x32_bf16 v[72:75], v[216:219], v[24:27], v[72:75]
    ds_read_b128 v[200:203], v141 offset:30720
    ds_read_b128 v[204:207], v141 offset:30976
    ds_read_b128 v[208:211], v141 offset:31232
    ds_read_b128 v[212:215], v141 offset:31488
    ds_read_b128 v[216:219], v141 offset:31744
    s_add_u32 s46, s49, 30720
    buffer_load_dwordx4 v[20:23], v7, s[20:23], s46 offen sc1
    s_waitcnt vmcnt(10) lgkmcnt(14)
    v_mfma_f32_16x16x32_bf16 v[56:59], v[220:223], v[28:31], v[56:59]
    s_waitcnt lgkmcnt(13)
    v_mfma_f32_16x16x32_bf16 v[60:63], v[224:227], v[28:31], v[60:63]
    s_waitcnt lgkmcnt(12)
    v_mfma_f32_16x16x32_bf16 v[64:67], v[228:231], v[28:31], v[64:67]
    s_waitcnt lgkmcnt(11)
    v_mfma_f32_16x16x32_bf16 v[68:71], v[232:235], v[28:31], v[68:71]
    s_waitcnt lgkmcnt(10)
    v_mfma_f32_16x16x32_bf16 v[72:75], v[236:239], v[28:31], v[72:75]
    ds_read_b128 v[220:223], v141 offset:40960
    ds_read_b128 v[224:227], v141 offset:41216
    ds_read_b128 v[228:231], v141 offset:41472
    ds_read_b128 v[232:235], v141 offset:41728
    ds_read_b128 v[236:239], v141 offset:41984
    s_add_u32 s46, s49, 32768
    buffer_load_dwordx4 v[24:27], v7, s[20:23], s46 offen sc1
    s_waitcnt vmcnt(10) lgkmcnt(14)
    v_mfma_f32_16x16x32_bf16 v[56:59], v[180:183], v[32:35], v[56:59]
    s_waitcnt lgkmcnt(13)
    v_mfma_f32_16x16x32_bf16 v[60:63], v[184:187], v[32:35], v[60:63]
    s_waitcnt lgkmcnt(12)
    v_mfma_f32_16x16x32_bf16 v[64:67], v[188:191], v[32:35], v[64:67]
    s_waitcnt lgkmcnt(11)
    v_mfma_f32_16x16x32_bf16 v[68:71], v[192:195], v[32:35], v[68:71]
    s_waitcnt lgkmcnt(10)
    v_mfma_f32_16x16x32_bf16 v[72:75], v[196:199], v[32:35], v[72:75]
    ds_read_b128 v[180:183], v141 offset:51200
    ds_read_b128 v[184:187], v141 offset:51456
    ds_read_b128 v[188:191], v141 offset:51712
    ds_read_b128 v[192:195], v141 offset:51968
    ds_read_b128 v[196:199], v141 offset:52224
    s_add_u32 s46, s49, 34816
    buffer_load_dwordx4 v[28:31], v7, s[20:23], s46 offen sc1
    s_waitcnt vmcnt(10) lgkmcnt(14)
    v_mfma_f32_16x16x32_bf16 v[56:59], v[200:203], v[36:39], v[56:59]
    s_waitcnt lgkmcnt(13)
    v_mfma_f32_16x16x32_bf16 v[60:63], v[204:207], v[36:39], v[60:63]
    s_waitcnt lgkmcnt(12)
    v_mfma_f32_16x16x32_bf16 v[64:67], v[208:211], v[36:39], v[64:67]
    s_waitcnt lgkmcnt(11)
    v_mfma_f32_16x16x32_bf16 v[68:71], v[212:215], v[36:39], v[68:71]
    s_waitcnt lgkmcnt(10)
    v_mfma_f32_16x16x32_bf16 v[72:75], v[216:219], v[36:39], v[72:75]
    s_waitcnt vmcnt(8)
    s_barrier
    s_lshr_b32 s41, s3, 2
    s_cmp_lg_u32 s41, 1
    s_cbranch_scc1 adaLN_cond__grouped_kv_mqa__glu_gated_swiglu__prompt_kernel_f2dma_171
    s_and_b32 s41, s3, 3
    s_mul_i32 s44, s41, 5120
    s_add_u32 s44, s44, 61440
    s_add_u32 s42, s41, 36
    s_mul_i32 s43, s42, 40960
    s_add_u32 s43, s43, s48
    s_mov_b32 m0, s44
    s_nop 0
    buffer_load_dwordx4 v2, s[16:19], s43 offen  lds
    s_add_u32 s44, s44, 1024
    s_mov_b32 m0, s44
    s_nop 0
    buffer_load_dwordx4 v3, s[16:19], s43 offen  lds
    s_add_u32 s44, s44, 1024
    s_mov_b32 m0, s44
    s_nop 0
    buffer_load_dwordx4 v4, s[16:19], s43 offen  lds
    s_add_u32 s44, s44, 1024
    s_mov_b32 m0, s44
    s_nop 0
    buffer_load_dwordx4 v5, s[16:19], s43 offen  lds
    s_add_u32 s44, s44, 1024
    s_mov_b32 m0, s44
    s_nop 0
    buffer_load_dwordx4 v6, s[16:19], s43 offen  lds
adaLN_cond__grouped_kv_mqa__glu_gated_swiglu__prompt_kernel_f2dma_171:
    s_lshr_b32 s41, s3, 2
    s_cmp_lg_u32 s41, 0
    s_cbranch_scc1 adaLN_cond__grouped_kv_mqa__glu_gated_swiglu__prompt_kernel_f2dma_172
    s_and_b32 s41, s3, 3
    s_mul_i32 s44, s41, 5120
    s_add_u32 s44, s44, 81920
    s_add_u32 s42, s41, 40
    s_mul_i32 s43, s42, 40960
    s_add_u32 s43, s43, s48
    s_mov_b32 m0, s44
    s_nop 0
    buffer_load_dwordx4 v2, s[16:19], s43 offen  lds
    s_add_u32 s44, s44, 1024
    s_mov_b32 m0, s44
    s_nop 0
    buffer_load_dwordx4 v3, s[16:19], s43 offen  lds
    s_add_u32 s44, s44, 1024
    s_mov_b32 m0, s44
    s_nop 0
    buffer_load_dwordx4 v4, s[16:19], s43 offen  lds
    s_add_u32 s44, s44, 1024
    s_mov_b32 m0, s44
    s_nop 0
    buffer_load_dwordx4 v5, s[16:19], s43 offen  lds
    s_add_u32 s44, s44, 1024
    s_mov_b32 m0, s44
    s_nop 0
    buffer_load_dwordx4 v6, s[16:19], s43 offen  lds
adaLN_cond__grouped_kv_mqa__glu_gated_swiglu__prompt_kernel_f2dma_172:
    ds_read_b128 v[200:203], v142 offset:0
    ds_read_b128 v[204:207], v142 offset:256
    ds_read_b128 v[208:211], v142 offset:512
    ds_read_b128 v[212:215], v142 offset:768
    ds_read_b128 v[216:219], v142 offset:1024
    s_add_u32 s46, s49, 36864
    buffer_load_dwordx4 v[32:35], v7, s[20:23], s46 offen sc1
    s_waitcnt lgkmcnt(14)
    v_mfma_f32_16x16x32_bf16 v[56:59], v[220:223], v[40:43], v[56:59]
    s_waitcnt lgkmcnt(13)
    v_mfma_f32_16x16x32_bf16 v[60:63], v[224:227], v[40:43], v[60:63]
    s_waitcnt lgkmcnt(12)
    v_mfma_f32_16x16x32_bf16 v[64:67], v[228:231], v[40:43], v[64:67]
    s_waitcnt lgkmcnt(11)
    v_mfma_f32_16x16x32_bf16 v[68:71], v[232:235], v[40:43], v[68:71]
    s_waitcnt lgkmcnt(10)
    v_mfma_f32_16x16x32_bf16 v[72:75], v[236:239], v[40:43], v[72:75]
    ds_read_b128 v[220:223], v142 offset:10240
    ds_read_b128 v[224:227], v142 offset:10496
    ds_read_b128 v[228:231], v142 offset:10752
    ds_read_b128 v[232:235], v142 offset:11008
    ds_read_b128 v[236:239], v142 offset:11264
    s_add_u32 s46, s49, 38912
    buffer_load_dwordx4 v[36:39], v7, s[20:23], s46 offen sc1
    s_waitcnt lgkmcnt(14)
    v_mfma_f32_16x16x32_bf16 v[56:59], v[180:183], v[44:47], v[56:59]
    s_waitcnt lgkmcnt(13)
    v_mfma_f32_16x16x32_bf16 v[60:63], v[184:187], v[44:47], v[60:63]
    s_waitcnt lgkmcnt(12)
    v_mfma_f32_16x16x32_bf16 v[64:67], v[188:191], v[44:47], v[64:67]
    s_waitcnt lgkmcnt(11)
    v_mfma_f32_16x16x32_bf16 v[68:71], v[192:195], v[44:47], v[68:71]
    s_waitcnt lgkmcnt(10)
    v_mfma_f32_16x16x32_bf16 v[72:75], v[196:199], v[44:47], v[72:75]
    ds_read_b128 v[180:183], v140 offset:0
    ds_read_b128 v[184:187], v140 offset:256
    ds_read_b128 v[188:191], v140 offset:512
    ds_read_b128 v[192:195], v140 offset:768
    ds_read_b128 v[196:199], v140 offset:1024
    s_add_u32 s46, s49, 40960
    buffer_load_dwordx4 v[40:43], v7, s[20:23], s46 offen sc1
    s_waitcnt vmcnt(10) lgkmcnt(14)
    v_mfma_f32_16x16x32_bf16 v[56:59], v[200:203], v[48:51], v[56:59]
    s_waitcnt lgkmcnt(13)
    v_mfma_f32_16x16x32_bf16 v[60:63], v[204:207], v[48:51], v[60:63]
    s_waitcnt lgkmcnt(12)
    v_mfma_f32_16x16x32_bf16 v[64:67], v[208:211], v[48:51], v[64:67]
    s_waitcnt lgkmcnt(11)
    v_mfma_f32_16x16x32_bf16 v[68:71], v[212:215], v[48:51], v[68:71]
    s_waitcnt lgkmcnt(10)
    v_mfma_f32_16x16x32_bf16 v[72:75], v[216:219], v[48:51], v[72:75]
    ds_read_b128 v[200:203], v140 offset:10240
    ds_read_b128 v[204:207], v140 offset:10496
    ds_read_b128 v[208:211], v140 offset:10752
    ds_read_b128 v[212:215], v140 offset:11008
    ds_read_b128 v[216:219], v140 offset:11264
    s_add_u32 s46, s49, 43008
    buffer_load_dwordx4 v[44:47], v7, s[20:23], s46 offen sc1
    s_waitcnt vmcnt(10) lgkmcnt(14)
    v_mfma_f32_16x16x32_bf16 v[56:59], v[220:223], v[52:55], v[56:59]
    s_waitcnt lgkmcnt(13)
    v_mfma_f32_16x16x32_bf16 v[60:63], v[224:227], v[52:55], v[60:63]
    s_waitcnt lgkmcnt(12)
    v_mfma_f32_16x16x32_bf16 v[64:67], v[228:231], v[52:55], v[64:67]
    s_waitcnt lgkmcnt(11)
    v_mfma_f32_16x16x32_bf16 v[68:71], v[232:235], v[52:55], v[68:71]
    s_waitcnt lgkmcnt(10)
    v_mfma_f32_16x16x32_bf16 v[72:75], v[236:239], v[52:55], v[72:75]
    s_waitcnt vmcnt(8)
    s_barrier
    s_lshr_b32 s41, s3, 2
    s_cmp_lg_u32 s41, 1
    s_cbranch_scc1 adaLN_cond__grouped_kv_mqa__glu_gated_swiglu__prompt_kernel_f2dma_173
    s_and_b32 s41, s3, 3
    s_mul_i32 s44, s41, 5120
    s_add_u32 s44, s44, 102400
    s_add_u32 s42, s41, 44
    s_mul_i32 s43, s42, 40960
    s_add_u32 s43, s43, s48
    s_mov_b32 m0, s44
    s_nop 0
    buffer_load_dwordx4 v2, s[16:19], s43 offen  lds
    s_add_u32 s44, s44, 1024
    s_mov_b32 m0, s44
    s_nop 0
    buffer_load_dwordx4 v3, s[16:19], s43 offen  lds
    s_add_u32 s44, s44, 1024
    s_mov_b32 m0, s44
    s_nop 0
    buffer_load_dwordx4 v4, s[16:19], s43 offen  lds
    s_add_u32 s44, s44, 1024
    s_mov_b32 m0, s44
    s_nop 0
    buffer_load_dwordx4 v5, s[16:19], s43 offen  lds
    s_add_u32 s44, s44, 1024
    s_mov_b32 m0, s44
    s_nop 0
    buffer_load_dwordx4 v6, s[16:19], s43 offen  lds
adaLN_cond__grouped_kv_mqa__glu_gated_swiglu__prompt_kernel_f2dma_173:
    s_lshr_b32 s41, s3, 2
    s_cmp_lg_u32 s41, 0
    s_cbranch_scc1 adaLN_cond__grouped_kv_mqa__glu_gated_swiglu__prompt_kernel_f2dma_174
    s_and_b32 s41, s3, 3
    s_mul_i32 s44, s41, 5120
    s_add_u32 s44, s44, 122880
    s_add_u32 s42, s41, 48
    s_mul_i32 s43, s42, 40960
    s_add_u32 s43, s43, s48
    s_mov_b32 m0, s44
    s_nop 0
    buffer_load_dwordx4 v2, s[16:19], s43 offen  lds
    s_add_u32 s44, s44, 1024
    s_mov_b32 m0, s44
    s_nop 0
    buffer_load_dwordx4 v3, s[16:19], s43 offen  lds
    s_add_u32 s44, s44, 1024
    s_mov_b32 m0, s44
    s_nop 0
    buffer_load_dwordx4 v4, s[16:19], s43 offen  lds
    s_add_u32 s44, s44, 1024
    s_mov_b32 m0, s44
    s_nop 0
    buffer_load_dwordx4 v5, s[16:19], s43 offen  lds
    s_add_u32 s44, s44, 1024
    s_mov_b32 m0, s44
    s_nop 0
    buffer_load_dwordx4 v6, s[16:19], s43 offen  lds
adaLN_cond__grouped_kv_mqa__glu_gated_swiglu__prompt_kernel_f2dma_174:
    ds_read_b128 v[220:223], v140 offset:20480
    ds_read_b128 v[224:227], v140 offset:20736
    ds_read_b128 v[228:231], v140 offset:20992
    ds_read_b128 v[232:235], v140 offset:21248
    ds_read_b128 v[236:239], v140 offset:21504
    s_add_u32 s46, s49, 45056
    buffer_load_dwordx4 v[48:51], v7, s[20:23], s46 offen sc1
    s_waitcnt lgkmcnt(14)
    v_mfma_f32_16x16x32_bf16 v[56:59], v[180:183], v[8:11], v[56:59]
    s_waitcnt lgkmcnt(13)
    v_mfma_f32_16x16x32_bf16 v[60:63], v[184:187], v[8:11], v[60:63]
    s_waitcnt lgkmcnt(12)
    v_mfma_f32_16x16x32_bf16 v[64:67], v[188:191], v[8:11], v[64:67]
    s_waitcnt lgkmcnt(11)
    v_mfma_f32_16x16x32_bf16 v[68:71], v[192:195], v[8:11], v[68:71]
    s_waitcnt lgkmcnt(10)
    v_mfma_f32_16x16x32_bf16 v[72:75], v[196:199], v[8:11], v[72:75]
    ds_read_b128 v[180:183], v140 offset:30720
    ds_read_b128 v[184:187], v140 offset:30976
    ds_read_b128 v[188:191], v140 offset:31232
    ds_read_b128 v[192:195], v140 offset:31488
    ds_read_b128 v[196:199], v140 offset:31744
    s_add_u32 s46, s49, 47104
    buffer_load_dwordx4 v[52:55], v7, s[20:23], s46 offen sc1
    s_waitcnt lgkmcnt(14)
    v_mfma_f32_16x16x32_bf16 v[56:59], v[200:203], v[12:15], v[56:59]
    s_waitcnt lgkmcnt(13)
    v_mfma_f32_16x16x32_bf16 v[60:63], v[204:207], v[12:15], v[60:63]
    s_waitcnt lgkmcnt(12)
    v_mfma_f32_16x16x32_bf16 v[64:67], v[208:211], v[12:15], v[64:67]
    s_waitcnt lgkmcnt(11)
    v_mfma_f32_16x16x32_bf16 v[68:71], v[212:215], v[12:15], v[68:71]
    s_waitcnt lgkmcnt(10)
    v_mfma_f32_16x16x32_bf16 v[72:75], v[216:219], v[12:15], v[72:75]
    ds_read_b128 v[200:203], v140 offset:40960
    ds_read_b128 v[204:207], v140 offset:41216
    ds_read_b128 v[208:211], v140 offset:41472
    ds_read_b128 v[212:215], v140 offset:41728
    ds_read_b128 v[216:219], v140 offset:41984
    s_add_u32 s46, s49, 49152
    buffer_load_dwordx4 v[8:11], v7, s[20:23], s46 offen sc1
    s_waitcnt vmcnt(10) lgkmcnt(14)
    v_mfma_f32_16x16x32_bf16 v[56:59], v[220:223], v[16:19], v[56:59]
    s_waitcnt lgkmcnt(13)
    v_mfma_f32_16x16x32_bf16 v[60:63], v[224:227], v[16:19], v[60:63]
    s_waitcnt lgkmcnt(12)
    v_mfma_f32_16x16x32_bf16 v[64:67], v[228:231], v[16:19], v[64:67]
    s_waitcnt lgkmcnt(11)
    v_mfma_f32_16x16x32_bf16 v[68:71], v[232:235], v[16:19], v[68:71]
    s_waitcnt lgkmcnt(10)
    v_mfma_f32_16x16x32_bf16 v[72:75], v[236:239], v[16:19], v[72:75]
    ds_read_b128 v[220:223], v140 offset:51200
    ds_read_b128 v[224:227], v140 offset:51456
    ds_read_b128 v[228:231], v140 offset:51712
    ds_read_b128 v[232:235], v140 offset:51968
    ds_read_b128 v[236:239], v140 offset:52224
    s_add_u32 s46, s49, 51200
    buffer_load_dwordx4 v[12:15], v7, s[20:23], s46 offen sc1
    s_waitcnt vmcnt(10) lgkmcnt(14)
    v_mfma_f32_16x16x32_bf16 v[56:59], v[180:183], v[20:23], v[56:59]
    s_waitcnt lgkmcnt(13)
    v_mfma_f32_16x16x32_bf16 v[60:63], v[184:187], v[20:23], v[60:63]
    s_waitcnt lgkmcnt(12)
    v_mfma_f32_16x16x32_bf16 v[64:67], v[188:191], v[20:23], v[64:67]
    s_waitcnt lgkmcnt(11)
    v_mfma_f32_16x16x32_bf16 v[68:71], v[192:195], v[20:23], v[68:71]
    s_waitcnt lgkmcnt(10)
    v_mfma_f32_16x16x32_bf16 v[72:75], v[196:199], v[20:23], v[72:75]
    s_waitcnt vmcnt(8)
    s_barrier
    s_lshr_b32 s41, s3, 2
    s_cmp_lg_u32 s41, 1
    s_cbranch_scc1 adaLN_cond__grouped_kv_mqa__glu_gated_swiglu__prompt_kernel_f2dma_175
    s_and_b32 s41, s3, 3
    s_cmp_ge_u32 s41, 2
    s_cbranch_scc1 adaLN_cond__grouped_kv_mqa__glu_gated_swiglu__prompt_kernel_f2dma_175
    s_mul_i32 s44, s41, 5120
    s_add_u32 s44, s44, 0
    s_add_u32 s42, s41, 52
    s_mul_i32 s43, s42, 40960
    s_add_u32 s43, s43, s48
    s_mov_b32 m0, s44
    s_nop 0
    buffer_load_dwordx4 v2, s[16:19], s43 offen  lds
    s_add_u32 s44, s44, 1024
    s_mov_b32 m0, s44
    s_nop 0
    buffer_load_dwordx4 v3, s[16:19], s43 offen  lds
    s_add_u32 s44, s44, 1024
    s_mov_b32 m0, s44
    s_nop 0
    buffer_load_dwordx4 v4, s[16:19], s43 offen  lds
    s_add_u32 s44, s44, 1024
    s_mov_b32 m0, s44
    s_nop 0
    buffer_load_dwordx4 v5, s[16:19], s43 offen  lds
    s_add_u32 s44, s44, 1024
    s_mov_b32 m0, s44
    s_nop 0
    buffer_load_dwordx4 v6, s[16:19], s43 offen  lds
adaLN_cond__grouped_kv_mqa__glu_gated_swiglu__prompt_kernel_f2dma_175:
    ds_read_b128 v[180:183], v141 offset:0
    ds_read_b128 v[184:187], v141 offset:256
    ds_read_b128 v[188:191], v141 offset:512
    ds_read_b128 v[192:195], v141 offset:768
    ds_read_b128 v[196:199], v141 offset:1024
    s_add_u32 s46, s49, 53248
    buffer_load_dwordx4 v[16:19], v7, s[20:23], s46 offen sc1
    s_waitcnt lgkmcnt(14)
    v_mfma_f32_16x16x32_bf16 v[56:59], v[200:203], v[24:27], v[56:59]
    s_waitcnt lgkmcnt(13)
    v_mfma_f32_16x16x32_bf16 v[60:63], v[204:207], v[24:27], v[60:63]
    s_waitcnt lgkmcnt(12)
    v_mfma_f32_16x16x32_bf16 v[64:67], v[208:211], v[24:27], v[64:67]
    s_waitcnt lgkmcnt(11)
    v_mfma_f32_16x16x32_bf16 v[68:71], v[212:215], v[24:27], v[68:71]
    s_waitcnt lgkmcnt(10)
    v_mfma_f32_16x16x32_bf16 v[72:75], v[216:219], v[24:27], v[72:75]
    ds_read_b128 v[200:203], v141 offset:10240
    ds_read_b128 v[204:207], v141 offset:10496
    ds_read_b128 v[208:211], v141 offset:10752
    ds_read_b128 v[212:215], v141 offset:11008
    ds_read_b128 v[216:219], v141 offset:11264
    s_waitcnt lgkmcnt(14)
    v_mfma_f32_16x16x32_bf16 v[56:59], v[220:223], v[28:31], v[56:59]
    s_waitcnt lgkmcnt(13)
    v_mfma_f32_16x16x32_bf16 v[60:63], v[224:227], v[28:31], v[60:63]
    s_waitcnt lgkmcnt(12)
    v_mfma_f32_16x16x32_bf16 v[64:67], v[228:231], v[28:31], v[64:67]
    s_waitcnt lgkmcnt(11)
    v_mfma_f32_16x16x32_bf16 v[68:71], v[232:235], v[28:31], v[68:71]
    s_waitcnt lgkmcnt(10)
    v_mfma_f32_16x16x32_bf16 v[72:75], v[236:239], v[28:31], v[72:75]
    ds_read_b128 v[220:223], v141 offset:20480
    ds_read_b128 v[224:227], v141 offset:20736
    ds_read_b128 v[228:231], v141 offset:20992
    ds_read_b128 v[232:235], v141 offset:21248
    ds_read_b128 v[236:239], v141 offset:21504
    s_waitcnt vmcnt(8) lgkmcnt(14)
    v_mfma_f32_16x16x32_bf16 v[56:59], v[180:183], v[32:35], v[56:59]
    s_waitcnt lgkmcnt(13)
    v_mfma_f32_16x16x32_bf16 v[60:63], v[184:187], v[32:35], v[60:63]
    s_waitcnt lgkmcnt(12)
    v_mfma_f32_16x16x32_bf16 v[64:67], v[188:191], v[32:35], v[64:67]
    s_waitcnt lgkmcnt(11)
    v_mfma_f32_16x16x32_bf16 v[68:71], v[192:195], v[32:35], v[68:71]
    s_waitcnt lgkmcnt(10)
    v_mfma_f32_16x16x32_bf16 v[72:75], v[196:199], v[32:35], v[72:75]
    ds_read_b128 v[180:183], v141 offset:30720
    ds_read_b128 v[184:187], v141 offset:30976
    ds_read_b128 v[188:191], v141 offset:31232
    ds_read_b128 v[192:195], v141 offset:31488
    ds_read_b128 v[196:199], v141 offset:31744
    s_waitcnt vmcnt(7) lgkmcnt(14)
    v_mfma_f32_16x16x32_bf16 v[56:59], v[200:203], v[36:39], v[56:59]
    s_waitcnt lgkmcnt(13)
    v_mfma_f32_16x16x32_bf16 v[60:63], v[204:207], v[36:39], v[60:63]
    s_waitcnt lgkmcnt(12)
    v_mfma_f32_16x16x32_bf16 v[64:67], v[208:211], v[36:39], v[64:67]
    s_waitcnt lgkmcnt(11)
    v_mfma_f32_16x16x32_bf16 v[68:71], v[212:215], v[36:39], v[68:71]
    s_waitcnt lgkmcnt(10)
    v_mfma_f32_16x16x32_bf16 v[72:75], v[216:219], v[36:39], v[72:75]
    s_waitcnt vmcnt(5)
    s_barrier
    ds_read_b128 v[200:203], v141 offset:40960
    ds_read_b128 v[204:207], v141 offset:41216
    ds_read_b128 v[208:211], v141 offset:41472
    ds_read_b128 v[212:215], v141 offset:41728
    ds_read_b128 v[216:219], v141 offset:41984
    s_waitcnt lgkmcnt(14)
    v_mfma_f32_16x16x32_bf16 v[56:59], v[220:223], v[40:43], v[56:59]
    s_waitcnt lgkmcnt(13)
    v_mfma_f32_16x16x32_bf16 v[60:63], v[224:227], v[40:43], v[60:63]
    s_waitcnt lgkmcnt(12)
    v_mfma_f32_16x16x32_bf16 v[64:67], v[228:231], v[40:43], v[64:67]
    s_waitcnt lgkmcnt(11)
    v_mfma_f32_16x16x32_bf16 v[68:71], v[232:235], v[40:43], v[68:71]
    s_waitcnt lgkmcnt(10)
    v_mfma_f32_16x16x32_bf16 v[72:75], v[236:239], v[40:43], v[72:75]
    ds_read_b128 v[220:223], v141 offset:51200
    ds_read_b128 v[224:227], v141 offset:51456
    ds_read_b128 v[228:231], v141 offset:51712
    ds_read_b128 v[232:235], v141 offset:51968
    ds_read_b128 v[236:239], v141 offset:52224
    s_waitcnt lgkmcnt(14)
    v_mfma_f32_16x16x32_bf16 v[56:59], v[180:183], v[44:47], v[56:59]
    s_waitcnt lgkmcnt(13)
    v_mfma_f32_16x16x32_bf16 v[60:63], v[184:187], v[44:47], v[60:63]
    s_waitcnt lgkmcnt(12)
    v_mfma_f32_16x16x32_bf16 v[64:67], v[188:191], v[44:47], v[64:67]
    s_waitcnt lgkmcnt(11)
    v_mfma_f32_16x16x32_bf16 v[68:71], v[192:195], v[44:47], v[68:71]
    s_waitcnt lgkmcnt(10)
    v_mfma_f32_16x16x32_bf16 v[72:75], v[196:199], v[44:47], v[72:75]
    ds_read_b128 v[180:183], v142 offset:0
    ds_read_b128 v[184:187], v142 offset:256
    ds_read_b128 v[188:191], v142 offset:512
    ds_read_b128 v[192:195], v142 offset:768
    ds_read_b128 v[196:199], v142 offset:1024
    s_waitcnt vmcnt(4) lgkmcnt(14)
    v_mfma_f32_16x16x32_bf16 v[56:59], v[200:203], v[48:51], v[56:59]
    s_waitcnt lgkmcnt(13)
    v_mfma_f32_16x16x32_bf16 v[60:63], v[204:207], v[48:51], v[60:63]
    s_waitcnt lgkmcnt(12)
    v_mfma_f32_16x16x32_bf16 v[64:67], v[208:211], v[48:51], v[64:67]
    s_waitcnt lgkmcnt(11)
    v_mfma_f32_16x16x32_bf16 v[68:71], v[212:215], v[48:51], v[68:71]
    s_waitcnt lgkmcnt(10)
    v_mfma_f32_16x16x32_bf16 v[72:75], v[216:219], v[48:51], v[72:75]
    ds_read_b128 v[200:203], v142 offset:10240
    ds_read_b128 v[204:207], v142 offset:10496
    ds_read_b128 v[208:211], v142 offset:10752
    ds_read_b128 v[212:215], v142 offset:11008
    ds_read_b128 v[216:219], v142 offset:11264
    s_waitcnt vmcnt(3) lgkmcnt(14)
    v_mfma_f32_16x16x32_bf16 v[56:59], v[220:223], v[52:55], v[56:59]
    s_waitcnt lgkmcnt(13)
    v_mfma_f32_16x16x32_bf16 v[60:63], v[224:227], v[52:55], v[60:63]
    s_waitcnt lgkmcnt(12)
    v_mfma_f32_16x16x32_bf16 v[64:67], v[228:231], v[52:55], v[64:67]
    s_waitcnt lgkmcnt(11)
    v_mfma_f32_16x16x32_bf16 v[68:71], v[232:235], v[52:55], v[68:71]
    s_waitcnt lgkmcnt(10)
    v_mfma_f32_16x16x32_bf16 v[72:75], v[236:239], v[52:55], v[72:75]
    s_waitcnt vmcnt(1)
    s_barrier
    ds_read_b128 v[220:223], v140 offset:0
    ds_read_b128 v[224:227], v140 offset:256
    ds_read_b128 v[228:231], v140 offset:512
    ds_read_b128 v[232:235], v140 offset:768
    ds_read_b128 v[236:239], v140 offset:1024
    s_waitcnt lgkmcnt(14)
    v_mfma_f32_16x16x32_bf16 v[56:59], v[180:183], v[8:11], v[56:59]
    s_waitcnt lgkmcnt(13)
    v_mfma_f32_16x16x32_bf16 v[60:63], v[184:187], v[8:11], v[60:63]
    s_waitcnt lgkmcnt(12)
    v_mfma_f32_16x16x32_bf16 v[64:67], v[188:191], v[8:11], v[64:67]
    s_waitcnt lgkmcnt(11)
    v_mfma_f32_16x16x32_bf16 v[68:71], v[192:195], v[8:11], v[68:71]
    s_waitcnt lgkmcnt(10)
    v_mfma_f32_16x16x32_bf16 v[72:75], v[196:199], v[8:11], v[72:75]
    s_waitcnt lgkmcnt(9)
    v_mfma_f32_16x16x32_bf16 v[56:59], v[200:203], v[12:15], v[56:59]
    s_waitcnt lgkmcnt(8)
    v_mfma_f32_16x16x32_bf16 v[60:63], v[204:207], v[12:15], v[60:63]
    s_waitcnt lgkmcnt(7)
    v_mfma_f32_16x16x32_bf16 v[64:67], v[208:211], v[12:15], v[64:67]
    s_waitcnt lgkmcnt(6)
    v_mfma_f32_16x16x32_bf16 v[68:71], v[212:215], v[12:15], v[68:71]
    s_waitcnt lgkmcnt(5)
    v_mfma_f32_16x16x32_bf16 v[72:75], v[216:219], v[12:15], v[72:75]
    s_waitcnt vmcnt(0) lgkmcnt(4)
    v_mfma_f32_16x16x32_bf16 v[56:59], v[220:223], v[16:19], v[56:59]
    s_waitcnt lgkmcnt(3)
    v_mfma_f32_16x16x32_bf16 v[60:63], v[224:227], v[16:19], v[60:63]
    s_waitcnt lgkmcnt(2)
    v_mfma_f32_16x16x32_bf16 v[64:67], v[228:231], v[16:19], v[64:67]
    s_waitcnt lgkmcnt(1)
    v_mfma_f32_16x16x32_bf16 v[68:71], v[232:235], v[16:19], v[68:71]
    s_waitcnt lgkmcnt(0)
    v_mfma_f32_16x16x32_bf16 v[72:75], v[236:239], v[16:19], v[72:75]
    s_waitcnt lgkmcnt(0)
    s_barrier
    s_and_b32 s40, s3, 3
    s_mul_i32 s40, s40, 5120
    v_lshlrev_b32 v116, 4, v1
    v_add_u32 v116, s40, v116
    v_add_u32 v116, 0, v116
    s_cmp_ge_u32 s3, 4
    s_cbranch_scc1 adaLN_cond__grouped_kv_mqa__glu_gated_swiglu__prompt_kernel_xp1_176
    ds_write_b128 v116, v[68:71] offset:3072
    ds_write_b128 v116, v[72:75] offset:4096
    s_branch adaLN_cond__grouped_kv_mqa__glu_gated_swiglu__prompt_kernel_xj1_177
adaLN_cond__grouped_kv_mqa__glu_gated_swiglu__prompt_kernel_xp1_176:
    ds_write_b128 v116, v[56:59] offset:0
    ds_write_b128 v116, v[60:63] offset:1024
    ds_write_b128 v116, v[64:67] offset:2048
adaLN_cond__grouped_kv_mqa__glu_gated_swiglu__prompt_kernel_xj1_177:
    s_waitcnt lgkmcnt(0)
    s_barrier
    v_lshrrev_b32 v121, 4, v1
    v_lshlrev_b32 v122, 4, v121
    s_mul_i32 s43, s37, 320
    v_add_u32 v122, s43, v122
    v_add_u32 v122, 143360, v122
    s_and_b32 s40, s3, 3
    v_lshlrev_b32 v124, 3, v1
    s_mul_i32 s43, s40, 2560
    s_add_u32 s43, s43, 152064
    v_add_u32 v124, s43, v124
    v_and_b32 v117, 15, v1
    s_lshl_b32 s40, s40, 4
    s_add_u32 s40, s40, s36
    v_add_u32 v117, s40, v117
    v_mul_u32_u24 v117, 1280, v117
    v_lshl_add_u32 v123, v121, 3, v117
    s_mul_i32 s42, s37, 160
    s_cmp_ge_u32 s3, 4
    s_cbranch_scc1 adaLN_cond__grouped_kv_mqa__glu_gated_swiglu__prompt_kernel_fp1_178
    ds_read_b128 v[144:147], v116 offset:0
    ds_read_b128 v[160:163], v122 offset:0
    ds_read_b64 v[176:177], v124 offset:0
    ds_read_b128 v[148:151], v116 offset:1024
    ds_read_b128 v[164:167], v122 offset:64
    ds_read_b64 v[178:179], v124 offset:512
    ds_read_b128 v[152:155], v116 offset:2048
    ds_read_b128 v[168:171], v122 offset:128
    ds_read_b64 v[180:181], v124 offset:1024
    s_waitcnt lgkmcnt(6)
    v_lshlrev_b32 v128, 16, v176
    v_and_b32 v129, 0xffff0000, v176
    v_lshlrev_b32 v130, 16, v177
    v_and_b32 v131, 0xffff0000, v177
    v_add_f32 v144, v144, v56
    v_fma_f32 v144, v144, v160, v128
    v_add_f32 v145, v145, v57
    v_fma_f32 v145, v145, v161, v129
    v_add_f32 v146, v146, v58
    v_fma_f32 v146, v146, v162, v130
    v_add_f32 v147, v147, v59
    v_fma_f32 v147, v147, v163, v131
    v_cvt_pk_bf16_f32 v176, v144, v145
    v_cvt_pk_bf16_f32 v177, v146, v147
    buffer_store_dwordx2 v[176:177], v123, s[28:31], s42 offen offset:0
    s_waitcnt lgkmcnt(3)
    v_lshlrev_b32 v128, 16, v178
    v_and_b32 v129, 0xffff0000, v178
    v_lshlrev_b32 v130, 16, v179
    v_and_b32 v131, 0xffff0000, v179
    v_add_f32 v148, v148, v60
    v_fma_f32 v148, v148, v164, v128
    v_add_f32 v149, v149, v61
    v_fma_f32 v149, v149, v165, v129
    v_add_f32 v150, v150, v62
    v_fma_f32 v150, v150, v166, v130
    v_add_f32 v151, v151, v63
    v_fma_f32 v151, v151, v167, v131
    v_cvt_pk_bf16_f32 v178, v148, v149
    v_cvt_pk_bf16_f32 v179, v150, v151
    buffer_store_dwordx2 v[178:179], v123, s[28:31], s42 offen offset:32
    s_waitcnt lgkmcnt(0)
    v_lshlrev_b32 v128, 16, v180
    v_and_b32 v129, 0xffff0000, v180
    v_lshlrev_b32 v130, 16, v181
    v_and_b32 v131, 0xffff0000, v181
    v_add_f32 v152, v152, v64
    v_fma_f32 v152, v152, v168, v128
    v_add_f32 v153, v153, v65
    v_fma_f32 v153, v153, v169, v129
    v_add_f32 v154, v154, v66
    v_fma_f32 v154, v154, v170, v130
    v_add_f32 v155, v155, v67
    v_fma_f32 v155, v155, v171, v131
    v_cvt_pk_bf16_f32 v180, v152, v153
    v_cvt_pk_bf16_f32 v181, v154, v155
    buffer_store_dwordx2 v[180:181], v123, s[28:31], s42 offen offset:64
    s_branch adaLN_cond__grouped_kv_mqa__glu_gated_swiglu__prompt_kernel_fj1_179
adaLN_cond__grouped_kv_mqa__glu_gated_swiglu__prompt_kernel_fp1_178:
    ds_read_b128 v[144:147], v116 offset:3072
    ds_read_b128 v[160:163], v122 offset:192
    ds_read_b64 v[176:177], v124 offset:1536
    ds_read_b128 v[148:151], v116 offset:4096
    ds_read_b128 v[164:167], v122 offset:256
    ds_read_b64 v[178:179], v124 offset:2048
    s_waitcnt lgkmcnt(3)
    v_lshlrev_b32 v128, 16, v176
    v_and_b32 v129, 0xffff0000, v176
    v_lshlrev_b32 v130, 16, v177
    v_and_b32 v131, 0xffff0000, v177
    v_add_f32 v144, v144, v68
    v_fma_f32 v144, v144, v160, v128
    v_add_f32 v145, v145, v69
    v_fma_f32 v145, v145, v161, v129
    v_add_f32 v146, v146, v70
    v_fma_f32 v146, v146, v162, v130
    v_add_f32 v147, v147, v71
    v_fma_f32 v147, v147, v163, v131
    v_cvt_pk_bf16_f32 v176, v144, v145
    v_cvt_pk_bf16_f32 v177, v146, v147
    buffer_store_dwordx2 v[176:177], v123, s[28:31], s42 offen offset:96
    s_waitcnt lgkmcnt(0)
    v_lshlrev_b32 v128, 16, v178
    v_and_b32 v129, 0xffff0000, v178
    v_lshlrev_b32 v130, 16, v179
    v_and_b32 v131, 0xffff0000, v179
    v_add_f32 v148, v148, v72
    v_fma_f32 v148, v148, v164, v128
    v_add_f32 v149, v149, v73
    v_fma_f32 v149, v149, v165, v129
    v_add_f32 v150, v150, v74
    v_fma_f32 v150, v150, v166, v130
    v_add_f32 v151, v151, v75
    v_fma_f32 v151, v151, v167, v131
    v_cvt_pk_bf16_f32 v178, v148, v149
    v_cvt_pk_bf16_f32 v179, v150, v151
    buffer_store_dwordx2 v[178:179], v123, s[28:31], s42 offen offset:128
adaLN_cond__grouped_kv_mqa__glu_gated_swiglu__prompt_kernel_fj1_179:
mega_end:
    s_endpgm
adaLN_cond__grouped_kv_mqa__glu_gated_swiglu__prompt_kernel_ool_52:
    v_lshlrev_b32 v232, 4, v1
    s_mov_b32 s42, 12288
    buffer_load_dwordx4 v[234:237], v232, s[60:63], s42 offen sc1
    s_branch adaLN_cond__grouped_kv_mqa__glu_gated_swiglu__prompt_kernel_ret_53
adaLN_cond__grouped_kv_mqa__glu_gated_swiglu__prompt_kernel_ool_54:
    s_cmp_lg_u32 s3, 6
    s_cbranch_scc1 adaLN_cond__grouped_kv_mqa__glu_gated_swiglu__prompt_kernel_wk_181
    s_add_u32 s38, s2, 0
    s_mov_b32 s39, 143360
    s_cmp_ge_u32 s38, 782
    s_cbranch_scc1 adaLN_cond__grouped_kv_mqa__glu_gated_swiglu__prompt_kernel_rl_done_182
    s_cmp_ge_u32 s38, 80
    s_cbranch_scc1 adaLN_cond__grouped_kv_mqa__glu_gated_swiglu__prompt_kernel_rl_next_183
    s_sub_u32 s40, s38, 0
    s_mul_i32 s41, s40, 6554
    s_lshr_b32 s41, s41, 16
    s_mul_i32 s42, s41, 10
    s_sub_u32 s42, s40, s42
    s_load_dwordx2 s[44:45], s[0:1], 32
    s_waitcnt lgkmcnt(0)
    s_mov_b32 s52, s44
    s_mov_b32 s53, s45
    s_mov_b32 s54, 819200
    s_mov_b32 s55, 0x00020000
    s_mul_i32 s43, s41, 102400
    s_lshl_b32 s44, s42, 7
    s_add_u32 s43, s43, s44
    v_lshrrev_b32 v160, 3, v1
    s_mov_b32 s44, 1280
    v_mul_lo_u32 v160, v160, s44
    v_and_b32 v161, 7, v1
    v_lshl_add_u32 v160, v161, 4, v160
    s_mov_b32 s44, s39
    s_mov_b32 m0, s44
    s_nop 0
    buffer_load_dwordx4 v160, s[52:55], s43 offen lds
    s_add_u32 s43, s43, 10240
    s_add_u32 s44, s44, 1024
    s_mov_b32 m0, s44
    s_nop 0
    buffer_load_dwordx4 v160, s[52:55], s43 offen lds
    s_add_u32 s43, s43, 10240
    s_add_u32 s44, s44, 1024
    s_mov_b32 m0, s44
    s_nop 0
    buffer_load_dwordx4 v160, s[52:55], s43 offen lds
    s_add_u32 s43, s43, 10240
    s_add_u32 s44, s44, 1024
    s_mov_b32 m0, s44
    s_nop 0
    buffer_load_dwordx4 v160, s[52:55], s43 offen lds
    s_add_u32 s43, s43, 10240
    s_add_u32 s44, s44, 1024
    s_mov_b32 m0, s44
    s_nop 0
    buffer_load_dwordx4 v160, s[52:55], s43 offen lds
    s_add_u32 s43, s43, 10240
    s_add_u32 s44, s44, 1024
    s_mov_b32 m0, s44
    s_nop 0
    buffer_load_dwordx4 v160, s[52:55], s43 offen lds
    s_add_u32 s43, s43, 10240
    s_add_u32 s44, s44, 1024
    s_mov_b32 m0, s44
    s_nop 0
    buffer_load_dwordx4 v160, s[52:55], s43 offen lds
    s_add_u32 s43, s43, 10240
    s_add_u32 s44, s44, 1024
    s_mov_b32 m0, s44
    s_nop 0
    buffer_load_dwordx4 v160, s[52:55], s43 offen lds
    s_add_u32 s43, s43, 10240
    s_add_u32 s44, s44, 1024
    s_mov_b32 m0, s44
    s_nop 0
    buffer_load_dwordx4 v160, s[52:55], s43 offen lds
    s_add_u32 s43, s43, 10240
    s_add_u32 s44, s44, 1024
    s_mov_b32 m0, s44
    s_nop 0
    buffer_load_dwordx4 v160, s[52:55], s43 offen lds
    s_branch adaLN_cond__grouped_kv_mqa__glu_gated_swiglu__prompt_kernel_rl_done_182
adaLN_cond__grouped_kv_mqa__glu_gated_swiglu__prompt_kernel_rl_next_183:
    s_cmp_ge_u32 s38, 296
    s_cbranch_scc1 adaLN_cond__grouped_kv_mqa__glu_gated_swiglu__prompt_kernel_rl_next_184
    s_sub_u32 s40, s38, 80
    s_mul_i32 s41, s40, 2428
    s_lshr_b32 s41, s41, 16
    s_mul_i32 s42, s41, 27
    s_sub_u32 s42, s40, s42
    s_load_dwordx2 s[44:45], s[0:1], 48
    s_waitcnt lgkmcnt(0)
    s_mov_b32 s52, s44
    s_mov_b32 s53, s45
    s_mov_b32 s54, 2211840
    s_mov_b32 s55, 0x00020000
    s_mul_i32 s43, s41, 276480
    s_lshl_b32 s44, s42, 7
    s_add_u32 s43, s43, s44
    v_lshrrev_b32 v160, 3, v1
    s_mov_b32 s44, 3456
    v_mul_lo_u32 v160, v160, s44
    v_and_b32 v161, 7, v1
    v_lshl_add_u32 v160, v161, 4, v160
    s_mov_b32 s44, s39
    s_mov_b32 m0, s44
    s_nop 0
    buffer_load_dwordx4 v160, s[52:55], s43 offen lds
    s_add_u32 s43, s43, 27648
    s_add_u32 s44, s44, 1024
    s_mov_b32 m0, s44
    s_nop 0
    buffer_load_dwordx4 v160, s[52:55], s43 offen lds
    s_add_u32 s43, s43, 27648
    s_add_u32 s44, s44, 1024
    s_mov_b32 m0, s44
    s_nop 0
    buffer_load_dwordx4 v160, s[52:55], s43 offen lds
    s_add_u32 s43, s43, 27648
    s_add_u32 s44, s44, 1024
    s_mov_b32 m0, s44
    s_nop 0
    buffer_load_dwordx4 v160, s[52:55], s43 offen lds
    s_add_u32 s43, s43, 27648
    s_add_u32 s44, s44, 1024
    s_mov_b32 m0, s44
    s_nop 0
    buffer_load_dwordx4 v160, s[52:55], s43 offen lds
    s_add_u32 s43, s43, 27648
    s_add_u32 s44, s44, 1024
    s_mov_b32 m0, s44
    s_nop 0
    buffer_load_dwordx4 v160, s[52:55], s43 offen lds
    s_add_u32 s43, s43, 27648
    s_add_u32 s44, s44, 1024
    s_mov_b32 m0, s44
    s_nop 0
    buffer_load_dwordx4 v160, s[52:55], s43 offen lds
    s_add_u32 s43, s43, 27648
    s_add_u32 s44, s44, 1024
    s_mov_b32 m0, s44
    s_nop 0
    buffer_load_dwordx4 v160, s[52:55], s43 offen lds
    s_add_u32 s43, s43, 27648
    s_add_u32 s44, s44, 1024
    s_mov_b32 m0, s44
    s_nop 0
    buffer_load_dwordx4 v160, s[52:55], s43 offen lds
    s_add_u32 s43, s43, 27648
    s_add_u32 s44, s44, 1024
    s_mov_b32 m0, s44
    s_nop 0
    buffer_load_dwordx4 v160, s[52:55], s43 offen lds
    s_branch adaLN_cond__grouped_kv_mqa__glu_gated_swiglu__prompt_kernel_rl_done_182
adaLN_cond__grouped_kv_mqa__glu_gated_swiglu__prompt_kernel_rl_next_184:
adaLN_cond__grouped_kv_mqa__glu_gated_swiglu__prompt_kernel_rl_done_182:
    s_branch adaLN_cond__grouped_kv_mqa__glu_gated_swiglu__prompt_kernel_wkd_180
adaLN_cond__grouped_kv_mqa__glu_gated_swiglu__prompt_kernel_wk_181:
    s_cmp_lg_u32 s3, 7
    s_cbranch_scc1 adaLN_cond__grouped_kv_mqa__glu_gated_swiglu__prompt_kernel_wk_185
    s_add_u32 s38, s2, 256
    s_mov_b32 s39, 153600
    s_cmp_ge_u32 s38, 782
    s_cbranch_scc1 adaLN_cond__grouped_kv_mqa__glu_gated_swiglu__prompt_kernel_rl_done_186
    s_cmp_ge_u32 s38, 296
    s_cbranch_scc1 adaLN_cond__grouped_kv_mqa__glu_gated_swiglu__prompt_kernel_rl_next_187
    s_sub_u32 s40, s38, 80
    s_mul_i32 s41, s40, 2428
    s_lshr_b32 s41, s41, 16
    s_mul_i32 s42, s41, 27
    s_sub_u32 s42, s40, s42
    s_load_dwordx2 s[44:45], s[0:1], 48
    s_waitcnt lgkmcnt(0)
    s_mov_b32 s52, s44
    s_mov_b32 s53, s45
    s_mov_b32 s54, 2211840
    s_mov_b32 s55, 0x00020000
    s_mul_i32 s43, s41, 276480
    s_lshl_b32 s44, s42, 7
    s_add_u32 s43, s43, s44
    v_lshrrev_b32 v160, 3, v1
    s_mov_b32 s44, 3456
    v_mul_lo_u32 v160, v160, s44
    v_and_b32 v161, 7, v1
    v_lshl_add_u32 v160, v161, 4, v160
    s_mov_b32 s44, s39
    s_mov_b32 m0, s44
    s_nop 0
    buffer_load_dwordx4 v160, s[52:55], s43 offen lds
    s_add_u32 s43, s43, 27648
    s_add_u32 s44, s44, 1024
    s_mov_b32 m0, s44
    s_nop 0
    buffer_load_dwordx4 v160, s[52:55], s43 offen lds
    s_add_u32 s43, s43, 27648
    s_add_u32 s44, s44, 1024
    s_mov_b32 m0, s44
    s_nop 0
    buffer_load_dwordx4 v160, s[52:55], s43 offen lds
    s_add_u32 s43, s43, 27648
    s_add_u32 s44, s44, 1024
    s_mov_b32 m0, s44
    s_nop 0
    buffer_load_dwordx4 v160, s[52:55], s43 offen lds
    s_add_u32 s43, s43, 27648
    s_add_u32 s44, s44, 1024
    s_mov_b32 m0, s44
    s_nop 0
    buffer_load_dwordx4 v160, s[52:55], s43 offen lds
    s_add_u32 s43, s43, 27648
    s_add_u32 s44, s44, 1024
    s_mov_b32 m0, s44
    s_nop 0
    buffer_load_dwordx4 v160, s[52:55], s43 offen lds
    s_add_u32 s43, s43, 27648
    s_add_u32 s44, s44, 1024
    s_mov_b32 m0, s44
    s_nop 0
    buffer_load_dwordx4 v160, s[52:55], s43 offen lds
    s_add_u32 s43, s43, 27648
    s_add_u32 s44, s44, 1024
    s_mov_b32 m0, s44
    s_nop 0
    buffer_load_dwordx4 v160, s[52:55], s43 offen lds
    s_add_u32 s43, s43, 27648
    s_add_u32 s44, s44, 1024
    s_mov_b32 m0, s44
    s_nop 0
    buffer_load_dwordx4 v160, s[52:55], s43 offen lds
    s_add_u32 s43, s43, 27648
    s_add_u32 s44, s44, 1024
    s_mov_b32 m0, s44
    s_nop 0
    buffer_load_dwordx4 v160, s[52:55], s43 offen lds
    s_branch adaLN_cond__grouped_kv_mqa__glu_gated_swiglu__prompt_kernel_rl_done_186
adaLN_cond__grouped_kv_mqa__glu_gated_swiglu__prompt_kernel_rl_next_187:
    s_cmp_ge_u32 s38, 512
    s_cbranch_scc1 adaLN_cond__grouped_kv_mqa__glu_gated_swiglu__prompt_kernel_rl_next_188
    s_sub_u32 s40, s38, 296
    s_mul_i32 s41, s40, 2428
    s_lshr_b32 s41, s41, 16
    s_mul_i32 s42, s41, 27
    s_sub_u32 s42, s40, s42
    s_load_dwordx2 s[44:45], s[0:1], 56
    s_waitcnt lgkmcnt(0)
    s_mov_b32 s52, s44
    s_mov_b32 s53, s45
    s_mov_b32 s54, 2211840
    s_mov_b32 s55, 0x00020000
    s_mul_i32 s43, s41, 276480
    s_lshl_b32 s44, s42, 7
    s_add_u32 s43, s43, s44
    v_lshrrev_b32 v160, 3, v1
    s_mov_b32 s44, 3456
    v_mul_lo_u32 v160, v160, s44
    v_and_b32 v161, 7, v1
    v_lshl_add_u32 v160, v161, 4, v160
    s_mov_b32 s44, s39
    s_mov_b32 m0, s44
    s_nop 0
    buffer_load_dwordx4 v160, s[52:55], s43 offen lds
    s_add_u32 s43, s43, 27648
    s_add_u32 s44, s44, 1024
    s_mov_b32 m0, s44
    s_nop 0
    buffer_load_dwordx4 v160, s[52:55], s43 offen lds
    s_add_u32 s43, s43, 27648
    s_add_u32 s44, s44, 1024
    s_mov_b32 m0, s44
    s_nop 0
    buffer_load_dwordx4 v160, s[52:55], s43 offen lds
    s_add_u32 s43, s43, 27648
    s_add_u32 s44, s44, 1024
    s_mov_b32 m0, s44
    s_nop 0
    buffer_load_dwordx4 v160, s[52:55], s43 offen lds
    s_add_u32 s43, s43, 27648
    s_add_u32 s44, s44, 1024
    s_mov_b32 m0, s44
    s_nop 0
    buffer_load_dwordx4 v160, s[52:55], s43 offen lds
    s_add_u32 s43, s43, 27648
    s_add_u32 s44, s44, 1024
    s_mov_b32 m0, s44
    s_nop 0
    buffer_load_dwordx4 v160, s[52:55], s43 offen lds
    s_add_u32 s43, s43, 27648
    s_add_u32 s44, s44, 1024
    s_mov_b32 m0, s44
    s_nop 0
    buffer_load_dwordx4 v160, s[52:55], s43 offen lds
    s_add_u32 s43, s43, 27648
    s_add_u32 s44, s44, 1024
    s_mov_b32 m0, s44
    s_nop 0
    buffer_load_dwordx4 v160, s[52:55], s43 offen lds
    s_add_u32 s43, s43, 27648
    s_add_u32 s44, s44, 1024
    s_mov_b32 m0, s44
    s_nop 0
    buffer_load_dwordx4 v160, s[52:55], s43 offen lds
    s_add_u32 s43, s43, 27648
    s_add_u32 s44, s44, 1024
    s_mov_b32 m0, s44
    s_nop 0
    buffer_load_dwordx4 v160, s[52:55], s43 offen lds
    s_branch adaLN_cond__grouped_kv_mqa__glu_gated_swiglu__prompt_kernel_rl_done_186
adaLN_cond__grouped_kv_mqa__glu_gated_swiglu__prompt_kernel_rl_next_188:
adaLN_cond__grouped_kv_mqa__glu_gated_swiglu__prompt_kernel_rl_done_186:
    s_branch adaLN_cond__grouped_kv_mqa__glu_gated_swiglu__prompt_kernel_wkd_180
adaLN_cond__grouped_kv_mqa__glu_gated_swiglu__prompt_kernel_wk_185:
    s_cmp_lg_u32 s3, 4
    s_cbranch_scc1 adaLN_cond__grouped_kv_mqa__glu_gated_swiglu__prompt_kernel_wk_189
    s_add_u32 s38, s2, 512
    s_mov_b32 s39, 122880
    s_cmp_ge_u32 s38, 782
    s_cbranch_scc1 adaLN_cond__grouped_kv_mqa__glu_gated_swiglu__prompt_kernel_rl_done_190
    s_cmp_ge_u32 s38, 782
    s_cbranch_scc1 adaLN_cond__grouped_kv_mqa__glu_gated_swiglu__prompt_kernel_rl_next_191
    s_sub_u32 s40, s38, 512
    s_mul_i32 s41, s40, 6554
    s_lshr_b32 s41, s41, 16
    s_mul_i32 s42, s41, 10
    s_sub_u32 s42, s40, s42
    s_load_dwordx2 s[44:45], s[0:1], 64
    s_waitcnt lgkmcnt(0)
    s_mov_b32 s52, s44
    s_mov_b32 s53, s45
    s_mov_b32 s54, 2211840
    s_mov_b32 s55, 0x00020000
    s_mul_i32 s43, s41, 81920
    s_lshl_b32 s44, s42, 7
    s_add_u32 s43, s43, s44
    v_lshrrev_b32 v160, 3, v1
    s_mov_b32 s44, 1280
    v_mul_lo_u32 v160, v160, s44
    v_and_b32 v161, 7, v1
    v_lshl_add_u32 v160, v161, 4, v160
    s_mov_b32 s44, s39
    s_mov_b32 m0, s44
    s_nop 0
    buffer_load_dwordx4 v160, s[52:55], s43 offen lds
    s_add_u32 s43, s43, 10240
    s_add_u32 s44, s44, 1024
    s_mov_b32 m0, s44
    s_nop 0
    buffer_load_dwordx4 v160, s[52:55], s43 offen lds
    s_add_u32 s43, s43, 10240
    s_add_u32 s44, s44, 1024
    s_mov_b32 m0, s44
    s_nop 0
    buffer_load_dwordx4 v160, s[52:55], s43 offen lds
    s_add_u32 s43, s43, 10240
    s_add_u32 s44, s44, 1024
    s_mov_b32 m0, s44
    s_nop 0
    buffer_load_dwordx4 v160, s[52:55], s43 offen lds
    s_add_u32 s43, s43, 10240
    s_add_u32 s44, s44, 1024
    s_mov_b32 m0, s44
    s_nop 0
    buffer_load_dwordx4 v160, s[52:55], s43 offen lds
    s_add_u32 s43, s43, 10240
    s_add_u32 s44, s44, 1024
    s_mov_b32 m0, s44
    s_nop 0
    buffer_load_dwordx4 v160, s[52:55], s43 offen lds
    s_add_u32 s43, s43, 10240
    s_add_u32 s44, s44, 1024
    s_mov_b32 m0, s44
    s_nop 0
    buffer_load_dwordx4 v160, s[52:55], s43 offen lds
    s_add_u32 s43, s43, 10240
    s_add_u32 s44, s44, 1024
    s_mov_b32 m0, s44
    s_nop 0
    buffer_load_dwordx4 v160, s[52:55], s43 offen lds
    s_branch adaLN_cond__grouped_kv_mqa__glu_gated_swiglu__prompt_kernel_rl_done_190
adaLN_cond__grouped_kv_mqa__glu_gated_swiglu__prompt_kernel_rl_next_191:
adaLN_cond__grouped_kv_mqa__glu_gated_swiglu__prompt_kernel_rl_done_190:
    s_branch adaLN_cond__grouped_kv_mqa__glu_gated_swiglu__prompt_kernel_wkd_180
adaLN_cond__grouped_kv_mqa__glu_gated_swiglu__prompt_kernel_wk_189:
    s_cmp_lg_u32 s3, 5
    s_cbranch_scc1 adaLN_cond__grouped_kv_mqa__glu_gated_swiglu__prompt_kernel_wk_192
    s_add_u32 s38, s2, 768
    s_mov_b32 s39, 133120
    s_cmp_ge_u32 s38, 782
    s_cbranch_scc1 adaLN_cond__grouped_kv_mqa__glu_gated_swiglu__prompt_kernel_rl_done_193
    s_cmp_ge_u32 s38, 782
    s_cbranch_scc1 adaLN_cond__grouped_kv_mqa__glu_gated_swiglu__prompt_kernel_rl_next_194
    s_sub_u32 s40, s38, 512
    s_mul_i32 s41, s40, 6554
    s_lshr_b32 s41, s41, 16
    s_mul_i32 s42, s41, 10
    s_sub_u32 s42, s40, s42
    s_load_dwordx2 s[44:45], s[0:1], 64
    s_waitcnt lgkmcnt(0)
    s_mov_b32 s52, s44
    s_mov_b32 s53, s45
    s_mov_b32 s54, 2211840
    s_mov_b32 s55, 0x00020000
    s_mul_i32 s43, s41, 81920
    s_lshl_b32 s44, s42, 7
    s_add_u32 s43, s43, s44
    v_lshrrev_b32 v160, 3, v1
    s_mov_b32 s44, 1280
    v_mul_lo_u32 v160, v160, s44
    v_and_b32 v161, 7, v1
    v_lshl_add_u32 v160, v161, 4, v160
    s_mov_b32 s44, s39
    s_mov_b32 m0, s44
    s_nop 0
    buffer_load_dwordx4 v160, s[52:55], s43 offen lds
    s_add_u32 s43, s43, 10240
    s_add_u32 s44, s44, 1024
    s_mov_b32 m0, s44
    s_nop 0
    buffer_load_dwordx4 v160, s[52:55], s43 offen lds
    s_add_u32 s43, s43, 10240
    s_add_u32 s44, s44, 1024
    s_mov_b32 m0, s44
    s_nop 0
    buffer_load_dwordx4 v160, s[52:55], s43 offen lds
    s_add_u32 s43, s43, 10240
    s_add_u32 s44, s44, 1024
    s_mov_b32 m0, s44
    s_nop 0
    buffer_load_dwordx4 v160, s[52:55], s43 offen lds
    s_add_u32 s43, s43, 10240
    s_add_u32 s44, s44, 1024
    s_mov_b32 m0, s44
    s_nop 0
    buffer_load_dwordx4 v160, s[52:55], s43 offen lds
    s_add_u32 s43, s43, 10240
    s_add_u32 s44, s44, 1024
    s_mov_b32 m0, s44
    s_nop 0
    buffer_load_dwordx4 v160, s[52:55], s43 offen lds
    s_add_u32 s43, s43, 10240
    s_add_u32 s44, s44, 1024
    s_mov_b32 m0, s44
    s_nop 0
    buffer_load_dwordx4 v160, s[52:55], s43 offen lds
    s_add_u32 s43, s43, 10240
    s_add_u32 s44, s44, 1024
    s_mov_b32 m0, s44
    s_nop 0
    buffer_load_dwordx4 v160, s[52:55], s43 offen lds
    s_branch adaLN_cond__grouped_kv_mqa__glu_gated_swiglu__prompt_kernel_rl_done_193
adaLN_cond__grouped_kv_mqa__glu_gated_swiglu__prompt_kernel_rl_next_194:
adaLN_cond__grouped_kv_mqa__glu_gated_swiglu__prompt_kernel_rl_done_193:
    s_branch adaLN_cond__grouped_kv_mqa__glu_gated_swiglu__prompt_kernel_wkd_180
adaLN_cond__grouped_kv_mqa__glu_gated_swiglu__prompt_kernel_wk_192:
adaLN_cond__grouped_kv_mqa__glu_gated_swiglu__prompt_kernel_wkd_180:
    s_branch adaLN_cond__grouped_kv_mqa__glu_gated_swiglu__prompt_kernel_ret_55
adaLN_cond__grouped_kv_mqa__glu_gated_swiglu__prompt_kernel_ool_56:
    s_waitcnt vmcnt(0)
    v_xor_b32 v234, s71, v234
    v_xor_b32 v235, s71, v235
    v_xor_b32 v236, s71, v236
    v_xor_b32 v237, s71, v237
    v_or_b32 v234, v234, v235
    v_or_b32 v236, v236, v237
    v_or_b32 v234, v234, v236
    v_cmp_ne_u32 vcc, 0, v234
    s_nop 0
    s_cbranch_vccz adaLN_cond__grouped_kv_mqa__glu_gated_swiglu__prompt_kernel_lflok_195
    v_lshlrev_b32 v232, 4, v1
    s_mov_b32 s40, 12288
    s_mov_b32 s42, 65536
adaLN_cond__grouped_kv_mqa__glu_gated_swiglu__prompt_kernel_poll_196:
    buffer_load_dwordx4 v[234:237], v232, s[60:63], s40 offen sc1
    s_sub_u32 s42, s42, 1
    s_cmp_eq_u32 s42, 0
    s_cbranch_scc1 adaLN_cond__grouped_kv_mqa__glu_gated_swiglu__prompt_kernel_polldone_197
    s_waitcnt vmcnt(0)
    v_xor_b32 v234, s71, v234
    v_xor_b32 v235, s71, v235
    v_xor_b32 v236, s71, v236
    v_xor_b32 v237, s71, v237
    v_or_b32 v234, v234, v235
    v_or_b32 v236, v236, v237
    v_or_b32 v234, v234, v236
    v_cmp_ne_u32 vcc, 0, v234
    s_nop 0
    s_cbranch_vccnz adaLN_cond__grouped_kv_mqa__glu_gated_swiglu__prompt_kernel_poll_196
adaLN_cond__grouped_kv_mqa__glu_gated_swiglu__prompt_kernel_polldone_197:
adaLN_cond__grouped_kv_mqa__glu_gated_swiglu__prompt_kernel_lflok_195:
    s_branch adaLN_cond__grouped_kv_mqa__glu_gated_swiglu__prompt_kernel_ret_57
adaLN_cond__grouped_kv_mqa__glu_gated_swiglu__prompt_kernel_ool_59:
    s_cmp_lg_u32 s3, 6
    s_cbranch_scc1 adaLN_cond__grouped_kv_mqa__glu_gated_swiglu__prompt_kernel_wk_199
    s_add_u32 s38, s2, 0
    s_mov_b32 s39, 143360
    s_cmp_ge_u32 s38, 782
    s_cbranch_scc1 adaLN_cond__grouped_kv_mqa__glu_gated_swiglu__prompt_kernel_rl_done_200
    s_cmp_lt_u32 s38, 80
    s_cbranch_scc1 adaLN_cond__grouped_kv_mqa__glu_gated_swiglu__prompt_kernel_rl_done_200
    s_cmp_ge_u32 s38, 296
    s_cbranch_scc1 adaLN_cond__grouped_kv_mqa__glu_gated_swiglu__prompt_kernel_rl_next_202
    s_sub_u32 s40, s38, 80
    s_mul_i32 s41, s40, 2428
    s_lshr_b32 s41, s41, 16
    s_mul_i32 s42, s41, 27
    s_sub_u32 s42, s40, s42
    s_mov_b32 s56, s6
    s_mov_b32 s57, s7
    s_mov_b32 s58, 61440
    s_mov_b32 s59, 0x00020000
    v_min_u32 v161, 39, v1
    v_lshlrev_b32 v161, 3, v161
    s_mul_i32 s43, s41, 320
    s_add_u32 s44, s43, 10240
    buffer_load_dwordx2 v[124:125], v161, s[56:59], s44 offen sc1
    s_add_u32 s44, s43, 25600
    buffer_load_dwordx2 v[126:127], v161, s[56:59], s44 offen sc1
    s_add_u32 s44, s43, 40960
    buffer_load_dwordx2 v[128:129], v161, s[56:59], s44 offen sc1
    s_add_u32 s44, s43, 56320
    buffer_load_dwordx2 v[130:131], v161, s[56:59], s44 offen sc1
    s_add_u32 s44, s43, 7680
    buffer_load_dwordx2 v[132:133], v161, s[56:59], s44 offen sc1
    s_add_u32 s44, s43, 23040
    buffer_load_dwordx2 v[134:135], v161, s[56:59], s44 offen sc1
    s_add_u32 s44, s43, 38400
    buffer_load_dwordx2 v[136:137], v161, s[56:59], s44 offen sc1
    s_add_u32 s44, s43, 53760
    buffer_load_dwordx2 v[138:139], v161, s[56:59], s44 offen sc1
    s_branch adaLN_cond__grouped_kv_mqa__glu_gated_swiglu__prompt_kernel_rl_done_200
adaLN_cond__grouped_kv_mqa__glu_gated_swiglu__prompt_kernel_rl_next_202:
adaLN_cond__grouped_kv_mqa__glu_gated_swiglu__prompt_kernel_rl_done_200:
    s_branch adaLN_cond__grouped_kv_mqa__glu_gated_swiglu__prompt_kernel_wkd_198
adaLN_cond__grouped_kv_mqa__glu_gated_swiglu__prompt_kernel_wk_199:
    s_cmp_lg_u32 s3, 7
    s_cbranch_scc1 adaLN_cond__grouped_kv_mqa__glu_gated_swiglu__prompt_kernel_wk_203
    s_add_u32 s38, s2, 256
    s_mov_b32 s39, 153600
    s_cmp_ge_u32 s38, 782
    s_cbranch_scc1 adaLN_cond__grouped_kv_mqa__glu_gated_swiglu__prompt_kernel_rl_done_204
    s_cmp_ge_u32 s38, 296
    s_cbranch_scc1 adaLN_cond__grouped_kv_mqa__glu_gated_swiglu__prompt_kernel_rl_next_205
    s_sub_u32 s40, s38, 80
    s_mul_i32 s41, s40, 2428
    s_lshr_b32 s41, s41, 16
    s_mul_i32 s42, s41, 27
    s_sub_u32 s42, s40, s42
    s_mov_b32 s56, s6
    s_mov_b32 s57, s7
    s_mov_b32 s58, 61440
    s_mov_b32 s59, 0x00020000
    v_min_u32 v161, 39, v1
    v_lshlrev_b32 v161, 3, v161
    s_mul_i32 s43, s41, 320
    s_add_u32 s44, s43, 10240
    buffer_load_dwordx2 v[124:125], v161, s[56:59], s44 offen sc1
    s_add_u32 s44, s43, 25600
    buffer_load_dwordx2 v[126:127], v161, s[56:59], s44 offen sc1
    s_add_u32 s44, s43, 40960
    buffer_load_dwordx2 v[128:129], v161, s[56:59], s44 offen sc1
    s_add_u32 s44, s43, 56320
    buffer_load_dwordx2 v[130:131], v161, s[56:59], s44 offen sc1
    s_add_u32 s44, s43, 7680
    buffer_load_dwordx2 v[132:133], v161, s[56:59], s44 offen sc1
    s_add_u32 s44, s43, 23040
    buffer_load_dwordx2 v[134:135], v161, s[56:59], s44 offen sc1
    s_add_u32 s44, s43, 38400
    buffer_load_dwordx2 v[136:137], v161, s[56:59], s44 offen sc1
    s_add_u32 s44, s43, 53760
    buffer_load_dwordx2 v[138:139], v161, s[56:59], s44 offen sc1
    s_branch adaLN_cond__grouped_kv_mqa__glu_gated_swiglu__prompt_kernel_rl_done_204
adaLN_cond__grouped_kv_mqa__glu_gated_swiglu__prompt_kernel_rl_next_205:
    s_cmp_ge_u32 s38, 512
    s_cbranch_scc1 adaLN_cond__grouped_kv_mqa__glu_gated_swiglu__prompt_kernel_rl_next_206
    s_sub_u32 s40, s38, 296
    s_mul_i32 s41, s40, 2428
    s_lshr_b32 s41, s41, 16
    s_mul_i32 s42, s41, 27
    s_sub_u32 s42, s40, s42
    s_mov_b32 s56, s6
    s_mov_b32 s57, s7
    s_mov_b32 s58, 61440
    s_mov_b32 s59, 0x00020000
    v_min_u32 v161, 39, v1
    v_lshlrev_b32 v161, 3, v161
    s_mul_i32 s43, s41, 320
    s_add_u32 s44, s43, 10240
    buffer_load_dwordx2 v[124:125], v161, s[56:59], s44 offen sc1
    s_add_u32 s44, s43, 25600
    buffer_load_dwordx2 v[126:127], v161, s[56:59], s44 offen sc1
    s_add_u32 s44, s43, 40960
    buffer_load_dwordx2 v[128:129], v161, s[56:59], s44 offen sc1
    s_add_u32 s44, s43, 56320
    buffer_load_dwordx2 v[130:131], v161, s[56:59], s44 offen sc1
    s_add_u32 s44, s43, 7680
    buffer_load_dwordx2 v[132:133], v161, s[56:59], s44 offen sc1
    s_add_u32 s44, s43, 23040
    buffer_load_dwordx2 v[134:135], v161, s[56:59], s44 offen sc1
    s_add_u32 s44, s43, 38400
    buffer_load_dwordx2 v[136:137], v161, s[56:59], s44 offen sc1
    s_add_u32 s44, s43, 53760
    buffer_load_dwordx2 v[138:139], v161, s[56:59], s44 offen sc1
    s_branch adaLN_cond__grouped_kv_mqa__glu_gated_swiglu__prompt_kernel_rl_done_204
adaLN_cond__grouped_kv_mqa__glu_gated_swiglu__prompt_kernel_rl_next_206:
adaLN_cond__grouped_kv_mqa__glu_gated_swiglu__prompt_kernel_rl_done_204:
    s_branch adaLN_cond__grouped_kv_mqa__glu_gated_swiglu__prompt_kernel_wkd_198
adaLN_cond__grouped_kv_mqa__glu_gated_swiglu__prompt_kernel_wk_203:
    s_cmp_lg_u32 s3, 4
    s_cbranch_scc1 adaLN_cond__grouped_kv_mqa__glu_gated_swiglu__prompt_kernel_wk_207
    s_add_u32 s38, s2, 512
    s_mov_b32 s39, 122880
    s_cmp_ge_u32 s38, 782
    s_cbranch_scc1 adaLN_cond__grouped_kv_mqa__glu_gated_swiglu__prompt_kernel_rl_done_208
    s_cmp_lt_u32 s38, 782
    s_cbranch_scc1 adaLN_cond__grouped_kv_mqa__glu_gated_swiglu__prompt_kernel_rl_done_208
adaLN_cond__grouped_kv_mqa__glu_gated_swiglu__prompt_kernel_rl_done_208:
    s_branch adaLN_cond__grouped_kv_mqa__glu_gated_swiglu__prompt_kernel_wkd_198
adaLN_cond__grouped_kv_mqa__glu_gated_swiglu__prompt_kernel_wk_207:
    s_cmp_lg_u32 s3, 5
    s_cbranch_scc1 adaLN_cond__grouped_kv_mqa__glu_gated_swiglu__prompt_kernel_wk_210
    s_add_u32 s38, s2, 768
    s_mov_b32 s39, 133120
    s_cmp_ge_u32 s38, 782
    s_cbranch_scc1 adaLN_cond__grouped_kv_mqa__glu_gated_swiglu__prompt_kernel_rl_done_211
    s_cmp_lt_u32 s38, 782
    s_cbranch_scc1 adaLN_cond__grouped_kv_mqa__glu_gated_swiglu__prompt_kernel_rl_done_211
adaLN_cond__grouped_kv_mqa__glu_gated_swiglu__prompt_kernel_rl_done_211:
    s_branch adaLN_cond__grouped_kv_mqa__glu_gated_swiglu__prompt_kernel_wkd_198
adaLN_cond__grouped_kv_mqa__glu_gated_swiglu__prompt_kernel_wk_210:
adaLN_cond__grouped_kv_mqa__glu_gated_swiglu__prompt_kernel_wkd_198:
    s_branch adaLN_cond__grouped_kv_mqa__glu_gated_swiglu__prompt_kernel_ret_60
adaLN_cond__grouped_kv_mqa__glu_gated_swiglu__prompt_kernel_ool_63:
    s_cmp_lg_u32 s3, 6
    s_cbranch_scc1 adaLN_cond__grouped_kv_mqa__glu_gated_swiglu__prompt_kernel_wk_214
    s_add_u32 s38, s2, 0
    s_mov_b32 s39, 143360
    s_cmp_ge_u32 s38, 782
    s_cbranch_scc1 adaLN_cond__grouped_kv_mqa__glu_gated_swiglu__prompt_kernel_rl_done_215
    s_cmp_ge_u32 s38, 80
    s_cbranch_scc1 adaLN_cond__grouped_kv_mqa__glu_gated_swiglu__prompt_kernel_rl_next_216
    s_sub_u32 s40, s38, 0
    s_mul_i32 s41, s40, 6554
    s_lshr_b32 s41, s41, 16
    s_mul_i32 s42, s41, 10
    s_sub_u32 s42, s40, s42
    s_lshl_b32 s44, s42, 10
    s_lshr_b32 s46, s41, 1
    s_and_b32 s47, s41, 1
    s_mul_i32 s46, s46, 20
    s_lshl_b32 s43, s47, 3
    s_add_u32 s43, s43, s46
    s_mul_i32 s43, s43, 10240
    s_add_u32 s43, s43, s44
    s_lshl_b32 s47, s47, 1
    s_add_u32 s47, s47, s46
    s_add_u32 s47, s47, 16
    s_mul_i32 s47, s47, 10240
    s_add_u32 s47, s47, s44
    s_add_u32 s56, s6, 1310720
    s_addc_u32 s57, s7, 0
    s_mov_b32 s58, 819200
    s_mov_b32 s59, 0x00020000
    v_bfe_u32 v161, v1, 2, 2
    v_lshlrev_b32 v161, 7, v161
    v_lshrrev_b32 v162, 4, v1
    v_lshl_add_u32 v161, v162, 5, v161
    v_and_b32 v162, 3, v1
    v_lshl_add_u32 v161, v162, 3, v161
    v_add_u32 v161, s39, v161
    v_lshlrev_b32 v162, 4, v1
    s_waitcnt vmcnt(0)
    ds_read_b64_tr_b16 v[164:165], v161 offset:0
    ds_read_b64_tr_b16 v[166:167], v161 offset:1024
    ds_read_b64_tr_b16 v[168:169], v161 offset:512
    ds_read_b64_tr_b16 v[170:171], v161 offset:1536
    ds_read_b64_tr_b16 v[172:173], v161 offset:2560
    ds_read_b64_tr_b16 v[174:175], v161 offset:3584
    ds_read_b64_tr_b16 v[176:177], v161 offset:3072
    ds_read_b64_tr_b16 v[178:179], v161 offset:4096
    ds_read_b64_tr_b16 v[180:181], v161 offset:5120
    ds_read_b64_tr_b16 v[182:183], v161 offset:6144
    ds_read_b64_tr_b16 v[184:185], v161 offset:5632
    ds_read_b64_tr_b16 v[186:187], v161 offset:6656
    ds_read_b64_tr_b16 v[188:189], v161 offset:7680
    ds_read_b64_tr_b16 v[190:191], v161 offset:8704
    ds_read_b64_tr_b16 v[192:193], v161 offset:8192
    ds_read_b64_tr_b16 v[194:195], v161 offset:9216
    ds_read_b64_tr_b16 v[196:197], v161 offset:2048
    ds_read_b64_tr_b16 v[198:199], v161 offset:4608
    ds_read_b64_tr_b16 v[200:201], v161 offset:7168
    ds_read_b64_tr_b16 v[202:203], v161 offset:9728
    s_add_u32 s45, s43, 0
    s_waitcnt lgkmcnt(15)
    buffer_store_dwordx4 v[164:167], v162, s[56:59], s45 offen sc1
    s_add_u32 s45, s43, 10240
    buffer_store_dwordx4 v[168:171], v162, s[56:59], s45 offen sc1
    s_add_u32 s45, s43, 20480
    s_waitcnt lgkmcnt(14)
    buffer_store_dwordx4 v[172:175], v162, s[56:59], s45 offen sc1
    s_add_u32 s45, s43, 30720
    s_waitcnt lgkmcnt(12)
    buffer_store_dwordx4 v[176:179], v162, s[56:59], s45 offen sc1
    s_add_u32 s45, s43, 40960
    s_waitcnt lgkmcnt(10)
    buffer_store_dwordx4 v[180:183], v162, s[56:59], s45 offen sc1
    s_add_u32 s45, s43, 51200
    s_waitcnt lgkmcnt(8)
    buffer_store_dwordx4 v[184:187], v162, s[56:59], s45 offen sc1
    s_add_u32 s45, s43, 61440
    s_waitcnt lgkmcnt(6)
    buffer_store_dwordx4 v[188:191], v162, s[56:59], s45 offen sc1
    s_add_u32 s45, s43, 71680
    s_waitcnt lgkmcnt(4)
    buffer_store_dwordx4 v[192:195], v162, s[56:59], s45 offen sc1
    s_add_u32 s45, s47, 0
    s_waitcnt lgkmcnt(2)
    buffer_store_dwordx4 v[196:199], v162, s[56:59], s45 offen sc1
    s_add_u32 s45, s47, 10240
    s_waitcnt lgkmcnt(0)
    buffer_store_dwordx4 v[200:203], v162, s[56:59], s45 offen sc1
    s_branch adaLN_cond__grouped_kv_mqa__glu_gated_swiglu__prompt_kernel_rl_done_215
adaLN_cond__grouped_kv_mqa__glu_gated_swiglu__prompt_kernel_rl_next_216:
    s_cmp_ge_u32 s38, 296
    s_cbranch_scc1 adaLN_cond__grouped_kv_mqa__glu_gated_swiglu__prompt_kernel_rl_next_217
    s_sub_u32 s40, s38, 80
    s_mul_i32 s41, s40, 2428
    s_lshr_b32 s41, s41, 16
    s_mul_i32 s42, s41, 27
    s_sub_u32 s42, s40, s42
    s_lshl_b32 s44, s42, 10
    s_mul_i32 s43, s41, 276480
    s_add_u32 s43, s43, s44
    s_add_u32 s56, s6, 2162688
    s_addc_u32 s57, s7, 0
    s_mov_b32 s58, 2211840
    s_mov_b32 s59, 0x00020000
    v_bfe_u32 v161, v1, 2, 2
    v_lshlrev_b32 v161, 7, v161
    v_lshrrev_b32 v162, 4, v1
    v_lshl_add_u32 v161, v162, 5, v161
    v_and_b32 v162, 3, v1
    v_lshl_add_u32 v161, v162, 3, v161
    v_add_u32 v161, s39, v161
    v_lshlrev_b32 v162, 4, v1
    s_waitcnt vmcnt(0)
    ds_read_b64_tr_b16 v[164:165], v161 offset:0
    ds_read_b64_tr_b16 v[166:167], v161 offset:512
    ds_read_b64_tr_b16 v[168:169], v161 offset:1024
    ds_read_b64_tr_b16 v[170:171], v161 offset:1536
    ds_read_b64_tr_b16 v[172:173], v161 offset:2048
    ds_read_b64_tr_b16 v[174:175], v161 offset:2560
    ds_read_b64_tr_b16 v[176:177], v161 offset:3072
    ds_read_b64_tr_b16 v[178:179], v161 offset:3584
    ds_read_b64_tr_b16 v[180:181], v161 offset:4096
    ds_read_b64_tr_b16 v[182:183], v161 offset:4608
    ds_read_b64_tr_b16 v[184:185], v161 offset:5120
    ds_read_b64_tr_b16 v[186:187], v161 offset:5632
    ds_read_b64_tr_b16 v[188:189], v161 offset:6144
    ds_read_b64_tr_b16 v[190:191], v161 offset:6656
    ds_read_b64_tr_b16 v[192:193], v161 offset:7168
    ds_read_b64_tr_b16 v[194:195], v161 offset:7680
    ds_read_b64_tr_b16 v[196:197], v161 offset:8192
    ds_read_b64_tr_b16 v[198:199], v161 offset:8704
    ds_read_b64_tr_b16 v[200:201], v161 offset:9216
    ds_read_b64_tr_b16 v[202:203], v161 offset:9728
    s_add_u32 s45, s43, 0
    s_waitcnt lgkmcnt(15)
    buffer_store_dwordx4 v[164:167], v162, s[56:59], s45 offen sc1
    s_add_u32 s45, s43, 27648
    buffer_store_dwordx4 v[168:171], v162, s[56:59], s45 offen sc1
    s_add_u32 s45, s43, 55296
    s_waitcnt lgkmcnt(14)
    buffer_store_dwordx4 v[172:175], v162, s[56:59], s45 offen sc1
    s_add_u32 s45, s43, 82944
    s_waitcnt lgkmcnt(12)
    buffer_store_dwordx4 v[176:179], v162, s[56:59], s45 offen sc1
    s_add_u32 s45, s43, 110592
    s_waitcnt lgkmcnt(10)
    buffer_store_dwordx4 v[180:183], v162, s[56:59], s45 offen sc1
    s_add_u32 s45, s43, 138240
    s_waitcnt lgkmcnt(8)
    buffer_store_dwordx4 v[184:187], v162, s[56:59], s45 offen sc1
    s_add_u32 s45, s43, 165888
    s_waitcnt lgkmcnt(6)
    buffer_store_dwordx4 v[188:191], v162, s[56:59], s45 offen sc1
    s_add_u32 s45, s43, 193536
    s_waitcnt lgkmcnt(4)
    buffer_store_dwordx4 v[192:195], v162, s[56:59], s45 offen sc1
    s_add_u32 s45, s43, 221184
    s_waitcnt lgkmcnt(2)
    buffer_store_dwordx4 v[196:199], v162, s[56:59], s45 offen sc1
    s_add_u32 s45, s43, 248832
    s_waitcnt lgkmcnt(0)
    buffer_store_dwordx4 v[200:203], v162, s[56:59], s45 offen sc1
    v_add_f32 v124, v124, v126
    v_add_f32 v128, v128, v130
    v_add_f32 v124, v124, v128
    v_cvt_pk_bf16_f32 v124, v124, v124
    v_lshlrev_b32 v124, 16, v124
    v_add_f32 v124, 1.0, v124
    v_add_f32 v125, v125, v127
    v_add_f32 v129, v129, v131
    v_add_f32 v125, v125, v129
    v_cvt_pk_bf16_f32 v125, v125, v125
    v_lshlrev_b32 v125, 16, v125
    v_add_f32 v125, 1.0, v125
    v_cvt_pk_bf16_f32 v204, v124, v125
    v_add_f32 v132, v132, v134
    v_add_f32 v136, v136, v138
    v_add_f32 v132, v132, v136
    v_cvt_pk_bf16_f32 v132, v132, v132
    v_lshlrev_b32 v132, 16, v132
    v_add_f32 v133, v133, v135
    v_add_f32 v137, v137, v139
    v_add_f32 v133, v133, v137
    v_cvt_pk_bf16_f32 v133, v133, v133
    v_lshlrev_b32 v133, 16, v133
    v_cvt_pk_bf16_f32 v205, v132, v133
    v_mov_b32 v124, 0
    v_mov_b32 v125, 0
    v_mov_b32 v126, 0
    v_mov_b32 v127, 0
    v_lshlrev_b32 v160, 2, v1
    v_add_u32 v160, s39, v160
    ds_write_b32 v160, v204
    ds_write_b32 v160, v205 offset:256
    s_branch adaLN_cond__grouped_kv_mqa__glu_gated_swiglu__prompt_kernel_rl_done_215
adaLN_cond__grouped_kv_mqa__glu_gated_swiglu__prompt_kernel_rl_next_217:
adaLN_cond__grouped_kv_mqa__glu_gated_swiglu__prompt_kernel_rl_done_215:
    s_add_u32 s38, s2, 0
    s_mov_b32 s39, 143360
    s_cmp_ge_u32 s38, 782
    s_cbranch_scc1 adaLN_cond__grouped_kv_mqa__glu_gated_swiglu__prompt_kernel_rl_done_218
    s_cmp_lt_u32 s38, 80
    s_cbranch_scc1 adaLN_cond__grouped_kv_mqa__glu_gated_swiglu__prompt_kernel_rl_done_218
    s_cmp_ge_u32 s38, 296
    s_cbranch_scc1 adaLN_cond__grouped_kv_mqa__glu_gated_swiglu__prompt_kernel_rl_next_220
    s_sub_u32 s40, s38, 80
    s_mul_i32 s41, s40, 2428
    s_lshr_b32 s41, s41, 16
    s_mul_i32 s42, s41, 27
    s_sub_u32 s42, s40, s42
    v_mov_b32 v160, s39
    s_waitcnt vmcnt(4)
    ds_read_b128 v[128:131], v160 offset:0
    s_waitcnt vmcnt(2)
    ds_read_b128 v[132:135], v160 offset:256
    s_waitcnt vmcnt(0)
    ds_read_b128 v[136:139], v160 offset:16
    ds_read_b128 v[140:143], v160 offset:272
    s_waitcnt lgkmcnt(3)
    v_dot2c_f32_bf16 v124, v128, v164
    s_waitcnt lgkmcnt(2)
    v_dot2c_f32_bf16 v125, v132, v164
    v_dot2c_f32_bf16 v126, v129, v165
    v_dot2c_f32_bf16 v127, v133, v165
    v_dot2c_f32_bf16 v124, v130, v166
    v_dot2c_f32_bf16 v125, v134, v166
    v_dot2c_f32_bf16 v126, v131, v167
    v_dot2c_f32_bf16 v127, v135, v167
    ds_read_b128 v[128:131], v160 offset:32
    ds_read_b128 v[132:135], v160 offset:288
    s_waitcnt lgkmcnt(3)
    v_dot2c_f32_bf16 v124, v136, v168
    s_waitcnt lgkmcnt(2)
    v_dot2c_f32_bf16 v125, v140, v168
    v_dot2c_f32_bf16 v126, v137, v169
    v_dot2c_f32_bf16 v127, v141, v169
    v_dot2c_f32_bf16 v124, v138, v170
    v_dot2c_f32_bf16 v125, v142, v170
    v_dot2c_f32_bf16 v126, v139, v171
    v_dot2c_f32_bf16 v127, v143, v171
    ds_read_b128 v[136:139], v160 offset:48
    ds_read_b128 v[140:143], v160 offset:304
    s_waitcnt lgkmcnt(3)
    v_dot2c_f32_bf16 v124, v128, v172
    s_waitcnt lgkmcnt(2)
    v_dot2c_f32_bf16 v125, v132, v172
    v_dot2c_f32_bf16 v126, v129, v173
    v_dot2c_f32_bf16 v127, v133, v173
    v_dot2c_f32_bf16 v124, v130, v174
    v_dot2c_f32_bf16 v125, v134, v174
    v_dot2c_f32_bf16 v126, v131, v175
    v_dot2c_f32_bf16 v127, v135, v175
    ds_read_b128 v[128:131], v160 offset:64
    ds_read_b128 v[132:135], v160 offset:320
    s_waitcnt lgkmcnt(3)
    v_dot2c_f32_bf16 v124, v136, v176
    s_waitcnt lgkmcnt(2)
    v_dot2c_f32_bf16 v125, v140, v176
    v_dot2c_f32_bf16 v126, v137, v177
    v_dot2c_f32_bf16 v127, v141, v177
    v_dot2c_f32_bf16 v124, v138, v178
    v_dot2c_f32_bf16 v125, v142, v178
    v_dot2c_f32_bf16 v126, v139, v179
    v_dot2c_f32_bf16 v127, v143, v179
    ds_read_b128 v[136:139], v160 offset:80
    ds_read_b128 v[140:143], v160 offset:336
    s_waitcnt lgkmcnt(3)
    v_dot2c_f32_bf16 v124, v128, v180
    s_waitcnt lgkmcnt(2)
    v_dot2c_f32_bf16 v125, v132, v180
    v_dot2c_f32_bf16 v126, v129, v181
    v_dot2c_f32_bf16 v127, v133, v181
    v_dot2c_f32_bf16 v124, v130, v182
    v_dot2c_f32_bf16 v125, v134, v182
    v_dot2c_f32_bf16 v126, v131, v183
    v_dot2c_f32_bf16 v127, v135, v183
    ds_read_b128 v[128:131], v160 offset:96
    ds_read_b128 v[132:135], v160 offset:352
    s_waitcnt lgkmcnt(3)
    v_dot2c_f32_bf16 v124, v136, v184
    s_waitcnt lgkmcnt(2)
    v_dot2c_f32_bf16 v125, v140, v184
    v_dot2c_f32_bf16 v126, v137, v185
    v_dot2c_f32_bf16 v127, v141, v185
    v_dot2c_f32_bf16 v124, v138, v186
    v_dot2c_f32_bf16 v125, v142, v186
    v_dot2c_f32_bf16 v126, v139, v187
    v_dot2c_f32_bf16 v127, v143, v187
    ds_read_b128 v[136:139], v160 offset:112
    ds_read_b128 v[140:143], v160 offset:368
    s_waitcnt lgkmcnt(3)
    v_dot2c_f32_bf16 v124, v128, v188
    s_waitcnt lgkmcnt(2)
    v_dot2c_f32_bf16 v125, v132, v188
    v_dot2c_f32_bf16 v126, v129, v189
    v_dot2c_f32_bf16 v127, v133, v189
    v_dot2c_f32_bf16 v124, v130, v190
    v_dot2c_f32_bf16 v125, v134, v190
    v_dot2c_f32_bf16 v126, v131, v191
    v_dot2c_f32_bf16 v127, v135, v191
    ds_read_b128 v[128:131], v160 offset:128
    ds_read_b128 v[132:135], v160 offset:384
    s_waitcnt lgkmcnt(3)
    v_dot2c_f32_bf16 v124, v136, v192
    s_waitcnt lgkmcnt(2)
    v_dot2c_f32_bf16 v125, v140, v192
    v_dot2c_f32_bf16 v126, v137, v193
    v_dot2c_f32_bf16 v127, v141, v193
    v_dot2c_f32_bf16 v124, v138, v194
    v_dot2c_f32_bf16 v125, v142, v194
    v_dot2c_f32_bf16 v126, v139, v195
    v_dot2c_f32_bf16 v127, v143, v195
    ds_read_b128 v[136:139], v160 offset:144
    ds_read_b128 v[140:143], v160 offset:400
    s_waitcnt lgkmcnt(3)
    v_dot2c_f32_bf16 v124, v128, v196
    s_waitcnt lgkmcnt(2)
    v_dot2c_f32_bf16 v125, v132, v196
    v_dot2c_f32_bf16 v126, v129, v197
    v_dot2c_f32_bf16 v127, v133, v197
    v_dot2c_f32_bf16 v124, v130, v198
    v_dot2c_f32_bf16 v125, v134, v198
    v_dot2c_f32_bf16 v126, v131, v199
    v_dot2c_f32_bf16 v127, v135, v199
    s_waitcnt lgkmcnt(1)
    v_dot2c_f32_bf16 v124, v136, v200
    s_waitcnt lgkmcnt(0)
    v_dot2c_f32_bf16 v125, v140, v200
    v_dot2c_f32_bf16 v126, v137, v201
    v_dot2c_f32_bf16 v127, v141, v201
    v_dot2c_f32_bf16 v124, v138, v202
    v_dot2c_f32_bf16 v125, v142, v202
    v_dot2c_f32_bf16 v126, v139, v203
    v_dot2c_f32_bf16 v127, v143, v203
    s_branch adaLN_cond__grouped_kv_mqa__glu_gated_swiglu__prompt_kernel_rl_done_218
adaLN_cond__grouped_kv_mqa__glu_gated_swiglu__prompt_kernel_rl_next_220:
adaLN_cond__grouped_kv_mqa__glu_gated_swiglu__prompt_kernel_rl_done_218:
    s_add_u32 s38, s2, 0
    s_mov_b32 s39, 143360
    s_cmp_ge_u32 s38, 782
    s_cbranch_scc1 adaLN_cond__grouped_kv_mqa__glu_gated_swiglu__prompt_kernel_rl_done_221
    s_cmp_lt_u32 s38, 80
    s_cbranch_scc1 adaLN_cond__grouped_kv_mqa__glu_gated_swiglu__prompt_kernel_rl_done_221
    s_cmp_ge_u32 s38, 296
    s_cbranch_scc1 adaLN_cond__grouped_kv_mqa__glu_gated_swiglu__prompt_kernel_rl_next_223
    s_sub_u32 s40, s38, 80
    s_mul_i32 s41, s40, 2428
    s_lshr_b32 s41, s41, 16
    s_mul_i32 s42, s41, 27
    s_sub_u32 s42, s40, s42
    s_waitcnt vmcnt(6)
    v_add_f32 v124, v124, v126
    v_add_f32 v125, v125, v127
    s_add_u32 s56, s6, 393216
    s_addc_u32 s57, s7, 0
    s_mov_b32 s58, 221184
    s_mov_b32 s59, 0x00020000
    s_mul_i32 s43, s41, 27648
    s_lshl_b32 s42, s42, 8
    s_add_u32 s43, s43, s42
    v_lshlrev_b32 v160, 2, v1
    buffer_store_dword v124, v160, s[56:59], s43 offen sc1
    s_add_u32 s43, s43, 13824
    buffer_store_dword v125, v160, s[56:59], s43 offen sc1
    s_branch adaLN_cond__grouped_kv_mqa__glu_gated_swiglu__prompt_kernel_rl_done_221
adaLN_cond__grouped_kv_mqa__glu_gated_swiglu__prompt_kernel_rl_next_223:
adaLN_cond__grouped_kv_mqa__glu_gated_swiglu__prompt_kernel_rl_done_221:
    s_branch adaLN_cond__grouped_kv_mqa__glu_gated_swiglu__prompt_kernel_wkd_213
adaLN_cond__grouped_kv_mqa__glu_gated_swiglu__prompt_kernel_wk_214:
    s_cmp_lg_u32 s3, 7
    s_cbranch_scc1 adaLN_cond__grouped_kv_mqa__glu_gated_swiglu__prompt_kernel_wk_224
    s_add_u32 s38, s2, 256
    s_mov_b32 s39, 153600
    s_cmp_ge_u32 s38, 782
    s_cbranch_scc1 adaLN_cond__grouped_kv_mqa__glu_gated_swiglu__prompt_kernel_rl_done_225
    s_cmp_ge_u32 s38, 296
    s_cbranch_scc1 adaLN_cond__grouped_kv_mqa__glu_gated_swiglu__prompt_kernel_rl_next_226
    s_sub_u32 s40, s38, 80
    s_mul_i32 s41, s40, 2428
    s_lshr_b32 s41, s41, 16
    s_mul_i32 s42, s41, 27
    s_sub_u32 s42, s40, s42
    s_lshl_b32 s44, s42, 10
    s_mul_i32 s43, s41, 276480
    s_add_u32 s43, s43, s44
    s_add_u32 s56, s6, 2162688
    s_addc_u32 s57, s7, 0
    s_mov_b32 s58, 2211840
    s_mov_b32 s59, 0x00020000
    v_bfe_u32 v161, v1, 2, 2
    v_lshlrev_b32 v161, 7, v161
    v_lshrrev_b32 v162, 4, v1
    v_lshl_add_u32 v161, v162, 5, v161
    v_and_b32 v162, 3, v1
    v_lshl_add_u32 v161, v162, 3, v161
    v_add_u32 v161, s39, v161
    v_lshlrev_b32 v162, 4, v1
    s_waitcnt vmcnt(0)
    ds_read_b64_tr_b16 v[164:165], v161 offset:0
    ds_read_b64_tr_b16 v[166:167], v161 offset:512
    ds_read_b64_tr_b16 v[168:169], v161 offset:1024
    ds_read_b64_tr_b16 v[170:171], v161 offset:1536
    ds_read_b64_tr_b16 v[172:173], v161 offset:2048
    ds_read_b64_tr_b16 v[174:175], v161 offset:2560
    ds_read_b64_tr_b16 v[176:177], v161 offset:3072
    ds_read_b64_tr_b16 v[178:179], v161 offset:3584
    ds_read_b64_tr_b16 v[180:181], v161 offset:4096
    ds_read_b64_tr_b16 v[182:183], v161 offset:4608
    ds_read_b64_tr_b16 v[184:185], v161 offset:5120
    ds_read_b64_tr_b16 v[186:187], v161 offset:5632
    ds_read_b64_tr_b16 v[188:189], v161 offset:6144
    ds_read_b64_tr_b16 v[190:191], v161 offset:6656
    ds_read_b64_tr_b16 v[192:193], v161 offset:7168
    ds_read_b64_tr_b16 v[194:195], v161 offset:7680
    ds_read_b64_tr_b16 v[196:197], v161 offset:8192
    ds_read_b64_tr_b16 v[198:199], v161 offset:8704
    ds_read_b64_tr_b16 v[200:201], v161 offset:9216
    ds_read_b64_tr_b16 v[202:203], v161 offset:9728
    s_add_u32 s45, s43, 0
    s_waitcnt lgkmcnt(15)
    buffer_store_dwordx4 v[164:167], v162, s[56:59], s45 offen sc1
    s_add_u32 s45, s43, 27648
    buffer_store_dwordx4 v[168:171], v162, s[56:59], s45 offen sc1
    s_add_u32 s45, s43, 55296
    s_waitcnt lgkmcnt(14)
    buffer_store_dwordx4 v[172:175], v162, s[56:59], s45 offen sc1
    s_add_u32 s45, s43, 82944
    s_waitcnt lgkmcnt(12)
    buffer_store_dwordx4 v[176:179], v162, s[56:59], s45 offen sc1
    s_add_u32 s45, s43, 110592
    s_waitcnt lgkmcnt(10)
    buffer_store_dwordx4 v[180:183], v162, s[56:59], s45 offen sc1
    s_add_u32 s45, s43, 138240
    s_waitcnt lgkmcnt(8)
    buffer_store_dwordx4 v[184:187], v162, s[56:59], s45 offen sc1
    s_add_u32 s45, s43, 165888
    s_waitcnt lgkmcnt(6)
    buffer_store_dwordx4 v[188:191], v162, s[56:59], s45 offen sc1
    s_add_u32 s45, s43, 193536
    s_waitcnt lgkmcnt(4)
    buffer_store_dwordx4 v[192:195], v162, s[56:59], s45 offen sc1
    s_add_u32 s45, s43, 221184
    s_waitcnt lgkmcnt(2)
    buffer_store_dwordx4 v[196:199], v162, s[56:59], s45 offen sc1
    s_add_u32 s45, s43, 248832
    s_waitcnt lgkmcnt(0)
    buffer_store_dwordx4 v[200:203], v162, s[56:59], s45 offen sc1
    v_add_f32 v124, v124, v126
    v_add_f32 v128, v128, v130
    v_add_f32 v124, v124, v128
    v_cvt_pk_bf16_f32 v124, v124, v124
    v_lshlrev_b32 v124, 16, v124
    v_add_f32 v124, 1.0, v124
    v_add_f32 v125, v125, v127
    v_add_f32 v129, v129, v131
    v_add_f32 v125, v125, v129
    v_cvt_pk_bf16_f32 v125, v125, v125
    v_lshlrev_b32 v125, 16, v125
    v_add_f32 v125, 1.0, v125
    v_cvt_pk_bf16_f32 v204, v124, v125
    v_add_f32 v132, v132, v134
    v_add_f32 v136, v136, v138
    v_add_f32 v132, v132, v136
    v_cvt_pk_bf16_f32 v132, v132, v132
    v_lshlrev_b32 v132, 16, v132
    v_add_f32 v133, v133, v135
    v_add_f32 v137, v137, v139
    v_add_f32 v133, v133, v137
    v_cvt_pk_bf16_f32 v133, v133, v133
    v_lshlrev_b32 v133, 16, v133
    v_cvt_pk_bf16_f32 v205, v132, v133
    v_mov_b32 v124, 0
    v_mov_b32 v125, 0
    v_mov_b32 v126, 0
    v_mov_b32 v127, 0
    v_lshlrev_b32 v160, 2, v1
    v_add_u32 v160, s39, v160
    ds_write_b32 v160, v204
    ds_write_b32 v160, v205 offset:256
    s_branch adaLN_cond__grouped_kv_mqa__glu_gated_swiglu__prompt_kernel_rl_done_225
adaLN_cond__grouped_kv_mqa__glu_gated_swiglu__prompt_kernel_rl_next_226:
    s_cmp_ge_u32 s38, 512
    s_cbranch_scc1 adaLN_cond__grouped_kv_mqa__glu_gated_swiglu__prompt_kernel_rl_next_227
    s_sub_u32 s40, s38, 296
    s_mul_i32 s41, s40, 2428
    s_lshr_b32 s41, s41, 16
    s_mul_i32 s42, s41, 27
    s_sub_u32 s42, s40, s42
    s_lshl_b32 s44, s42, 10
    s_mul_i32 s43, s41, 276480
    s_add_u32 s43, s43, s44
    s_add_u32 s56, s6, 4390912
    s_addc_u32 s57, s7, 0
    s_mov_b32 s58, 2211840
    s_mov_b32 s59, 0x00020000
    v_bfe_u32 v161, v1, 2, 2
    v_lshlrev_b32 v161, 7, v161
    v_lshrrev_b32 v162, 4, v1
    v_lshl_add_u32 v161, v162, 5, v161
    v_and_b32 v162, 3, v1
    v_lshl_add_u32 v161, v162, 3, v161
    v_add_u32 v161, s39, v161
    v_lshlrev_b32 v162, 4, v1
    s_waitcnt vmcnt(0)
    ds_read_b64_tr_b16 v[164:165], v161 offset:0
    ds_read_b64_tr_b16 v[166:167], v161 offset:512
    ds_read_b64_tr_b16 v[168:169], v161 offset:1024
    ds_read_b64_tr_b16 v[170:171], v161 offset:1536
    ds_read_b64_tr_b16 v[172:173], v161 offset:2048
    ds_read_b64_tr_b16 v[174:175], v161 offset:2560
    ds_read_b64_tr_b16 v[176:177], v161 offset:3072
    ds_read_b64_tr_b16 v[178:179], v161 offset:3584
    ds_read_b64_tr_b16 v[180:181], v161 offset:4096
    ds_read_b64_tr_b16 v[182:183], v161 offset:4608
    ds_read_b64_tr_b16 v[184:185], v161 offset:5120
    ds_read_b64_tr_b16 v[186:187], v161 offset:5632
    ds_read_b64_tr_b16 v[188:189], v161 offset:6144
    ds_read_b64_tr_b16 v[190:191], v161 offset:6656
    ds_read_b64_tr_b16 v[192:193], v161 offset:7168
    ds_read_b64_tr_b16 v[194:195], v161 offset:7680
    ds_read_b64_tr_b16 v[196:197], v161 offset:8192
    ds_read_b64_tr_b16 v[198:199], v161 offset:8704
    ds_read_b64_tr_b16 v[200:201], v161 offset:9216
    ds_read_b64_tr_b16 v[202:203], v161 offset:9728
    s_add_u32 s45, s43, 0
    s_waitcnt lgkmcnt(15)
    buffer_store_dwordx4 v[164:167], v162, s[56:59], s45 offen sc1
    s_add_u32 s45, s43, 27648
    buffer_store_dwordx4 v[168:171], v162, s[56:59], s45 offen sc1
    s_add_u32 s45, s43, 55296
    s_waitcnt lgkmcnt(14)
    buffer_store_dwordx4 v[172:175], v162, s[56:59], s45 offen sc1
    s_add_u32 s45, s43, 82944
    s_waitcnt lgkmcnt(12)
    buffer_store_dwordx4 v[176:179], v162, s[56:59], s45 offen sc1
    s_add_u32 s45, s43, 110592
    s_waitcnt lgkmcnt(10)
    buffer_store_dwordx4 v[180:183], v162, s[56:59], s45 offen sc1
    s_add_u32 s45, s43, 138240
    s_waitcnt lgkmcnt(8)
    buffer_store_dwordx4 v[184:187], v162, s[56:59], s45 offen sc1
    s_add_u32 s45, s43, 165888
    s_waitcnt lgkmcnt(6)
    buffer_store_dwordx4 v[188:191], v162, s[56:59], s45 offen sc1
    s_add_u32 s45, s43, 193536
    s_waitcnt lgkmcnt(4)
    buffer_store_dwordx4 v[192:195], v162, s[56:59], s45 offen sc1
    s_add_u32 s45, s43, 221184
    s_waitcnt lgkmcnt(2)
    buffer_store_dwordx4 v[196:199], v162, s[56:59], s45 offen sc1
    s_add_u32 s45, s43, 248832
    s_waitcnt lgkmcnt(0)
    buffer_store_dwordx4 v[200:203], v162, s[56:59], s45 offen sc1
    v_add_f32 v124, v124, v126
    v_add_f32 v128, v128, v130
    v_add_f32 v124, v124, v128
    v_cvt_pk_bf16_f32 v124, v124, v124
    v_lshlrev_b32 v124, 16, v124
    v_add_f32 v124, 1.0, v124
    v_add_f32 v125, v125, v127
    v_add_f32 v129, v129, v131
    v_add_f32 v125, v125, v129
    v_cvt_pk_bf16_f32 v125, v125, v125
    v_lshlrev_b32 v125, 16, v125
    v_add_f32 v125, 1.0, v125
    v_cvt_pk_bf16_f32 v204, v124, v125
    v_add_f32 v132, v132, v134
    v_add_f32 v136, v136, v138
    v_add_f32 v132, v132, v136
    v_cvt_pk_bf16_f32 v132, v132, v132
    v_lshlrev_b32 v132, 16, v132
    v_add_f32 v133, v133, v135
    v_add_f32 v137, v137, v139
    v_add_f32 v133, v133, v137
    v_cvt_pk_bf16_f32 v133, v133, v133
    v_lshlrev_b32 v133, 16, v133
    v_cvt_pk_bf16_f32 v205, v132, v133
    v_mov_b32 v124, 0
    v_mov_b32 v125, 0
    v_mov_b32 v126, 0
    v_mov_b32 v127, 0
    v_lshlrev_b32 v160, 2, v1
    v_add_u32 v160, s39, v160
    ds_write_b32 v160, v204
    ds_write_b32 v160, v205 offset:256
    s_branch adaLN_cond__grouped_kv_mqa__glu_gated_swiglu__prompt_kernel_rl_done_225
adaLN_cond__grouped_kv_mqa__glu_gated_swiglu__prompt_kernel_rl_next_227:
adaLN_cond__grouped_kv_mqa__glu_gated_swiglu__prompt_kernel_rl_done_225:
    s_add_u32 s38, s2, 256
    s_mov_b32 s39, 153600
    s_cmp_ge_u32 s38, 782
    s_cbranch_scc1 adaLN_cond__grouped_kv_mqa__glu_gated_swiglu__prompt_kernel_rl_done_228
    s_cmp_ge_u32 s38, 296
    s_cbranch_scc1 adaLN_cond__grouped_kv_mqa__glu_gated_swiglu__prompt_kernel_rl_next_229
    s_sub_u32 s40, s38, 80
    s_mul_i32 s41, s40, 2428
    s_lshr_b32 s41, s41, 16
    s_mul_i32 s42, s41, 27
    s_sub_u32 s42, s40, s42
    v_mov_b32 v160, s39
    s_waitcnt vmcnt(4)
    ds_read_b128 v[128:131], v160 offset:0
    s_waitcnt vmcnt(2)
    ds_read_b128 v[132:135], v160 offset:256
    s_waitcnt vmcnt(0)
    ds_read_b128 v[136:139], v160 offset:16
    ds_read_b128 v[140:143], v160 offset:272
    s_waitcnt lgkmcnt(3)
    v_dot2c_f32_bf16 v124, v128, v164
    s_waitcnt lgkmcnt(2)
    v_dot2c_f32_bf16 v125, v132, v164
    v_dot2c_f32_bf16 v126, v129, v165
    v_dot2c_f32_bf16 v127, v133, v165
    v_dot2c_f32_bf16 v124, v130, v166
    v_dot2c_f32_bf16 v125, v134, v166
    v_dot2c_f32_bf16 v126, v131, v167
    v_dot2c_f32_bf16 v127, v135, v167
    ds_read_b128 v[128:131], v160 offset:32
    ds_read_b128 v[132:135], v160 offset:288
    s_waitcnt lgkmcnt(3)
    v_dot2c_f32_bf16 v124, v136, v168
    s_waitcnt lgkmcnt(2)
    v_dot2c_f32_bf16 v125, v140, v168
    v_dot2c_f32_bf16 v126, v137, v169
    v_dot2c_f32_bf16 v127, v141, v169
    v_dot2c_f32_bf16 v124, v138, v170
    v_dot2c_f32_bf16 v125, v142, v170
    v_dot2c_f32_bf16 v126, v139, v171
    v_dot2c_f32_bf16 v127, v143, v171
    ds_read_b128 v[136:139], v160 offset:48
    ds_read_b128 v[140:143], v160 offset:304
    s_waitcnt lgkmcnt(3)
    v_dot2c_f32_bf16 v124, v128, v172
    s_waitcnt lgkmcnt(2)
    v_dot2c_f32_bf16 v125, v132, v172
    v_dot2c_f32_bf16 v126, v129, v173
    v_dot2c_f32_bf16 v127, v133, v173
    v_dot2c_f32_bf16 v124, v130, v174
    v_dot2c_f32_bf16 v125, v134, v174
    v_dot2c_f32_bf16 v126, v131, v175
    v_dot2c_f32_bf16 v127, v135, v175
    ds_read_b128 v[128:131], v160 offset:64
    ds_read_b128 v[132:135], v160 offset:320
    s_waitcnt lgkmcnt(3)
    v_dot2c_f32_bf16 v124, v136, v176
    s_waitcnt lgkmcnt(2)
    v_dot2c_f32_bf16 v125, v140, v176
    v_dot2c_f32_bf16 v126, v137, v177
    v_dot2c_f32_bf16 v127, v141, v177
    v_dot2c_f32_bf16 v124, v138, v178
    v_dot2c_f32_bf16 v125, v142, v178
    v_dot2c_f32_bf16 v126, v139, v179
    v_dot2c_f32_bf16 v127, v143, v179
    ds_read_b128 v[136:139], v160 offset:80
    ds_read_b128 v[140:143], v160 offset:336
    s_waitcnt lgkmcnt(3)
    v_dot2c_f32_bf16 v124, v128, v180
    s_waitcnt lgkmcnt(2)
    v_dot2c_f32_bf16 v125, v132, v180
    v_dot2c_f32_bf16 v126, v129, v181
    v_dot2c_f32_bf16 v127, v133, v181
    v_dot2c_f32_bf16 v124, v130, v182
    v_dot2c_f32_bf16 v125, v134, v182
    v_dot2c_f32_bf16 v126, v131, v183
    v_dot2c_f32_bf16 v127, v135, v183
    ds_read_b128 v[128:131], v160 offset:96
    ds_read_b128 v[132:135], v160 offset:352
    s_waitcnt lgkmcnt(3)
    v_dot2c_f32_bf16 v124, v136, v184
    s_waitcnt lgkmcnt(2)
    v_dot2c_f32_bf16 v125, v140, v184
    v_dot2c_f32_bf16 v126, v137, v185
    v_dot2c_f32_bf16 v127, v141, v185
    v_dot2c_f32_bf16 v124, v138, v186
    v_dot2c_f32_bf16 v125, v142, v186
    v_dot2c_f32_bf16 v126, v139, v187
    v_dot2c_f32_bf16 v127, v143, v187
    ds_read_b128 v[136:139], v160 offset:112
    ds_read_b128 v[140:143], v160 offset:368
    s_waitcnt lgkmcnt(3)
    v_dot2c_f32_bf16 v124, v128, v188
    s_waitcnt lgkmcnt(2)
    v_dot2c_f32_bf16 v125, v132, v188
    v_dot2c_f32_bf16 v126, v129, v189
    v_dot2c_f32_bf16 v127, v133, v189
    v_dot2c_f32_bf16 v124, v130, v190
    v_dot2c_f32_bf16 v125, v134, v190
    v_dot2c_f32_bf16 v126, v131, v191
    v_dot2c_f32_bf16 v127, v135, v191
    ds_read_b128 v[128:131], v160 offset:128
    ds_read_b128 v[132:135], v160 offset:384
    s_waitcnt lgkmcnt(3)
    v_dot2c_f32_bf16 v124, v136, v192
    s_waitcnt lgkmcnt(2)
    v_dot2c_f32_bf16 v125, v140, v192
    v_dot2c_f32_bf16 v126, v137, v193
    v_dot2c_f32_bf16 v127, v141, v193
    v_dot2c_f32_bf16 v124, v138, v194
    v_dot2c_f32_bf16 v125, v142, v194
    v_dot2c_f32_bf16 v126, v139, v195
    v_dot2c_f32_bf16 v127, v143, v195
    ds_read_b128 v[136:139], v160 offset:144
    ds_read_b128 v[140:143], v160 offset:400
    s_waitcnt lgkmcnt(3)
    v_dot2c_f32_bf16 v124, v128, v196
    s_waitcnt lgkmcnt(2)
    v_dot2c_f32_bf16 v125, v132, v196
    v_dot2c_f32_bf16 v126, v129, v197
    v_dot2c_f32_bf16 v127, v133, v197
    v_dot2c_f32_bf16 v124, v130, v198
    v_dot2c_f32_bf16 v125, v134, v198
    v_dot2c_f32_bf16 v126, v131, v199
    v_dot2c_f32_bf16 v127, v135, v199
    s_waitcnt lgkmcnt(1)
    v_dot2c_f32_bf16 v124, v136, v200
    s_waitcnt lgkmcnt(0)
    v_dot2c_f32_bf16 v125, v140, v200
    v_dot2c_f32_bf16 v126, v137, v201
    v_dot2c_f32_bf16 v127, v141, v201
    v_dot2c_f32_bf16 v124, v138, v202
    v_dot2c_f32_bf16 v125, v142, v202
    v_dot2c_f32_bf16 v126, v139, v203
    v_dot2c_f32_bf16 v127, v143, v203
    s_branch adaLN_cond__grouped_kv_mqa__glu_gated_swiglu__prompt_kernel_rl_done_228
adaLN_cond__grouped_kv_mqa__glu_gated_swiglu__prompt_kernel_rl_next_229:
    s_cmp_ge_u32 s38, 512
    s_cbranch_scc1 adaLN_cond__grouped_kv_mqa__glu_gated_swiglu__prompt_kernel_rl_next_230
    s_sub_u32 s40, s38, 296
    s_mul_i32 s41, s40, 2428
    s_lshr_b32 s41, s41, 16
    s_mul_i32 s42, s41, 27
    s_sub_u32 s42, s40, s42
    v_mov_b32 v160, s39
    s_waitcnt vmcnt(4)
    ds_read_b128 v[128:131], v160 offset:0
    s_waitcnt vmcnt(2)
    ds_read_b128 v[132:135], v160 offset:256
    s_waitcnt vmcnt(0)
    ds_read_b128 v[136:139], v160 offset:16
    ds_read_b128 v[140:143], v160 offset:272
    s_waitcnt lgkmcnt(3)
    v_dot2c_f32_bf16 v124, v128, v164
    s_waitcnt lgkmcnt(2)
    v_dot2c_f32_bf16 v125, v132, v164
    v_dot2c_f32_bf16 v126, v129, v165
    v_dot2c_f32_bf16 v127, v133, v165
    v_dot2c_f32_bf16 v124, v130, v166
    v_dot2c_f32_bf16 v125, v134, v166
    v_dot2c_f32_bf16 v126, v131, v167
    v_dot2c_f32_bf16 v127, v135, v167
    ds_read_b128 v[128:131], v160 offset:32
    ds_read_b128 v[132:135], v160 offset:288
    s_waitcnt lgkmcnt(3)
    v_dot2c_f32_bf16 v124, v136, v168
    s_waitcnt lgkmcnt(2)
    v_dot2c_f32_bf16 v125, v140, v168
    v_dot2c_f32_bf16 v126, v137, v169
    v_dot2c_f32_bf16 v127, v141, v169
    v_dot2c_f32_bf16 v124, v138, v170
    v_dot2c_f32_bf16 v125, v142, v170
    v_dot2c_f32_bf16 v126, v139, v171
    v_dot2c_f32_bf16 v127, v143, v171
    ds_read_b128 v[136:139], v160 offset:48
    ds_read_b128 v[140:143], v160 offset:304
    s_waitcnt lgkmcnt(3)
    v_dot2c_f32_bf16 v124, v128, v172
    s_waitcnt lgkmcnt(2)
    v_dot2c_f32_bf16 v125, v132, v172
    v_dot2c_f32_bf16 v126, v129, v173
    v_dot2c_f32_bf16 v127, v133, v173
    v_dot2c_f32_bf16 v124, v130, v174
    v_dot2c_f32_bf16 v125, v134, v174
    v_dot2c_f32_bf16 v126, v131, v175
    v_dot2c_f32_bf16 v127, v135, v175
    ds_read_b128 v[128:131], v160 offset:64
    ds_read_b128 v[132:135], v160 offset:320
    s_waitcnt lgkmcnt(3)
    v_dot2c_f32_bf16 v124, v136, v176
    s_waitcnt lgkmcnt(2)
    v_dot2c_f32_bf16 v125, v140, v176
    v_dot2c_f32_bf16 v126, v137, v177
    v_dot2c_f32_bf16 v127, v141, v177
    v_dot2c_f32_bf16 v124, v138, v178
    v_dot2c_f32_bf16 v125, v142, v178
    v_dot2c_f32_bf16 v126, v139, v179
    v_dot2c_f32_bf16 v127, v143, v179
    ds_read_b128 v[136:139], v160 offset:80
    ds_read_b128 v[140:143], v160 offset:336
    s_waitcnt lgkmcnt(3)
    v_dot2c_f32_bf16 v124, v128, v180
    s_waitcnt lgkmcnt(2)
    v_dot2c_f32_bf16 v125, v132, v180
    v_dot2c_f32_bf16 v126, v129, v181
    v_dot2c_f32_bf16 v127, v133, v181
    v_dot2c_f32_bf16 v124, v130, v182
    v_dot2c_f32_bf16 v125, v134, v182
    v_dot2c_f32_bf16 v126, v131, v183
    v_dot2c_f32_bf16 v127, v135, v183
    ds_read_b128 v[128:131], v160 offset:96
    ds_read_b128 v[132:135], v160 offset:352
    s_waitcnt lgkmcnt(3)
    v_dot2c_f32_bf16 v124, v136, v184
    s_waitcnt lgkmcnt(2)
    v_dot2c_f32_bf16 v125, v140, v184
    v_dot2c_f32_bf16 v126, v137, v185
    v_dot2c_f32_bf16 v127, v141, v185
    v_dot2c_f32_bf16 v124, v138, v186
    v_dot2c_f32_bf16 v125, v142, v186
    v_dot2c_f32_bf16 v126, v139, v187
    v_dot2c_f32_bf16 v127, v143, v187
    ds_read_b128 v[136:139], v160 offset:112
    ds_read_b128 v[140:143], v160 offset:368
    s_waitcnt lgkmcnt(3)
    v_dot2c_f32_bf16 v124, v128, v188
    s_waitcnt lgkmcnt(2)
    v_dot2c_f32_bf16 v125, v132, v188
    v_dot2c_f32_bf16 v126, v129, v189
    v_dot2c_f32_bf16 v127, v133, v189
    v_dot2c_f32_bf16 v124, v130, v190
    v_dot2c_f32_bf16 v125, v134, v190
    v_dot2c_f32_bf16 v126, v131, v191
    v_dot2c_f32_bf16 v127, v135, v191
    ds_read_b128 v[128:131], v160 offset:128
    ds_read_b128 v[132:135], v160 offset:384
    s_waitcnt lgkmcnt(3)
    v_dot2c_f32_bf16 v124, v136, v192
    s_waitcnt lgkmcnt(2)
    v_dot2c_f32_bf16 v125, v140, v192
    v_dot2c_f32_bf16 v126, v137, v193
    v_dot2c_f32_bf16 v127, v141, v193
    v_dot2c_f32_bf16 v124, v138, v194
    v_dot2c_f32_bf16 v125, v142, v194
    v_dot2c_f32_bf16 v126, v139, v195
    v_dot2c_f32_bf16 v127, v143, v195
    ds_read_b128 v[136:139], v160 offset:144
    ds_read_b128 v[140:143], v160 offset:400
    s_waitcnt lgkmcnt(3)
    v_dot2c_f32_bf16 v124, v128, v196
    s_waitcnt lgkmcnt(2)
    v_dot2c_f32_bf16 v125, v132, v196
    v_dot2c_f32_bf16 v126, v129, v197
    v_dot2c_f32_bf16 v127, v133, v197
    v_dot2c_f32_bf16 v124, v130, v198
    v_dot2c_f32_bf16 v125, v134, v198
    v_dot2c_f32_bf16 v126, v131, v199
    v_dot2c_f32_bf16 v127, v135, v199
    s_waitcnt lgkmcnt(1)
    v_dot2c_f32_bf16 v124, v136, v200
    s_waitcnt lgkmcnt(0)
    v_dot2c_f32_bf16 v125, v140, v200
    v_dot2c_f32_bf16 v126, v137, v201
    v_dot2c_f32_bf16 v127, v141, v201
    v_dot2c_f32_bf16 v124, v138, v202
    v_dot2c_f32_bf16 v125, v142, v202
    v_dot2c_f32_bf16 v126, v139, v203
    v_dot2c_f32_bf16 v127, v143, v203
    s_branch adaLN_cond__grouped_kv_mqa__glu_gated_swiglu__prompt_kernel_rl_done_228
adaLN_cond__grouped_kv_mqa__glu_gated_swiglu__prompt_kernel_rl_next_230:
adaLN_cond__grouped_kv_mqa__glu_gated_swiglu__prompt_kernel_rl_done_228:
    s_add_u32 s38, s2, 256
    s_mov_b32 s39, 153600
    s_cmp_ge_u32 s38, 782
    s_cbranch_scc1 adaLN_cond__grouped_kv_mqa__glu_gated_swiglu__prompt_kernel_rl_done_231
    s_cmp_ge_u32 s38, 296
    s_cbranch_scc1 adaLN_cond__grouped_kv_mqa__glu_gated_swiglu__prompt_kernel_rl_next_232
    s_sub_u32 s40, s38, 80
    s_mul_i32 s41, s40, 2428
    s_lshr_b32 s41, s41, 16
    s_mul_i32 s42, s41, 27
    s_sub_u32 s42, s40, s42
    s_waitcnt vmcnt(6)
    v_add_f32 v124, v124, v126
    v_add_f32 v125, v125, v127
    s_add_u32 s56, s6, 393216
    s_addc_u32 s57, s7, 0
    s_mov_b32 s58, 221184
    s_mov_b32 s59, 0x00020000
    s_mul_i32 s43, s41, 27648
    s_lshl_b32 s42, s42, 8
    s_add_u32 s43, s43, s42
    v_lshlrev_b32 v160, 2, v1
    buffer_store_dword v124, v160, s[56:59], s43 offen sc1
    s_add_u32 s43, s43, 13824
    buffer_store_dword v125, v160, s[56:59], s43 offen sc1
    s_branch adaLN_cond__grouped_kv_mqa__glu_gated_swiglu__prompt_kernel_rl_done_231
adaLN_cond__grouped_kv_mqa__glu_gated_swiglu__prompt_kernel_rl_next_232:
    s_cmp_ge_u32 s38, 512
    s_cbranch_scc1 adaLN_cond__grouped_kv_mqa__glu_gated_swiglu__prompt_kernel_rl_next_233
    s_sub_u32 s40, s38, 296
    s_mul_i32 s41, s40, 2428
    s_lshr_b32 s41, s41, 16
    s_mul_i32 s42, s41, 27
    s_sub_u32 s42, s40, s42
    s_waitcnt vmcnt(6)
    v_add_f32 v124, v124, v126
    v_add_f32 v125, v125, v127
    s_add_u32 s56, s6, 393216
    s_addc_u32 s57, s7, 0
    s_mov_b32 s58, 221184
    s_mov_b32 s59, 0x00020000
    s_mul_i32 s43, s41, 27648
    s_lshl_b32 s42, s42, 8
    s_add_u32 s43, s43, s42
    s_add_u32 s43, s43, 6912
    v_lshlrev_b32 v160, 2, v1
    buffer_store_dword v124, v160, s[56:59], s43 offen sc1
    s_add_u32 s43, s43, 13824
    buffer_store_dword v125, v160, s[56:59], s43 offen sc1
    s_branch adaLN_cond__grouped_kv_mqa__glu_gated_swiglu__prompt_kernel_rl_done_231
adaLN_cond__grouped_kv_mqa__glu_gated_swiglu__prompt_kernel_rl_next_233:
adaLN_cond__grouped_kv_mqa__glu_gated_swiglu__prompt_kernel_rl_done_231:
    s_branch adaLN_cond__grouped_kv_mqa__glu_gated_swiglu__prompt_kernel_wkd_213
adaLN_cond__grouped_kv_mqa__glu_gated_swiglu__prompt_kernel_wk_224:
    s_cmp_lg_u32 s3, 4
    s_cbranch_scc1 adaLN_cond__grouped_kv_mqa__glu_gated_swiglu__prompt_kernel_wk_234
    s_add_u32 s38, s2, 512
    s_mov_b32 s39, 122880
    s_cmp_ge_u32 s38, 782
    s_cbranch_scc1 adaLN_cond__grouped_kv_mqa__glu_gated_swiglu__prompt_kernel_rl_done_235
    s_cmp_ge_u32 s38, 782
    s_cbranch_scc1 adaLN_cond__grouped_kv_mqa__glu_gated_swiglu__prompt_kernel_rl_next_236
    s_sub_u32 s40, s38, 512
    s_mul_i32 s41, s40, 6554
    s_lshr_b32 s41, s41, 16
    s_mul_i32 s42, s41, 10
    s_sub_u32 s42, s40, s42
    s_lshl_b32 s44, s42, 10
    s_mul_i32 s43, s41, 81920
    s_add_u32 s43, s43, s44
    s_add_u32 s56, s6, 6619136
    s_addc_u32 s57, s7, 0
    s_mov_b32 s58, 2211840
    s_mov_b32 s59, 0x00020000
    v_bfe_u32 v161, v1, 2, 2
    v_lshlrev_b32 v161, 7, v161
    v_lshrrev_b32 v162, 4, v1
    v_lshl_add_u32 v161, v162, 5, v161
    v_and_b32 v162, 3, v1
    v_lshl_add_u32 v161, v162, 3, v161
    v_add_u32 v161, s39, v161
    v_lshlrev_b32 v162, 4, v1
    s_waitcnt vmcnt(0)
    ds_read_b64_tr_b16 v[164:165], v161 offset:0
    ds_read_b64_tr_b16 v[166:167], v161 offset:1024
    ds_read_b64_tr_b16 v[168:169], v161 offset:512
    ds_read_b64_tr_b16 v[170:171], v161 offset:1536
    ds_read_b64_tr_b16 v[172:173], v161 offset:2048
    ds_read_b64_tr_b16 v[174:175], v161 offset:3072
    ds_read_b64_tr_b16 v[176:177], v161 offset:2560
    ds_read_b64_tr_b16 v[178:179], v161 offset:3584
    ds_read_b64_tr_b16 v[180:181], v161 offset:4096
    ds_read_b64_tr_b16 v[182:183], v161 offset:5120
    ds_read_b64_tr_b16 v[184:185], v161 offset:4608
    ds_read_b64_tr_b16 v[186:187], v161 offset:5632
    ds_read_b64_tr_b16 v[188:189], v161 offset:6144
    ds_read_b64_tr_b16 v[190:191], v161 offset:7168
    ds_read_b64_tr_b16 v[192:193], v161 offset:6656
    ds_read_b64_tr_b16 v[194:195], v161 offset:7680
    s_add_u32 s45, s43, 0
    s_waitcnt lgkmcnt(14)
    buffer_store_dwordx4 v[164:167], v162, s[56:59], s45 offen sc1
    s_add_u32 s45, s43, 10240
    s_waitcnt lgkmcnt(12)
    buffer_store_dwordx4 v[168:171], v162, s[56:59], s45 offen sc1
    s_add_u32 s45, s43, 20480
    s_waitcnt lgkmcnt(10)
    buffer_store_dwordx4 v[172:175], v162, s[56:59], s45 offen sc1
    s_add_u32 s45, s43, 30720
    s_waitcnt lgkmcnt(8)
    buffer_store_dwordx4 v[176:179], v162, s[56:59], s45 offen sc1
    s_add_u32 s45, s43, 40960
    s_waitcnt lgkmcnt(6)
    buffer_store_dwordx4 v[180:183], v162, s[56:59], s45 offen sc1
    s_add_u32 s45, s43, 51200
    s_waitcnt lgkmcnt(4)
    buffer_store_dwordx4 v[184:187], v162, s[56:59], s45 offen sc1
    s_add_u32 s45, s43, 61440
    s_waitcnt lgkmcnt(2)
    buffer_store_dwordx4 v[188:191], v162, s[56:59], s45 offen sc1
    s_add_u32 s45, s43, 71680
    s_waitcnt lgkmcnt(0)
    buffer_store_dwordx4 v[192:195], v162, s[56:59], s45 offen sc1
    s_branch adaLN_cond__grouped_kv_mqa__glu_gated_swiglu__prompt_kernel_rl_done_235
adaLN_cond__grouped_kv_mqa__glu_gated_swiglu__prompt_kernel_rl_next_236:
adaLN_cond__grouped_kv_mqa__glu_gated_swiglu__prompt_kernel_rl_done_235:
    s_add_u32 s38, s2, 512
    s_mov_b32 s39, 122880
    s_cmp_ge_u32 s38, 782
    s_cbranch_scc1 adaLN_cond__grouped_kv_mqa__glu_gated_swiglu__prompt_kernel_rl_done_237
    s_cmp_lt_u32 s38, 782
    s_cbranch_scc1 adaLN_cond__grouped_kv_mqa__glu_gated_swiglu__prompt_kernel_rl_done_237
adaLN_cond__grouped_kv_mqa__glu_gated_swiglu__prompt_kernel_rl_done_237:
    s_add_u32 s38, s2, 512
    s_mov_b32 s39, 122880
    s_cmp_ge_u32 s38, 782
    s_cbranch_scc1 adaLN_cond__grouped_kv_mqa__glu_gated_swiglu__prompt_kernel_rl_done_239
    s_cmp_lt_u32 s38, 782
    s_cbranch_scc1 adaLN_cond__grouped_kv_mqa__glu_gated_swiglu__prompt_kernel_rl_done_239
adaLN_cond__grouped_kv_mqa__glu_gated_swiglu__prompt_kernel_rl_done_239:
    s_branch adaLN_cond__grouped_kv_mqa__glu_gated_swiglu__prompt_kernel_wkd_213
adaLN_cond__grouped_kv_mqa__glu_gated_swiglu__prompt_kernel_wk_234:
    s_cmp_lg_u32 s3, 5
    s_cbranch_scc1 adaLN_cond__grouped_kv_mqa__glu_gated_swiglu__prompt_kernel_wk_241
    s_add_u32 s38, s2, 768
    s_mov_b32 s39, 133120
    s_cmp_ge_u32 s38, 782
    s_cbranch_scc1 adaLN_cond__grouped_kv_mqa__glu_gated_swiglu__prompt_kernel_rl_done_242
    s_cmp_ge_u32 s38, 782
    s_cbranch_scc1 adaLN_cond__grouped_kv_mqa__glu_gated_swiglu__prompt_kernel_rl_next_243
    s_sub_u32 s40, s38, 512
    s_mul_i32 s41, s40, 6554
    s_lshr_b32 s41, s41, 16
    s_mul_i32 s42, s41, 10
    s_sub_u32 s42, s40, s42
    s_lshl_b32 s44, s42, 10
    s_mul_i32 s43, s41, 81920
    s_add_u32 s43, s43, s44
    s_add_u32 s56, s6, 6619136
    s_addc_u32 s57, s7, 0
    s_mov_b32 s58, 2211840
    s_mov_b32 s59, 0x00020000
    v_bfe_u32 v161, v1, 2, 2
    v_lshlrev_b32 v161, 7, v161
    v_lshrrev_b32 v162, 4, v1
    v_lshl_add_u32 v161, v162, 5, v161
    v_and_b32 v162, 3, v1
    v_lshl_add_u32 v161, v162, 3, v161
    v_add_u32 v161, s39, v161
    v_lshlrev_b32 v162, 4, v1
    s_waitcnt vmcnt(0)
    ds_read_b64_tr_b16 v[164:165], v161 offset:0
    ds_read_b64_tr_b16 v[166:167], v161 offset:1024
    ds_read_b64_tr_b16 v[168:169], v161 offset:512
    ds_read_b64_tr_b16 v[170:171], v161 offset:1536
    ds_read_b64_tr_b16 v[172:173], v161 offset:2048
    ds_read_b64_tr_b16 v[174:175], v161 offset:3072
    ds_read_b64_tr_b16 v[176:177], v161 offset:2560
    ds_read_b64_tr_b16 v[178:179], v161 offset:3584
    ds_read_b64_tr_b16 v[180:181], v161 offset:4096
    ds_read_b64_tr_b16 v[182:183], v161 offset:5120
    ds_read_b64_tr_b16 v[184:185], v161 offset:4608
    ds_read_b64_tr_b16 v[186:187], v161 offset:5632
    ds_read_b64_tr_b16 v[188:189], v161 offset:6144
    ds_read_b64_tr_b16 v[190:191], v161 offset:7168
    ds_read_b64_tr_b16 v[192:193], v161 offset:6656
    ds_read_b64_tr_b16 v[194:195], v161 offset:7680
    s_add_u32 s45, s43, 0
    s_waitcnt lgkmcnt(14)
    buffer_store_dwordx4 v[164:167], v162, s[56:59], s45 offen sc1
    s_add_u32 s45, s43, 10240
    s_waitcnt lgkmcnt(12)
    buffer_store_dwordx4 v[168:171], v162, s[56:59], s45 offen sc1
    s_add_u32 s45, s43, 20480
    s_waitcnt lgkmcnt(10)
    buffer_store_dwordx4 v[172:175], v162, s[56:59], s45 offen sc1
    s_add_u32 s45, s43, 30720
    s_waitcnt lgkmcnt(8)
    buffer_store_dwordx4 v[176:179], v162, s[56:59], s45 offen sc1
    s_add_u32 s45, s43, 40960
    s_waitcnt lgkmcnt(6)
    buffer_store_dwordx4 v[180:183], v162, s[56:59], s45 offen sc1
    s_add_u32 s45, s43, 51200
    s_waitcnt lgkmcnt(4)
    buffer_store_dwordx4 v[184:187], v162, s[56:59], s45 offen sc1
    s_add_u32 s45, s43, 61440
    s_waitcnt lgkmcnt(2)
    buffer_store_dwordx4 v[188:191], v162, s[56:59], s45 offen sc1
    s_add_u32 s45, s43, 71680
    s_waitcnt lgkmcnt(0)
    buffer_store_dwordx4 v[192:195], v162, s[56:59], s45 offen sc1
    s_branch adaLN_cond__grouped_kv_mqa__glu_gated_swiglu__prompt_kernel_rl_done_242
adaLN_cond__grouped_kv_mqa__glu_gated_swiglu__prompt_kernel_rl_next_243:
adaLN_cond__grouped_kv_mqa__glu_gated_swiglu__prompt_kernel_rl_done_242:
    s_add_u32 s38, s2, 768
    s_mov_b32 s39, 133120
    s_cmp_ge_u32 s38, 782
    s_cbranch_scc1 adaLN_cond__grouped_kv_mqa__glu_gated_swiglu__prompt_kernel_rl_done_244
    s_cmp_lt_u32 s38, 782
    s_cbranch_scc1 adaLN_cond__grouped_kv_mqa__glu_gated_swiglu__prompt_kernel_rl_done_244
adaLN_cond__grouped_kv_mqa__glu_gated_swiglu__prompt_kernel_rl_done_244:
    s_add_u32 s38, s2, 768
    s_mov_b32 s39, 133120
    s_cmp_ge_u32 s38, 782
    s_cbranch_scc1 adaLN_cond__grouped_kv_mqa__glu_gated_swiglu__prompt_kernel_rl_done_246
    s_cmp_lt_u32 s38, 782
    s_cbranch_scc1 adaLN_cond__grouped_kv_mqa__glu_gated_swiglu__prompt_kernel_rl_done_246
adaLN_cond__grouped_kv_mqa__glu_gated_swiglu__prompt_kernel_rl_done_246:
    s_branch adaLN_cond__grouped_kv_mqa__glu_gated_swiglu__prompt_kernel_wkd_213
adaLN_cond__grouped_kv_mqa__glu_gated_swiglu__prompt_kernel_wk_241:
adaLN_cond__grouped_kv_mqa__glu_gated_swiglu__prompt_kernel_wkd_213:
    s_branch adaLN_cond__grouped_kv_mqa__glu_gated_swiglu__prompt_kernel_ret_64
adaLN_cond__grouped_kv_mqa__glu_gated_swiglu__prompt_kernel_ool_65:
    s_and_b32 s42, s2, 7
    s_lshl_b32 s42, s42, 7
    s_lshr_b32 s43, s2, 3
    s_lshl_b32 s43, s43, 2
    s_add_u32 s42, s42, s43
    s_add_u32 s42, s42, 8192
    v_mov_b32 v220, s71
    v_mov_b32 v221, 0
    s_mov_b64 exec, 1
    buffer_store_dword v220, v221, s[60:63], s42 offen sc1
    s_mov_b64 exec, -1
    s_cmp_ge_u32 s2, 80
    s_cbranch_scc1 adaLN_cond__grouped_kv_mqa__glu_gated_swiglu__prompt_kernel_lfo_248
    s_lshl_b32 s42, s2, 2
    s_add_u32 s42, s42, 13312
    v_mov_b32 v220, s71
    v_mov_b32 v221, 0
    s_mov_b64 exec, 1
    buffer_store_dword v220, v221, s[60:63], s42 offen sc1
    s_mov_b64 exec, -1
adaLN_cond__grouped_kv_mqa__glu_gated_swiglu__prompt_kernel_lfo_248:
    s_branch adaLN_cond__grouped_kv_mqa__glu_gated_swiglu__prompt_kernel_ret_66
adaLN_cond__grouped_kv_mqa__glu_gated_swiglu__prompt_kernel_ool_67:
    s_add_u32 s56, s6, 16973824
    s_addc_u32 s57, s7, 0
    s_mov_b32 s58, 7077888
    s_mov_b32 s59, 0x00020000
    s_and_b32 s42, s2, 7
    s_mul_i32 s42, s42, 884736
    s_lshr_b32 s43, s2, 3
    s_mul_i32 s43, s43, 27648
    s_add_u32 s42, s42, s43
    s_lshl_b32 s43, s3, 6
    v_add_u32 v231, s43, v1
    v_min_u32 v231, 215, v231
    v_lshlrev_b32 v231, 7, v231
    buffer_load_dword v228, v231, s[56:59], s42 offen
    s_branch adaLN_cond__grouped_kv_mqa__glu_gated_swiglu__prompt_kernel_ret_68
adaLN_cond__grouped_kv_mqa__glu_gated_swiglu__prompt_kernel_ool_69:
    s_add_u32 s56, s6, 16973824
    s_addc_u32 s57, s7, 0
    s_mov_b32 s58, 7077888
    s_mov_b32 s59, 0x00020000
    s_and_b32 s42, s2, 7
    s_mul_i32 s42, s42, 884736
    s_lshr_b32 s43, s2, 3
    s_mul_i32 s43, s43, 27648
    s_add_u32 s42, s42, s43
    s_lshl_b32 s43, s3, 6
    v_add_u32 v231, s43, v1
    v_min_u32 v231, 215, v231
    v_lshlrev_b32 v231, 7, v231
    buffer_load_dword v228, v231, s[56:59], s42 offen
    s_branch adaLN_cond__grouped_kv_mqa__glu_gated_swiglu__prompt_kernel_ret_70
adaLN_cond__grouped_kv_mqa__glu_gated_swiglu__prompt_kernel_ool_71:
    s_add_u32 s56, s6, 16973824
    s_addc_u32 s57, s7, 0
    s_mov_b32 s58, 7077888
    s_mov_b32 s59, 0x00020000
    s_and_b32 s42, s2, 7
    s_mul_i32 s42, s42, 884736
    s_lshr_b32 s43, s2, 3
    s_mul_i32 s43, s43, 27648
    s_add_u32 s42, s42, s43
    s_lshl_b32 s43, s3, 6
    v_add_u32 v231, s43, v1
    v_min_u32 v231, 215, v231
    v_lshlrev_b32 v231, 7, v231
    buffer_load_dword v228, v231, s[56:59], s42 offen
    s_branch adaLN_cond__grouped_kv_mqa__glu_gated_swiglu__prompt_kernel_ret_72
adaLN_cond__grouped_kv_mqa__glu_gated_swiglu__prompt_kernel_ool_73:
    s_add_u32 s56, s6, 16973824
    s_addc_u32 s57, s7, 0
    s_mov_b32 s58, 7077888
    s_mov_b32 s59, 0x00020000
    s_and_b32 s42, s2, 7
    s_mul_i32 s42, s42, 884736
    s_lshr_b32 s43, s2, 3
    s_mul_i32 s43, s43, 27648
    s_add_u32 s42, s42, s43
    s_lshl_b32 s43, s3, 6
    v_add_u32 v231, s43, v1
    v_min_u32 v231, 215, v231
    v_lshlrev_b32 v231, 7, v231
    buffer_load_dword v228, v231, s[56:59], s42 offen
    s_branch adaLN_cond__grouped_kv_mqa__glu_gated_swiglu__prompt_kernel_ret_74
adaLN_cond__grouped_kv_mqa__glu_gated_swiglu__prompt_kernel_ool_75:
    s_add_u32 s56, s6, 11468800
    s_addc_u32 s57, s7, 0
    s_mov_b32 s58, 2621440
    s_mov_b32 s59, 0x00020000
    s_and_b32 s42, s2, 7
    s_mul_i32 s42, s42, 327680
    s_lshr_b32 s43, s2, 3
    s_mul_i32 s43, s43, 10240
    s_add_u32 s42, s42, s43
    s_lshl_b32 s43, s3, 6
    v_add_u32 v231, s43, v1
    v_min_u32 v231, 79, v231
    v_lshlrev_b32 v231, 7, v231
    buffer_load_dword v228, v231, s[56:59], s42 offen
    s_branch adaLN_cond__grouped_kv_mqa__glu_gated_swiglu__prompt_kernel_ret_76
adaLN_cond__grouped_kv_mqa__glu_gated_swiglu__prompt_kernel_ool_77:
    s_add_u32 s56, s6, 11468800
    s_addc_u32 s57, s7, 0
    s_mov_b32 s58, 2621440
    s_mov_b32 s59, 0x00020000
    s_and_b32 s42, s2, 7
    s_mul_i32 s42, s42, 327680
    s_lshr_b32 s43, s2, 3
    s_mul_i32 s43, s43, 10240
    s_add_u32 s42, s42, s43
    s_lshl_b32 s43, s3, 6
    v_add_u32 v231, s43, v1
    v_min_u32 v231, 79, v231
    v_lshlrev_b32 v231, 7, v231
    buffer_load_dword v228, v231, s[56:59], s42 offen
    s_branch adaLN_cond__grouped_kv_mqa__glu_gated_swiglu__prompt_kernel_ret_78
adaLN_cond__grouped_kv_mqa__glu_gated_swiglu__prompt_kernel_ool_79:
    s_add_u32 s56, s6, 14090240
    s_addc_u32 s57, s7, 0
    s_mov_b32 s58, 262144
    s_mov_b32 s59, 0x00020000
    s_and_b32 s42, s2, 7
    s_mul_i32 s42, s42, 32768
    s_lshr_b32 s43, s2, 3
    s_mul_i32 s43, s43, 1024
    s_add_u32 s42, s42, s43
    s_lshl_b32 s43, s3, 6
    v_add_u32 v231, s43, v1
    v_min_u32 v231, 7, v231
    v_lshlrev_b32 v231, 7, v231
    buffer_load_dword v228, v231, s[56:59], s42 offen
    s_branch adaLN_cond__grouped_kv_mqa__glu_gated_swiglu__prompt_kernel_ret_80
adaLN_cond__grouped_kv_mqa__glu_gated_swiglu__prompt_kernel_ool_81:
    s_add_u32 s56, s6, 8847360
    s_addc_u32 s57, s7, 0
    s_mov_b32 s58, 2621440
    s_mov_b32 s59, 0x00020000
    s_and_b32 s42, s2, 7
    s_mul_i32 s42, s42, 327680
    s_lshr_b32 s43, s2, 3
    s_mul_i32 s43, s43, 10240
    s_add_u32 s42, s42, s43
    s_lshl_b32 s43, s3, 6
    v_add_u32 v231, s43, v1
    v_min_u32 v231, 79, v231
    v_lshlrev_b32 v231, 7, v231
    buffer_load_dword v228, v231, s[56:59], s42 offen
    s_branch adaLN_cond__grouped_kv_mqa__glu_gated_swiglu__prompt_kernel_ret_82
adaLN_cond__grouped_kv_mqa__glu_gated_swiglu__prompt_kernel_ool_83:
    s_add_u32 s56, s6, 8847360
    s_addc_u32 s57, s7, 0
    s_mov_b32 s58, 2621440
    s_mov_b32 s59, 0x00020000
    s_and_b32 s42, s2, 7
    s_mul_i32 s42, s42, 327680
    s_lshr_b32 s43, s2, 3
    s_mul_i32 s43, s43, 10240
    s_add_u32 s42, s42, s43
    s_lshl_b32 s43, s3, 6
    v_add_u32 v231, s43, v1
    v_min_u32 v231, 79, v231
    v_lshlrev_b32 v231, 7, v231
    buffer_load_dword v228, v231, s[56:59], s42 offen
    s_branch adaLN_cond__grouped_kv_mqa__glu_gated_swiglu__prompt_kernel_ret_84
adaLN_cond__grouped_kv_mqa__glu_gated_swiglu__prompt_kernel_ool_85:
    v_lshlrev_b32 v232, 4, v1
    s_mov_b32 s42, 13312
    s_mov_b64 exec, 0xfffff
    buffer_load_dwordx4 v[234:237], v232, s[60:63], s42 offen sc1
    s_mov_b64 exec, -1
    s_branch adaLN_cond__grouped_kv_mqa__glu_gated_swiglu__prompt_kernel_ret_86
adaLN_cond__grouped_kv_mqa__glu_gated_swiglu__prompt_kernel_ool_87:
    v_lshlrev_b32 v232, 4, v1
    s_mov_b32 s42, 8192
    s_waitcnt vmcnt(0)
    buffer_load_dwordx4 v[234:237], v232, s[60:63], s42 offen sc1
    s_branch adaLN_cond__grouped_kv_mqa__glu_gated_swiglu__prompt_kernel_ret_88
adaLN_cond__grouped_kv_mqa__glu_gated_swiglu__prompt_kernel_ool_89:
    s_mov_b64 exec, 0xfffff
    s_waitcnt vmcnt(0)
    v_xor_b32 v234, s71, v234
    v_xor_b32 v235, s71, v235
    v_xor_b32 v236, s71, v236
    v_xor_b32 v237, s71, v237
    v_or_b32 v234, v234, v235
    v_or_b32 v236, v236, v237
    v_or_b32 v234, v234, v236
    v_cmp_ne_u32 vcc, 0, v234
    s_mov_b64 exec, -1
    s_cmp_lg_u64 vcc, 0
    s_cbranch_scc0 adaLN_cond__grouped_kv_mqa__glu_gated_swiglu__prompt_kernel_wook_249
    s_mov_b32 s39, 13312
    v_lshlrev_b32 v232, 4, v1
    s_mov_b64 exec, 0xfffff
    s_mov_b32 s40, 65536
adaLN_cond__grouped_kv_mqa__glu_gated_swiglu__prompt_kernel_cf_250:
    buffer_load_dwordx4 v[234:237], v232, s[60:63], s39 offen sc1
    s_waitcnt vmcnt(0)
    v_xor_b32 v234, s71, v234
    v_xor_b32 v235, s71, v235
    v_xor_b32 v236, s71, v236
    v_xor_b32 v237, s71, v237
    v_or_b32 v234, v234, v235
    v_or_b32 v236, v236, v237
    v_or_b32 v234, v234, v236
    v_cmp_ne_u32 vcc, 0, v234
    s_nop 0
    s_cbranch_vccz adaLN_cond__grouped_kv_mqa__glu_gated_swiglu__prompt_kernel_cfd_251
    s_sub_u32 s40, s40, 1
    s_cmp_eq_u32 s40, 0
    s_cbranch_scc1 adaLN_cond__grouped_kv_mqa__glu_gated_swiglu__prompt_kernel_cfd_251
    s_sleep 8
    s_branch adaLN_cond__grouped_kv_mqa__glu_gated_swiglu__prompt_kernel_cf_250
adaLN_cond__grouped_kv_mqa__glu_gated_swiglu__prompt_kernel_cfd_251:
    s_mov_b64 exec, -1
adaLN_cond__grouped_kv_mqa__glu_gated_swiglu__prompt_kernel_wook_249:
    s_branch adaLN_cond__grouped_kv_mqa__glu_gated_swiglu__prompt_kernel_ret_90
adaLN_cond__grouped_kv_mqa__glu_gated_swiglu__prompt_kernel_ool_92:
    s_waitcnt vmcnt(8)
    v_xor_b32 v234, s71, v234
    v_xor_b32 v235, s71, v235
    v_xor_b32 v236, s71, v236
    v_xor_b32 v237, s71, v237
    v_or_b32 v234, v234, v235
    v_or_b32 v236, v236, v237
    v_or_b32 v234, v234, v236
    v_cmp_ne_u32 vcc, 0, v234
    s_nop 0
    s_cbranch_vccz adaLN_cond__grouped_kv_mqa__glu_gated_swiglu__prompt_kernel_lflok_252
    v_lshlrev_b32 v232, 4, v1
    s_mov_b32 s40, 8192
    s_mov_b32 s42, 65536
adaLN_cond__grouped_kv_mqa__glu_gated_swiglu__prompt_kernel_poll_253:
    buffer_load_dwordx4 v[234:237], v232, s[60:63], s40 offen sc1
    s_sub_u32 s42, s42, 1
    s_cmp_eq_u32 s42, 0
    s_cbranch_scc1 adaLN_cond__grouped_kv_mqa__glu_gated_swiglu__prompt_kernel_polldone_254
    s_waitcnt vmcnt(0)
    v_xor_b32 v234, s71, v234
    v_xor_b32 v235, s71, v235
    v_xor_b32 v236, s71, v236
    v_xor_b32 v237, s71, v237
    v_or_b32 v234, v234, v235
    v_or_b32 v236, v236, v237
    v_or_b32 v234, v234, v236
    v_cmp_ne_u32 vcc, 0, v234
    s_nop 0
    s_cbranch_vccnz adaLN_cond__grouped_kv_mqa__glu_gated_swiglu__prompt_kernel_poll_253
adaLN_cond__grouped_kv_mqa__glu_gated_swiglu__prompt_kernel_polldone_254:
adaLN_cond__grouped_kv_mqa__glu_gated_swiglu__prompt_kernel_lflok_252:
    s_branch adaLN_cond__grouped_kv_mqa__glu_gated_swiglu__prompt_kernel_ret_93
adaLN_cond__grouped_kv_mqa__glu_gated_swiglu__prompt_kernel_ool_94:
    buffer_load_dword v227, v225, s[16:19], s50 offen
    s_branch adaLN_cond__grouped_kv_mqa__glu_gated_swiglu__prompt_kernel_ret_95
adaLN_cond__grouped_kv_mqa__glu_gated_swiglu__prompt_kernel_ool_96:
    buffer_load_dword v227, v225, s[16:19], s50 offen
    s_branch adaLN_cond__grouped_kv_mqa__glu_gated_swiglu__prompt_kernel_ret_97
adaLN_cond__grouped_kv_mqa__glu_gated_swiglu__prompt_kernel_ool_98:
    buffer_load_dword v227, v225, s[16:19], s50 offen
    s_branch adaLN_cond__grouped_kv_mqa__glu_gated_swiglu__prompt_kernel_ret_99
adaLN_cond__grouped_kv_mqa__glu_gated_swiglu__prompt_kernel_ool_100:
    buffer_load_dword v227, v225, s[16:19], s50 offen
    s_branch adaLN_cond__grouped_kv_mqa__glu_gated_swiglu__prompt_kernel_ret_101
adaLN_cond__grouped_kv_mqa__glu_gated_swiglu__prompt_kernel_ool_102:
    buffer_load_dword v227, v225, s[16:19], s50 offen
    s_branch adaLN_cond__grouped_kv_mqa__glu_gated_swiglu__prompt_kernel_ret_103
adaLN_cond__grouped_kv_mqa__glu_gated_swiglu__prompt_kernel_ool_105:
    buffer_load_dword v227, v225, s[16:19], s50 offen
    s_branch adaLN_cond__grouped_kv_mqa__glu_gated_swiglu__prompt_kernel_ret_106
adaLN_cond__grouped_kv_mqa__glu_gated_swiglu__prompt_kernel_ool_108:
    buffer_load_dword v227, v225, s[16:19], s50 offen
    s_branch adaLN_cond__grouped_kv_mqa__glu_gated_swiglu__prompt_kernel_ret_109
adaLN_cond__grouped_kv_mqa__glu_gated_swiglu__prompt_kernel_ool_111:
    buffer_load_dword v227, v225, s[16:19], s50 offen
    s_branch adaLN_cond__grouped_kv_mqa__glu_gated_swiglu__prompt_kernel_ret_112
adaLN_cond__grouped_kv_mqa__glu_gated_swiglu__prompt_kernel_ool_114:
    s_add_u32 s42, s50, 1769472
    buffer_load_dword v227, v225, s[16:19], s42 offen
    s_branch adaLN_cond__grouped_kv_mqa__glu_gated_swiglu__prompt_kernel_ret_115
adaLN_cond__grouped_kv_mqa__glu_gated_swiglu__prompt_kernel_ool_117:
    s_add_u32 s42, s50, 1769472
    buffer_load_dword v227, v225, s[16:19], s42 offen
    s_branch adaLN_cond__grouped_kv_mqa__glu_gated_swiglu__prompt_kernel_ret_118
adaLN_cond__grouped_kv_mqa__glu_gated_swiglu__prompt_kernel_code_end:
    s_endpgm
.section .rodata,"a"
.p2align 6
.amdhsa_kernel adaLN_cond__grouped_kv_mqa__glu_gated_swiglu__prompt_kernel
  .amdhsa_next_free_vgpr 256
  .amdhsa_next_free_sgpr 100
  .amdhsa_accum_offset 256
  .amdhsa_group_segment_fixed_size 0
  .amdhsa_kernarg_size 112
  .amdhsa_user_sgpr_count 2
  .amdhsa_user_sgpr_kernarg_segment_ptr 1
  .amdhsa_system_sgpr_workgroup_id_x 1
.end_amdhsa_kernel
```
